```python
import torch

def _softmax(x, axis=-1):
    return torch.softmax(x, dim=axis)
def _gelu(x):
    return torch.nn.functional.gelu(x, approximate="tanh")
def _silu(x):
    return torch.nn.functional.silu(x)
def _sigmoid(x):
    return torch.sigmoid(x)
def _layernorm(x, axis=-1, eps=1e-5):
    m = x.mean(dim=axis, keepdim=True)
    v = x.var(dim=axis, keepdim=True, unbiased=False)
    return (x - m) / torch.sqrt(v + eps)
def _scatter_add(tgt, idx, src, axis=0):
    return tgt.clone().index_add_(axis, idx, src)
def _segment_sum(src, seg, n):
    out = torch.zeros((n,) + src.shape[1:], dtype=src.dtype)
    return out.index_add_(0, seg, src)
def _pad(x, pw):
    flat = tuple(v for pair in reversed(pw) for v in pair)
    return torch.nn.functional.pad(x, flat)

kernel_name = 'concat_heads__linear_attn_block__ssm_conv_s5__prompt'

def setup_inputs():

    _w = (lambda a: (lambda t: t.to(torch.bfloat16) if t.is_floating_point() else t)(torch.as_tensor(a)))
    def _A_setup():
        B, S, D = 1, 2048, 640
        return {
            "x": _w((lambda *s: torch.randn(*s, dtype=torch.bfloat16) * 0.05)(B, S, D)),
            "wqkv": _w((lambda *s: torch.randn(*s, dtype=torch.bfloat16) * 0.4)(D, 3 * D)),
            "wo": _w((lambda *s: torch.randn(*s, dtype=torch.bfloat16) * 0.05)(D, D)),
        }
    _A_in = _A_setup()

    def _B_setup():
        B, S, D = 1, 2048, 640
        P = D
        Lambda_re = -0.5 * (lambda _x: torch.exp(torch.as_tensor(_x)))((lambda *s: torch.randn(*s, dtype=torch.bfloat16) * 0.2)(P))
        Lambda_im = (lambda *s: torch.randn(*s, dtype=torch.bfloat16) * 0.8)(P) * 1.0
        B_re = (lambda *s: torch.randn(*s, dtype=torch.bfloat16) * 0.4)(P, D) * (D ** -0.5)
        B_im = (lambda *s: torch.randn(*s, dtype=torch.bfloat16) * 0.2)(P, D) * (D ** -0.5)
        C_re = (lambda *s: torch.randn(*s, dtype=torch.bfloat16) * 0.2)(D, P) * (P ** -0.5)
        C_im = (lambda *s: torch.randn(*s, dtype=torch.bfloat16) * 0.4)(D, P) * (P ** -0.5)
        log_dt = (lambda *s: torch.randn(*s, dtype=torch.bfloat16) * 0.2)(P) * 0.3 - 2.0
        Dskip = (lambda *s: torch.randn(*s, dtype=torch.bfloat16) * 0.05)(D)
        return {
            "x": _w((lambda *s: torch.randn(*s, dtype=torch.bfloat16) * 0.05)(B, S, D)),
            "Lambda_re": _w(Lambda_re),
            "Lambda_im": _w(Lambda_im),
            "B_re": _w(B_re),
            "B_im": _w(B_im),
            "C_re": _w(C_re),
            "C_im": _w(C_im),
            "log_dt": _w(log_dt),
            "Dskip": _w(Dskip),
        }
    _B_in = _B_setup()

    return {
        "A_x": _A_in["x"],
        "A_wqkv": _A_in["wqkv"],
        "A_wo": _A_in["wo"],
        "B_x": _B_in["x"],
        "B_Lambda_re": _B_in["Lambda_re"],
        "B_Lambda_im": _B_in["Lambda_im"],
        "B_B_re": _B_in["B_re"],
        "B_B_im": _B_in["B_im"],
        "B_C_re": _B_in["C_re"],
        "B_C_im": _B_in["C_im"],
        "B_log_dt": _B_in["log_dt"],
        "B_Dskip": _B_in["Dskip"],
    }

def reference(A_x, A_wqkv, A_wo, B_x, B_Lambda_re, B_Lambda_im, B_B_re, B_B_im, B_C_re, B_C_im, B_log_dt, B_Dskip):
    def _A_ref(x, wqkv, wo):
        B, S, D = x.shape
        H = 32; Dh = D // H
        qkv = (lambda x, *d: x.permute(*d))((x @ wqkv).reshape(B, S, 3, H, Dh), 2, 0, 3, 1, 4)
        q, k, v = qkv[0], qkv[1], qkv[2]
        phi = lambda t: torch.where(t > 0, t + 1, torch.exp(t)) + 1e-6
        pq, pk = phi(q), phi(k)
        kv = torch.einsum("bhsd,bhse->bhde", pk, v)
        z = torch.einsum("bhsd->bhd", pk)
        num = torch.einsum("bhqd,bhde->bhqe", pq, kv)
        den = torch.einsum("bhqd,bhd->bhq", pq, z)[..., None] + 1e-6
        o = num / den
        return (lambda x, *d: x.permute(*d))(o, 0, 2, 1, 3).reshape(B, S, D) @ wo

    def _B_ref(x, Lambda_re, Lambda_im, B_re, B_im, C_re, C_im, log_dt, Dskip):
        Bsz, L, H = x.shape
        Lam = Lambda_re + 1j * Lambda_im
        Bmat = B_re + 1j * B_im
        Cmat = C_re + 1j * C_im
        dt = torch.exp(log_dt)
        Lam_bar = torch.exp(dt * Lam)
        B_bar = ((Lam_bar - 1.0) / Lam)[:, None] * Bmat
        Bu = torch.einsum("bld,pd->blp", x + 0j, B_bar)
        h = torch.zeros_like(Bu[:, 0, :])
        hs = []
        for t in range(L):
            h = Lam_bar[None, :] * h + Bu[:, t, :]
            hs.append(h)
        hseq = torch.stack(hs, 1)
        y = 2.0 * torch.einsum("blp,dp->bld", hseq, Cmat).real + x * Dskip[None, None, :]
        return y

    a = _A_ref(A_x, A_wqkv, A_wo)
    b = _B_ref(B_x, B_Lambda_re, B_Lambda_im, B_B_re, B_B_im, B_C_re, B_C_im, B_log_dt, B_Dskip)
    return torch.concatenate([a, b], axis=-1)
```

```asm
; @launch grid=(256,1,1) block=(256,1,1) lds=163840
.amdgcn_target "amdgcn-amd-amdhsa--gfx950"
.text
.globl concat_heads__linear_attn_block__ssm_conv_s5__prompt_kernel
.p2align 8
.type concat_heads__linear_attn_block__ssm_conv_s5__prompt_kernel,@function
concat_heads__linear_attn_block__ssm_conv_s5__prompt_kernel:
    s_cmp_ge_u32 s2, 256
    s_cbranch_scc1 L_end
    s_load_dwordx16 s[4:19], s[0:1], 0
    s_load_dwordx8 s[20:27], s[0:1], 64
    s_load_dwordx4 s[28:31], s[0:1], 96
    s_load_dwordx2 s[32:33], s[0:1], 112
    v_lshrrev_b32 v2, 6, v0
    v_and_b32 v1, 63, v0
    v_readfirstlane_b32 s76, v2
    s_and_b32 s100, s2, 7
    s_lshl_b32 s3, s100, 2
    s_lshr_b32 s100, 0x76325410, s3
    s_and_b32 s100, s100, 7
    s_lshr_b32 s3, s2, 3
    s_lshr_b32 s78, s3, 2
    s_and_b32 s3, s3, 3
    s_cmp_lg_u32 s3, s76
    s_cbranch_scc1 L_nopf
    s_getpc_b64 s[60:61]
L_pc:
    s_cmp_ge_u32 s100, 4
    s_cselect_b32 s80, L_sideB-L_pc, 0
    v_lshl_add_u32 v3, v0, 7, s80
    v_min_u32 v3, L_end-L_pc, v3
    v_mov_b32 v5, s61
    v_add_co_u32 v6, vcc, s60, v3
    s_nop 1
    v_addc_co_u32 v7, vcc, 0, v5, vcc
    global_load_dword v255, v[6:7], off
    s_cbranch_scc0 L_nopf
    s_and_b32 s80, s78, 3
    s_mul_i32 s80, s80, L_own2-L_own1
    s_add_u32 s80, s80, L_own0-L_pc
    v_lshl_add_u32 v3, v1, 7, s80
    v_min_u32 v3, L_end-L_pc, v3
    v_add_co_u32 v6, vcc, s60, v3
    s_nop 1
    v_addc_co_u32 v7, vcc, 0, v5, vcc
    global_load_dword v254, v[6:7], off
L_nopf:
    s_and_b32 s80, s100, 3
    s_lshl_b32 s77, s80, 2
    s_add_u32 s77, s77, s3
    s_mul_i32 s3, s3, 20
    s_mul_i32 s80, s80, 5
    s_add_u32 s3, s3, s80
    s_mul_i32 s80, s78, 10
    s_add_u32 s3, s3, s80
    s_lshr_b32 s3, s3, 3
    s_and_b32 s81, s77, 3
    s_add_u32 s81, s81, s78
    s_mul_i32 s80, s81, 52
    s_lshr_b32 s80, s80, 8
    s_mul_i32 s80, s80, 5
    s_sub_u32 s81, s81, s80
    s_lshl_b32 s81, s81, 1
    s_cmp_ge_u32 s100, 4
    s_cselect_b32 s3, s3, s81
    s_sub_u32 s80, s3, 10
    s_cselect_b32 s3, s3, s80
    s_lshl_b32 s80, s3, 7
    s_lshl_b32 s97, s76, 12
    s_lshl_b32 s81, s77, 2
    s_add_u32 s81, s81, s76
    s_mul_i32 s101, s81, 40960
    v_lshrrev_b32 v2, 3, v1
    v_lshrrev_b32 v3, 4, v1
    v_and_b32 v5, 7, v1
    v_xor_b32 v5, v5, v3
    v_lshlrev_b32 v5, 4, v5
    s_movk_i32 s84, 9216
    s_movk_i32 s85, 18432
    s_movk_i32 s86, 27648
    s_cmp_ge_u32 s100, 4
    s_cselect_b32 s93, 1, 0
    s_cselect_b32 s84, 19456, s84
    s_cselect_b32 s85, 3072, s85
    s_cselect_b32 s86, 22528, s86
    v_and_b32 v7, 4, v2
    v_mad_u32_u24 v7, v7, s93, v2
    v_mul_u32_u24 v7, 1280, v7
    v_add3_u32 v16, v7, v5, s101
    v_xor_b32 v8, 64, v16
    v_add_u32 v17, s84, v8
    v_add_u32 v18, s85, v16
    v_add_u32 v19, s86, v8
    s_mov_b32 m0, s97
    s_mov_b32 s38, 2621440
    s_mov_b32 s39, 0x20000
    s_waitcnt lgkmcnt(0)
    s_cselect_b32 s36, s10, s4
    s_cselect_b32 s37, s11, s5
    buffer_load_dwordx4 v16, s[36:39], s80 offen offset:0 lds
    buffer_load_dwordx4 v17, s[36:39], s80 offen offset:1024 lds
    buffer_load_dwordx4 v18, s[36:39], s80 offen offset:2048 lds
    buffer_load_dwordx4 v19, s[36:39], s80 offen offset:3072 lds
    s_mul_i32 s98, s76, 5120
    s_cbranch_scc1 L_sideB
    v_lshrrev_b32 v83, 2, v1
    v_lshrrev_b32 v7, 5, v1
    v_bfe_u32 v82, v1, 1, 1
    v_xor_b32 v82, v82, v7
    v_and_b32 v7, 1, v1
    v_lshlrev_b32 v7, 4, v7
    v_lshl_add_u32 v7, v82, 5, v7
    s_mul_i32 s81, s78, 160
    s_addk_i32 s81, 0x1000
    v_add_u32 v84, s81, v7
    s_mul_i32 s101, s76, 61440
    v_mul_u32_u24 v7, 3840, v83
    v_add3_u32 v7, v7, v84, s101
    v_add_u32 v20, 1280, v7
    v_add_u32 v21, 320, v7
    v_mul_u32_u24 v8, 1120, v82
    v_add_u32 v9, 0xfffffd80, v7
    v_add_u32 v22, v8, v9
    v_add_u32 v23, 0xfffffe20, v7
    v_add_u32 v24, 2656, v7
    s_mul_i32 s81, s80, 1920
    s_sub_u32 s40, s6, 4096
    s_subb_u32 s41, s7, 0
    s_mov_b32 s42, 2461696
    s_mov_b32 s43, 0x20000
    s_add_u32 m0, s98, 16384
    s_nop 0
    buffer_load_dwordx4 v20, s[40:43], s81 offen offset:0 lds
    buffer_load_dwordx4 v21, s[40:43], s81 offen offset:1024 lds
    buffer_load_dwordx4 v22, s[40:43], s81 offen offset:2048 lds
    buffer_load_dwordx4 v23, s[40:43], s81 offen offset:3072 lds
    s_add_u32 m0, s98, 20480
    s_nop 0
    buffer_load_dwordx4 v24, s[40:43], s81 offen offset:0 lds
    s_sub_u32 s81, s3, 5
    s_cselect_b32 s3, s3, s81
    s_cselect_b32 s99, 0, 1
    s_add_u32 s101, s3, 0
    s_sub_u32 s81, s101, 5
    s_cselect_b32 s101, s101, s81
    s_lshl_b32 s83, s101, 7
    s_add_u32 s101, s3, 1
    s_sub_u32 s81, s101, 5
    s_cselect_b32 s101, s101, s81
    s_lshl_b32 s84, s101, 7
    s_add_u32 s101, s3, 2
    s_sub_u32 s81, s101, 5
    s_cselect_b32 s101, s101, s81
    s_lshl_b32 s85, s101, 7
    s_add_u32 s101, s3, 3
    s_sub_u32 s81, s101, 5
    s_cselect_b32 s101, s101, s81
    s_lshl_b32 s86, s101, 7
    s_add_u32 s101, s3, 4
    s_sub_u32 s81, s101, 5
    s_cselect_b32 s101, s101, s81
    s_lshl_b32 s87, s101, 7
    s_mul_i32 s93, s99, 640
    s_sub_u32 s94, 640, s93
    v_and_b32 v4, 15, v1
    v_lshlrev_b32 v45, 4, v1
    v_lshrrev_b32 v6, 1, v4
    v_xor_b32 v6, v6, v3
    v_lshlrev_b32 v6, 4, v6
    v_lshl_add_u32 v6, v4, 7, v6
    v_add_u32 v98, s97, v6
    v_xor_b32 v101, 64, v98
    v_add_u32 v99, 0x10000, v98
    v_add_u32 v102, 0x10000, v101
    s_lshl_b32 s3, s2, 8
    v_or_b32 v7, s3, v0
    v_mov_b32 v8, 2147483648
    v_cmp_eq_u32 vcc, 0, v7
    s_nop 1
    v_cndmask_b32_e64 v46, v8, 0, vcc
    s_mul_i32 s88, s83, 1920
    s_mul_i32 s89, s84, 1920
    s_mul_i32 s90, s85, 1920
    s_mul_i32 s91, s86, 1920
    s_mul_i32 s92, s87, 1920
    s_mul_i32 s95, s93, 1920
    s_mul_i32 s96, s94, 1920
    v_bfe_u32 v7, v1, 2, 2
    v_and_b32 v9, 1, v3
    v_lshl_add_u32 v7, v9, 3, v7
    v_lshlrev_b32 v7, 6, v7
    v_and_b32 v8, 3, v1
    v_lshl_add_u32 v7, v8, 3, v7
    v_lshrrev_b32 v8, 1, v3
    v_mul_u32_u24 v8, 5120, v8
    v_add_u32 v7, v7, v8
    v_lshl_add_u32 v39, v9, 5, v7
    v_xor_b32 v42, 32, v39
    v_add_u32 v40, 0x10000, v39
    v_add_u32 v43, 0x10000, v42
    v_mov_b32 v48, 0x358637bd
    v_mov_b32 v49, 0x358637bd
    v_mov_b32 v50, 0x358637bd
    v_mov_b32 v51, 0x358637bd
    s_mov_b32 s48, s32
    s_mov_b32 s49, s33
    s_mov_b32 s50, 0x10000000
    s_mov_b32 s51, 0x20000
    s_mov_b32 s52, s28
    s_mov_b32 s53, s29
    s_mov_b32 s54, 10485760
    s_mov_b32 s55, 0x20000
    s_mov_b32 s56, s30
    s_mov_b32 s57, s31
    s_mov_b32 s58, 256
    s_mov_b32 s59, 0x20000
    s_sub_u32 s44, s8, 4096
    s_subb_u32 s45, s9, 0
    s_mov_b32 s46, 823296
    s_mov_b32 s47, 0x20000
    buffer_load_dword v47, v46, s[48:51], 0 offen sc1
    s_add_u32 m0, s97, 36864
    s_add_u32 s80, s84, s93
    buffer_load_dwordx4 v16, s[36:39], s80 offen offset:0 lds
    buffer_load_dwordx4 v17, s[36:39], s80 offen offset:1024 lds
    v_add_u32 v100, 0x20000, v98
    v_add_u32 v103, 0x20000, v101
    v_add_u32 v41, 0x20000, v39
    v_add_u32 v44, 0x20000, v42
    s_lshr_b32 s3, s100, 2
    s_lshl_b32 s3, s3, 4
    s_add_u32 s3, s3, s77
    s_lshl_b32 s3, s3, 10
    s_add_u32 s3, s3, 786432
    v_lshrrev_b32 v7, 3, v1
    v_lshl_add_u32 v105, v7, 7, s3
    s_lshl_b32 s34, s78, 7
    s_add_u32 s3, s3, s34
    v_mov_b32 v7, s3
    v_mov_b32 v8, 2147483648
    v_cmp_eq_u32 vcc, 0, v0
    s_nop 1
    v_cndmask_b32 v104, v8, v7, vcc
    s_getreg_b32 s3, hwreg(HW_REG_XCC_ID, 0, 4)
    v_mov_b32 v107, s3
    s_lshr_b32 s3, s2, 3
    s_lshl_b32 s3, s3, 2
    s_add_u32 s3, s3, s76
    s_mul_i32 s3, s3, 50
    v_add_u32 v7, s3, v1
    v_lshlrev_b32 v37, 7, v7
    v_add_u32 v37, 0x1000, v37
    v_mul_u32_u24 v8, 6554, v7
    v_lshrrev_b32 v8, 16, v8
    v_mul_u32_u24 v8, 2560, v8
    v_add_u32 v36, v37, v8
    s_and_b32 s35, s100, 3
    s_mul_i32 s35, s35, 13
    v_add_u32 v7, s35, v7
    v_lshlrev_b32 v9, 7, v7
    v_add_u32 v9, 0x1000, v9
    v_mul_u32_u24 v8, 6554, v7
    v_lshrrev_b32 v8, 16, v8
    v_mul_u32_u24 v8, 2560, v8
    v_add_u32 v8, v9, v8
    v_mov_b32 v10, 2147483648
    v_cmp_gt_u32 vcc, 13, v1
    s_nop 1
    v_cndmask_b32 v38, v10, v8, vcc
    v_cndmask_b32 v97, v10, v9, vcc
    s_mul_i32 s3, s76, 61440
    v_mul_u32_u24 v7, 3840, v83
    v_add3_u32 v7, v7, v84, s3
    s_mul_i32 s3, s99, 1228800
    s_sub_u32 s35, 1228640, s3
    v_add_u32 v8, s3, v7
    v_add_u32 v9, s35, v7
    v_mov_b32 v25, v8
    v_add_u32 v26, 0xfffffc40, v8
    v_cmp_eq_u32 vcc, 0, v82
    s_nop 1
    v_cndmask_b32 v10, v9, v8, vcc
    v_add_u32 v27, 0xfffff880, v10
    v_add_u32 v28, 0xfffff4c0, v9
    v_add_u32 v29, 256, v9
    s_lshl_b32 s3, s76, 1
    v_lshrrev_b32 v7, 3, v83
    v_add_u32 v7, s3, v7
    v_and_b32 v7, 3, v7
    v_mul_u32_u24 v7, 5, v7
    v_and_b32 v8, 3, v83
    v_mul_u32_u24 v8, 20, v8
    v_bfe_u32 v10, v83, 2, 1
    v_add3_u32 v7, v7, v8, v10
    v_mul_u32_u24 v7, 1280, v7
    v_add_u32 v30, v7, v84
    v_add_u32 v31, 0xfffffc40, v30
    v_mul_u32_u24 v8, 102240, v82
    v_add_u32 v9, 0xfffff880, v30
    v_add_u32 v32, v8, v9
    v_add_u32 v33, 99360, v30
    v_add_u32 v34, 102496, v30
    v_mul_u32_u24 v85, 101120, v10
    v_mul_u32_u24 v8, 307200, v82
    v_add_u32 v86, v85, v8
    v_add_u32 v87, 307200, v85
    s_lshr_b32 s3, s76, 1
    s_mul_i32 s35, s3, 2560
    s_add_u32 s60, s35, 0
    s_add_u32 s61, s35, 204800
    s_add_u32 s62, s35, 409600
    s_add_u32 s63, s35, 614400
    s_mul_i32 s3, s3, 204800
    s_add_u32 s64, s3, 5120
    s_movk_i32 s65, 0x1000
    s_movk_i32 s66, 0x2000
    v_mov_b32 v52, 0x3fb8aa3b
    v_mov_b32 v53, 0xb5c1a2a0
    v_mov_b32 v56, 0
    v_mov_b32 v57, 0x358637bd
    v_mov_b32 v58, 0
    v_mov_b32 v59, 0x358637bd
    s_mul_i32 s3, s76, 10496
    s_add_u32 s3, s3, 0
    v_add_u32 v60, s3, v45
    v_and_b32 v7, 1, v1
    v_mul_u32_u24 v8, 0x3f80, v7
    v_lshl_or_b32 v8, v8, 16, v8
    v_lshl_add_u32 v35, v7, 4, s3
    v_mov_b32 v54, v8
    s_mov_b32 s3, s76
    s_and_b32 s35, s76, 1
    v_mov_b32 v12, 10240
    v_mov_b32 v7, s35
    v_lshl_add_u32 v7, v7, 4, v4
    v_mov_b32 v8, s3
    v_lshlrev_b32 v9, 2, v8
    v_sub_u32 v7, v7, v9
    v_add_u32 v8, s35, v8
    v_lshl_add_u32 v8, v8, 10, v45
    v_add_u32 v8, 0, v8
    v_cmp_gt_u32 vcc, 20, v7
    s_nop 1
    v_cndmask_b32 v61, v12, v8, vcc
    s_mov_b32 s3, s76
    s_andn2_b32 s35, 1, s76
    v_mov_b32 v12, 10240
    v_mov_b32 v7, s35
    v_lshl_add_u32 v7, v7, 4, v4
    v_mov_b32 v8, s3
    v_lshlrev_b32 v9, 2, v8
    v_sub_u32 v7, v7, v9
    v_add_u32 v8, s35, v8
    v_lshl_add_u32 v8, v8, 10, v45
    v_add_u32 v8, 0, v8
    v_cmp_gt_u32 vcc, 20, v7
    s_nop 1
    v_cndmask_b32 v62, v12, v8, vcc
    s_xor_b32 s3, s76, 1
    s_and_b32 s35, s76, 1
    v_mov_b32 v12, 10240
    v_mov_b32 v7, s35
    v_lshl_add_u32 v7, v7, 4, v4
    v_mov_b32 v8, s3
    v_lshlrev_b32 v9, 2, v8
    v_sub_u32 v7, v7, v9
    v_add_u32 v8, s35, v8
    v_lshl_add_u32 v8, v8, 10, v45
    v_add_u32 v8, 0, v8
    v_cmp_gt_u32 vcc, 20, v7
    s_nop 1
    v_cndmask_b32 v63, v12, v8, vcc
    v_lshrrev_b32 v13, 2, v4
    v_mul_u32_u24 v13, 5, v13
    v_and_b32 v14, 3, v4
    s_mul_i32 s3, s76, 20
    v_add3_u32 v7, v13, v14, s3
    v_lshrrev_b32 v9, 4, v7
    v_and_b32 v10, 15, v7
    v_lshlrev_b32 v10, 4, v10
    v_lshl_add_u32 v10, v3, 8, v10
    v_lshl_add_u32 v10, v9, 10, v10
    v_add_u32 v64, 5120, v10
    s_mov_b32 s3, s76
    s_and_b32 s35, s3, 1
    s_lshl_b32 s35, s35, 1
    s_mul_i32 s3, s3, 20
    v_add3_u32 v7, v13, 4, s3
    v_lshrrev_b32 v9, 4, v7
    v_and_b32 v10, 15, v7
    v_lshlrev_b32 v10, 4, v10
    v_lshl_add_u32 v10, v3, 8, v10
    v_lshl_add_u32 v10, v9, 10, v10
    v_add_u32 v8, 5120, v10
    v_subrev_u32 v7, s35, v14
    v_mov_b32 v9, 10240
    v_mov_b32 v10, 10256
    v_cmp_eq_u32 vcc, 1, v7
    s_nop 1
    v_cndmask_b32 v9, v9, v10, vcc
    v_cmp_eq_u32 vcc, 0, v7
    s_nop 1
    v_cndmask_b32 v65, v9, v8, vcc
    s_xor_b32 s3, s76, 1
    s_and_b32 s35, s3, 1
    s_lshl_b32 s35, s35, 1
    s_mul_i32 s3, s3, 20
    v_add3_u32 v7, v13, 4, s3
    v_lshrrev_b32 v9, 4, v7
    v_and_b32 v10, 15, v7
    v_lshlrev_b32 v10, 4, v10
    v_lshl_add_u32 v10, v3, 8, v10
    v_lshl_add_u32 v10, v9, 10, v10
    v_add_u32 v8, 5120, v10
    v_subrev_u32 v7, s35, v14
    v_mov_b32 v9, 10240
    v_mov_b32 v10, 10256
    v_cmp_eq_u32 vcc, 1, v7
    s_nop 1
    v_cndmask_b32 v9, v9, v10, vcc
    v_cmp_eq_u32 vcc, 0, v7
    s_nop 1
    v_cndmask_b32 v66, v9, v8, vcc
    s_lshl_b32 s3, s78, 2
    s_add_u32 s3, s3, s76
    v_mov_b32 v12, 2147483648
    v_bfe_u32 v7, v1, 2, 1
    v_and_b32 v9, 3, v1
    v_lshlrev_b32 v9, 4, v9
    v_lshl_add_u32 v9, v7, 10, v9
    s_lshl_b32 s35, s77, 6
    v_add_u32 v9, s35, v9
    s_lshl_b32 s35, s3, 11
    s_add_u32 s35, s35, 655360
    buffer_load_dwordx4 v18, s[36:39], s80 offen offset:2048 lds
    buffer_load_dwordx4 v19, s[36:39], s80 offen offset:3072 lds
    s_add_u32 m0, s98, 53248
    s_add_u32 s81, s89, s95
    buffer_load_dwordx4 v20, s[40:43], s81 offen offset:0 lds
    buffer_load_dwordx4 v21, s[40:43], s81 offen offset:1024 lds
    buffer_load_dwordx4 v22, s[40:43], s81 offen offset:2048 lds
    buffer_load_dwordx4 v23, s[40:43], s81 offen offset:3072 lds
    s_add_u32 m0, s98, 57344
    s_nop 0
    buffer_load_dwordx4 v24, s[40:43], s81 offen offset:0 lds
    s_waitcnt vmcnt(10)
    s_barrier
    ds_read_b128 a[0:3], v98 offset:0
    ds_read_b128 a[4:7], v98 offset:2048
    ds_read_b64_tr_b16 a[160:161], v39 offset:16384
    ds_read_b64_tr_b16 a[162:163], v39 offset:16640
    ds_read_b64_tr_b16 a[164:165], v42 offset:16384
    ds_read_b64_tr_b16 a[166:167], v42 offset:16640
    ds_read_b64_tr_b16 a[168:169], v39 offset:17408
    ds_read_b64_tr_b16 a[170:171], v39 offset:17664
    ds_read_b64_tr_b16 a[172:173], v42 offset:17408
    ds_read_b64_tr_b16 a[174:175], v42 offset:17664
    ds_read_b64_tr_b16 a[176:177], v39 offset:18432
    ds_read_b64_tr_b16 a[178:179], v39 offset:18688
    ds_read_b64_tr_b16 a[180:181], v42 offset:18432
    ds_read_b64_tr_b16 a[182:183], v42 offset:18688
    ds_read_b64_tr_b16 a[184:185], v39 offset:19456
    ds_read_b64_tr_b16 a[186:187], v39 offset:19712
    ds_read_b64_tr_b16 a[188:189], v42 offset:19456
    ds_read_b64_tr_b16 a[190:191], v42 offset:19712
    ds_read_b64_tr_b16 a[192:193], v39 offset:20480
    ds_read_b64_tr_b16 a[194:195], v39 offset:20736
    ds_read_b64_tr_b16 a[196:197], v42 offset:20480
    ds_read_b64_tr_b16 a[198:199], v42 offset:20736
    s_waitcnt lgkmcnt(14)
    v_mfma_f32_16x16x32_bf16 v[176:179], a[0:3], a[160:163], v[48:51]
    ds_read_b128 a[8:11], v101 offset:0
    ds_read_b128 a[12:15], v101 offset:2048
    v_mfma_f32_16x16x32_bf16 v[180:183], a[4:7], a[160:163], v[48:51]
    ds_read_b64_tr_b16 a[200:201], v39 offset:26624
    s_add_u32 m0, s97, 73728
    s_add_u32 s80, s85, s93
    buffer_load_dwordx4 v16, s[36:39], s80 offen offset:0 lds
    v_mfma_f32_16x16x32_bf16 v[184:187], a[0:3], a[164:167], v[48:51]
    ds_read_b64_tr_b16 a[202:203], v39 offset:26880
    v_add_u32 v7, s35, v9
    v_cmp_gt_u32 vcc, 8, v1
    s_nop 1
    v_cndmask_b32 v72, v12, v7, vcc
    s_lshl_b32 s3, s3, 15
    s_add_u32 s3, s3, 1048576
    v_lshl_add_u32 v9, v3, 13, v9
    v_mfma_f32_16x16x32_bf16 v[188:191], a[4:7], a[164:167], v[48:51]
    ds_read_b64_tr_b16 a[204:205], v42 offset:26624
    buffer_load_dwordx4 v17, s[36:39], s80 offen offset:1024 lds
    v_add_u32 v7, s3, v9
    v_cmp_gt_u32 vcc, 8, v4
    s_nop 1
    v_cndmask_b32 v70, v12, v7, vcc
    v_cndmask_b32_e64 v79, 0, -1, vcc
    v_add_u32 v7, 4096, v7
    v_cndmask_b32 v71, v12, v7, vcc
    s_lshl_b32 s35, s77, 11
    s_add_u32 s3, s3, s35
    v_mfma_f32_16x16x32_bf16 v[192:195], a[0:3], a[168:171], v[48:51]
    ds_read_b64_tr_b16 a[206:207], v42 offset:26880
    v_add_u32 v7, s3, v45
    s_and_b32 s35, s76, 1
    s_lshl_b32 s35, s35, 10
    v_add_u32 v67, s35, v7
    v_mfma_f32_16x16x32_bf16 v[196:199], a[4:7], a[168:171], v[48:51]
    ds_read_b64_tr_b16 a[208:209], v39 offset:27648
    buffer_load_dwordx4 v18, s[36:39], s80 offen offset:2048 lds
    s_xor_b32 s35, s35, 1024
    v_add_u32 v68, s35, v7
    s_lshl_b32 s3, s78, 13
    s_add_u32 s3, s3, 655360
    s_waitcnt lgkmcnt(15)
    v_mfma_f32_16x16x32_bf16 v[200:203], a[0:3], a[172:175], v[48:51]
    ds_read_b64_tr_b16 a[210:211], v39 offset:27904
    ds_read_b64_tr_b16 a[212:213], v42 offset:27648
    v_lshl_add_u32 v73, v1, 4, s3
    v_and_b32 v7, 1, v4
    v_lshlrev_b32 v7, 4, v7
    v_mov_b32 v8, 0x3f80
    v_mfma_f32_16x16x32_bf16 v[204:207], a[4:7], a[172:175], v[48:51]
    ds_read_b64_tr_b16 a[214:215], v42 offset:27904
    buffer_load_dwordx4 v19, s[36:39], s80 offen offset:3072 lds
    v_lshlrev_b32 v7, v7, v8
    v_lshrrev_b32 v8, 1, v4
    v_cmp_eq_u32 vcc, 0, v8
    s_nop 1
    v_cndmask_b32_e64 v88, 0, v7, vcc
    v_cmp_eq_u32 vcc, 1, v8
    s_nop 1
    v_cndmask_b32_e64 v89, 0, v7, vcc
    v_mfma_f32_16x16x32_bf16 v[208:211], a[0:3], a[176:179], v[48:51]
    ds_read_b64_tr_b16 a[216:217], v39 offset:28672
    v_mov_b32 v90, 0
    v_mov_b32 v91, 0
    v_mov_b32 v92, 0
    v_mov_b32 v93, 0
    v_mov_b32 v94, v88
    v_mfma_f32_16x16x32_bf16 v[212:215], a[4:7], a[176:179], v[48:51]
    ds_read_b64_tr_b16 a[218:219], v39 offset:28928
    s_add_u32 m0, s98, 90112
    s_add_u32 s81, s90, s95
    buffer_load_dwordx4 v20, s[40:43], s81 offen offset:0 lds
    v_mov_b32 v95, 0
    s_lshl_b32 s3, s77, 2
    s_add_u32 s3, s3, s76
    s_mul_i32 s35, s3, 40960
    v_mfma_f32_16x16x32_bf16 v[216:219], a[0:3], a[180:183], 0
    ds_read_b64_tr_b16 a[220:221], v42 offset:28672
    s_add_u32 s35, s35, 4194304
    v_add_u32 v76, s35, v45
    s_lshl_b32 s3, s3, 10
    s_add_u32 s3, s3, 524288
    v_mfma_f32_16x16x32_bf16 v[220:223], a[4:7], a[180:183], 0
    ds_read_b64_tr_b16 a[222:223], v42 offset:28928
    buffer_load_dwordx4 v21, s[40:43], s81 offen offset:1024 lds
    v_lshrrev_b32 v7, 3, v1
    v_lshl_add_u32 v78, v7, 7, s3
    s_lshl_b32 s35, s78, 7
    s_add_u32 s3, s3, s35
    s_waitcnt lgkmcnt(14)
    v_mfma_f32_16x16x32_bf16 v[224:227], a[0:3], a[184:187], 0
    ds_read_b64_tr_b16 a[224:225], v39 offset:29696
    ds_read_b64_tr_b16 a[226:227], v39 offset:29952
    v_mov_b32 v7, s3
    v_cmp_eq_u32 vcc, 0, v1
    s_nop 1
    v_cndmask_b32 v77, v12, v7, vcc
    s_lshr_b32 s3, s78, 1
    s_mul_i32 s3, s3, 10240
    v_mfma_f32_16x16x32_bf16 v[228:231], a[4:7], a[184:187], 0
    ds_read_b64_tr_b16 a[228:229], v42 offset:29696
    buffer_load_dwordx4 v22, s[40:43], s81 offen offset:2048 lds
    v_add_u32 v7, s3, v76
    s_and_b32 s3, s78, 1
    s_lshl_b32 s35, s3, 12
    v_add_u32 v74, s35, v7
    v_mfma_f32_16x16x32_bf16 v[232:235], a[0:3], a[188:191], 0
    ds_read_b64_tr_b16 a[230:231], v42 offset:29952
    s_lshl_b32 s3, s3, 10
    s_add_u32 s3, s3, 8192
    v_lshlrev_b32 v8, 3, v1
    v_sub_u32 v7, v7, v8
    v_add_u32 v75, s3, v7
    v_mfma_f32_16x16x32_bf16 v[236:239], a[4:7], a[188:191], 0
    ds_read_b64_tr_b16 a[232:233], v39 offset:30720
    buffer_load_dwordx4 v23, s[40:43], s81 offen offset:3072 lds
    v_sub_u32 v81, v76, v8
    v_mul_u32_u24 v8, 112, v1
    v_add_u32 v9, v74, v8
    v_mul_u32_u24 v8, 120, v1
    v_mfma_f32_16x16x32_bf16 v[240:243], a[0:3], a[192:195], 0
    ds_read_b64_tr_b16 a[234:235], v39 offset:30976
    v_add3_u32 v8, v8, v75, 0
    v_add_u32 v8, 0xfffff000, v8
    v_cmp_gt_u32 vcc, 32, v1
    s_nop 1
    v_cndmask_b32 v8, v8, v9, vcc
    v_cmp_gt_u32 vcc, 40, v1
    s_nop 1
    v_cndmask_b32 v55, v12, v8, vcc
    v_mfma_f32_16x16x32_bf16 v[244:247], a[4:7], a[192:195], 0
    ds_read_b64_tr_b16 a[236:237], v42 offset:30720
    s_add_u32 m0, s98, 94208
    s_nop 0
    buffer_load_dwordx4 v24, s[40:43], s81 offen offset:0 lds
    s_and_b32 s35, s76, 1
    s_lshl_b32 s35, s35, 10
    v_subrev_u32 v7, s35, v67
    v_mul_u32_u24 v8, 112, v1
    v_mfma_f32_16x16x32_bf16 v[248:251], a[0:3], a[196:199], 0
    ds_read_b64_tr_b16 a[238:239], v42 offset:30976
    v_add_u32 v7, v7, v8
    v_add_u32 v7, 0xfffff800, v7
    v_mov_b32 v10, 2147483648
    v_cmp_eq_u32 vcc, 1, v3
    s_nop 1
    v_cndmask_b32 v7, v10, v7, vcc
    v_mfma_f32_16x16x32_bf16 v[252:255], a[4:7], a[196:199], 0
    v_cmp_gt_u32 vcc, 8, v1
    s_nop 1
    v_cndmask_b32 v7, v7, v72, vcc
    v_readfirstlane_b32 s35, v77
    s_nop 1
    v_mov_b32 v8, s35
    v_cmp_eq_u32 vcc, 8, v1
    s_nop 1
    v_cndmask_b32 v69, v7, v8, vcc
    s_waitcnt vmcnt(9)
    s_barrier
    s_waitcnt lgkmcnt(14)
    v_mfma_f32_16x16x32_bf16 v[176:179], a[8:11], a[200:203], v[176:179]
    ds_read_b128 a[16:19], v98 offset:36864
    ds_read_b128 a[20:23], v98 offset:38912
    v_mfma_f32_16x16x32_bf16 v[180:183], a[12:15], a[200:203], v[180:183]
    ds_read_b64_tr_b16 a[160:161], v39 offset:53248
    v_add_u32 v47, 0x9E3779B1, v47
    v_cmp_eq_u32 vcc, 0, v47
    s_nop 1
    v_cndmask_b32_e64 v47, v47, 1, vcc
    buffer_store_dword v47, v46, s[48:51], 0 offen sc1
    buffer_store_dword v47, v46, s[56:59], 0 offen sc1
    v_mfma_f32_16x16x32_bf16 v[184:187], a[8:11], a[204:207], v[184:187]
    ds_read_b64_tr_b16 a[162:163], v39 offset:53504
    v_mfma_f32_16x16x32_bf16 v[188:191], a[12:15], a[204:207], v[188:191]
    ds_read_b64_tr_b16 a[164:165], v42 offset:53248
    v_mfma_f32_16x16x32_bf16 v[192:195], a[8:11], a[208:211], v[192:195]
    ds_read_b64_tr_b16 a[166:167], v42 offset:53504
    s_add_u32 m0, s97, 110592
    s_add_u32 s80, s86, s93
    buffer_load_dwordx4 v16, s[36:39], s80 offen offset:0 lds
    v_mfma_f32_16x16x32_bf16 v[196:199], a[12:15], a[208:211], v[196:199]
    ds_read_b64_tr_b16 a[168:169], v39 offset:54272
    s_waitcnt lgkmcnt(15)
    v_mfma_f32_16x16x32_bf16 v[200:203], a[8:11], a[212:215], v[200:203]
    ds_read_b64_tr_b16 a[170:171], v39 offset:54528
    ds_read_b64_tr_b16 a[172:173], v42 offset:54272
    v_mfma_f32_16x16x32_bf16 v[204:207], a[12:15], a[212:215], v[204:207]
    ds_read_b64_tr_b16 a[174:175], v42 offset:54528
    buffer_load_dwordx4 v17, s[36:39], s80 offen offset:1024 lds
    v_mfma_f32_16x16x32_bf16 v[208:211], a[8:11], a[216:219], v[208:211]
    ds_read_b64_tr_b16 a[176:177], v39 offset:55296
    v_mfma_f32_16x16x32_bf16 v[212:215], a[12:15], a[216:219], v[212:215]
    ds_read_b64_tr_b16 a[178:179], v39 offset:55552
    v_mfma_f32_16x16x32_bf16 v[216:219], a[8:11], a[220:223], v[216:219]
    ds_read_b64_tr_b16 a[180:181], v42 offset:55296
    buffer_load_dwordx4 v18, s[36:39], s80 offen offset:2048 lds
    v_mfma_f32_16x16x32_bf16 v[220:223], a[12:15], a[220:223], v[220:223]
    ds_read_b64_tr_b16 a[182:183], v42 offset:55552
    s_waitcnt lgkmcnt(14)
    v_mfma_f32_16x16x32_bf16 v[224:227], a[8:11], a[224:227], v[224:227]
    ds_read_b64_tr_b16 a[184:185], v39 offset:56320
    ds_read_b64_tr_b16 a[186:187], v39 offset:56576
    v_mfma_f32_16x16x32_bf16 v[228:231], a[12:15], a[224:227], v[228:231]
    ds_read_b64_tr_b16 a[188:189], v42 offset:56320
    buffer_load_dwordx4 v19, s[36:39], s80 offen offset:3072 lds
    v_mfma_f32_16x16x32_bf16 v[232:235], a[8:11], a[228:231], v[232:235]
    ds_read_b64_tr_b16 a[190:191], v42 offset:56576
    v_mfma_f32_16x16x32_bf16 v[236:239], a[12:15], a[228:231], v[236:239]
    ds_read_b64_tr_b16 a[192:193], v39 offset:57344
    v_mfma_f32_16x16x32_bf16 v[240:243], a[8:11], a[232:235], v[240:243]
    ds_read_b64_tr_b16 a[194:195], v39 offset:57600
    s_add_u32 m0, s98, 126976
    s_add_u32 s81, s91, s95
    buffer_load_dwordx4 v20, s[40:43], s81 offen offset:0 lds
    v_mfma_f32_16x16x32_bf16 v[244:247], a[12:15], a[232:235], v[244:247]
    ds_read_b64_tr_b16 a[196:197], v42 offset:57344
    v_mfma_f32_16x16x32_bf16 v[248:251], a[8:11], a[236:239], v[248:251]
    ds_read_b64_tr_b16 a[198:199], v42 offset:57600
    v_mfma_f32_16x16x32_bf16 v[252:255], a[12:15], a[236:239], v[252:255]
    s_waitcnt lgkmcnt(14)
    v_mfma_f32_16x16x32_bf16 v[176:179], a[16:19], a[160:163], v[176:179]
    ds_read_b128 a[24:27], v101 offset:36864
    ds_read_b128 a[28:31], v101 offset:38912
    v_mfma_f32_16x16x32_bf16 v[180:183], a[20:23], a[160:163], v[180:183]
    ds_read_b64_tr_b16 a[200:201], v39 offset:63488
    buffer_load_dwordx4 v21, s[40:43], s81 offen offset:1024 lds
    v_mfma_f32_16x16x32_bf16 v[184:187], a[16:19], a[164:167], v[184:187]
    ds_read_b64_tr_b16 a[202:203], v39 offset:63744
    v_mfma_f32_16x16x32_bf16 v[188:191], a[20:23], a[164:167], v[188:191]
    ds_read_b64_tr_b16 a[204:205], v42 offset:63488
    v_mfma_f32_16x16x32_bf16 v[192:195], a[16:19], a[168:171], v[192:195]
    ds_read_b64_tr_b16 a[206:207], v42 offset:63744
    buffer_load_dwordx4 v22, s[40:43], s81 offen offset:2048 lds
    v_mfma_f32_16x16x32_bf16 v[196:199], a[20:23], a[168:171], v[196:199]
    ds_read_b64_tr_b16 a[208:209], v39 offset:64512
    s_waitcnt lgkmcnt(15)
    v_mfma_f32_16x16x32_bf16 v[200:203], a[16:19], a[172:175], v[200:203]
    ds_read_b64_tr_b16 a[210:211], v39 offset:64768
    ds_read_b64_tr_b16 a[212:213], v42 offset:64512
    v_mfma_f32_16x16x32_bf16 v[204:207], a[20:23], a[172:175], v[204:207]
    ds_read_b64_tr_b16 a[214:215], v42 offset:64768
    buffer_load_dwordx4 v23, s[40:43], s81 offen offset:3072 lds
    v_mfma_f32_16x16x32_bf16 v[208:211], a[16:19], a[176:179], v[208:211]
    ds_read_b64_tr_b16 a[216:217], v40 offset:0
    v_mfma_f32_16x16x32_bf16 v[212:215], a[20:23], a[176:179], v[212:215]
    ds_read_b64_tr_b16 a[218:219], v40 offset:256
    v_mfma_f32_16x16x32_bf16 v[216:219], a[16:19], a[180:183], v[216:219]
    ds_read_b64_tr_b16 a[220:221], v43 offset:0
    s_add_u32 m0, s98, 131072
    s_nop 0
    buffer_load_dwordx4 v24, s[40:43], s81 offen offset:0 lds
    v_mfma_f32_16x16x32_bf16 v[220:223], a[20:23], a[180:183], v[220:223]
    ds_read_b64_tr_b16 a[222:223], v43 offset:256
    s_waitcnt lgkmcnt(14)
    v_mfma_f32_16x16x32_bf16 v[224:227], a[16:19], a[184:187], v[224:227]
    ds_read_b64_tr_b16 a[224:225], v40 offset:1024
    ds_read_b64_tr_b16 a[226:227], v40 offset:1280
    v_mfma_f32_16x16x32_bf16 v[228:231], a[20:23], a[184:187], v[228:231]
    ds_read_b64_tr_b16 a[228:229], v43 offset:1024
    buffer_load_dword v38, v38, s[40:43], 0 offen
    v_mfma_f32_16x16x32_bf16 v[232:235], a[16:19], a[188:191], v[232:235]
    ds_read_b64_tr_b16 a[230:231], v43 offset:1280
    v_mfma_f32_16x16x32_bf16 v[236:239], a[20:23], a[188:191], v[236:239]
    ds_read_b64_tr_b16 a[232:233], v40 offset:2048
    v_mfma_f32_16x16x32_bf16 v[240:243], a[16:19], a[192:195], v[240:243]
    ds_read_b64_tr_b16 a[234:235], v40 offset:2304
    buffer_load_dword v97, v97, s[44:47], 0 offen
    v_mfma_f32_16x16x32_bf16 v[244:247], a[20:23], a[192:195], v[244:247]
    ds_read_b64_tr_b16 a[236:237], v43 offset:2048
    v_mfma_f32_16x16x32_bf16 v[248:251], a[16:19], a[196:199], v[248:251]
    ds_read_b64_tr_b16 a[238:239], v43 offset:2304
    v_mfma_f32_16x16x32_bf16 v[252:255], a[20:23], a[196:199], v[252:255]
    s_waitcnt vmcnt(13)
    s_barrier
    s_waitcnt lgkmcnt(14)
    v_mfma_f32_16x16x32_bf16 v[176:179], a[24:27], a[200:203], v[176:179]
    ds_read_b128 a[32:35], v99 offset:8192
    ds_read_b128 a[36:39], v99 offset:10240
    v_mfma_f32_16x16x32_bf16 v[180:183], a[28:31], a[200:203], v[180:183]
    ds_read_b64_tr_b16 a[160:161], v40 offset:24576
    s_add_u32 m0, s97, 0
    s_add_u32 s80, s87, s93
    buffer_load_dwordx4 v16, s[36:39], s80 offen offset:0 lds
    v_mfma_f32_16x16x32_bf16 v[184:187], a[24:27], a[204:207], v[184:187]
    ds_read_b64_tr_b16 a[162:163], v40 offset:24832
    v_mfma_f32_16x16x32_bf16 v[188:191], a[28:31], a[204:207], v[188:191]
    ds_read_b64_tr_b16 a[164:165], v43 offset:24576
    v_mfma_f32_16x16x32_bf16 v[192:195], a[24:27], a[208:211], v[192:195]
    ds_read_b64_tr_b16 a[166:167], v43 offset:24832
    buffer_load_dwordx4 v17, s[36:39], s80 offen offset:1024 lds
    v_mfma_f32_16x16x32_bf16 v[196:199], a[28:31], a[208:211], v[196:199]
    ds_read_b64_tr_b16 a[168:169], v40 offset:25600
    s_waitcnt lgkmcnt(15)
    v_mfma_f32_16x16x32_bf16 v[200:203], a[24:27], a[212:215], v[200:203]
    ds_read_b64_tr_b16 a[170:171], v40 offset:25856
    ds_read_b64_tr_b16 a[172:173], v43 offset:25600
    v_mfma_f32_16x16x32_bf16 v[204:207], a[28:31], a[212:215], v[204:207]
    ds_read_b64_tr_b16 a[174:175], v43 offset:25856
    v_mfma_f32_16x16x32_bf16 v[208:211], a[24:27], a[216:219], v[208:211]
    ds_read_b64_tr_b16 a[176:177], v40 offset:26624
    buffer_load_dwordx4 v18, s[36:39], s80 offen offset:2048 lds
    v_mfma_f32_16x16x32_bf16 v[212:215], a[28:31], a[216:219], v[212:215]
    ds_read_b64_tr_b16 a[178:179], v40 offset:26880
    v_mfma_f32_16x16x32_bf16 v[216:219], a[24:27], a[220:223], v[216:219]
    ds_read_b64_tr_b16 a[180:181], v43 offset:26624
    v_mfma_f32_16x16x32_bf16 v[220:223], a[28:31], a[220:223], v[220:223]
    ds_read_b64_tr_b16 a[182:183], v43 offset:26880
    s_waitcnt lgkmcnt(14)
    v_mfma_f32_16x16x32_bf16 v[224:227], a[24:27], a[224:227], v[224:227]
    ds_read_b64_tr_b16 a[184:185], v40 offset:27648
    ds_read_b64_tr_b16 a[186:187], v40 offset:27904
    buffer_load_dwordx4 v19, s[36:39], s80 offen offset:3072 lds
    v_mfma_f32_16x16x32_bf16 v[228:231], a[28:31], a[224:227], v[228:231]
    ds_read_b64_tr_b16 a[188:189], v43 offset:27648
    v_mfma_f32_16x16x32_bf16 v[232:235], a[24:27], a[228:231], v[232:235]
    ds_read_b64_tr_b16 a[190:191], v43 offset:27904
    v_mfma_f32_16x16x32_bf16 v[236:239], a[28:31], a[228:231], v[236:239]
    ds_read_b64_tr_b16 a[192:193], v40 offset:28672
    v_mfma_f32_16x16x32_bf16 v[240:243], a[24:27], a[232:235], v[240:243]
    ds_read_b64_tr_b16 a[194:195], v40 offset:28928
    s_add_u32 m0, s98, 16384
    s_add_u32 s81, s92, s95
    buffer_load_dwordx4 v20, s[40:43], s81 offen offset:0 lds
    v_mfma_f32_16x16x32_bf16 v[244:247], a[28:31], a[232:235], v[244:247]
    ds_read_b64_tr_b16 a[196:197], v43 offset:28672
    v_mfma_f32_16x16x32_bf16 v[248:251], a[24:27], a[236:239], v[248:251]
    ds_read_b64_tr_b16 a[198:199], v43 offset:28928
    v_mfma_f32_16x16x32_bf16 v[252:255], a[28:31], a[236:239], v[252:255]
    s_waitcnt lgkmcnt(14)
    v_mfma_f32_16x16x32_bf16 v[176:179], a[32:35], a[160:163], v[176:179]
    ds_read_b128 a[40:43], v102 offset:8192
    ds_read_b128 a[44:47], v102 offset:10240
    v_mfma_f32_16x16x32_bf16 v[180:183], a[36:39], a[160:163], v[180:183]
    ds_read_b64_tr_b16 a[200:201], v40 offset:34816
    buffer_load_dwordx4 v21, s[40:43], s81 offen offset:1024 lds
    v_mfma_f32_16x16x32_bf16 v[184:187], a[32:35], a[164:167], v[184:187]
    ds_read_b64_tr_b16 a[202:203], v40 offset:35072
    v_mfma_f32_16x16x32_bf16 v[188:191], a[36:39], a[164:167], v[188:191]
    ds_read_b64_tr_b16 a[204:205], v43 offset:34816
    v_mfma_f32_16x16x32_bf16 v[192:195], a[32:35], a[168:171], v[192:195]
    ds_read_b64_tr_b16 a[206:207], v43 offset:35072
    v_mfma_f32_16x16x32_bf16 v[196:199], a[36:39], a[168:171], v[196:199]
    ds_read_b64_tr_b16 a[208:209], v40 offset:35840
    buffer_load_dwordx4 v22, s[40:43], s81 offen offset:2048 lds
    s_waitcnt lgkmcnt(15)
    v_mfma_f32_16x16x32_bf16 v[200:203], a[32:35], a[172:175], v[200:203]
    ds_read_b64_tr_b16 a[210:211], v40 offset:36096
    ds_read_b64_tr_b16 a[212:213], v43 offset:35840
    v_mfma_f32_16x16x32_bf16 v[204:207], a[36:39], a[172:175], v[204:207]
    ds_read_b64_tr_b16 a[214:215], v43 offset:36096
    v_mfma_f32_16x16x32_bf16 v[208:211], a[32:35], a[176:179], v[208:211]
    ds_read_b64_tr_b16 a[216:217], v40 offset:36864
    v_mfma_f32_16x16x32_bf16 v[212:215], a[36:39], a[176:179], v[212:215]
    ds_read_b64_tr_b16 a[218:219], v40 offset:37120
    v_mfma_f32_16x16x32_bf16 v[216:219], a[32:35], a[180:183], v[216:219]
    ds_read_b64_tr_b16 a[220:221], v43 offset:36864
    buffer_load_dwordx4 v23, s[40:43], s81 offen offset:3072 lds
    v_mfma_f32_16x16x32_bf16 v[220:223], a[36:39], a[180:183], v[220:223]
    ds_read_b64_tr_b16 a[222:223], v43 offset:37120
    s_waitcnt lgkmcnt(14)
    v_mfma_f32_16x16x32_bf16 v[224:227], a[32:35], a[184:187], v[224:227]
    ds_read_b64_tr_b16 a[224:225], v40 offset:37888
    ds_read_b64_tr_b16 a[226:227], v40 offset:38144
    v_mfma_f32_16x16x32_bf16 v[228:231], a[36:39], a[184:187], v[228:231]
    ds_read_b64_tr_b16 a[228:229], v43 offset:37888
    v_mfma_f32_16x16x32_bf16 v[232:235], a[32:35], a[188:191], v[232:235]
    ds_read_b64_tr_b16 a[230:231], v43 offset:38144
    v_mfma_f32_16x16x32_bf16 v[236:239], a[36:39], a[188:191], v[236:239]
    ds_read_b64_tr_b16 a[232:233], v40 offset:38912
    s_add_u32 m0, s98, 20480
    s_nop 0
    buffer_load_dwordx4 v24, s[40:43], s81 offen offset:0 lds
    v_mfma_f32_16x16x32_bf16 v[240:243], a[32:35], a[192:195], v[240:243]
    ds_read_b64_tr_b16 a[234:235], v40 offset:39168
    v_mfma_f32_16x16x32_bf16 v[244:247], a[36:39], a[192:195], v[244:247]
    ds_read_b64_tr_b16 a[236:237], v43 offset:38912
    v_mfma_f32_16x16x32_bf16 v[248:251], a[32:35], a[196:199], v[248:251]
    ds_read_b64_tr_b16 a[238:239], v43 offset:39168
    v_mfma_f32_16x16x32_bf16 v[252:255], a[36:39], a[196:199], v[252:255]
    s_waitcnt vmcnt(11)
    s_barrier
    s_waitcnt lgkmcnt(14)
    v_mfma_f32_16x16x32_bf16 v[176:179], a[40:43], a[200:203], v[176:179]
    ds_read_b128 a[48:51], v99 offset:45056
    ds_read_b128 a[52:55], v99 offset:47104
    v_mfma_f32_16x16x32_bf16 v[180:183], a[44:47], a[200:203], v[180:183]
    ds_read_b64_tr_b16 a[160:161], v40 offset:61440
    s_add_u32 m0, s97, 36864
    s_add_u32 s80, s83, s94
    buffer_load_dwordx4 v16, s[36:39], s80 offen offset:0 lds
    v_mfma_f32_16x16x32_bf16 v[184:187], a[40:43], a[204:207], v[184:187]
    ds_read_b64_tr_b16 a[162:163], v40 offset:61696
    v_mfma_f32_16x16x32_bf16 v[188:191], a[44:47], a[204:207], v[188:191]
    ds_read_b64_tr_b16 a[164:165], v43 offset:61440
    v_mfma_f32_16x16x32_bf16 v[192:195], a[40:43], a[208:211], v[192:195]
    ds_read_b64_tr_b16 a[166:167], v43 offset:61696
    buffer_load_dwordx4 v17, s[36:39], s80 offen offset:1024 lds
    v_mfma_f32_16x16x32_bf16 v[196:199], a[44:47], a[208:211], v[196:199]
    ds_read_b64_tr_b16 a[168:169], v40 offset:62464
    s_waitcnt lgkmcnt(15)
    v_mfma_f32_16x16x32_bf16 v[200:203], a[40:43], a[212:215], v[200:203]
    ds_read_b64_tr_b16 a[170:171], v40 offset:62720
    ds_read_b64_tr_b16 a[172:173], v43 offset:62464
    v_mfma_f32_16x16x32_bf16 v[204:207], a[44:47], a[212:215], v[204:207]
    ds_read_b64_tr_b16 a[174:175], v43 offset:62720
    v_mfma_f32_16x16x32_bf16 v[208:211], a[40:43], a[216:219], v[208:211]
    ds_read_b64_tr_b16 a[176:177], v40 offset:63488
    buffer_load_dwordx4 v18, s[36:39], s80 offen offset:2048 lds
    v_mfma_f32_16x16x32_bf16 v[212:215], a[44:47], a[216:219], v[212:215]
    ds_read_b64_tr_b16 a[178:179], v40 offset:63744
    v_mfma_f32_16x16x32_bf16 v[216:219], a[40:43], a[220:223], v[216:219]
    ds_read_b64_tr_b16 a[180:181], v43 offset:63488
    v_mfma_f32_16x16x32_bf16 v[220:223], a[44:47], a[220:223], v[220:223]
    ds_read_b64_tr_b16 a[182:183], v43 offset:63744
    s_waitcnt lgkmcnt(14)
    v_mfma_f32_16x16x32_bf16 v[224:227], a[40:43], a[224:227], v[224:227]
    ds_read_b64_tr_b16 a[184:185], v40 offset:64512
    ds_read_b64_tr_b16 a[186:187], v40 offset:64768
    buffer_load_dwordx4 v19, s[36:39], s80 offen offset:3072 lds
    v_mfma_f32_16x16x32_bf16 v[228:231], a[44:47], a[224:227], v[228:231]
    ds_read_b64_tr_b16 a[188:189], v43 offset:64512
    v_mfma_f32_16x16x32_bf16 v[232:235], a[40:43], a[228:231], v[232:235]
    ds_read_b64_tr_b16 a[190:191], v43 offset:64768
    v_mfma_f32_16x16x32_bf16 v[236:239], a[44:47], a[228:231], v[236:239]
    ds_read_b64_tr_b16 a[192:193], v41 offset:0
    v_mfma_f32_16x16x32_bf16 v[240:243], a[40:43], a[232:235], v[240:243]
    ds_read_b64_tr_b16 a[194:195], v41 offset:256
    s_add_u32 m0, s98, 53248
    s_add_u32 s81, s88, s96
    buffer_load_dwordx4 v20, s[40:43], s81 offen offset:0 lds
    v_mfma_f32_16x16x32_bf16 v[244:247], a[44:47], a[232:235], v[244:247]
    ds_read_b64_tr_b16 a[196:197], v44 offset:0
    v_mfma_f32_16x16x32_bf16 v[248:251], a[40:43], a[236:239], v[248:251]
    ds_read_b64_tr_b16 a[198:199], v44 offset:256
    v_mfma_f32_16x16x32_bf16 v[252:255], a[44:47], a[236:239], v[252:255]
    s_waitcnt lgkmcnt(14)
    v_mfma_f32_16x16x32_bf16 v[176:179], a[48:51], a[160:163], v[176:179]
    ds_read_b128 a[56:59], v102 offset:45056
    ds_read_b128 a[60:63], v102 offset:47104
    v_mfma_f32_16x16x32_bf16 v[180:183], a[52:55], a[160:163], v[180:183]
    ds_read_b64_tr_b16 a[200:201], v41 offset:6144
    buffer_load_dwordx4 v21, s[40:43], s81 offen offset:1024 lds
    v_mfma_f32_16x16x32_bf16 v[184:187], a[48:51], a[164:167], v[184:187]
    ds_read_b64_tr_b16 a[202:203], v41 offset:6400
    v_mfma_f32_16x16x32_bf16 v[188:191], a[52:55], a[164:167], v[188:191]
    ds_read_b64_tr_b16 a[204:205], v44 offset:6144
    v_mfma_f32_16x16x32_bf16 v[192:195], a[48:51], a[168:171], v[192:195]
    ds_read_b64_tr_b16 a[206:207], v44 offset:6400
    v_mfma_f32_16x16x32_bf16 v[196:199], a[52:55], a[168:171], v[196:199]
    ds_read_b64_tr_b16 a[208:209], v41 offset:7168
    buffer_load_dwordx4 v22, s[40:43], s81 offen offset:2048 lds
    s_waitcnt lgkmcnt(15)
    v_mfma_f32_16x16x32_bf16 v[200:203], a[48:51], a[172:175], v[200:203]
    ds_read_b64_tr_b16 a[210:211], v41 offset:7424
    ds_read_b64_tr_b16 a[212:213], v44 offset:7168
    v_mfma_f32_16x16x32_bf16 v[204:207], a[52:55], a[172:175], v[204:207]
    ds_read_b64_tr_b16 a[214:215], v44 offset:7424
    v_mfma_f32_16x16x32_bf16 v[208:211], a[48:51], a[176:179], v[208:211]
    ds_read_b64_tr_b16 a[216:217], v41 offset:8192
    v_mfma_f32_16x16x32_bf16 v[212:215], a[52:55], a[176:179], v[212:215]
    ds_read_b64_tr_b16 a[218:219], v41 offset:8448
    v_mfma_f32_16x16x32_bf16 v[216:219], a[48:51], a[180:183], v[216:219]
    ds_read_b64_tr_b16 a[220:221], v44 offset:8192
    buffer_load_dwordx4 v23, s[40:43], s81 offen offset:3072 lds
    v_mfma_f32_16x16x32_bf16 v[220:223], a[52:55], a[180:183], v[220:223]
    ds_read_b64_tr_b16 a[222:223], v44 offset:8448
    s_waitcnt lgkmcnt(14)
    v_mfma_f32_16x16x32_bf16 v[224:227], a[48:51], a[184:187], v[224:227]
    ds_read_b64_tr_b16 a[224:225], v41 offset:9216
    ds_read_b64_tr_b16 a[226:227], v41 offset:9472
    v_mfma_f32_16x16x32_bf16 v[228:231], a[52:55], a[184:187], v[228:231]
    ds_read_b64_tr_b16 a[228:229], v44 offset:9216
    v_mfma_f32_16x16x32_bf16 v[232:235], a[48:51], a[188:191], v[232:235]
    ds_read_b64_tr_b16 a[230:231], v44 offset:9472
    v_mfma_f32_16x16x32_bf16 v[236:239], a[52:55], a[188:191], v[236:239]
    ds_read_b64_tr_b16 a[232:233], v41 offset:10240
    s_add_u32 m0, s98, 57344
    s_nop 0
    buffer_load_dwordx4 v24, s[40:43], s81 offen offset:0 lds
    v_mfma_f32_16x16x32_bf16 v[240:243], a[48:51], a[192:195], v[240:243]
    ds_read_b64_tr_b16 a[234:235], v41 offset:10496
    v_mfma_f32_16x16x32_bf16 v[244:247], a[52:55], a[192:195], v[244:247]
    ds_read_b64_tr_b16 a[236:237], v44 offset:10240
    v_mfma_f32_16x16x32_bf16 v[248:251], a[48:51], a[196:199], v[248:251]
    ds_read_b64_tr_b16 a[238:239], v44 offset:10496
    v_mfma_f32_16x16x32_bf16 v[252:255], a[52:55], a[196:199], v[252:255]
    s_waitcnt vmcnt(9)
    s_barrier
    s_waitcnt lgkmcnt(14)
    v_mfma_f32_16x16x32_bf16 v[176:179], a[56:59], a[200:203], v[176:179]
    ds_read_b128 a[64:67], v98 offset:0
    ds_read_b128 a[68:71], v98 offset:2048
    v_mfma_f32_16x16x32_bf16 v[180:183], a[60:63], a[200:203], v[180:183]
    ds_read_b64_tr_b16 a[160:161], v39 offset:16384
    s_add_u32 m0, s97, 73728
    s_add_u32 s80, s84, s94
    buffer_load_dwordx4 v16, s[36:39], s80 offen offset:0 lds
    v_mfma_f32_16x16x32_bf16 v[184:187], a[56:59], a[204:207], v[184:187]
    ds_read_b64_tr_b16 a[162:163], v39 offset:16640
    v_mfma_f32_16x16x32_bf16 v[188:191], a[60:63], a[204:207], v[188:191]
    ds_read_b64_tr_b16 a[164:165], v42 offset:16384
    v_mfma_f32_16x16x32_bf16 v[192:195], a[56:59], a[208:211], v[192:195]
    ds_read_b64_tr_b16 a[166:167], v42 offset:16640
    buffer_load_dwordx4 v17, s[36:39], s80 offen offset:1024 lds
    v_mfma_f32_16x16x32_bf16 v[196:199], a[60:63], a[208:211], v[196:199]
    ds_read_b64_tr_b16 a[168:169], v39 offset:17408
    s_waitcnt lgkmcnt(15)
    v_mfma_f32_16x16x32_bf16 v[200:203], a[56:59], a[212:215], v[200:203]
    ds_read_b64_tr_b16 a[170:171], v39 offset:17664
    ds_read_b64_tr_b16 a[172:173], v42 offset:17408
    v_mfma_f32_16x16x32_bf16 v[204:207], a[60:63], a[212:215], v[204:207]
    ds_read_b64_tr_b16 a[174:175], v42 offset:17664
    v_mfma_f32_16x16x32_bf16 v[208:211], a[56:59], a[216:219], v[208:211]
    ds_read_b64_tr_b16 a[176:177], v39 offset:18432
    buffer_load_dwordx4 v18, s[36:39], s80 offen offset:2048 lds
    v_mfma_f32_16x16x32_bf16 v[212:215], a[60:63], a[216:219], v[212:215]
    ds_read_b64_tr_b16 a[178:179], v39 offset:18688
    v_mfma_f32_16x16x32_bf16 v[216:219], a[56:59], a[220:223], v[216:219]
    ds_read_b64_tr_b16 a[180:181], v42 offset:18432
    v_mfma_f32_16x16x32_bf16 v[220:223], a[60:63], a[220:223], v[220:223]
    ds_read_b64_tr_b16 a[182:183], v42 offset:18688
    s_waitcnt lgkmcnt(14)
    v_mfma_f32_16x16x32_bf16 v[224:227], a[56:59], a[224:227], v[224:227]
    ds_read_b64_tr_b16 a[184:185], v39 offset:19456
    ds_read_b64_tr_b16 a[186:187], v39 offset:19712
    buffer_load_dwordx4 v19, s[36:39], s80 offen offset:3072 lds
    v_mfma_f32_16x16x32_bf16 v[228:231], a[60:63], a[224:227], v[228:231]
    ds_read_b64_tr_b16 a[188:189], v42 offset:19456
    v_mfma_f32_16x16x32_bf16 v[232:235], a[56:59], a[228:231], v[232:235]
    ds_read_b64_tr_b16 a[190:191], v42 offset:19712
    v_mfma_f32_16x16x32_bf16 v[236:239], a[60:63], a[228:231], v[236:239]
    ds_read_b64_tr_b16 a[192:193], v39 offset:20480
    v_mfma_f32_16x16x32_bf16 v[240:243], a[56:59], a[232:235], v[240:243]
    ds_read_b64_tr_b16 a[194:195], v39 offset:20736
    s_add_u32 m0, s98, 90112
    s_add_u32 s81, s89, s96
    buffer_load_dwordx4 v20, s[40:43], s81 offen offset:0 lds
    v_mfma_f32_16x16x32_bf16 v[244:247], a[60:63], a[232:235], v[244:247]
    ds_read_b64_tr_b16 a[196:197], v42 offset:20480
    v_mfma_f32_16x16x32_bf16 v[248:251], a[56:59], a[236:239], v[248:251]
    ds_read_b64_tr_b16 a[198:199], v42 offset:20736
    v_mfma_f32_16x16x32_bf16 v[252:255], a[60:63], a[236:239], v[252:255]
    s_waitcnt lgkmcnt(14)
    v_mfma_f32_16x16x32_bf16 v[176:179], a[64:67], a[160:163], v[176:179]
    ds_read_b128 a[72:75], v101 offset:0
    ds_read_b128 a[76:79], v101 offset:2048
    v_mfma_f32_16x16x32_bf16 v[180:183], a[68:71], a[160:163], v[180:183]
    ds_read_b64_tr_b16 a[200:201], v39 offset:26624
    buffer_load_dwordx4 v21, s[40:43], s81 offen offset:1024 lds
    v_mfma_f32_16x16x32_bf16 v[184:187], a[64:67], a[164:167], v[184:187]
    ds_read_b64_tr_b16 a[202:203], v39 offset:26880
    v_mfma_f32_16x16x32_bf16 v[188:191], a[68:71], a[164:167], v[188:191]
    ds_read_b64_tr_b16 a[204:205], v42 offset:26624
    v_mfma_f32_16x16x32_bf16 v[192:195], a[64:67], a[168:171], v[192:195]
    ds_read_b64_tr_b16 a[206:207], v42 offset:26880
    v_mfma_f32_16x16x32_bf16 v[196:199], a[68:71], a[168:171], v[196:199]
    ds_read_b64_tr_b16 a[208:209], v39 offset:27648
    buffer_load_dwordx4 v22, s[40:43], s81 offen offset:2048 lds
    s_waitcnt lgkmcnt(15)
    v_mfma_f32_16x16x32_bf16 v[200:203], a[64:67], a[172:175], v[200:203]
    ds_read_b64_tr_b16 a[210:211], v39 offset:27904
    ds_read_b64_tr_b16 a[212:213], v42 offset:27648
    v_mfma_f32_16x16x32_bf16 v[204:207], a[68:71], a[172:175], v[204:207]
    ds_read_b64_tr_b16 a[214:215], v42 offset:27904
    v_mfma_f32_16x16x32_bf16 v[208:211], a[64:67], a[176:179], v[208:211]
    ds_read_b64_tr_b16 a[216:217], v39 offset:28672
    v_mfma_f32_16x16x32_bf16 v[212:215], a[68:71], a[176:179], v[212:215]
    ds_read_b64_tr_b16 a[218:219], v39 offset:28928
    v_mfma_f32_16x16x32_bf16 v[216:219], a[64:67], a[180:183], v[216:219]
    ds_read_b64_tr_b16 a[220:221], v42 offset:28672
    buffer_load_dwordx4 v23, s[40:43], s81 offen offset:3072 lds
    v_mfma_f32_16x16x32_bf16 v[220:223], a[68:71], a[180:183], v[220:223]
    ds_read_b64_tr_b16 a[222:223], v42 offset:28928
    s_waitcnt lgkmcnt(14)
    v_mfma_f32_16x16x32_bf16 v[224:227], a[64:67], a[184:187], v[224:227]
    ds_read_b64_tr_b16 a[224:225], v39 offset:29696
    ds_read_b64_tr_b16 a[226:227], v39 offset:29952
    v_mfma_f32_16x16x32_bf16 v[228:231], a[68:71], a[184:187], v[228:231]
    ds_read_b64_tr_b16 a[228:229], v42 offset:29696
    v_mfma_f32_16x16x32_bf16 v[232:235], a[64:67], a[188:191], v[232:235]
    ds_read_b64_tr_b16 a[230:231], v42 offset:29952
    v_mfma_f32_16x16x32_bf16 v[236:239], a[68:71], a[188:191], v[236:239]
    ds_read_b64_tr_b16 a[232:233], v39 offset:30720
    s_add_u32 m0, s98, 94208
    s_nop 0
    buffer_load_dwordx4 v24, s[40:43], s81 offen offset:0 lds
    v_mfma_f32_16x16x32_bf16 v[240:243], a[64:67], a[192:195], v[240:243]
    ds_read_b64_tr_b16 a[234:235], v39 offset:30976
    v_mfma_f32_16x16x32_bf16 v[244:247], a[68:71], a[192:195], v[244:247]
    ds_read_b64_tr_b16 a[236:237], v42 offset:30720
    v_mfma_f32_16x16x32_bf16 v[248:251], a[64:67], a[196:199], v[248:251]
    ds_read_b64_tr_b16 a[238:239], v42 offset:30976
    v_mfma_f32_16x16x32_bf16 v[252:255], a[68:71], a[196:199], v[252:255]
    s_waitcnt vmcnt(9)
    s_barrier
    s_waitcnt lgkmcnt(14)
    v_mfma_f32_16x16x32_bf16 v[176:179], a[72:75], a[200:203], v[176:179]
    ds_read_b128 a[80:83], v98 offset:36864
    ds_read_b128 a[84:87], v98 offset:38912
    v_mfma_f32_16x16x32_bf16 v[180:183], a[76:79], a[200:203], v[180:183]
    ds_read_b64_tr_b16 a[160:161], v39 offset:53248
    s_add_u32 m0, s97, 110592
    s_add_u32 s80, s85, s94
    buffer_load_dwordx4 v16, s[36:39], s80 offen offset:0 lds
    v_mfma_f32_16x16x32_bf16 v[184:187], a[72:75], a[204:207], v[184:187]
    ds_read_b64_tr_b16 a[162:163], v39 offset:53504
    v_mfma_f32_16x16x32_bf16 v[188:191], a[76:79], a[204:207], v[188:191]
    ds_read_b64_tr_b16 a[164:165], v42 offset:53248
    v_mfma_f32_16x16x32_bf16 v[192:195], a[72:75], a[208:211], v[192:195]
    ds_read_b64_tr_b16 a[166:167], v42 offset:53504
    buffer_load_dwordx4 v17, s[36:39], s80 offen offset:1024 lds
    v_mfma_f32_16x16x32_bf16 v[196:199], a[76:79], a[208:211], v[196:199]
    ds_read_b64_tr_b16 a[168:169], v39 offset:54272
    s_waitcnt lgkmcnt(15)
    v_mfma_f32_16x16x32_bf16 v[200:203], a[72:75], a[212:215], v[200:203]
    ds_read_b64_tr_b16 a[170:171], v39 offset:54528
    ds_read_b64_tr_b16 a[172:173], v42 offset:54272
    v_mfma_f32_16x16x32_bf16 v[204:207], a[76:79], a[212:215], v[204:207]
    ds_read_b64_tr_b16 a[174:175], v42 offset:54528
    v_mfma_f32_16x16x32_bf16 v[208:211], a[72:75], a[216:219], v[208:211]
    ds_read_b64_tr_b16 a[176:177], v39 offset:55296
    buffer_load_dwordx4 v18, s[36:39], s80 offen offset:2048 lds
    v_mfma_f32_16x16x32_bf16 v[212:215], a[76:79], a[216:219], v[212:215]
    ds_read_b64_tr_b16 a[178:179], v39 offset:55552
    v_mfma_f32_16x16x32_bf16 v[216:219], a[72:75], a[220:223], v[216:219]
    ds_read_b64_tr_b16 a[180:181], v42 offset:55296
    v_mfma_f32_16x16x32_bf16 v[220:223], a[76:79], a[220:223], v[220:223]
    ds_read_b64_tr_b16 a[182:183], v42 offset:55552
    s_waitcnt lgkmcnt(14)
    v_mfma_f32_16x16x32_bf16 v[224:227], a[72:75], a[224:227], v[224:227]
    ds_read_b64_tr_b16 a[184:185], v39 offset:56320
    ds_read_b64_tr_b16 a[186:187], v39 offset:56576
    buffer_load_dwordx4 v19, s[36:39], s80 offen offset:3072 lds
    v_mfma_f32_16x16x32_bf16 v[228:231], a[76:79], a[224:227], v[228:231]
    ds_read_b64_tr_b16 a[188:189], v42 offset:56320
    v_mfma_f32_16x16x32_bf16 v[232:235], a[72:75], a[228:231], v[232:235]
    ds_read_b64_tr_b16 a[190:191], v42 offset:56576
    v_mfma_f32_16x16x32_bf16 v[236:239], a[76:79], a[228:231], v[236:239]
    ds_read_b64_tr_b16 a[192:193], v39 offset:57344
    v_mfma_f32_16x16x32_bf16 v[240:243], a[72:75], a[232:235], v[240:243]
    ds_read_b64_tr_b16 a[194:195], v39 offset:57600
    s_add_u32 m0, s98, 126976
    s_add_u32 s81, s90, s96
    buffer_load_dwordx4 v20, s[40:43], s81 offen offset:0 lds
    v_mfma_f32_16x16x32_bf16 v[244:247], a[76:79], a[232:235], v[244:247]
    ds_read_b64_tr_b16 a[196:197], v42 offset:57344
    v_mfma_f32_16x16x32_bf16 v[248:251], a[72:75], a[236:239], v[248:251]
    ds_read_b64_tr_b16 a[198:199], v42 offset:57600
    v_mfma_f32_16x16x32_bf16 v[252:255], a[76:79], a[236:239], v[252:255]
    s_waitcnt lgkmcnt(14)
    v_mfma_f32_16x16x32_bf16 v[176:179], a[80:83], a[160:163], v[176:179]
    ds_read_b128 a[88:91], v101 offset:36864
    ds_read_b128 a[92:95], v101 offset:38912
    v_mfma_f32_16x16x32_bf16 v[180:183], a[84:87], a[160:163], v[180:183]
    ds_read_b64_tr_b16 a[200:201], v39 offset:63488
    buffer_load_dwordx4 v21, s[40:43], s81 offen offset:1024 lds
    v_mfma_f32_16x16x32_bf16 v[184:187], a[80:83], a[164:167], v[184:187]
    ds_read_b64_tr_b16 a[202:203], v39 offset:63744
    v_mfma_f32_16x16x32_bf16 v[188:191], a[84:87], a[164:167], v[188:191]
    ds_read_b64_tr_b16 a[204:205], v42 offset:63488
    v_mfma_f32_16x16x32_bf16 v[192:195], a[80:83], a[168:171], v[192:195]
    ds_read_b64_tr_b16 a[206:207], v42 offset:63744
    v_mfma_f32_16x16x32_bf16 v[196:199], a[84:87], a[168:171], v[196:199]
    ds_read_b64_tr_b16 a[208:209], v39 offset:64512
    buffer_load_dwordx4 v22, s[40:43], s81 offen offset:2048 lds
    s_waitcnt lgkmcnt(15)
    v_mfma_f32_16x16x32_bf16 v[200:203], a[80:83], a[172:175], v[200:203]
    ds_read_b64_tr_b16 a[210:211], v39 offset:64768
    ds_read_b64_tr_b16 a[212:213], v42 offset:64512
    v_mfma_f32_16x16x32_bf16 v[204:207], a[84:87], a[172:175], v[204:207]
    ds_read_b64_tr_b16 a[214:215], v42 offset:64768
    v_mfma_f32_16x16x32_bf16 v[208:211], a[80:83], a[176:179], v[208:211]
    ds_read_b64_tr_b16 a[216:217], v40 offset:0
    v_mfma_f32_16x16x32_bf16 v[212:215], a[84:87], a[176:179], v[212:215]
    ds_read_b64_tr_b16 a[218:219], v40 offset:256
    v_mfma_f32_16x16x32_bf16 v[216:219], a[80:83], a[180:183], v[216:219]
    ds_read_b64_tr_b16 a[220:221], v43 offset:0
    buffer_load_dwordx4 v23, s[40:43], s81 offen offset:3072 lds
    v_mfma_f32_16x16x32_bf16 v[220:223], a[84:87], a[180:183], v[220:223]
    ds_read_b64_tr_b16 a[222:223], v43 offset:256
    s_waitcnt lgkmcnt(14)
    v_mfma_f32_16x16x32_bf16 v[224:227], a[80:83], a[184:187], v[224:227]
    ds_read_b64_tr_b16 a[224:225], v40 offset:1024
    ds_read_b64_tr_b16 a[226:227], v40 offset:1280
    v_mfma_f32_16x16x32_bf16 v[228:231], a[84:87], a[184:187], v[228:231]
    ds_read_b64_tr_b16 a[228:229], v43 offset:1024
    v_mfma_f32_16x16x32_bf16 v[232:235], a[80:83], a[188:191], v[232:235]
    ds_read_b64_tr_b16 a[230:231], v43 offset:1280
    v_mfma_f32_16x16x32_bf16 v[236:239], a[84:87], a[188:191], v[236:239]
    ds_read_b64_tr_b16 a[232:233], v40 offset:2048
    s_add_u32 m0, s98, 131072
    s_nop 0
    buffer_load_dwordx4 v24, s[40:43], s81 offen offset:0 lds
    v_mfma_f32_16x16x32_bf16 v[240:243], a[80:83], a[192:195], v[240:243]
    ds_read_b64_tr_b16 a[234:235], v40 offset:2304
    v_mfma_f32_16x16x32_bf16 v[244:247], a[84:87], a[192:195], v[244:247]
    ds_read_b64_tr_b16 a[236:237], v43 offset:2048
    v_mfma_f32_16x16x32_bf16 v[248:251], a[80:83], a[196:199], v[248:251]
    ds_read_b64_tr_b16 a[238:239], v43 offset:2304
    v_mfma_f32_16x16x32_bf16 v[252:255], a[84:87], a[196:199], v[252:255]
    s_waitcnt vmcnt(9)
    s_barrier
    s_waitcnt lgkmcnt(14)
    v_mfma_f32_16x16x32_bf16 v[176:179], a[88:91], a[200:203], v[176:179]
    ds_read_b128 a[96:99], v99 offset:8192
    ds_read_b128 a[100:103], v99 offset:10240
    v_mfma_f32_16x16x32_bf16 v[180:183], a[92:95], a[200:203], v[180:183]
    ds_read_b64_tr_b16 a[160:161], v40 offset:24576
    s_add_u32 m0, s97, 0
    s_add_u32 s80, s86, s94
    buffer_load_dwordx4 v16, s[36:39], s80 offen offset:0 lds
    v_mfma_f32_16x16x32_bf16 v[184:187], a[88:91], a[204:207], v[184:187]
    ds_read_b64_tr_b16 a[162:163], v40 offset:24832
    v_mfma_f32_16x16x32_bf16 v[188:191], a[92:95], a[204:207], v[188:191]
    ds_read_b64_tr_b16 a[164:165], v43 offset:24576
    v_mfma_f32_16x16x32_bf16 v[192:195], a[88:91], a[208:211], v[192:195]
    ds_read_b64_tr_b16 a[166:167], v43 offset:24832
    buffer_load_dwordx4 v17, s[36:39], s80 offen offset:1024 lds
    v_mfma_f32_16x16x32_bf16 v[196:199], a[92:95], a[208:211], v[196:199]
    ds_read_b64_tr_b16 a[168:169], v40 offset:25600
    s_waitcnt lgkmcnt(15)
    v_mfma_f32_16x16x32_bf16 v[200:203], a[88:91], a[212:215], v[200:203]
    ds_read_b64_tr_b16 a[170:171], v40 offset:25856
    ds_read_b64_tr_b16 a[172:173], v43 offset:25600
    v_mfma_f32_16x16x32_bf16 v[204:207], a[92:95], a[212:215], v[204:207]
    ds_read_b64_tr_b16 a[174:175], v43 offset:25856
    v_mfma_f32_16x16x32_bf16 v[208:211], a[88:91], a[216:219], v[208:211]
    ds_read_b64_tr_b16 a[176:177], v40 offset:26624
    buffer_load_dwordx4 v18, s[36:39], s80 offen offset:2048 lds
    v_mfma_f32_16x16x32_bf16 v[212:215], a[92:95], a[216:219], v[212:215]
    ds_read_b64_tr_b16 a[178:179], v40 offset:26880
    v_mfma_f32_16x16x32_bf16 v[216:219], a[88:91], a[220:223], v[216:219]
    ds_read_b64_tr_b16 a[180:181], v43 offset:26624
    v_mfma_f32_16x16x32_bf16 v[220:223], a[92:95], a[220:223], v[220:223]
    ds_read_b64_tr_b16 a[182:183], v43 offset:26880
    s_waitcnt lgkmcnt(14)
    v_mfma_f32_16x16x32_bf16 v[224:227], a[88:91], a[224:227], v[224:227]
    ds_read_b64_tr_b16 a[184:185], v40 offset:27648
    ds_read_b64_tr_b16 a[186:187], v40 offset:27904
    buffer_load_dwordx4 v19, s[36:39], s80 offen offset:3072 lds
    v_mfma_f32_16x16x32_bf16 v[228:231], a[92:95], a[224:227], v[228:231]
    ds_read_b64_tr_b16 a[188:189], v43 offset:27648
    v_mfma_f32_16x16x32_bf16 v[232:235], a[88:91], a[228:231], v[232:235]
    ds_read_b64_tr_b16 a[190:191], v43 offset:27904
    v_mfma_f32_16x16x32_bf16 v[236:239], a[92:95], a[228:231], v[236:239]
    ds_read_b64_tr_b16 a[192:193], v40 offset:28672
    v_mfma_f32_16x16x32_bf16 v[240:243], a[88:91], a[232:235], v[240:243]
    ds_read_b64_tr_b16 a[194:195], v40 offset:28928
    s_add_u32 m0, s98, 16384
    s_add_u32 s81, s91, s96
    buffer_load_dwordx4 v20, s[40:43], s81 offen offset:0 lds
    v_mfma_f32_16x16x32_bf16 v[244:247], a[92:95], a[232:235], v[244:247]
    ds_read_b64_tr_b16 a[196:197], v43 offset:28672
    v_mfma_f32_16x16x32_bf16 v[248:251], a[88:91], a[236:239], v[248:251]
    ds_read_b64_tr_b16 a[198:199], v43 offset:28928
    v_mfma_f32_16x16x32_bf16 v[252:255], a[92:95], a[236:239], v[252:255]
    s_waitcnt lgkmcnt(14)
    v_mfma_f32_16x16x32_bf16 v[176:179], a[96:99], a[160:163], v[176:179]
    ds_read_b128 a[104:107], v102 offset:8192
    ds_read_b128 a[108:111], v102 offset:10240
    v_mfma_f32_16x16x32_bf16 v[180:183], a[100:103], a[160:163], v[180:183]
    ds_read_b64_tr_b16 a[200:201], v40 offset:34816
    buffer_load_dwordx4 v21, s[40:43], s81 offen offset:1024 lds
    v_mfma_f32_16x16x32_bf16 v[184:187], a[96:99], a[164:167], v[184:187]
    ds_read_b64_tr_b16 a[202:203], v40 offset:35072
    v_mfma_f32_16x16x32_bf16 v[188:191], a[100:103], a[164:167], v[188:191]
    ds_read_b64_tr_b16 a[204:205], v43 offset:34816
    v_mfma_f32_16x16x32_bf16 v[192:195], a[96:99], a[168:171], v[192:195]
    ds_read_b64_tr_b16 a[206:207], v43 offset:35072
    buffer_load_dwordx4 v22, s[40:43], s81 offen offset:2048 lds
    v_mfma_f32_16x16x32_bf16 v[196:199], a[100:103], a[168:171], v[196:199]
    ds_read_b64_tr_b16 a[208:209], v40 offset:35840
    s_waitcnt lgkmcnt(15)
    v_mfma_f32_16x16x32_bf16 v[200:203], a[96:99], a[172:175], v[200:203]
    ds_read_b64_tr_b16 a[210:211], v40 offset:36096
    ds_read_b64_tr_b16 a[212:213], v43 offset:35840
    v_mfma_f32_16x16x32_bf16 v[204:207], a[100:103], a[172:175], v[204:207]
    ds_read_b64_tr_b16 a[214:215], v43 offset:36096
    v_mfma_f32_16x16x32_bf16 v[208:211], a[96:99], a[176:179], v[208:211]
    ds_read_b64_tr_b16 a[216:217], v40 offset:36864
    buffer_load_dwordx4 v23, s[40:43], s81 offen offset:3072 lds
    v_mfma_f32_16x16x32_bf16 v[212:215], a[100:103], a[176:179], v[212:215]
    ds_read_b64_tr_b16 a[218:219], v40 offset:37120
    v_mfma_f32_16x16x32_bf16 v[216:219], a[96:99], a[180:183], v[216:219]
    ds_read_b64_tr_b16 a[220:221], v43 offset:36864
    v_mfma_f32_16x16x32_bf16 v[220:223], a[100:103], a[180:183], v[220:223]
    ds_read_b64_tr_b16 a[222:223], v43 offset:37120
    s_waitcnt lgkmcnt(14)
    v_mfma_f32_16x16x32_bf16 v[224:227], a[96:99], a[184:187], v[224:227]
    ds_read_b64_tr_b16 a[224:225], v40 offset:37888
    ds_read_b64_tr_b16 a[226:227], v40 offset:38144
    s_add_u32 m0, s98, 20480
    s_nop 0
    buffer_load_dwordx4 v24, s[40:43], s81 offen offset:0 lds
    v_mfma_f32_16x16x32_bf16 v[228:231], a[100:103], a[184:187], v[228:231]
    ds_read_b64_tr_b16 a[228:229], v43 offset:37888
    v_mfma_f32_16x16x32_bf16 v[232:235], a[96:99], a[188:191], v[232:235]
    ds_read_b64_tr_b16 a[230:231], v43 offset:38144
    v_mfma_f32_16x16x32_bf16 v[236:239], a[100:103], a[188:191], v[236:239]
    ds_read_b64_tr_b16 a[232:233], v40 offset:38912
    v_mfma_f32_16x16x32_bf16 v[240:243], a[96:99], a[192:195], v[240:243]
    ds_read_b64_tr_b16 a[234:235], v40 offset:39168
    buffer_load_dword v47, off, s[56:59], 0 sc1
    v_mfma_f32_16x16x32_bf16 v[244:247], a[100:103], a[192:195], v[244:247]
    ds_read_b64_tr_b16 a[236:237], v43 offset:38912
    v_mfma_f32_16x16x32_bf16 v[248:251], a[96:99], a[196:199], v[248:251]
    ds_read_b64_tr_b16 a[238:239], v43 offset:39168
    v_mfma_f32_16x16x32_bf16 v[252:255], a[100:103], a[196:199], v[252:255]
    s_waitcnt vmcnt(10)
    s_barrier
    s_waitcnt lgkmcnt(14)
    v_mfma_f32_16x16x32_bf16 v[176:179], a[104:107], a[200:203], v[176:179]
    ds_read_b128 a[112:115], v99 offset:45056
    ds_read_b128 a[116:119], v99 offset:47104
    v_mfma_f32_16x16x32_bf16 v[180:183], a[108:111], a[200:203], v[180:183]
    ds_read_b64_tr_b16 a[160:161], v40 offset:61440
    s_add_u32 m0, s97, 36864
    s_add_u32 s80, s87, s94
    buffer_load_dwordx4 v16, s[36:39], s80 offen offset:0 lds
    v_mfma_f32_16x16x32_bf16 v[184:187], a[104:107], a[204:207], v[184:187]
    ds_read_b64_tr_b16 a[162:163], v40 offset:61696
    v_mfma_f32_16x16x32_bf16 v[188:191], a[108:111], a[204:207], v[188:191]
    ds_read_b64_tr_b16 a[164:165], v43 offset:61440
    v_mfma_f32_16x16x32_bf16 v[192:195], a[104:107], a[208:211], v[192:195]
    ds_read_b64_tr_b16 a[166:167], v43 offset:61696
    buffer_load_dwordx4 v17, s[36:39], s80 offen offset:1024 lds
    v_mfma_f32_16x16x32_bf16 v[196:199], a[108:111], a[208:211], v[196:199]
    ds_read_b64_tr_b16 a[168:169], v40 offset:62464
    s_waitcnt lgkmcnt(15)
    v_mfma_f32_16x16x32_bf16 v[200:203], a[104:107], a[212:215], v[200:203]
    ds_read_b64_tr_b16 a[170:171], v40 offset:62720
    ds_read_b64_tr_b16 a[172:173], v43 offset:62464
    v_mfma_f32_16x16x32_bf16 v[204:207], a[108:111], a[212:215], v[204:207]
    ds_read_b64_tr_b16 a[174:175], v43 offset:62720
    v_mfma_f32_16x16x32_bf16 v[208:211], a[104:107], a[216:219], v[208:211]
    ds_read_b64_tr_b16 a[176:177], v40 offset:63488
    buffer_load_dwordx4 v18, s[36:39], s80 offen offset:2048 lds
    v_mfma_f32_16x16x32_bf16 v[212:215], a[108:111], a[216:219], v[212:215]
    ds_read_b64_tr_b16 a[178:179], v40 offset:63744
    v_mfma_f32_16x16x32_bf16 v[216:219], a[104:107], a[220:223], v[216:219]
    ds_read_b64_tr_b16 a[180:181], v43 offset:63488
    v_mfma_f32_16x16x32_bf16 v[220:223], a[108:111], a[220:223], v[220:223]
    ds_read_b64_tr_b16 a[182:183], v43 offset:63744
    s_waitcnt lgkmcnt(14)
    v_mfma_f32_16x16x32_bf16 v[224:227], a[104:107], a[224:227], v[224:227]
    ds_read_b64_tr_b16 a[184:185], v40 offset:64512
    ds_read_b64_tr_b16 a[186:187], v40 offset:64768
    buffer_load_dwordx4 v19, s[36:39], s80 offen offset:3072 lds
    v_mfma_f32_16x16x32_bf16 v[228:231], a[108:111], a[224:227], v[228:231]
    ds_read_b64_tr_b16 a[188:189], v43 offset:64512
    v_mfma_f32_16x16x32_bf16 v[232:235], a[104:107], a[228:231], v[232:235]
    ds_read_b64_tr_b16 a[190:191], v43 offset:64768
    v_mfma_f32_16x16x32_bf16 v[236:239], a[108:111], a[228:231], v[236:239]
    ds_read_b64_tr_b16 a[192:193], v41 offset:0
    v_mfma_f32_16x16x32_bf16 v[240:243], a[104:107], a[232:235], v[240:243]
    ds_read_b64_tr_b16 a[194:195], v41 offset:256
    s_add_u32 m0, s98, 53248
    s_add_u32 s81, s92, s96
    buffer_load_dwordx4 v20, s[40:43], s81 offen offset:0 lds
    v_mfma_f32_16x16x32_bf16 v[244:247], a[108:111], a[232:235], v[244:247]
    ds_read_b64_tr_b16 a[196:197], v44 offset:0
    v_mfma_f32_16x16x32_bf16 v[248:251], a[104:107], a[236:239], v[248:251]
    ds_read_b64_tr_b16 a[198:199], v44 offset:256
    v_mfma_f32_16x16x32_bf16 v[252:255], a[108:111], a[236:239], v[252:255]
    s_waitcnt lgkmcnt(14)
    v_mfma_f32_16x16x32_bf16 v[176:179], a[112:115], a[160:163], v[176:179]
    ds_read_b128 a[120:123], v102 offset:45056
    ds_read_b128 a[124:127], v102 offset:47104
    v_mfma_f32_16x16x32_bf16 v[180:183], a[116:119], a[160:163], v[180:183]
    ds_read_b64_tr_b16 a[200:201], v41 offset:6144
    buffer_load_dwordx4 v21, s[40:43], s81 offen offset:1024 lds
    v_mfma_f32_16x16x32_bf16 v[184:187], a[112:115], a[164:167], v[184:187]
    ds_read_b64_tr_b16 a[202:203], v41 offset:6400
    v_mfma_f32_16x16x32_bf16 v[188:191], a[116:119], a[164:167], v[188:191]
    ds_read_b64_tr_b16 a[204:205], v44 offset:6144
    v_mfma_f32_16x16x32_bf16 v[192:195], a[112:115], a[168:171], v[192:195]
    ds_read_b64_tr_b16 a[206:207], v44 offset:6400
    v_mfma_f32_16x16x32_bf16 v[196:199], a[116:119], a[168:171], v[196:199]
    ds_read_b64_tr_b16 a[208:209], v41 offset:7168
    buffer_load_dwordx4 v22, s[40:43], s81 offen offset:2048 lds
    s_waitcnt lgkmcnt(15)
    v_mfma_f32_16x16x32_bf16 v[200:203], a[112:115], a[172:175], v[200:203]
    ds_read_b64_tr_b16 a[210:211], v41 offset:7424
    ds_read_b64_tr_b16 a[212:213], v44 offset:7168
    v_mfma_f32_16x16x32_bf16 v[204:207], a[116:119], a[172:175], v[204:207]
    ds_read_b64_tr_b16 a[214:215], v44 offset:7424
    v_mfma_f32_16x16x32_bf16 v[208:211], a[112:115], a[176:179], v[208:211]
    ds_read_b64_tr_b16 a[216:217], v41 offset:8192
    v_mfma_f32_16x16x32_bf16 v[212:215], a[116:119], a[176:179], v[212:215]
    ds_read_b64_tr_b16 a[218:219], v41 offset:8448
    v_mfma_f32_16x16x32_bf16 v[216:219], a[112:115], a[180:183], v[216:219]
    ds_read_b64_tr_b16 a[220:221], v44 offset:8192
    buffer_load_dwordx4 v23, s[40:43], s81 offen offset:3072 lds
    v_mfma_f32_16x16x32_bf16 v[220:223], a[116:119], a[180:183], v[220:223]
    ds_read_b64_tr_b16 a[222:223], v44 offset:8448
    s_waitcnt lgkmcnt(14)
    v_mfma_f32_16x16x32_bf16 v[224:227], a[112:115], a[184:187], v[224:227]
    ds_read_b64_tr_b16 a[224:225], v41 offset:9216
    ds_read_b64_tr_b16 a[226:227], v41 offset:9472
    v_mfma_f32_16x16x32_bf16 v[228:231], a[116:119], a[184:187], v[228:231]
    ds_read_b64_tr_b16 a[228:229], v44 offset:9216
    v_mfma_f32_16x16x32_bf16 v[232:235], a[112:115], a[188:191], v[232:235]
    ds_read_b64_tr_b16 a[230:231], v44 offset:9472
    v_mfma_f32_16x16x32_bf16 v[236:239], a[116:119], a[188:191], v[236:239]
    ds_read_b64_tr_b16 a[232:233], v41 offset:10240
    s_add_u32 m0, s98, 57344
    s_nop 0
    buffer_load_dwordx4 v24, s[40:43], s81 offen offset:0 lds
    v_mfma_f32_16x16x32_bf16 v[240:243], a[112:115], a[192:195], v[240:243]
    ds_read_b64_tr_b16 a[234:235], v41 offset:10496
    v_mfma_f32_16x16x32_bf16 v[244:247], a[116:119], a[192:195], v[244:247]
    ds_read_b64_tr_b16 a[236:237], v44 offset:10240
    v_mfma_f32_16x16x32_bf16 v[248:251], a[112:115], a[196:199], v[248:251]
    ds_read_b64_tr_b16 a[238:239], v44 offset:10496
    v_mfma_f32_16x16x32_bf16 v[252:255], a[116:119], a[196:199], v[252:255]
    s_waitcnt vmcnt(10)
    s_barrier
    s_waitcnt vmcnt(9)
    v_readfirstlane_b32 s79, v47
    s_nop 3
    s_cmp_lg_u32 s79, 0
    s_cbranch_scc1 L_nonce_1
    s_mov_b32 s82, 0x40000
L_nlp_2:
    buffer_load_dword v47, off, s[56:59], 0 sc1
    s_waitcnt vmcnt(0)
    v_readfirstlane_b32 s79, v47
    s_nop 3
    s_cmp_lg_u32 s79, 0
    s_cbranch_scc1 L_nonce_1
    s_sub_u32 s82, s82, 1
    s_cbranch_scc0 L_nlp_2
L_nonce_1:
    s_waitcnt lgkmcnt(14)
    v_mfma_f32_16x16x32_bf16 v[176:179], a[120:123], a[200:203], v[176:179]
    ds_read_b128 a[128:131], v98 offset:0
    ds_read_b128 a[132:135], v98 offset:2048
    v_mfma_f32_16x16x32_bf16 v[180:183], a[124:127], a[200:203], v[180:183]
    ds_read_b64_tr_b16 a[160:161], v39 offset:16384
    v_mov_b32 v106, s79
    buffer_store_dwordx2 v[106:107], v104, s[48:51], 0 offen sc1
    v_mfma_f32_16x16x32_bf16 v[184:187], a[120:123], a[204:207], v[184:187]
    ds_read_b64_tr_b16 a[162:163], v39 offset:16640
    v_mfma_f32_16x16x32_bf16 v[188:191], a[124:127], a[204:207], v[188:191]
    ds_read_b64_tr_b16 a[164:165], v42 offset:16384
    v_mfma_f32_16x16x32_bf16 v[192:195], a[120:123], a[208:211], v[192:195]
    ds_read_b64_tr_b16 a[166:167], v42 offset:16640
    v_mfma_f32_16x16x32_bf16 v[196:199], a[124:127], a[208:211], v[196:199]
    ds_read_b64_tr_b16 a[168:169], v39 offset:17408
    s_waitcnt lgkmcnt(15)
    v_mfma_f32_16x16x32_bf16 v[200:203], a[120:123], a[212:215], v[200:203]
    ds_read_b64_tr_b16 a[170:171], v39 offset:17664
    ds_read_b64_tr_b16 a[172:173], v42 offset:17408
    v_mfma_f32_16x16x32_bf16 v[204:207], a[124:127], a[212:215], v[204:207]
    ds_read_b64_tr_b16 a[174:175], v42 offset:17664
    s_add_u32 m0, s98, 73728
    s_nop 0
    buffer_load_dwordx4 v25, s[40:43], s88 offen offset:0 lds
    v_mfma_f32_16x16x32_bf16 v[208:211], a[120:123], a[216:219], v[208:211]
    ds_read_b64_tr_b16 a[176:177], v39 offset:18432
    v_mfma_f32_16x16x32_bf16 v[212:215], a[124:127], a[216:219], v[212:215]
    ds_read_b64_tr_b16 a[178:179], v39 offset:18688
    v_mfma_f32_16x16x32_bf16 v[216:219], a[120:123], a[220:223], v[216:219]
    ds_read_b64_tr_b16 a[180:181], v42 offset:18432
    v_mfma_f32_16x16x32_bf16 v[220:223], a[124:127], a[220:223], v[220:223]
    ds_read_b64_tr_b16 a[182:183], v42 offset:18688
    s_waitcnt lgkmcnt(14)
    v_mfma_f32_16x16x32_bf16 v[224:227], a[120:123], a[224:227], v[224:227]
    ds_read_b64_tr_b16 a[184:185], v39 offset:19456
    ds_read_b64_tr_b16 a[186:187], v39 offset:19712
    v_mfma_f32_16x16x32_bf16 v[228:231], a[124:127], a[224:227], v[228:231]
    ds_read_b64_tr_b16 a[188:189], v42 offset:19456
    buffer_load_dwordx4 v26, s[40:43], s88 offen offset:1024 lds
    v_mfma_f32_16x16x32_bf16 v[232:235], a[120:123], a[228:231], v[232:235]
    ds_read_b64_tr_b16 a[190:191], v42 offset:19712
    v_mfma_f32_16x16x32_bf16 v[236:239], a[124:127], a[228:231], v[236:239]
    ds_read_b64_tr_b16 a[192:193], v39 offset:20480
    v_mfma_f32_16x16x32_bf16 v[240:243], a[120:123], a[232:235], v[240:243]
    ds_read_b64_tr_b16 a[194:195], v39 offset:20736
    v_mfma_f32_16x16x32_bf16 v[244:247], a[124:127], a[232:235], v[244:247]
    ds_read_b64_tr_b16 a[196:197], v42 offset:20480
    v_mfma_f32_16x16x32_bf16 v[248:251], a[120:123], a[236:239], v[248:251]
    ds_read_b64_tr_b16 a[198:199], v42 offset:20736
    v_mfma_f32_16x16x32_bf16 v[252:255], a[124:127], a[236:239], v[252:255]
    s_waitcnt lgkmcnt(14)
    v_mfma_f32_16x16x32_bf16 v[176:179], a[128:131], a[160:163], v[176:179]
    ds_read_b128 a[136:139], v101 offset:0
    ds_read_b128 a[140:143], v101 offset:2048
    v_mfma_f32_16x16x32_bf16 v[180:183], a[132:135], a[160:163], v[180:183]
    ds_read_b64_tr_b16 a[200:201], v39 offset:26624
    buffer_load_dwordx4 v27, s[40:43], s88 offen offset:2048 lds
    buffer_load_dwordx4 v28, s[40:43], s88 offen offset:3072 lds
    v_mfma_f32_16x16x32_bf16 v[184:187], a[128:131], a[164:167], v[184:187]
    ds_read_b64_tr_b16 a[202:203], v39 offset:26880
    s_add_u32 m0, s98, 77824
    s_nop 0
    buffer_load_dwordx4 v29, s[40:43], s88 offen offset:0 lds
    v_mfma_f32_16x16x32_bf16 v[188:191], a[132:135], a[164:167], v[188:191]
    ds_read_b64_tr_b16 a[204:205], v42 offset:26624
    s_lshl_b32 s3, s77, 2
    v_mfma_f32_16x16x32_bf16 v[192:195], a[128:131], a[168:171], v[192:195]
    ds_read_b64_tr_b16 a[206:207], v42 offset:26880
    s_add_u32 s3, s3, s76
    v_mfma_f32_16x16x32_bf16 v[196:199], a[132:135], a[168:171], v[196:199]
    ds_read_b64_tr_b16 a[208:209], v39 offset:27648
    s_mul_i32 s3, s3, 163840
    s_waitcnt lgkmcnt(15)
    v_mfma_f32_16x16x32_bf16 v[200:203], a[128:131], a[172:175], v[200:203]
    ds_read_b64_tr_b16 a[210:211], v39 offset:27904
    ds_read_b64_tr_b16 a[212:213], v42 offset:27648
    v_add_u32 v16, s3, v45
    v_mfma_f32_16x16x32_bf16 v[204:207], a[132:135], a[172:175], v[204:207]
    ds_read_b64_tr_b16 a[214:215], v42 offset:27904
    v_bfe_u32 v7, v0, 5, 1
    v_mfma_f32_16x16x32_bf16 v[208:211], a[128:131], a[176:179], v[208:211]
    ds_read_b64_tr_b16 a[216:217], v39 offset:28672
    v_mul_u32_u24 v7, 2560, v7
    v_mfma_f32_16x16x32_bf16 v[212:215], a[132:135], a[176:179], v[212:215]
    ds_read_b64_tr_b16 a[218:219], v39 offset:28928
    v_add3_u32 v17, v7, v16, 0
    v_mfma_f32_16x16x32_bf16 v[216:219], a[128:131], a[180:183], v[216:219]
    ds_read_b64_tr_b16 a[220:221], v42 offset:28672
    v_add_u32 v17, 2048, v17
    v_add_u32 v18, 5632, v16
    v_mfma_f32_16x16x32_bf16 v[220:223], a[132:135], a[180:183], v[220:223]
    ds_read_b64_tr_b16 a[222:223], v42 offset:28928
    v_add_u32 v19, 10240, v16
    s_waitcnt lgkmcnt(14)
    v_mfma_f32_16x16x32_bf16 v[224:227], a[128:131], a[184:187], v[224:227]
    ds_read_b64_tr_b16 a[224:225], v39 offset:29696
    ds_read_b64_tr_b16 a[226:227], v39 offset:29952
    v_add_u32 v20, 10240, v17
    v_mfma_f32_16x16x32_bf16 v[228:231], a[132:135], a[184:187], v[228:231]
    ds_read_b64_tr_b16 a[228:229], v42 offset:29696
    v_add_u32 v21, 15872, v16
    v_mfma_f32_16x16x32_bf16 v[232:235], a[128:131], a[188:191], v[232:235]
    ds_read_b64_tr_b16 a[230:231], v42 offset:29952
    s_lshr_b32 s35, s78, 1
    v_mfma_f32_16x16x32_bf16 v[236:239], a[132:135], a[188:191], v[236:239]
    ds_read_b64_tr_b16 a[232:233], v39 offset:30720
    s_mul_i32 s67, s35, 20480
    v_mfma_f32_16x16x32_bf16 v[240:243], a[128:131], a[192:195], v[240:243]
    ds_read_b64_tr_b16 a[234:235], v39 offset:30976
    v_add_u32 v7, 1024, v16
    v_mfma_f32_16x16x32_bf16 v[244:247], a[132:135], a[192:195], v[244:247]
    ds_read_b64_tr_b16 a[236:237], v42 offset:30720
    v_add_u32 v8, 1024, v18
    v_mfma_f32_16x16x32_bf16 v[248:251], a[128:131], a[196:199], v[248:251]
    ds_read_b64_tr_b16 a[238:239], v42 offset:30976
    v_add_u32 v9, 1024, v19
    v_mfma_f32_16x16x32_bf16 v[252:255], a[132:135], a[196:199], v[252:255]
    s_and_b32 s35, s78, 1
    s_cselect_b64 vcc, -1, 0
    v_cndmask_b32 v22, v16, v8, vcc
    v_cndmask_b32 v23, v7, v19, vcc
    v_cndmask_b32 v24, v17, v9, vcc
    v_cndmask_b32 v36, v18, v20, vcc
    s_waitcnt vmcnt(6)
    s_barrier
    s_waitcnt lgkmcnt(14)
    v_mfma_f32_16x16x32_bf16 v[176:179], a[136:139], a[200:203], v[176:179]
    ds_read_b128 a[144:147], v98 offset:36864
    ds_read_b128 a[148:151], v98 offset:38912
    v_mfma_f32_16x16x32_bf16 v[180:183], a[140:143], a[200:203], v[180:183]
    ds_read_b64_tr_b16 a[160:161], v39 offset:53248
    v_lshlrev_b32 v7, 3, v1
    v_sub_u32 v38, v21, v7
    v_mfma_f32_16x16x32_bf16 v[184:187], a[136:139], a[204:207], v[184:187]
    ds_read_b64_tr_b16 a[162:163], v39 offset:53504
    s_lshl_b32 s35, s35, 10
    v_mfma_f32_16x16x32_bf16 v[188:191], a[140:143], a[204:207], v[188:191]
    ds_read_b64_tr_b16 a[164:165], v42 offset:53248
    v_add_u32 v37, s35, v38
    v_mfma_f32_16x16x32_bf16 v[192:195], a[136:139], a[208:211], v[192:195]
    ds_read_b64_tr_b16 a[166:167], v42 offset:53504
    s_lshr_b32 s35, s35, 7
    v_mfma_f32_16x16x32_bf16 v[196:199], a[140:143], a[208:211], v[196:199]
    ds_read_b64_tr_b16 a[168:169], v39 offset:54272
    v_add_u32 v7, 32, v1
    s_waitcnt lgkmcnt(15)
    v_mfma_f32_16x16x32_bf16 v[200:203], a[136:139], a[212:215], v[200:203]
    ds_read_b64_tr_b16 a[170:171], v39 offset:54528
    ds_read_b64_tr_b16 a[172:173], v42 offset:54272
    v_add_u32 v7, s35, v7
    v_mfma_f32_16x16x32_bf16 v[204:207], a[140:143], a[212:215], v[204:207]
    ds_read_b64_tr_b16 a[174:175], v42 offset:54528
    s_lshl_b32 s35, s35, 2
    v_mfma_f32_16x16x32_bf16 v[208:211], a[136:139], a[216:219], v[208:211]
    ds_read_b64_tr_b16 a[176:177], v39 offset:55296
    v_add_u32 v8, s35, v1
    v_mfma_f32_16x16x32_bf16 v[212:215], a[140:143], a[216:219], v[212:215]
    ds_read_b64_tr_b16 a[178:179], v39 offset:55552
    v_cmp_gt_u32 vcc, 32, v1
    s_nop 1
    v_cndmask_b32 v7, v7, v8, vcc
    v_mfma_f32_16x16x32_bf16 v[216:219], a[136:139], a[220:223], v[216:219]
    ds_read_b64_tr_b16 a[180:181], v42 offset:55296
    v_mul_u32_u24 v8, 205, v7
    v_lshrrev_b32 v8, 12, v8
    v_mfma_f32_16x16x32_bf16 v[220:223], a[140:143], a[220:223], v[220:223]
    ds_read_b64_tr_b16 a[182:183], v42 offset:55552
    v_mul_u32_u24 v8, 2560, v8
    s_waitcnt lgkmcnt(14)
    v_mfma_f32_16x16x32_bf16 v[224:227], a[136:139], a[224:227], v[224:227]
    ds_read_b64_tr_b16 a[184:185], v39 offset:56320
    ds_read_b64_tr_b16 a[186:187], v39 offset:56576
    v_lshl_add_u32 v7, v7, 7, v8
    v_mfma_f32_16x16x32_bf16 v[228:231], a[140:143], a[224:227], v[228:231]
    ds_read_b64_tr_b16 a[188:189], v42 offset:56320
    s_add_u32 s3, s3, s67
    v_mfma_f32_16x16x32_bf16 v[232:235], a[136:139], a[228:231], v[232:235]
    ds_read_b64_tr_b16 a[190:191], v42 offset:56576
    v_add_u32 v7, s3, v7
    v_mfma_f32_16x16x32_bf16 v[236:239], a[140:143], a[228:231], v[236:239]
    ds_read_b64_tr_b16 a[192:193], v39 offset:57344
    v_mov_b32 v8, 2147483648
    v_mfma_f32_16x16x32_bf16 v[240:243], a[136:139], a[232:235], v[240:243]
    ds_read_b64_tr_b16 a[194:195], v39 offset:57600
    v_cmp_gt_u32 vcc, 40, v1
    s_nop 1
    v_cndmask_b32 v55, v8, v7, vcc
    v_mfma_f32_16x16x32_bf16 v[244:247], a[140:143], a[232:235], v[244:247]
    ds_read_b64_tr_b16 a[196:197], v42 offset:57344
    s_add_u32 m0, s98, 94208
    s_nop 0
    buffer_load_dwordx4 v25, s[40:43], s89 offen offset:0 lds
    v_mfma_f32_16x16x32_bf16 v[248:251], a[136:139], a[236:239], v[248:251]
    ds_read_b64_tr_b16 a[198:199], v42 offset:57600
    buffer_load_dwordx4 v26, s[40:43], s89 offen offset:1024 lds
    v_mfma_f32_16x16x32_bf16 v[252:255], a[140:143], a[236:239], v[252:255]
    buffer_load_dwordx4 v27, s[40:43], s89 offen offset:2048 lds
    s_waitcnt lgkmcnt(14)
    v_mfma_f32_16x16x32_bf16 v[176:179], a[144:147], a[160:163], v[176:179]
    ds_read_b128 a[152:155], v101 offset:36864
    ds_read_b128 a[156:159], v101 offset:38912
    v_mfma_f32_16x16x32_bf16 v[180:183], a[148:151], a[160:163], v[180:183]
    ds_read_b64_tr_b16 a[200:201], v39 offset:63488
    buffer_load_dwordx4 v28, s[40:43], s89 offen offset:3072 lds
    v_mfma_f32_16x16x32_bf16 v[184:187], a[144:147], a[164:167], v[184:187]
    ds_read_b64_tr_b16 a[202:203], v39 offset:63744
    v_mfma_f32_16x16x32_bf16 v[188:191], a[148:151], a[164:167], v[188:191]
    ds_read_b64_tr_b16 a[204:205], v42 offset:63488
    v_mfma_f32_16x16x32_bf16 v[192:195], a[144:147], a[168:171], v[192:195]
    ds_read_b64_tr_b16 a[206:207], v42 offset:63744
    v_mfma_f32_16x16x32_bf16 v[196:199], a[148:151], a[168:171], v[196:199]
    ds_read_b64_tr_b16 a[208:209], v39 offset:64512
    s_add_u32 m0, s98, 98304
    s_nop 0
    buffer_load_dwordx4 v29, s[40:43], s89 offen offset:0 lds
    s_waitcnt lgkmcnt(15)
    v_mfma_f32_16x16x32_bf16 v[200:203], a[144:147], a[172:175], v[200:203]
    ds_read_b64_tr_b16 a[210:211], v39 offset:64768
    ds_read_b64_tr_b16 a[212:213], v42 offset:64512
    v_mfma_f32_16x16x32_bf16 v[204:207], a[148:151], a[172:175], v[204:207]
    ds_read_b64_tr_b16 a[214:215], v42 offset:64768
    v_mfma_f32_16x16x32_bf16 v[208:211], a[144:147], a[176:179], v[208:211]
    ds_read_b64_tr_b16 a[216:217], v40 offset:0
    v_mfma_f32_16x16x32_bf16 v[212:215], a[148:151], a[176:179], v[212:215]
    ds_read_b64_tr_b16 a[218:219], v40 offset:256
    v_mfma_f32_16x16x32_bf16 v[216:219], a[144:147], a[180:183], v[216:219]
    ds_read_b64_tr_b16 a[220:221], v43 offset:0
    s_add_u32 m0, s98, 114688
    s_nop 0
    buffer_load_dwordx4 v25, s[40:43], s90 offen offset:0 lds
    v_mfma_f32_16x16x32_bf16 v[220:223], a[148:151], a[180:183], v[220:223]
    ds_read_b64_tr_b16 a[222:223], v43 offset:256
    s_waitcnt lgkmcnt(14)
    v_mfma_f32_16x16x32_bf16 v[224:227], a[144:147], a[184:187], v[224:227]
    ds_read_b64_tr_b16 a[224:225], v40 offset:1024
    ds_read_b64_tr_b16 a[226:227], v40 offset:1280
    v_mfma_f32_16x16x32_bf16 v[228:231], a[148:151], a[184:187], v[228:231]
    ds_read_b64_tr_b16 a[228:229], v43 offset:1024
    v_mfma_f32_16x16x32_bf16 v[232:235], a[144:147], a[188:191], v[232:235]
    ds_read_b64_tr_b16 a[230:231], v43 offset:1280
    v_mfma_f32_16x16x32_bf16 v[236:239], a[148:151], a[188:191], v[236:239]
    ds_read_b64_tr_b16 a[232:233], v40 offset:2048
    buffer_load_dwordx4 v26, s[40:43], s90 offen offset:1024 lds
    v_mfma_f32_16x16x32_bf16 v[240:243], a[144:147], a[192:195], v[240:243]
    ds_read_b64_tr_b16 a[234:235], v40 offset:2304
    v_mfma_f32_16x16x32_bf16 v[244:247], a[148:151], a[192:195], v[244:247]
    ds_read_b64_tr_b16 a[236:237], v43 offset:2048
    v_mfma_f32_16x16x32_bf16 v[248:251], a[144:147], a[196:199], v[248:251]
    ds_read_b64_tr_b16 a[238:239], v43 offset:2304
    v_mfma_f32_16x16x32_bf16 v[252:255], a[148:151], a[196:199], v[252:255]
    s_waitcnt lgkmcnt(0)
    s_barrier
    v_mfma_f32_16x16x32_bf16 v[176:179], a[152:155], a[200:203], v[176:179]
    v_mfma_f32_16x16x32_bf16 v[180:183], a[156:159], a[200:203], v[180:183]
    buffer_load_dwordx4 v27, s[40:43], s90 offen offset:2048 lds
    v_mfma_f32_16x16x32_bf16 v[184:187], a[152:155], a[204:207], v[184:187]
    v_mfma_f32_16x16x32_bf16 v[188:191], a[156:159], a[204:207], v[188:191]
    buffer_load_dwordx4 v28, s[40:43], s90 offen offset:3072 lds
    v_mfma_f32_16x16x32_bf16 v[192:195], a[152:155], a[208:211], v[192:195]
    v_mfma_f32_16x16x32_bf16 v[196:199], a[156:159], a[208:211], v[196:199]
    s_add_u32 m0, s98, 118784
    s_nop 0
    buffer_load_dwordx4 v29, s[40:43], s90 offen offset:0 lds
    v_mfma_f32_16x16x32_bf16 v[200:203], a[152:155], a[212:215], v[200:203]
    v_mfma_f32_16x16x32_bf16 v[204:207], a[156:159], a[212:215], v[204:207]
    s_add_u32 m0, s98, 135168
    s_nop 0
    buffer_load_dwordx4 v25, s[40:43], s91 offen offset:0 lds
    v_mfma_f32_16x16x32_bf16 v[208:211], a[152:155], a[216:219], v[208:211]
    v_mfma_f32_16x16x32_bf16 v[212:215], a[156:159], a[216:219], v[212:215]
    v_mov_b32 v12, v54
    v_mov_b32 v13, v54
    v_mov_b32 v14, v54
    v_mov_b32 v15, v54
    ds_write_b128 v35, v[12:15] offset:10240
    v_mfma_f32_16x16x32_bf16 v[216:219], a[152:155], a[220:223], v[216:219]
    v_pk_fma_f32 v[2:3], v[176:177], v[52:53], v[52:53] op_sel:[0,0,1] op_sel_hi:[1,0,1]
    v_pk_fma_f32 v[4:5], v[178:179], v[52:53], v[52:53] op_sel:[0,0,1] op_sel_hi:[1,0,1]
    buffer_load_dwordx4 v26, s[40:43], s91 offen offset:1024 lds
    v_mfma_f32_16x16x32_bf16 v[220:223], a[156:159], a[220:223], v[220:223]
    v_pk_fma_f32 v[6:7], v[180:181], v[52:53], v[52:53] op_sel:[0,0,1] op_sel_hi:[1,0,1]
    v_pk_fma_f32 v[8:9], v[182:183], v[52:53], v[52:53] op_sel:[0,0,1] op_sel_hi:[1,0,1]
    v_mfma_f32_16x16x32_bf16 v[224:227], a[152:155], a[224:227], v[224:227]
    v_exp_f32 v2, v2 clamp
    v_max_f32 v176, v48, v176
    v_mfma_f32_16x16x32_bf16 v[228:231], a[156:159], a[224:227], v[228:231]
    buffer_load_dwordx4 v27, s[40:43], s91 offen offset:2048 lds
    v_exp_f32 v3, v3 clamp
    v_max_f32 v177, v48, v177
    v_mfma_f32_16x16x32_bf16 v[232:235], a[152:155], a[228:231], v[232:235]
    v_exp_f32 v4, v4 clamp
    v_max_f32 v178, v48, v178
    v_mfma_f32_16x16x32_bf16 v[236:239], a[156:159], a[228:231], v[236:239]
    v_exp_f32 v5, v5 clamp
    v_max_f32 v179, v48, v179
    buffer_load_dwordx4 v28, s[40:43], s91 offen offset:3072 lds
    v_mfma_f32_16x16x32_bf16 v[240:243], a[152:155], a[232:235], v[240:243]
    v_exp_f32 v6, v6 clamp
    v_max_f32 v180, v48, v180
    v_mfma_f32_16x16x32_bf16 v[244:247], a[156:159], a[232:235], v[244:247]
    v_exp_f32 v7, v7 clamp
    v_max_f32 v181, v48, v181
    v_mfma_f32_16x16x32_bf16 v[248:251], a[152:155], a[236:239], v[248:251]
    v_exp_f32 v8, v8 clamp
    s_add_u32 m0, s98, 139264
    s_nop 0
    buffer_load_dwordx4 v29, s[40:43], s91 offen offset:0 lds
    v_max_f32 v182, v48, v182
    v_mfma_f32_16x16x32_bf16 v[252:255], a[156:159], a[236:239], v[252:255]
    v_exp_f32 v9, v9 clamp
    v_max_f32 v183, v48, v183
    v_pk_add_f32 v[176:177], v[176:177], v[2:3]
    v_pk_add_f32 v[178:179], v[178:179], v[4:5]
    v_pk_add_f32 v[180:181], v[180:181], v[6:7]
    s_add_u32 m0, s98, 49152
    s_nop 0
    buffer_load_dwordx4 v25, s[40:43], s92 offen offset:0 lds
    v_pk_add_f32 v[182:183], v[182:183], v[8:9]
    v_cvt_pk_bf16_f32 v108, v176, v177
    v_cvt_pk_bf16_f32 v109, v178, v179
    v_cvt_pk_bf16_f32 v110, v180, v181
    v_cvt_pk_bf16_f32 v111, v182, v183
    ds_write_b128 v60, v[108:111] offset:0
    v_pk_fma_f32 v[2:3], v[184:185], v[52:53], v[52:53] op_sel:[0,0,1] op_sel_hi:[1,0,1]
    v_pk_fma_f32 v[4:5], v[186:187], v[52:53], v[52:53] op_sel:[0,0,1] op_sel_hi:[1,0,1]
    buffer_load_dwordx4 v26, s[40:43], s92 offen offset:1024 lds
    v_pk_fma_f32 v[6:7], v[188:189], v[52:53], v[52:53] op_sel:[0,0,1] op_sel_hi:[1,0,1]
    v_pk_fma_f32 v[8:9], v[190:191], v[52:53], v[52:53] op_sel:[0,0,1] op_sel_hi:[1,0,1]
    v_exp_f32 v2, v2 clamp
    v_max_f32 v184, v48, v184
    v_exp_f32 v3, v3 clamp
    v_max_f32 v185, v48, v185
    v_exp_f32 v4, v4 clamp
    v_max_f32 v186, v48, v186
    buffer_load_dwordx4 v27, s[40:43], s92 offen offset:2048 lds
    v_exp_f32 v5, v5 clamp
    v_max_f32 v187, v48, v187
    v_exp_f32 v6, v6 clamp
    v_max_f32 v188, v48, v188
    v_exp_f32 v7, v7 clamp
    v_max_f32 v189, v48, v189
    v_exp_f32 v8, v8 clamp
    buffer_load_dwordx4 v28, s[40:43], s92 offen offset:3072 lds
    v_max_f32 v190, v48, v190
    v_exp_f32 v9, v9 clamp
    v_max_f32 v191, v48, v191
    v_pk_add_f32 v[184:185], v[184:185], v[2:3]
    v_pk_add_f32 v[186:187], v[186:187], v[4:5]
    v_pk_add_f32 v[188:189], v[188:189], v[6:7]
    v_pk_add_f32 v[190:191], v[190:191], v[8:9]
    v_cvt_pk_bf16_f32 v112, v184, v185
    s_add_u32 m0, s98, 53248
    s_nop 0
    buffer_load_dwordx4 v29, s[40:43], s92 offen offset:0 lds
    v_cvt_pk_bf16_f32 v113, v186, v187
    v_cvt_pk_bf16_f32 v114, v188, v189
    v_cvt_pk_bf16_f32 v115, v190, v191
    ds_write_b128 v60, v[112:115] offset:1024
    v_cvt_pk_bf16_f32 v128, v216, v217
    v_cvt_pk_bf16_f32 v129, v218, v219
    v_cvt_pk_bf16_f32 v130, v220, v221
    v_cvt_pk_bf16_f32 v131, v222, v223
    ds_write_b128 v60, v[128:131] offset:5120
    v_pk_fma_f32 v[2:3], v[192:193], v[52:53], v[52:53] op_sel:[0,0,1] op_sel_hi:[1,0,1]
    v_pk_fma_f32 v[4:5], v[194:195], v[52:53], v[52:53] op_sel:[0,0,1] op_sel_hi:[1,0,1]
    v_pk_fma_f32 v[6:7], v[196:197], v[52:53], v[52:53] op_sel:[0,0,1] op_sel_hi:[1,0,1]
    v_pk_fma_f32 v[8:9], v[198:199], v[52:53], v[52:53] op_sel:[0,0,1] op_sel_hi:[1,0,1]
    v_exp_f32 v2, v2 clamp
    v_max_f32 v192, v48, v192
    v_exp_f32 v3, v3 clamp
    v_max_f32 v193, v48, v193
    buffer_load_dword v69, v69, s[48:51], 0 offen
    v_exp_f32 v4, v4 clamp
    buffer_load_dword v55, v55, s[52:55], 0 offen
    v_max_f32 v194, v48, v194
    v_exp_f32 v5, v5 clamp
    s_mov_b32 s3, 393216
    buffer_load_dword v97, v77, s[48:51], s3 offen
    v_max_f32 v195, v48, v195
    v_exp_f32 v6, v6 clamp
    v_max_f32 v196, v48, v196
    v_exp_f32 v7, v7 clamp
    v_max_f32 v197, v48, v197
    v_exp_f32 v8, v8 clamp
    v_max_f32 v198, v48, v198
    v_exp_f32 v9, v9 clamp
    v_max_f32 v199, v48, v199
    v_pk_add_f32 v[192:193], v[192:193], v[2:3]
    v_pk_add_f32 v[194:195], v[194:195], v[4:5]
    v_pk_add_f32 v[196:197], v[196:197], v[6:7]
    v_pk_add_f32 v[198:199], v[198:199], v[8:9]
    v_cvt_pk_bf16_f32 v116, v192, v193
    v_cvt_pk_bf16_f32 v117, v194, v195
    v_cvt_pk_bf16_f32 v118, v196, v197
    v_cvt_pk_bf16_f32 v119, v198, v199
    ds_write_b128 v60, v[116:119] offset:2048
    v_cvt_pk_bf16_f32 v132, v224, v225
    v_cvt_pk_bf16_f32 v133, v226, v227
    v_cvt_pk_bf16_f32 v134, v228, v229
    v_cvt_pk_bf16_f32 v135, v230, v231
    ds_write_b128 v60, v[132:135] offset:6144
    v_pk_fma_f32 v[2:3], v[200:201], v[52:53], v[52:53] op_sel:[0,0,1] op_sel_hi:[1,0,1]
    v_pk_fma_f32 v[4:5], v[202:203], v[52:53], v[52:53] op_sel:[0,0,1] op_sel_hi:[1,0,1]
    v_pk_fma_f32 v[6:7], v[204:205], v[52:53], v[52:53] op_sel:[0,0,1] op_sel_hi:[1,0,1]
    v_pk_fma_f32 v[8:9], v[206:207], v[52:53], v[52:53] op_sel:[0,0,1] op_sel_hi:[1,0,1]
    v_exp_f32 v2, v2 clamp
    v_max_f32 v200, v48, v200
    v_exp_f32 v3, v3 clamp
    v_max_f32 v201, v48, v201
    v_exp_f32 v4, v4 clamp
    v_max_f32 v202, v48, v202
    v_exp_f32 v5, v5 clamp
    v_max_f32 v203, v48, v203
    v_exp_f32 v6, v6 clamp
    v_max_f32 v204, v48, v204
    v_exp_f32 v7, v7 clamp
    v_max_f32 v205, v48, v205
    v_exp_f32 v8, v8 clamp
    v_max_f32 v206, v48, v206
    v_exp_f32 v9, v9 clamp
    v_max_f32 v207, v48, v207
    v_pk_add_f32 v[200:201], v[200:201], v[2:3]
    v_pk_add_f32 v[202:203], v[202:203], v[4:5]
    v_pk_add_f32 v[204:205], v[204:205], v[6:7]
    v_pk_add_f32 v[206:207], v[206:207], v[8:9]
    v_cvt_pk_bf16_f32 v120, v200, v201
    v_cvt_pk_bf16_f32 v121, v202, v203
    v_cvt_pk_bf16_f32 v122, v204, v205
    v_cvt_pk_bf16_f32 v123, v206, v207
    ds_write_b128 v60, v[120:123] offset:3072
    v_cvt_pk_bf16_f32 v136, v232, v233
    v_cvt_pk_bf16_f32 v137, v234, v235
    v_cvt_pk_bf16_f32 v138, v236, v237
    v_cvt_pk_bf16_f32 v139, v238, v239
    ds_write_b128 v60, v[136:139] offset:7168
    v_pk_fma_f32 v[2:3], v[208:209], v[52:53], v[52:53] op_sel:[0,0,1] op_sel_hi:[1,0,1]
    v_pk_fma_f32 v[4:5], v[210:211], v[52:53], v[52:53] op_sel:[0,0,1] op_sel_hi:[1,0,1]
    v_pk_fma_f32 v[6:7], v[212:213], v[52:53], v[52:53] op_sel:[0,0,1] op_sel_hi:[1,0,1]
    v_pk_fma_f32 v[8:9], v[214:215], v[52:53], v[52:53] op_sel:[0,0,1] op_sel_hi:[1,0,1]
    v_exp_f32 v2, v2 clamp
    v_max_f32 v208, v48, v208
    v_exp_f32 v3, v3 clamp
    v_max_f32 v209, v48, v209
    v_exp_f32 v4, v4 clamp
    v_max_f32 v210, v48, v210
    v_exp_f32 v5, v5 clamp
    v_max_f32 v211, v48, v211
    v_exp_f32 v6, v6 clamp
    v_max_f32 v212, v48, v212
    v_exp_f32 v7, v7 clamp
    v_max_f32 v213, v48, v213
    v_exp_f32 v8, v8 clamp
    v_max_f32 v214, v48, v214
    v_exp_f32 v9, v9 clamp
    v_max_f32 v215, v48, v215
    v_pk_add_f32 v[208:209], v[208:209], v[2:3]
    v_pk_add_f32 v[210:211], v[210:211], v[4:5]
    v_pk_add_f32 v[212:213], v[212:213], v[6:7]
    v_pk_add_f32 v[214:215], v[214:215], v[8:9]
    v_cvt_pk_bf16_f32 v124, v208, v209
    v_cvt_pk_bf16_f32 v125, v210, v211
    v_cvt_pk_bf16_f32 v126, v212, v213
    v_cvt_pk_bf16_f32 v127, v214, v215
    ds_write_b128 v60, v[124:127] offset:4096
    v_cvt_pk_bf16_f32 v140, v240, v241
    v_cvt_pk_bf16_f32 v141, v242, v243
    v_cvt_pk_bf16_f32 v142, v244, v245
    v_cvt_pk_bf16_f32 v143, v246, v247
    ds_write_b128 v60, v[140:143] offset:8192
    v_cvt_pk_bf16_f32 v144, v248, v249
    v_cvt_pk_bf16_f32 v145, v250, v251
    v_cvt_pk_bf16_f32 v146, v252, v253
    v_cvt_pk_bf16_f32 v147, v254, v255
    ds_write_b128 v60, v[144:147] offset:9216
    s_waitcnt vmcnt(23) lgkmcnt(0)
    s_barrier
    v_mov_b32 v159, s79
    v_mov_b32 v163, s79
    v_mov_b32 v171, s79
    s_and_b32 s81, s76, 1
    s_cmp_eq_u32 s81, 0
    s_cselect_b64 s[68:69], -1, 0
    ds_read_b128 a[160:163], v61 offset:0
    ds_read_b128 a[164:167], v64 offset:0
    ds_read_b128 a[168:171], v62 offset:0
    ds_read_b128 a[172:175], v65 offset:0
    ds_read_b128 a[176:179], v63 offset:0
    ds_read_b128 a[180:183], v66 offset:0
    ds_read_b128 a[184:187], v61 offset:10496
    ds_read_b128 a[188:191], v64 offset:10496
    ds_read_b128 a[192:195], v62 offset:10496
    ds_read_b128 a[196:199], v65 offset:10496
    ds_read_b128 a[200:203], v63 offset:10496
    ds_read_b128 a[204:207], v66 offset:10496
    ds_read_b128 a[208:211], v61 offset:20992
    ds_read_b128 a[212:215], v64 offset:20992
    ds_read_b128 a[216:219], v62 offset:20992
    ds_read_b128 a[220:223], v65 offset:20992
    ds_read_b128 a[224:227], v63 offset:20992
    ds_read_b128 a[228:231], v66 offset:20992
    s_waitcnt lgkmcnt(15)
    v_mfma_f32_16x16x32_bf16 v[144:147], a[160:163], a[164:167], 0
    s_waitcnt lgkmcnt(15)
    v_mfma_f32_16x16x32_bf16 v[148:151], a[168:171], a[164:167], 0
    s_waitcnt lgkmcnt(14)
    v_mfma_f32_16x16x32_bf16 v[152:155], a[160:163], a[172:175], 0
    s_waitcnt lgkmcnt(12)
    v_mfma_f32_16x16x32_bf16 v[152:155], a[176:179], a[180:183], v[152:155]
    ds_read_b128 a[232:235], v61 offset:31488
    ds_read_b128 a[236:239], v64 offset:31488
    ds_read_b128 a[240:243], v62 offset:31488
    ds_read_b128 a[244:247], v65 offset:31488
    ds_read_b128 a[248:251], v63 offset:31488
    ds_read_b128 a[252:255], v66 offset:31488
    s_waitcnt lgkmcnt(15)
    v_mfma_f32_16x16x32_bf16 v[144:147], a[184:187], a[188:191], v[144:147]
    s_waitcnt lgkmcnt(15)
    v_mfma_f32_16x16x32_bf16 v[148:151], a[192:195], a[188:191], v[148:151]
    s_waitcnt lgkmcnt(14)
    v_mfma_f32_16x16x32_bf16 v[152:155], a[184:187], a[196:199], v[152:155]
    s_waitcnt lgkmcnt(12)
    v_mfma_f32_16x16x32_bf16 v[152:155], a[200:203], a[204:207], v[152:155]
    s_waitcnt lgkmcnt(10)
    v_mfma_f32_16x16x32_bf16 v[144:147], a[208:211], a[212:215], v[144:147]
    s_waitcnt lgkmcnt(9)
    v_mfma_f32_16x16x32_bf16 v[148:151], a[216:219], a[212:215], v[148:151]
    s_waitcnt lgkmcnt(8)
    v_mfma_f32_16x16x32_bf16 v[152:155], a[208:211], a[220:223], v[152:155]
    s_waitcnt lgkmcnt(6)
    v_mfma_f32_16x16x32_bf16 v[152:155], a[224:227], a[228:231], v[152:155]
    s_waitcnt lgkmcnt(4)
    v_mfma_f32_16x16x32_bf16 v[144:147], a[232:235], a[236:239], v[144:147]
    s_waitcnt lgkmcnt(3)
    v_mfma_f32_16x16x32_bf16 v[148:151], a[240:243], a[236:239], v[148:151]
    s_waitcnt lgkmcnt(2)
    v_mfma_f32_16x16x32_bf16 v[152:155], a[232:235], a[244:247], v[152:155]
    s_waitcnt lgkmcnt(0)
    v_mfma_f32_16x16x32_bf16 v[152:155], a[248:251], a[252:255], v[152:155]
    ds_read_b64_tr_b16 a[208:209], v40 offset:8192
    ds_read_b64_tr_b16 a[210:211], v40 offset:8448
    ds_read_b64_tr_b16 a[212:213], v43 offset:8192
    ds_read_b64_tr_b16 a[214:215], v43 offset:8448
    ds_read_b64_tr_b16 a[216:217], v40 offset:9216
    ds_read_b64_tr_b16 a[218:219], v40 offset:9472
    ds_read_b64_tr_b16 a[220:221], v43 offset:9216
    ds_read_b64_tr_b16 a[222:223], v43 offset:9472
    ds_read_b64_tr_b16 a[224:225], v40 offset:10240
    ds_read_b64_tr_b16 a[226:227], v40 offset:10496
    v_cvt_pk_bf16_f32 v156, v144, v145
    v_cvt_pk_bf16_f32 v157, v146, v147
    v_cvt_pk_bf16_f32 v160, v148, v149
    v_cvt_pk_bf16_f32 v161, v150, v151
    v_cvt_pk_bf16_f32 v164, v152, v153
    v_cvt_pk_bf16_f32 v165, v154, v155
    v_cndmask_b32_e64 v158, v165, v164, s[68:69]
    v_cndmask_b32_e64 v162, v164, v165, s[68:69]
    buffer_store_dwordx4 v[156:159], v67, s[48:51], 0 offen sc1
    buffer_store_dwordx4 v[160:163], v68, s[48:51], 0 offen sc1
    v_and_b32 v79, s79, v79
    s_mov_b32 s72, s48
    s_mov_b32 s73, s49
    s_mov_b32 s74, 0x10000000
    s_mov_b32 s75, 0x20000
    s_mov_b32 s68, s48
    s_mov_b32 s69, s49
    s_mov_b32 s70, 0
    s_mov_b32 s71, 0x20000
    s_waitcnt lgkmcnt(0)
    v_mfma_f32_16x16x32_bf16 v[176:179], a[208:211], a[0:3], v[48:51]
    ds_read_b64_tr_b16 a[228:229], v40 offset:18432
    ds_read_b64_tr_b16 a[230:231], v40 offset:18688
    v_mfma_f32_16x16x32_bf16 v[180:183], a[208:211], a[4:7], v[48:51]
    ds_read_b64_tr_b16 a[232:233], v43 offset:18432
    ds_read_b64_tr_b16 a[234:235], v43 offset:18688
    v_mfma_f32_16x16x32_bf16 v[184:187], a[212:215], a[0:3], v[48:51]
    ds_read_b64_tr_b16 a[236:237], v40 offset:19456
    ds_read_b64_tr_b16 a[238:239], v40 offset:19712
    v_mfma_f32_16x16x32_bf16 v[188:191], a[212:215], a[4:7], v[48:51]
    ds_read_b64_tr_b16 a[240:241], v43 offset:19456
    ds_read_b64_tr_b16 a[242:243], v43 offset:19712
    v_mfma_f32_16x16x32_bf16 v[192:195], a[216:219], a[0:3], v[48:51]
    ds_read_b64_tr_b16 a[244:245], v40 offset:20480
    ds_read_b64_tr_b16 a[246:247], v40 offset:20736
    v_mfma_f32_16x16x32_bf16 v[196:199], a[216:219], a[4:7], v[48:51]
    v_mfma_f32_16x16x32_bf16 v[200:203], a[220:223], a[0:3], v[48:51]
    v_mfma_f32_16x16x32_bf16 v[204:207], a[220:223], a[4:7], v[48:51]
    v_mfma_f32_16x16x32_bf16 v[208:211], a[224:227], a[0:3], v[48:51]
    v_mfma_f32_16x16x32_bf16 v[212:215], a[224:227], a[4:7], v[48:51]
    s_waitcnt lgkmcnt(0)
    v_mfma_f32_16x16x32_bf16 v[176:179], a[228:231], a[8:11], v[176:179]
    ds_read_b64_tr_b16 a[208:209], v43 offset:10240
    ds_read_b64_tr_b16 a[210:211], v43 offset:10496
    v_mfma_f32_16x16x32_bf16 v[180:183], a[228:231], a[12:15], v[180:183]
    ds_read_b64_tr_b16 a[212:213], v40 offset:11264
    ds_read_b64_tr_b16 a[214:215], v40 offset:11520
    v_mfma_f32_16x16x32_bf16 v[184:187], a[232:235], a[8:11], v[184:187]
    ds_read_b64_tr_b16 a[216:217], v43 offset:11264
    ds_read_b64_tr_b16 a[218:219], v43 offset:11520
    v_mfma_f32_16x16x32_bf16 v[188:191], a[232:235], a[12:15], v[188:191]
    ds_read_b64_tr_b16 a[220:221], v40 offset:12288
    ds_read_b64_tr_b16 a[222:223], v40 offset:12544
    v_mfma_f32_16x16x32_bf16 v[192:195], a[236:239], a[8:11], v[192:195]
    ds_read_b64_tr_b16 a[224:225], v43 offset:12288
    ds_read_b64_tr_b16 a[226:227], v43 offset:12544
    v_mfma_f32_16x16x32_bf16 v[196:199], a[236:239], a[12:15], v[196:199]
    buffer_load_dwordx2 v[12:13], v105, s[48:51], 0 offen sc1
    v_mfma_f32_16x16x32_bf16 v[200:203], a[240:243], a[8:11], v[200:203]
    v_mfma_f32_16x16x32_bf16 v[204:207], a[240:243], a[12:15], v[204:207]
    v_mfma_f32_16x16x32_bf16 v[208:211], a[244:247], a[8:11], v[208:211]
    v_mfma_f32_16x16x32_bf16 v[212:215], a[244:247], a[12:15], v[212:215]
    s_waitcnt lgkmcnt(0)
    v_mfma_f32_16x16x32_bf16 v[176:179], a[208:211], a[80:83], v[176:179]
    ds_read_b64_tr_b16 a[228:229], v43 offset:20480
    ds_read_b64_tr_b16 a[230:231], v43 offset:20736
    v_mfma_f32_16x16x32_bf16 v[180:183], a[208:211], a[84:87], v[180:183]
    ds_read_b64_tr_b16 a[232:233], v40 offset:21504
    ds_read_b64_tr_b16 a[234:235], v40 offset:21760
    v_mfma_f32_16x16x32_bf16 v[184:187], a[212:215], a[80:83], v[184:187]
    ds_read_b64_tr_b16 a[236:237], v43 offset:21504
    ds_read_b64_tr_b16 a[238:239], v43 offset:21760
    v_mfma_f32_16x16x32_bf16 v[188:191], a[212:215], a[84:87], v[188:191]
    ds_read_b64_tr_b16 a[240:241], v40 offset:22528
    ds_read_b64_tr_b16 a[242:243], v40 offset:22784
    v_mfma_f32_16x16x32_bf16 v[192:195], a[216:219], a[80:83], v[192:195]
    ds_read_b64_tr_b16 a[244:245], v43 offset:22528
    ds_read_b64_tr_b16 a[246:247], v43 offset:22784
    v_mfma_f32_16x16x32_bf16 v[196:199], a[216:219], a[84:87], v[196:199]
    v_mfma_f32_16x16x32_bf16 v[200:203], a[220:223], a[80:83], v[200:203]
    v_mfma_f32_16x16x32_bf16 v[204:207], a[220:223], a[84:87], v[204:207]
    v_mfma_f32_16x16x32_bf16 v[208:211], a[224:227], a[80:83], v[208:211]
    v_mfma_f32_16x16x32_bf16 v[212:215], a[224:227], a[84:87], v[212:215]
    s_waitcnt vmcnt(21) lgkmcnt(0)
    s_barrier
    v_mfma_f32_16x16x32_bf16 v[176:179], a[228:231], a[88:91], v[176:179]
    ds_read_b64_tr_b16 a[208:209], v40 offset:28672
    ds_read_b64_tr_b16 a[210:211], v40 offset:28928
    v_mfma_f32_16x16x32_bf16 v[180:183], a[228:231], a[92:95], v[180:183]
    ds_read_b64_tr_b16 a[212:213], v43 offset:28672
    ds_read_b64_tr_b16 a[214:215], v43 offset:28928
    v_mfma_f32_16x16x32_bf16 v[184:187], a[232:235], a[88:91], v[184:187]
    ds_read_b64_tr_b16 a[216:217], v40 offset:29696
    ds_read_b64_tr_b16 a[218:219], v40 offset:29952
    v_mfma_f32_16x16x32_bf16 v[188:191], a[232:235], a[92:95], v[188:191]
    ds_read_b64_tr_b16 a[220:221], v43 offset:29696
    ds_read_b64_tr_b16 a[222:223], v43 offset:29952
    v_mfma_f32_16x16x32_bf16 v[192:195], a[236:239], a[88:91], v[192:195]
    ds_read_b64_tr_b16 a[224:225], v40 offset:30720
    ds_read_b64_tr_b16 a[226:227], v40 offset:30976
    v_mfma_f32_16x16x32_bf16 v[196:199], a[236:239], a[92:95], v[196:199]
    s_add_u32 m0, s98, 73728
    s_nop 0
    buffer_load_dwordx4 v30, s[44:47], s60 offen offset:0 lds
    v_mfma_f32_16x16x32_bf16 v[200:203], a[240:243], a[88:91], v[200:203]
    v_mfma_f32_16x16x32_bf16 v[204:207], a[240:243], a[92:95], v[204:207]
    v_mfma_f32_16x16x32_bf16 v[208:211], a[244:247], a[88:91], v[208:211]
    v_mfma_f32_16x16x32_bf16 v[212:215], a[244:247], a[92:95], v[212:215]
    s_waitcnt lgkmcnt(0)
    v_mfma_f32_16x16x32_bf16 v[176:179], a[208:211], a[16:19], v[176:179]
    ds_read_b64_tr_b16 a[228:229], v40 offset:38912
    ds_read_b64_tr_b16 a[230:231], v40 offset:39168
    v_mfma_f32_16x16x32_bf16 v[180:183], a[208:211], a[20:23], v[180:183]
    ds_read_b64_tr_b16 a[232:233], v43 offset:38912
    ds_read_b64_tr_b16 a[234:235], v43 offset:39168
    v_mfma_f32_16x16x32_bf16 v[184:187], a[212:215], a[16:19], v[184:187]
    ds_read_b64_tr_b16 a[236:237], v40 offset:39936
    ds_read_b64_tr_b16 a[238:239], v40 offset:40192
    v_mfma_f32_16x16x32_bf16 v[188:191], a[212:215], a[20:23], v[188:191]
    ds_read_b64_tr_b16 a[240:241], v43 offset:39936
    ds_read_b64_tr_b16 a[242:243], v43 offset:40192
    v_mfma_f32_16x16x32_bf16 v[192:195], a[216:219], a[16:19], v[192:195]
    ds_read_b64_tr_b16 a[244:245], v40 offset:40960
    ds_read_b64_tr_b16 a[246:247], v40 offset:41216
    v_mfma_f32_16x16x32_bf16 v[196:199], a[216:219], a[20:23], v[196:199]
    buffer_load_dwordx4 v31, s[44:47], s60 offen offset:1024 lds
    v_mfma_f32_16x16x32_bf16 v[200:203], a[220:223], a[16:19], v[200:203]
    v_mfma_f32_16x16x32_bf16 v[204:207], a[220:223], a[20:23], v[204:207]
    buffer_load_dwordx4 v32, s[44:47], s60 offen offset:2048 lds
    v_mfma_f32_16x16x32_bf16 v[208:211], a[224:227], a[16:19], v[208:211]
    v_mfma_f32_16x16x32_bf16 v[212:215], a[224:227], a[20:23], v[212:215]
    s_waitcnt lgkmcnt(0)
    v_mfma_f32_16x16x32_bf16 v[176:179], a[228:231], a[24:27], v[176:179]
    ds_read_b64_tr_b16 a[208:209], v43 offset:30720
    ds_read_b64_tr_b16 a[210:211], v43 offset:30976
    v_mfma_f32_16x16x32_bf16 v[180:183], a[228:231], a[28:31], v[180:183]
    ds_read_b64_tr_b16 a[212:213], v40 offset:31744
    ds_read_b64_tr_b16 a[214:215], v40 offset:32000
    v_mfma_f32_16x16x32_bf16 v[184:187], a[232:235], a[24:27], v[184:187]
    ds_read_b64_tr_b16 a[216:217], v43 offset:31744
    ds_read_b64_tr_b16 a[218:219], v43 offset:32000
    v_mfma_f32_16x16x32_bf16 v[188:191], a[232:235], a[28:31], v[188:191]
    ds_read_b64_tr_b16 a[220:221], v40 offset:32768
    ds_read_b64_tr_b16 a[222:223], v40 offset:33024
    v_mfma_f32_16x16x32_bf16 v[192:195], a[236:239], a[24:27], v[192:195]
    ds_read_b64_tr_b16 a[224:225], v43 offset:32768
    ds_read_b64_tr_b16 a[226:227], v43 offset:33024
    v_mfma_f32_16x16x32_bf16 v[196:199], a[236:239], a[28:31], v[196:199]
    buffer_load_dwordx4 v33, s[44:47], s60 offen offset:3072 lds
    v_mfma_f32_16x16x32_bf16 v[200:203], a[240:243], a[24:27], v[200:203]
    v_mfma_f32_16x16x32_bf16 v[204:207], a[240:243], a[28:31], v[204:207]
    s_add_u32 m0, s98, 77824
    s_nop 0
    buffer_load_dwordx4 v34, s[44:47], s60 offen offset:0 lds
    v_mfma_f32_16x16x32_bf16 v[208:211], a[244:247], a[24:27], v[208:211]
    v_mfma_f32_16x16x32_bf16 v[212:215], a[244:247], a[28:31], v[212:215]
    s_waitcnt lgkmcnt(0)
    v_mfma_f32_16x16x32_bf16 v[176:179], a[208:211], a[96:99], v[176:179]
    ds_read_b64_tr_b16 a[228:229], v43 offset:40960
    ds_read_b64_tr_b16 a[230:231], v43 offset:41216
    v_mfma_f32_16x16x32_bf16 v[180:183], a[208:211], a[100:103], v[180:183]
    ds_read_b64_tr_b16 a[232:233], v40 offset:41984
    ds_read_b64_tr_b16 a[234:235], v40 offset:42240
    v_mfma_f32_16x16x32_bf16 v[184:187], a[212:215], a[96:99], v[184:187]
    ds_read_b64_tr_b16 a[236:237], v43 offset:41984
    ds_read_b64_tr_b16 a[238:239], v43 offset:42240
    v_mfma_f32_16x16x32_bf16 v[188:191], a[212:215], a[100:103], v[188:191]
    ds_read_b64_tr_b16 a[240:241], v40 offset:43008
    ds_read_b64_tr_b16 a[242:243], v40 offset:43264
    v_mfma_f32_16x16x32_bf16 v[192:195], a[216:219], a[96:99], v[192:195]
    ds_read_b64_tr_b16 a[244:245], v43 offset:43008
    ds_read_b64_tr_b16 a[246:247], v43 offset:43264
    v_mfma_f32_16x16x32_bf16 v[196:199], a[216:219], a[100:103], v[196:199]
    buffer_load_dwordx4 v[108:111], v70, s[72:75], 0 offen offset:0 sc1
    v_mfma_f32_16x16x32_bf16 v[200:203], a[220:223], a[96:99], v[200:203]
    buffer_load_dwordx4 v[112:115], v70, s[72:75], 0 offen offset:2048 sc1
    v_mfma_f32_16x16x32_bf16 v[204:207], a[220:223], a[100:103], v[204:207]
    buffer_load_dwordx4 v[116:119], v71, s[72:75], 0 offen offset:0 sc1
    v_mfma_f32_16x16x32_bf16 v[208:211], a[224:227], a[96:99], v[208:211]
    buffer_load_dwordx4 v[120:123], v71, s[72:75], 0 offen offset:2048 sc1
    v_mfma_f32_16x16x32_bf16 v[212:215], a[224:227], a[100:103], v[212:215]
    s_waitcnt vmcnt(25) lgkmcnt(0)
    s_barrier
    v_mfma_f32_16x16x32_bf16 v[176:179], a[228:231], a[104:107], v[176:179]
    ds_read_b64_tr_b16 a[208:209], v40 offset:49152
    ds_read_b64_tr_b16 a[210:211], v40 offset:49408
    v_mfma_f32_16x16x32_bf16 v[180:183], a[228:231], a[108:111], v[180:183]
    ds_read_b64_tr_b16 a[212:213], v43 offset:49152
    ds_read_b64_tr_b16 a[214:215], v43 offset:49408
    v_mfma_f32_16x16x32_bf16 v[184:187], a[232:235], a[104:107], v[184:187]
    ds_read_b64_tr_b16 a[216:217], v40 offset:50176
    ds_read_b64_tr_b16 a[218:219], v40 offset:50432
    v_mfma_f32_16x16x32_bf16 v[188:191], a[232:235], a[108:111], v[188:191]
    ds_read_b64_tr_b16 a[220:221], v43 offset:50176
    ds_read_b64_tr_b16 a[222:223], v43 offset:50432
    v_mfma_f32_16x16x32_bf16 v[192:195], a[236:239], a[104:107], v[192:195]
    ds_read_b64_tr_b16 a[224:225], v40 offset:51200
    ds_read_b64_tr_b16 a[226:227], v40 offset:51456
    v_mfma_f32_16x16x32_bf16 v[196:199], a[236:239], a[108:111], v[196:199]
    s_add_u32 m0, s98, 94208
    s_nop 0
    buffer_load_dwordx4 v30, s[44:47], s61 offen offset:0 lds
    v_mfma_f32_16x16x32_bf16 v[200:203], a[240:243], a[104:107], v[200:203]
    v_mfma_f32_16x16x32_bf16 v[204:207], a[240:243], a[108:111], v[204:207]
    buffer_load_dwordx4 v31, s[44:47], s61 offen offset:1024 lds
    v_mfma_f32_16x16x32_bf16 v[208:211], a[244:247], a[104:107], v[208:211]
    v_mfma_f32_16x16x32_bf16 v[212:215], a[244:247], a[108:111], v[212:215]
    s_waitcnt lgkmcnt(0)
    v_mfma_f32_16x16x32_bf16 v[176:179], a[208:211], a[32:35], v[176:179]
    ds_read_b64_tr_b16 a[228:229], v40 offset:59392
    ds_read_b64_tr_b16 a[230:231], v40 offset:59648
    v_mfma_f32_16x16x32_bf16 v[180:183], a[208:211], a[36:39], v[180:183]
    ds_read_b64_tr_b16 a[232:233], v43 offset:59392
    ds_read_b64_tr_b16 a[234:235], v43 offset:59648
    v_mfma_f32_16x16x32_bf16 v[184:187], a[212:215], a[32:35], v[184:187]
    ds_read_b64_tr_b16 a[236:237], v40 offset:60416
    ds_read_b64_tr_b16 a[238:239], v40 offset:60672
    v_mfma_f32_16x16x32_bf16 v[188:191], a[212:215], a[36:39], v[188:191]
    ds_read_b64_tr_b16 a[240:241], v43 offset:60416
    ds_read_b64_tr_b16 a[242:243], v43 offset:60672
    v_mfma_f32_16x16x32_bf16 v[192:195], a[216:219], a[32:35], v[192:195]
    ds_read_b64_tr_b16 a[244:245], v40 offset:61440
    ds_read_b64_tr_b16 a[246:247], v40 offset:61696
    v_mfma_f32_16x16x32_bf16 v[196:199], a[216:219], a[36:39], v[196:199]
    buffer_load_dwordx4 v32, s[44:47], s61 offen offset:2048 lds
    v_mfma_f32_16x16x32_bf16 v[200:203], a[220:223], a[32:35], v[200:203]
    v_mfma_f32_16x16x32_bf16 v[204:207], a[220:223], a[36:39], v[204:207]
    buffer_load_dwordx4 v33, s[44:47], s61 offen offset:3072 lds
    v_mfma_f32_16x16x32_bf16 v[208:211], a[224:227], a[32:35], v[208:211]
    v_mfma_f32_16x16x32_bf16 v[212:215], a[224:227], a[36:39], v[212:215]
    s_waitcnt lgkmcnt(0)
    v_mfma_f32_16x16x32_bf16 v[176:179], a[228:231], a[40:43], v[176:179]
    ds_read_b64_tr_b16 a[208:209], v43 offset:51200
    ds_read_b64_tr_b16 a[210:211], v43 offset:51456
    v_mfma_f32_16x16x32_bf16 v[180:183], a[228:231], a[44:47], v[180:183]
    ds_read_b64_tr_b16 a[212:213], v40 offset:52224
    ds_read_b64_tr_b16 a[214:215], v40 offset:52480
    v_mfma_f32_16x16x32_bf16 v[184:187], a[232:235], a[40:43], v[184:187]
    ds_read_b64_tr_b16 a[216:217], v43 offset:52224
    ds_read_b64_tr_b16 a[218:219], v43 offset:52480
    v_mfma_f32_16x16x32_bf16 v[188:191], a[232:235], a[44:47], v[188:191]
    ds_read_b64_tr_b16 a[220:221], v40 offset:53248
    ds_read_b64_tr_b16 a[222:223], v40 offset:53504
    v_mfma_f32_16x16x32_bf16 v[192:195], a[236:239], a[40:43], v[192:195]
    ds_read_b64_tr_b16 a[224:225], v43 offset:53248
    ds_read_b64_tr_b16 a[226:227], v43 offset:53504
    v_mfma_f32_16x16x32_bf16 v[196:199], a[236:239], a[44:47], v[196:199]
    v_mfma_f32_16x16x32_bf16 v[200:203], a[240:243], a[40:43], v[200:203]
    v_mfma_f32_16x16x32_bf16 v[204:207], a[240:243], a[44:47], v[204:207]
    v_mfma_f32_16x16x32_bf16 v[208:211], a[244:247], a[40:43], v[208:211]
    v_mfma_f32_16x16x32_bf16 v[212:215], a[244:247], a[44:47], v[212:215]
    s_waitcnt lgkmcnt(0)
    v_mfma_f32_16x16x32_bf16 v[176:179], a[208:211], a[112:115], v[176:179]
    ds_read_b64_tr_b16 a[228:229], v43 offset:61440
    ds_read_b64_tr_b16 a[230:231], v43 offset:61696
    v_mfma_f32_16x16x32_bf16 v[180:183], a[208:211], a[116:119], v[180:183]
    ds_read_b64_tr_b16 a[232:233], v40 offset:62464
    ds_read_b64_tr_b16 a[234:235], v40 offset:62720
    v_mfma_f32_16x16x32_bf16 v[184:187], a[212:215], a[112:115], v[184:187]
    ds_read_b64_tr_b16 a[236:237], v43 offset:62464
    ds_read_b64_tr_b16 a[238:239], v43 offset:62720
    v_mfma_f32_16x16x32_bf16 v[188:191], a[212:215], a[116:119], v[188:191]
    ds_read_b64_tr_b16 a[240:241], v40 offset:63488
    ds_read_b64_tr_b16 a[242:243], v40 offset:63744
    v_mfma_f32_16x16x32_bf16 v[192:195], a[216:219], a[112:115], v[192:195]
    ds_read_b64_tr_b16 a[244:245], v43 offset:63488
    ds_read_b64_tr_b16 a[246:247], v43 offset:63744
    v_mfma_f32_16x16x32_bf16 v[196:199], a[216:219], a[116:119], v[196:199]
    v_mfma_f32_16x16x32_bf16 v[200:203], a[220:223], a[112:115], v[200:203]
    v_mfma_f32_16x16x32_bf16 v[204:207], a[220:223], a[116:119], v[204:207]
    v_mfma_f32_16x16x32_bf16 v[208:211], a[224:227], a[112:115], v[208:211]
    v_mfma_f32_16x16x32_bf16 v[212:215], a[224:227], a[116:119], v[212:215]
    s_waitcnt vmcnt(24) lgkmcnt(0)
    s_barrier
    s_waitcnt vmcnt(4)
    s_cmp_eq_u32 s74, 0
    s_cbranch_scc1 L_rd_3
    v_xor_b32 v14, v111, v79
    v_bitop3_b32 v14, v14, v115, v79 bitop3:0xf6
    v_bitop3_b32 v14, v14, v119, v79 bitop3:0xf6
    v_bitop3_b32 v14, v14, v123, v79 bitop3:0xf6
    v_cmp_ne_u32 vcc, 0, v14
    s_nop 3
    s_cbranch_vccz L_rd_5
    s_mov_b32 s82, 0x40000
L_rp_4:
    buffer_load_dwordx4 v[108:111], v70, s[72:75], 0 offen offset:0 sc1
    buffer_load_dwordx4 v[112:115], v70, s[72:75], 0 offen offset:2048 sc1
    buffer_load_dwordx4 v[116:119], v71, s[72:75], 0 offen offset:0 sc1
    buffer_load_dwordx4 v[120:123], v71, s[72:75], 0 offen offset:2048 sc1
    s_waitcnt vmcnt(0)
    v_xor_b32 v14, v111, v79
    v_bitop3_b32 v14, v14, v115, v79 bitop3:0xf6
    v_bitop3_b32 v14, v14, v119, v79 bitop3:0xf6
    v_bitop3_b32 v14, v14, v123, v79 bitop3:0xf6
    v_cmp_ne_u32 vcc, 0, v14
    s_nop 3
    s_cbranch_vccz L_rd_5
    s_sub_u32 s82, s82, 1
    s_cbranch_scc0 L_rp_4
L_rd_5:
    v_mov_b32 v111, 0
    v_mov_b32 v115, 0
    v_mov_b32 v119, 0
    v_mov_b32 v123, 0
    v_mfma_f32_16x16x32_bf16 v[124:127], v[88:91], v[108:111], 0
    v_mfma_f32_16x16x32_bf16 v[128:131], v[92:95], v[108:111], 0
    v_mfma_f32_16x16x32_bf16 v[124:127], v[88:91], v[112:115], v[124:127]
    v_mfma_f32_16x16x32_bf16 v[128:131], v[92:95], v[112:115], v[128:131]
    v_mfma_f32_16x16x32_bf16 v[124:127], v[88:91], v[116:119], v[124:127]
    v_mfma_f32_16x16x32_bf16 v[128:131], v[92:95], v[116:119], v[128:131]
    v_mfma_f32_16x16x32_bf16 v[124:127], v[88:91], v[120:123], v[124:127]
    v_mfma_f32_16x16x32_bf16 v[128:131], v[92:95], v[120:123], v[128:131]
    s_mov_b32 s74, 0
    s_mov_b32 s70, 0x10000000
L_rd_3:
    v_mfma_f32_16x16x32_bf16 v[176:179], a[228:231], a[120:123], v[176:179]
    ds_read_b64_tr_b16 a[208:209], v41 offset:4096
    ds_read_b64_tr_b16 a[210:211], v41 offset:4352
    v_mfma_f32_16x16x32_bf16 v[180:183], a[228:231], a[124:127], v[180:183]
    ds_read_b64_tr_b16 a[212:213], v44 offset:4096
    ds_read_b64_tr_b16 a[214:215], v44 offset:4352
    v_mfma_f32_16x16x32_bf16 v[184:187], a[232:235], a[120:123], v[184:187]
    ds_read_b64_tr_b16 a[216:217], v41 offset:5120
    ds_read_b64_tr_b16 a[218:219], v41 offset:5376
    v_mfma_f32_16x16x32_bf16 v[188:191], a[232:235], a[124:127], v[188:191]
    ds_read_b64_tr_b16 a[220:221], v44 offset:5120
    ds_read_b64_tr_b16 a[222:223], v44 offset:5376
    v_mfma_f32_16x16x32_bf16 v[192:195], a[236:239], a[120:123], v[192:195]
    ds_read_b64_tr_b16 a[224:225], v41 offset:6144
    ds_read_b64_tr_b16 a[226:227], v41 offset:6400
    v_mfma_f32_16x16x32_bf16 v[196:199], a[236:239], a[124:127], v[196:199]
    v_mfma_f32_16x16x32_bf16 v[200:203], a[240:243], a[120:123], v[200:203]
    v_mfma_f32_16x16x32_bf16 v[204:207], a[240:243], a[124:127], v[204:207]
    v_mfma_f32_16x16x32_bf16 v[208:211], a[244:247], a[120:123], v[208:211]
    v_mfma_f32_16x16x32_bf16 v[212:215], a[244:247], a[124:127], v[212:215]
    s_waitcnt lgkmcnt(0)
    v_mfma_f32_16x16x32_bf16 v[176:179], a[208:211], a[48:51], v[176:179]
    ds_read_b64_tr_b16 a[228:229], v41 offset:14336
    ds_read_b64_tr_b16 a[230:231], v41 offset:14592
    v_mfma_f32_16x16x32_bf16 v[180:183], a[208:211], a[52:55], v[180:183]
    ds_read_b64_tr_b16 a[232:233], v44 offset:14336
    ds_read_b64_tr_b16 a[234:235], v44 offset:14592
    v_cvt_pk_bf16_f32 v168, v124, v125
    v_mfma_f32_16x16x32_bf16 v[184:187], a[212:215], a[48:51], v[184:187]
    ds_read_b64_tr_b16 a[236:237], v41 offset:15360
    ds_read_b64_tr_b16 a[238:239], v41 offset:15616
    v_cvt_pk_bf16_f32 v169, v126, v127
    v_mfma_f32_16x16x32_bf16 v[188:191], a[212:215], a[52:55], v[188:191]
    ds_read_b64_tr_b16 a[240:241], v44 offset:15360
    ds_read_b64_tr_b16 a[242:243], v44 offset:15616
    v_mfma_f32_16x16x32_bf16 v[192:195], a[216:219], a[48:51], v[192:195]
    ds_read_b64_tr_b16 a[244:245], v41 offset:16384
    ds_read_b64_tr_b16 a[246:247], v41 offset:16640
    v_cvt_pk_bf16_f32 v170, v128, v129
    v_mfma_f32_16x16x32_bf16 v[196:199], a[216:219], a[52:55], v[196:199]
    buffer_store_dwordx4 v[168:171], v72, s[68:71], 0 offen sc1
    s_mov_b32 s70, 0
    v_mfma_f32_16x16x32_bf16 v[200:203], a[220:223], a[48:51], v[200:203]
    v_mfma_f32_16x16x32_bf16 v[204:207], a[220:223], a[52:55], v[204:207]
    s_add_u32 m0, s98, 98304
    s_nop 0
    buffer_load_dwordx4 v34, s[44:47], s61 offen offset:0 lds
    v_mfma_f32_16x16x32_bf16 v[208:211], a[224:227], a[48:51], v[208:211]
    s_add_u32 m0, s98, 114688
    s_nop 0
    buffer_load_dwordx4 v30, s[44:47], s62 offen offset:0 lds
    v_mfma_f32_16x16x32_bf16 v[212:215], a[224:227], a[52:55], v[212:215]
    s_waitcnt lgkmcnt(0)
    v_mfma_f32_16x16x32_bf16 v[176:179], a[228:231], a[56:59], v[176:179]
    ds_read_b64_tr_b16 a[208:209], v44 offset:6144
    ds_read_b64_tr_b16 a[210:211], v44 offset:6400
    v_mfma_f32_16x16x32_bf16 v[180:183], a[228:231], a[60:63], v[180:183]
    ds_read_b64_tr_b16 a[212:213], v41 offset:7168
    ds_read_b64_tr_b16 a[214:215], v41 offset:7424
    v_mfma_f32_16x16x32_bf16 v[184:187], a[232:235], a[56:59], v[184:187]
    ds_read_b64_tr_b16 a[216:217], v44 offset:7168
    ds_read_b64_tr_b16 a[218:219], v44 offset:7424
    v_mfma_f32_16x16x32_bf16 v[188:191], a[232:235], a[60:63], v[188:191]
    ds_read_b64_tr_b16 a[220:221], v41 offset:8192
    ds_read_b64_tr_b16 a[222:223], v41 offset:8448
    v_mfma_f32_16x16x32_bf16 v[192:195], a[236:239], a[56:59], v[192:195]
    ds_read_b64_tr_b16 a[224:225], v44 offset:8192
    ds_read_b64_tr_b16 a[226:227], v44 offset:8448
    v_mfma_f32_16x16x32_bf16 v[196:199], a[236:239], a[60:63], v[196:199]
    buffer_load_dwordx4 v31, s[44:47], s62 offen offset:1024 lds
    v_mfma_f32_16x16x32_bf16 v[200:203], a[240:243], a[56:59], v[200:203]
    v_mfma_f32_16x16x32_bf16 v[204:207], a[240:243], a[60:63], v[204:207]
    buffer_load_dwordx4 v32, s[44:47], s62 offen offset:2048 lds
    v_mfma_f32_16x16x32_bf16 v[208:211], a[244:247], a[56:59], v[208:211]
    v_mfma_f32_16x16x32_bf16 v[212:215], a[244:247], a[60:63], v[212:215]
    s_waitcnt lgkmcnt(0)
    v_mfma_f32_16x16x32_bf16 v[176:179], a[208:211], a[128:131], v[176:179]
    ds_read_b64_tr_b16 a[228:229], v44 offset:16384
    ds_read_b64_tr_b16 a[230:231], v44 offset:16640
    v_mfma_f32_16x16x32_bf16 v[180:183], a[208:211], a[132:135], v[180:183]
    ds_read_b64_tr_b16 a[232:233], v41 offset:17408
    ds_read_b64_tr_b16 a[234:235], v41 offset:17664
    v_mfma_f32_16x16x32_bf16 v[184:187], a[212:215], a[128:131], v[184:187]
    ds_read_b64_tr_b16 a[236:237], v44 offset:17408
    ds_read_b64_tr_b16 a[238:239], v44 offset:17664
    v_mfma_f32_16x16x32_bf16 v[188:191], a[212:215], a[132:135], v[188:191]
    ds_read_b64_tr_b16 a[240:241], v41 offset:18432
    ds_read_b64_tr_b16 a[242:243], v41 offset:18688
    v_mfma_f32_16x16x32_bf16 v[192:195], a[216:219], a[128:131], v[192:195]
    ds_read_b64_tr_b16 a[244:245], v44 offset:18432
    ds_read_b64_tr_b16 a[246:247], v44 offset:18688
    v_mfma_f32_16x16x32_bf16 v[196:199], a[216:219], a[132:135], v[196:199]
    v_cmp_ne_u64 vcc, v[12:13], v[106:107]
    s_nop 3
    s_cmp_eq_u64 vcc, 0
    s_cselect_b32 s34, 1, 0
    v_mfma_f32_16x16x32_bf16 v[200:203], a[220:223], a[128:131], v[200:203]
    v_mfma_f32_16x16x32_bf16 v[204:207], a[220:223], a[132:135], v[204:207]
    v_mfma_f32_16x16x32_bf16 v[208:211], a[224:227], a[128:131], v[208:211]
    v_mfma_f32_16x16x32_bf16 v[212:215], a[224:227], a[132:135], v[212:215]
    s_waitcnt lgkmcnt(0)
    s_barrier
    v_mfma_f32_16x16x32_bf16 v[176:179], a[228:231], a[136:139], v[176:179]
    ds_read_b64_tr_b16 a[208:209], v39 offset:49152
    ds_read_b64_tr_b16 a[210:211], v39 offset:49408
    v_mfma_f32_16x16x32_bf16 v[180:183], a[228:231], a[140:143], v[180:183]
    ds_read_b64_tr_b16 a[212:213], v42 offset:49152
    ds_read_b64_tr_b16 a[214:215], v42 offset:49408
    v_mfma_f32_16x16x32_bf16 v[184:187], a[232:235], a[136:139], v[184:187]
    ds_read_b64_tr_b16 a[216:217], v39 offset:50176
    ds_read_b64_tr_b16 a[218:219], v39 offset:50432
    v_mfma_f32_16x16x32_bf16 v[188:191], a[232:235], a[140:143], v[188:191]
    ds_read_b64_tr_b16 a[220:221], v42 offset:50176
    ds_read_b64_tr_b16 a[222:223], v42 offset:50432
    v_mfma_f32_16x16x32_bf16 v[192:195], a[236:239], a[136:139], v[192:195]
    ds_read_b64_tr_b16 a[224:225], v39 offset:51200
    ds_read_b64_tr_b16 a[226:227], v39 offset:51456
    v_mfma_f32_16x16x32_bf16 v[196:199], a[236:239], a[140:143], v[196:199]
    buffer_load_dwordx4 v33, s[44:47], s62 offen offset:3072 lds
    v_mfma_f32_16x16x32_bf16 v[200:203], a[240:243], a[136:139], v[200:203]
    v_mfma_f32_16x16x32_bf16 v[204:207], a[240:243], a[140:143], v[204:207]
    s_add_u32 m0, s98, 118784
    s_nop 0
    buffer_load_dwordx4 v34, s[44:47], s62 offen offset:0 lds
    v_mfma_f32_16x16x32_bf16 v[208:211], a[244:247], a[136:139], v[208:211]
    v_mfma_f32_16x16x32_bf16 v[212:215], a[244:247], a[140:143], v[212:215]
    s_waitcnt lgkmcnt(0)
    v_mfma_f32_16x16x32_bf16 v[176:179], a[208:211], a[64:67], v[176:179]
    ds_read_b64_tr_b16 a[228:229], v39 offset:59392
    ds_read_b64_tr_b16 a[230:231], v39 offset:59648
    v_mfma_f32_16x16x32_bf16 v[180:183], a[208:211], a[68:71], v[180:183]
    ds_read_b64_tr_b16 a[232:233], v42 offset:59392
    ds_read_b64_tr_b16 a[234:235], v42 offset:59648
    v_mfma_f32_16x16x32_bf16 v[184:187], a[212:215], a[64:67], v[184:187]
    ds_read_b64_tr_b16 a[236:237], v39 offset:60416
    ds_read_b64_tr_b16 a[238:239], v39 offset:60672
    v_mfma_f32_16x16x32_bf16 v[188:191], a[212:215], a[68:71], v[188:191]
    ds_read_b64_tr_b16 a[240:241], v42 offset:60416
    ds_read_b64_tr_b16 a[242:243], v42 offset:60672
    v_mfma_f32_16x16x32_bf16 v[192:195], a[216:219], a[64:67], v[192:195]
    ds_read_b64_tr_b16 a[244:245], v39 offset:61440
    ds_read_b64_tr_b16 a[246:247], v39 offset:61696
    v_mfma_f32_16x16x32_bf16 v[196:199], a[216:219], a[68:71], v[196:199]
    s_add_u32 m0, s98, 135168
    s_nop 0
    buffer_load_dwordx4 v30, s[44:47], s63 offen offset:0 lds
    v_mfma_f32_16x16x32_bf16 v[200:203], a[220:223], a[64:67], v[200:203]
    v_mfma_f32_16x16x32_bf16 v[204:207], a[220:223], a[68:71], v[204:207]
    buffer_load_dwordx4 v31, s[44:47], s63 offen offset:1024 lds
    v_mfma_f32_16x16x32_bf16 v[208:211], a[224:227], a[64:67], v[208:211]
    v_mfma_f32_16x16x32_bf16 v[212:215], a[224:227], a[68:71], v[212:215]
    s_waitcnt lgkmcnt(0)
    v_mfma_f32_16x16x32_bf16 v[176:179], a[228:231], a[72:75], v[176:179]
    ds_read_b64_tr_b16 a[208:209], v42 offset:51200
    ds_read_b64_tr_b16 a[210:211], v42 offset:51456
    v_mfma_f32_16x16x32_bf16 v[180:183], a[228:231], a[76:79], v[180:183]
    ds_read_b64_tr_b16 a[212:213], v39 offset:52224
    ds_read_b64_tr_b16 a[214:215], v39 offset:52480
    buffer_load_dwordx4 v32, s[44:47], s63 offen offset:2048 lds
    v_mfma_f32_16x16x32_bf16 v[184:187], a[232:235], a[72:75], v[184:187]
    ds_read_b64_tr_b16 a[216:217], v42 offset:52224
    ds_read_b64_tr_b16 a[218:219], v42 offset:52480
    buffer_load_dwordx4 v33, s[44:47], s63 offen offset:3072 lds
    v_mfma_f32_16x16x32_bf16 v[188:191], a[232:235], a[76:79], v[188:191]
    ds_read_b64_tr_b16 a[220:221], v39 offset:53248
    ds_read_b64_tr_b16 a[222:223], v39 offset:53504
    v_add_u32 v15, 4096, v73
    v_mfma_f32_16x16x32_bf16 v[192:195], a[236:239], a[72:75], v[192:195]
    ds_read_b64_tr_b16 a[224:225], v42 offset:53248
    ds_read_b64_tr_b16 a[226:227], v42 offset:53504
    buffer_load_dwordx4 v[108:111], v73, s[48:51], 0 offen offset:0 sc1
    v_mfma_f32_16x16x32_bf16 v[196:199], a[236:239], a[76:79], v[196:199]
    v_mfma_f32_16x16x32_bf16 v[200:203], a[240:243], a[72:75], v[200:203]
    buffer_load_dwordx4 v[112:115], v73, s[48:51], 0 offen offset:1024 sc1
    v_mfma_f32_16x16x32_bf16 v[204:207], a[240:243], a[76:79], v[204:207]
    buffer_load_dwordx4 v[116:119], v73, s[48:51], 0 offen offset:2048 sc1
    v_mfma_f32_16x16x32_bf16 v[208:211], a[244:247], a[72:75], v[208:211]
    buffer_load_dwordx4 v[120:123], v73, s[48:51], 0 offen offset:3072 sc1
    v_mfma_f32_16x16x32_bf16 v[212:215], a[244:247], a[76:79], v[212:215]
    s_waitcnt lgkmcnt(0)
    v_mfma_f32_16x16x32_bf16 v[176:179], a[208:211], a[144:147], v[176:179]
    ds_read_b64_tr_b16 a[228:229], v42 offset:61440
    ds_read_b64_tr_b16 a[230:231], v42 offset:61696
    v_mfma_f32_16x16x32_bf16 v[184:187], a[212:215], a[144:147], v[184:187]
    ds_read_b64_tr_b16 a[232:233], v39 offset:62464
    ds_read_b64_tr_b16 a[234:235], v39 offset:62720
    s_add_u32 m0, s98, 139264
    s_nop 0
    buffer_load_dwordx4 v34, s[44:47], s63 offen offset:0 lds
    buffer_load_dwordx4 v[124:127], v15, s[48:51], 0 offen offset:0 sc1
    v_mfma_f32_16x16x32_bf16 v[192:195], a[216:219], a[144:147], v[192:195]
    ds_read_b64_tr_b16 a[236:237], v42 offset:62464
    ds_read_b64_tr_b16 a[238:239], v42 offset:62720
    buffer_load_dwordx4 v[128:131], v15, s[48:51], 0 offen offset:1024 sc1
    v_mfma_f32_16x16x32_bf16 v[200:203], a[220:223], a[144:147], v[200:203]
    ds_read_b64_tr_b16 a[240:241], v39 offset:63488
    ds_read_b64_tr_b16 a[242:243], v39 offset:63744
    buffer_load_dwordx4 v[132:135], v15, s[48:51], 0 offen offset:2048 sc1
    v_mfma_f32_16x16x32_bf16 v[208:211], a[224:227], a[144:147], v[208:211]
    ds_read_b64_tr_b16 a[244:245], v42 offset:63488
    ds_read_b64_tr_b16 a[246:247], v42 offset:63744
    buffer_load_dwordx4 v[136:139], v15, s[48:51], 0 offen offset:3072 sc1
    s_waitcnt lgkmcnt(0)
    s_barrier
    v_mfma_f32_16x16x32_bf16 v[176:179], a[228:231], a[152:155], v[176:179]
    v_mfma_f32_16x16x32_bf16 v[184:187], a[232:235], a[152:155], v[184:187]
    v_add_u32 v30, v30, v85
    v_add_u32 v31, v31, v85
    v_mfma_f32_16x16x32_bf16 v[192:195], a[236:239], a[152:155], v[192:195]
    v_add_u32 v32, v32, v86
    v_add_u32 v33, v33, v87
    v_mfma_f32_16x16x32_bf16 v[200:203], a[240:243], a[152:155], v[200:203]
    v_add_u32 v34, v34, v87
    s_add_u32 m0, s98, 49152
    s_nop 0
    buffer_load_dwordx4 v30, s[44:47], s64 offen offset:0 lds
    v_mfma_f32_16x16x32_bf16 v[208:211], a[244:247], a[152:155], v[208:211]
    buffer_load_dwordx4 v31, s[44:47], s64 offen offset:1024 lds
    v_mfma_f32_16x16x32_bf16 v[180:183], a[208:211], a[148:151], v[180:183]
    v_mfma_f32_16x16x32_bf16 v[188:191], a[212:215], a[148:151], v[188:191]
    v_pk_fma_f32 v[2:3], v[176:177], v[52:53], v[52:53] op_sel:[0,0,1] op_sel_hi:[1,0,1]
    v_pk_fma_f32 v[4:5], v[178:179], v[52:53], v[52:53] op_sel:[0,0,1] op_sel_hi:[1,0,1]
    v_pk_fma_f32 v[6:7], v[184:185], v[52:53], v[52:53] op_sel:[0,0,1] op_sel_hi:[1,0,1]
    v_mfma_f32_16x16x32_bf16 v[196:199], a[216:219], a[148:151], v[196:199]
    buffer_load_dwordx4 v32, s[44:47], s64 offen offset:2048 lds
    v_pk_fma_f32 v[8:9], v[186:187], v[52:53], v[52:53] op_sel:[0,0,1] op_sel_hi:[1,0,1]
    v_exp_f32 v2, v2 clamp
    v_mfma_f32_16x16x32_bf16 v[204:207], a[220:223], a[148:151], v[204:207]
    v_max_f32 v176, v48, v176
    v_exp_f32 v3, v3 clamp
    v_mfma_f32_16x16x32_bf16 v[212:215], a[224:227], a[148:151], v[212:215]
    v_max_f32 v177, v48, v177
    v_exp_f32 v4, v4 clamp
    v_mfma_f32_16x16x32_bf16 v[180:183], a[228:231], a[156:159], v[180:183]
    v_max_f32 v178, v48, v178
    v_exp_f32 v5, v5 clamp
    v_max_f32 v179, v48, v179
    v_mfma_f32_16x16x32_bf16 v[188:191], a[232:235], a[156:159], v[188:191]
    buffer_load_dwordx4 v33, s[44:47], s64 offen offset:3072 lds
    v_exp_f32 v6, v6 clamp
    v_max_f32 v184, v48, v184
    v_mfma_f32_16x16x32_bf16 v[196:199], a[236:239], a[156:159], v[196:199]
    v_exp_f32 v7, v7 clamp
    v_max_f32 v185, v48, v185
    v_mfma_f32_16x16x32_bf16 v[204:207], a[240:243], a[156:159], v[204:207]
    v_exp_f32 v8, v8 clamp
    v_max_f32 v186, v48, v186
    v_mfma_f32_16x16x32_bf16 v[212:215], a[244:247], a[156:159], v[212:215]
    v_exp_f32 v9, v9 clamp
    v_max_f32 v187, v48, v187
    v_pk_add_f32 v[176:177], v[176:177], v[2:3]
    v_pk_add_f32 v[178:179], v[178:179], v[4:5]
    v_pk_add_f32 v[184:185], v[184:185], v[6:7]
    s_add_u32 m0, s98, 53248
    s_nop 0
    buffer_load_dwordx4 v34, s[44:47], s64 offen offset:0 lds
    v_pk_add_f32 v[186:187], v[186:187], v[8:9]
    v_cvt_pk_bf16_f32 v150, v176, v177
    v_cvt_pk_bf16_f32 v151, v178, v179
    v_cvt_pk_bf16_f32 v152, v184, v185
    v_cvt_pk_bf16_f32 v153, v186, v187
    v_pk_fma_f32 v[2:3], v[192:193], v[52:53], v[52:53] op_sel:[0,0,1] op_sel_hi:[1,0,1]
    v_pk_fma_f32 v[4:5], v[194:195], v[52:53], v[52:53] op_sel:[0,0,1] op_sel_hi:[1,0,1]
    v_pk_fma_f32 v[6:7], v[200:201], v[52:53], v[52:53] op_sel:[0,0,1] op_sel_hi:[1,0,1]
    v_pk_fma_f32 v[8:9], v[202:203], v[52:53], v[52:53] op_sel:[0,0,1] op_sel_hi:[1,0,1]
    v_exp_f32 v2, v2 clamp
    v_max_f32 v192, v48, v192
    v_exp_f32 v3, v3 clamp
    v_max_f32 v193, v48, v193
    v_exp_f32 v4, v4 clamp
    v_max_f32 v194, v48, v194
    v_exp_f32 v5, v5 clamp
    v_max_f32 v195, v48, v195
    v_exp_f32 v6, v6 clamp
    v_max_f32 v200, v48, v200
    v_exp_f32 v7, v7 clamp
    v_max_f32 v201, v48, v201
    v_exp_f32 v8, v8 clamp
    v_max_f32 v202, v48, v202
    v_exp_f32 v9, v9 clamp
    v_max_f32 v203, v48, v203
    v_pk_add_f32 v[192:193], v[192:193], v[2:3]
    v_pk_add_f32 v[194:195], v[194:195], v[4:5]
    v_pk_add_f32 v[200:201], v[200:201], v[6:7]
    v_pk_add_f32 v[202:203], v[202:203], v[8:9]
    v_cvt_pk_bf16_f32 v154, v192, v193
    v_cvt_pk_bf16_f32 v155, v194, v195
    v_cvt_pk_bf16_f32 v156, v200, v201
    v_cvt_pk_bf16_f32 v157, v202, v203
    v_pk_fma_f32 v[2:3], v[208:209], v[52:53], v[52:53] op_sel:[0,0,1] op_sel_hi:[1,0,1]
    v_pk_fma_f32 v[4:5], v[210:211], v[52:53], v[52:53] op_sel:[0,0,1] op_sel_hi:[1,0,1]
    v_pk_fma_f32 v[6:7], v[180:181], v[52:53], v[52:53] op_sel:[0,0,1] op_sel_hi:[1,0,1]
    v_pk_fma_f32 v[8:9], v[182:183], v[52:53], v[52:53] op_sel:[0,0,1] op_sel_hi:[1,0,1]
    v_exp_f32 v2, v2 clamp
    v_max_f32 v208, v48, v208
    v_exp_f32 v3, v3 clamp
    v_max_f32 v209, v48, v209
    v_exp_f32 v4, v4 clamp
    v_max_f32 v210, v48, v210
    v_exp_f32 v5, v5 clamp
    v_max_f32 v211, v48, v211
    v_exp_f32 v6, v6 clamp
    v_max_f32 v180, v48, v180
    v_exp_f32 v7, v7 clamp
    v_max_f32 v181, v48, v181
    v_exp_f32 v8, v8 clamp
    v_max_f32 v182, v48, v182
    v_exp_f32 v9, v9 clamp
    v_max_f32 v183, v48, v183
    v_pk_add_f32 v[208:209], v[208:209], v[2:3]
    v_pk_add_f32 v[210:211], v[210:211], v[4:5]
    v_pk_add_f32 v[180:181], v[180:181], v[6:7]
    v_pk_add_f32 v[182:183], v[182:183], v[8:9]
    v_cvt_pk_bf16_f32 v158, v208, v209
    v_cvt_pk_bf16_f32 v159, v210, v211
    v_cvt_pk_bf16_f32 v160, v180, v181
    v_cvt_pk_bf16_f32 v161, v182, v183
    v_pk_fma_f32 v[2:3], v[188:189], v[52:53], v[52:53] op_sel:[0,0,1] op_sel_hi:[1,0,1]
    v_pk_fma_f32 v[4:5], v[190:191], v[52:53], v[52:53] op_sel:[0,0,1] op_sel_hi:[1,0,1]
    v_pk_fma_f32 v[6:7], v[196:197], v[52:53], v[52:53] op_sel:[0,0,1] op_sel_hi:[1,0,1]
    v_pk_fma_f32 v[8:9], v[198:199], v[52:53], v[52:53] op_sel:[0,0,1] op_sel_hi:[1,0,1]
    v_exp_f32 v2, v2 clamp
    v_max_f32 v188, v48, v188
    v_exp_f32 v3, v3 clamp
    v_max_f32 v189, v48, v189
    v_exp_f32 v4, v4 clamp
    v_max_f32 v190, v48, v190
    v_exp_f32 v5, v5 clamp
    v_max_f32 v191, v48, v191
    v_exp_f32 v6, v6 clamp
    v_max_f32 v196, v48, v196
    v_exp_f32 v7, v7 clamp
    v_max_f32 v197, v48, v197
    v_exp_f32 v8, v8 clamp
    v_max_f32 v198, v48, v198
    v_exp_f32 v9, v9 clamp
    v_max_f32 v199, v48, v199
    v_pk_add_f32 v[188:189], v[188:189], v[2:3]
    v_pk_add_f32 v[190:191], v[190:191], v[4:5]
    v_pk_add_f32 v[196:197], v[196:197], v[6:7]
    v_pk_add_f32 v[198:199], v[198:199], v[8:9]
    v_cvt_pk_bf16_f32 v162, v188, v189
    v_cvt_pk_bf16_f32 v163, v190, v191
    v_cvt_pk_bf16_f32 v164, v196, v197
    v_cvt_pk_bf16_f32 v165, v198, v199
    v_pk_fma_f32 v[2:3], v[204:205], v[52:53], v[52:53] op_sel:[0,0,1] op_sel_hi:[1,0,1]
    v_pk_fma_f32 v[4:5], v[206:207], v[52:53], v[52:53] op_sel:[0,0,1] op_sel_hi:[1,0,1]
    v_pk_fma_f32 v[6:7], v[212:213], v[52:53], v[52:53] op_sel:[0,0,1] op_sel_hi:[1,0,1]
    v_pk_fma_f32 v[8:9], v[214:215], v[52:53], v[52:53] op_sel:[0,0,1] op_sel_hi:[1,0,1]
    v_exp_f32 v2, v2 clamp
    v_max_f32 v204, v48, v204
    v_exp_f32 v3, v3 clamp
    v_max_f32 v205, v48, v205
    v_exp_f32 v4, v4 clamp
    v_max_f32 v206, v48, v206
    v_exp_f32 v5, v5 clamp
    v_max_f32 v207, v48, v207
    v_exp_f32 v6, v6 clamp
    v_max_f32 v212, v48, v212
    v_exp_f32 v7, v7 clamp
    v_max_f32 v213, v48, v213
    v_exp_f32 v8, v8 clamp
    v_max_f32 v214, v48, v214
    v_exp_f32 v9, v9 clamp
    v_max_f32 v215, v48, v215
    v_pk_add_f32 v[204:205], v[204:205], v[2:3]
    v_pk_add_f32 v[206:207], v[206:207], v[4:5]
    v_pk_add_f32 v[212:213], v[212:213], v[6:7]
    v_pk_add_f32 v[214:215], v[214:215], v[8:9]
    v_cvt_pk_bf16_f32 v166, v204, v205
    v_cvt_pk_bf16_f32 v167, v206, v207
    v_cvt_pk_bf16_f32 v168, v212, v213
    v_cvt_pk_bf16_f32 v169, v214, v215
    s_waitcnt vmcnt(13)
    v_xor_b32 v14, s79, v111
    s_waitcnt vmcnt(12)
    v_bitop3_b32 v14, v14, v115, s79 bitop3:0xf6
    s_waitcnt vmcnt(11)
    v_bitop3_b32 v14, v14, v119, s79 bitop3:0xf6
    s_waitcnt vmcnt(10)
    v_bitop3_b32 v14, v14, v123, s79 bitop3:0xf6
    s_waitcnt vmcnt(8)
    v_bitop3_b32 v14, v14, v127, s79 bitop3:0xf6
    s_waitcnt vmcnt(7)
    v_bitop3_b32 v14, v14, v131, s79 bitop3:0xf6
    s_waitcnt vmcnt(6)
    v_bitop3_b32 v14, v14, v135, s79 bitop3:0xf6
    s_waitcnt vmcnt(5)
    v_bitop3_b32 v14, v14, v139, s79 bitop3:0xf6
    v_cmp_ne_u32 vcc, 0, v14
    s_nop 3
    s_cbranch_vccz L_rd_7
    s_mov_b32 s82, 0x40000
L_rp_6:
    buffer_load_dwordx4 v[108:111], v73, s[48:51], 0 offen offset:0 sc1
    buffer_load_dwordx4 v[112:115], v73, s[48:51], 0 offen offset:1024 sc1
    buffer_load_dwordx4 v[116:119], v73, s[48:51], 0 offen offset:2048 sc1
    buffer_load_dwordx4 v[120:123], v73, s[48:51], 0 offen offset:3072 sc1
    buffer_load_dwordx4 v[124:127], v15, s[48:51], 0 offen offset:0 sc1
    buffer_load_dwordx4 v[128:131], v15, s[48:51], 0 offen offset:1024 sc1
    buffer_load_dwordx4 v[132:135], v15, s[48:51], 0 offen offset:2048 sc1
    buffer_load_dwordx4 v[136:139], v15, s[48:51], 0 offen offset:3072 sc1
    s_waitcnt vmcnt(0)
    v_xor_b32 v14, s79, v111
    v_bitop3_b32 v14, v14, v115, s79 bitop3:0xf6
    v_bitop3_b32 v14, v14, v119, s79 bitop3:0xf6
    v_bitop3_b32 v14, v14, v123, s79 bitop3:0xf6
    v_bitop3_b32 v14, v14, v127, s79 bitop3:0xf6
    v_bitop3_b32 v14, v14, v131, s79 bitop3:0xf6
    v_bitop3_b32 v14, v14, v135, s79 bitop3:0xf6
    v_bitop3_b32 v14, v14, v139, s79 bitop3:0xf6
    v_cmp_ne_u32 vcc, 0, v14
    s_nop 3
    s_cbranch_vccz L_rd_7
    s_sub_u32 s82, s82, 1
    s_cbranch_scc0 L_rp_6
L_rd_7:
    v_mov_b32 v140, v110
    v_mov_b32 v141, v114
    v_mov_b32 v142, v118
    v_mov_b32 v143, v122
    v_mov_b32 v144, v126
    v_mov_b32 v145, v130
    v_mov_b32 v146, v134
    v_mov_b32 v147, v138
    v_mov_b32 v110, v112
    v_mov_b32 v111, v113
    v_mov_b32 v118, v120
    v_mov_b32 v119, v121
    v_mov_b32 v126, v128
    v_mov_b32 v127, v129
    v_mov_b32 v134, v136
    v_mov_b32 v135, v137
    v_mfma_f32_16x16x32_bf16 v[176:179], v[108:111], v[150:153], 0
    v_mfma_f32_16x16x32_bf16 v[180:183], v[140:143], v[150:153], v[56:59]
    v_mfma_f32_16x16x32_bf16 v[184:187], v[116:119], v[152:155], 0
    v_mfma_f32_16x16x32_bf16 v[188:191], v[140:143], v[152:155], v[56:59]
    v_mfma_f32_16x16x32_bf16 v[192:195], v[124:127], v[154:157], 0
    v_mfma_f32_16x16x32_bf16 v[196:199], v[144:147], v[154:157], v[56:59]
    v_mfma_f32_16x16x32_bf16 v[200:203], v[132:135], v[156:159], 0
    v_mfma_f32_16x16x32_bf16 v[204:207], v[144:147], v[156:159], v[56:59]
    v_mfma_f32_16x16x32_bf16 v[208:211], v[108:111], v[160:163], 0
    v_mfma_f32_16x16x32_bf16 v[212:215], v[140:143], v[160:163], v[56:59]
    v_mfma_f32_16x16x32_bf16 v[216:219], v[116:119], v[162:165], 0
    v_mfma_f32_16x16x32_bf16 v[220:223], v[140:143], v[162:165], v[56:59]
    v_mfma_f32_16x16x32_bf16 v[224:227], v[124:127], v[164:167], 0
    v_mfma_f32_16x16x32_bf16 v[228:231], v[144:147], v[164:167], v[56:59]
    v_mfma_f32_16x16x32_bf16 v[232:235], v[132:135], v[166:169], 0
    v_mfma_f32_16x16x32_bf16 v[236:239], v[144:147], v[166:169], v[56:59]
    v_rcp_f32 v181, v181
    v_rcp_f32 v191, v191
    v_rcp_f32 v197, v197
    v_rcp_f32 v207, v207
    v_pk_mul_f32 v[176:177], v[176:177], v[180:181] op_sel:[0,1] op_sel_hi:[1,1]
    v_pk_mul_f32 v[184:185], v[184:185], v[190:191] op_sel:[0,1] op_sel_hi:[1,1]
    v_pk_mul_f32 v[178:179], v[178:179], v[180:181] op_sel:[0,1] op_sel_hi:[1,1]
    v_pk_mul_f32 v[186:187], v[186:187], v[190:191] op_sel:[0,1] op_sel_hi:[1,1]
    v_mul_f32 v180, v180, v181
    v_mul_f32 v190, v190, v191
    v_pk_mul_f32 v[192:193], v[192:193], v[196:197] op_sel:[0,1] op_sel_hi:[1,1]
    v_pk_mul_f32 v[200:201], v[200:201], v[206:207] op_sel:[0,1] op_sel_hi:[1,1]
    v_pk_mul_f32 v[194:195], v[194:195], v[196:197] op_sel:[0,1] op_sel_hi:[1,1]
    v_pk_mul_f32 v[202:203], v[202:203], v[206:207] op_sel:[0,1] op_sel_hi:[1,1]
    v_mul_f32 v196, v196, v197
    v_mul_f32 v206, v206, v207
    v_cvt_pk_bf16_f32 v82, v176, v184
    v_cvt_pk_bf16_f32 v83, v192, v200
    v_cvt_pk_bf16_f32 v84, v177, v185
    v_cvt_pk_bf16_f32 v85, v193, v201
    v_cvt_pk_bf16_f32 v86, v178, v186
    v_cvt_pk_bf16_f32 v87, v194, v202
    v_cvt_pk_bf16_f32 v88, v179, v187
    v_cvt_pk_bf16_f32 v89, v195, v203
    v_cvt_pk_bf16_f32 v90, v180, v190
    v_cvt_pk_bf16_f32 v91, v196, v206
    v_rcp_f32 v213, v213
    v_rcp_f32 v223, v223
    v_rcp_f32 v229, v229
    v_rcp_f32 v239, v239
    v_pk_mul_f32 v[208:209], v[208:209], v[212:213] op_sel:[0,1] op_sel_hi:[1,1]
    v_pk_mul_f32 v[216:217], v[216:217], v[222:223] op_sel:[0,1] op_sel_hi:[1,1]
    v_pk_mul_f32 v[210:211], v[210:211], v[212:213] op_sel:[0,1] op_sel_hi:[1,1]
    v_pk_mul_f32 v[218:219], v[218:219], v[222:223] op_sel:[0,1] op_sel_hi:[1,1]
    v_mul_f32 v212, v212, v213
    v_mul_f32 v222, v222, v223
    v_pk_mul_f32 v[224:225], v[224:225], v[228:229] op_sel:[0,1] op_sel_hi:[1,1]
    v_pk_mul_f32 v[232:233], v[232:233], v[238:239] op_sel:[0,1] op_sel_hi:[1,1]
    v_pk_mul_f32 v[226:227], v[226:227], v[228:229] op_sel:[0,1] op_sel_hi:[1,1]
    v_pk_mul_f32 v[234:235], v[234:235], v[238:239] op_sel:[0,1] op_sel_hi:[1,1]
    v_mul_f32 v228, v228, v229
    v_mul_f32 v238, v238, v239
    v_cvt_pk_bf16_f32 v92, v208, v216
    v_cvt_pk_bf16_f32 v93, v224, v232
    v_cvt_pk_bf16_f32 v94, v209, v217
    v_cvt_pk_bf16_f32 v95, v225, v233
    v_cvt_pk_bf16_f32 v96, v210, v218
    v_cvt_pk_bf16_f32 v97, v226, v234
    v_cvt_pk_bf16_f32 v98, v211, v219
    v_cvt_pk_bf16_f32 v99, v227, v235
    v_cvt_pk_bf16_f32 v100, v212, v222
    v_cvt_pk_bf16_f32 v101, v228, v238
    s_cmp_eq_u32 s34, 0
    s_cbranch_scc1 L_wt_8
    buffer_store_dwordx4 v[82:85], v22, s[52:55], s67 offen
    buffer_store_dwordx4 v[86:89], v24, s[52:55], s67 offen
    buffer_store_dwordx2 v[90:91], v37, s[52:55], s67 offen offset:0
    buffer_store_dwordx4 v[92:95], v23, s[52:55], s67 offen
    buffer_store_dwordx4 v[96:99], v36, s[52:55], s67 offen
    buffer_store_dwordx2 v[100:101], v37, s[52:55], s67 offen offset:512
    s_branch L_j_9
L_wt_8:
    buffer_store_dwordx4 v[82:85], v22, s[52:55], s67 offen sc1
    buffer_store_dwordx4 v[86:89], v24, s[52:55], s67 offen sc1
    buffer_store_dwordx2 v[90:91], v37, s[52:55], s67 offen offset:0 sc1
    buffer_store_dwordx4 v[92:95], v23, s[52:55], s67 offen sc1
    buffer_store_dwordx4 v[96:99], v36, s[52:55], s67 offen sc1
    buffer_store_dwordx2 v[100:101], v37, s[52:55], s67 offen offset:512 sc1
L_j_9:
    v_mov_b32 v4, s79
    s_waitcnt vmcnt(0)
    s_cmp_eq_u32 s34, 0
    s_cbranch_scc1 L_wt_10
    buffer_store_dword v4, v77, s[48:51], 0 offen
    s_branch L_j_11
L_wt_10:
    buffer_store_dword v4, v77, s[48:51], 0 offen sc1
L_j_11:
    s_barrier
    ds_read_b64_tr_b16 a[160:161], v40 offset:8192
    ds_read_b64_tr_b16 a[162:163], v40 offset:8448
    ds_read_b64_tr_b16 a[164:165], v43 offset:8192
    ds_read_b64_tr_b16 a[166:167], v43 offset:8448
    ds_read_b64_tr_b16 a[168:169], v40 offset:9216
    ds_read_b64_tr_b16 a[170:171], v40 offset:9472
    ds_read_b64_tr_b16 a[172:173], v43 offset:9216
    ds_read_b64_tr_b16 a[174:175], v43 offset:9472
    ds_read_b64_tr_b16 a[176:177], v40 offset:10240
    ds_read_b64_tr_b16 a[178:179], v40 offset:10496
    v_and_b32 v4, 15, v0
    v_bfe_u32 v3, v0, 4, 2
    s_mul_i32 s94, s76, 10752
    s_add_u32 s94, s94, 0
    v_mul_u32_u24 v5, 336, v4
    v_lshl_add_u32 v5, v3, 4, v5
    v_add_u32 v48, s94, v5
    s_lshl_b32 s95, s77, 7
    s_lshl_b32 s96, s76, 5
    s_add_u32 s95, s95, s96
    s_mul_i32 s95, s95, 5120
    s_mul_i32 s96, s78, 320
    s_add_u32 s95, s95, s96
    s_add_u32 s95, s95, 0
    v_and_b32 v3, 63, v0
    v_add_u32 v4, 0, v3
    v_mul_u32_u24 v5, 3277, v4
    v_lshrrev_b32 v5, 16, v5
    v_lshlrev_b32 v4, 4, v4
    v_lshl_add_u32 v6, v5, 4, v4
    v_add_u32 v55, s94, v6
    v_mul_u32_u24 v5, 4800, v5
    v_add3_u32 v50, v5, v4, s95
    v_add_u32 v4, 64, v3
    v_mul_u32_u24 v5, 3277, v4
    v_lshrrev_b32 v5, 16, v5
    v_lshlrev_b32 v4, 4, v4
    v_lshl_add_u32 v6, v5, 4, v4
    v_add_u32 v56, s94, v6
    v_mul_u32_u24 v5, 4800, v5
    v_add3_u32 v51, v5, v4, s95
    v_add_u32 v4, 128, v3
    v_mul_u32_u24 v5, 3277, v4
    v_lshrrev_b32 v5, 16, v5
    v_lshlrev_b32 v4, 4, v4
    v_lshl_add_u32 v6, v5, 4, v4
    v_add_u32 v57, s94, v6
    v_mul_u32_u24 v5, 4800, v5
    v_add3_u32 v52, v5, v4, s95
    v_add_u32 v4, 192, v3
    v_mul_u32_u24 v5, 3277, v4
    v_lshrrev_b32 v5, 16, v5
    v_lshlrev_b32 v4, 4, v4
    v_lshl_add_u32 v6, v5, 4, v4
    v_add_u32 v58, s94, v6
    v_mul_u32_u24 v5, 4800, v5
    v_add3_u32 v53, v5, v4, s95
    v_add_u32 v4, 256, v3
    v_mul_u32_u24 v5, 3277, v4
    v_lshrrev_b32 v5, 16, v5
    v_lshlrev_b32 v4, 4, v4
    v_lshl_add_u32 v6, v5, 4, v4
    v_add_u32 v59, s94, v6
    v_mul_u32_u24 v5, 4800, v5
    v_add3_u32 v54, v5, v4, s95
    s_mov_b32 s93, 81920
    s_mov_b32 s82, 0x40000
L_poll_12:
    buffer_load_dword v4, v78, s[48:51], 0 offen sc1
    s_waitcnt vmcnt(0)
    v_xor_b32 v4, s79, v4
    v_cmp_ne_u32 vcc, 0, v4
    s_nop 3
    s_cbranch_vccz L_pdone_13
    s_sub_u32 s82, s82, 1
    s_cbranch_scc0 L_poll_12
L_pdone_13:
    s_mov_b32 s81, 0
    buffer_load_dwordx4 a[0:3], v16, s[52:55], s81 offen offset:0
    buffer_load_dwordx4 a[4:7], v16, s[52:55], s81 offen offset:1024
    buffer_load_dwordx4 a[8:11], v17, s[52:55], s81 offen offset:0
    buffer_load_dwordx4 a[12:15], v18, s[52:55], s81 offen offset:0
    buffer_load_dwordx4 a[16:19], v18, s[52:55], s81 offen offset:1024
    buffer_load_dwordx4 a[20:23], v19, s[52:55], s81 offen offset:0
    buffer_load_dwordx4 a[24:27], v19, s[52:55], s81 offen offset:1024
    buffer_load_dwordx4 a[28:31], v20, s[52:55], s81 offen offset:0
    buffer_load_dwordx2 a[32:33], v38, s[52:55], s81 offen offset:0
    buffer_load_dwordx2 a[34:35], v38, s[52:55], s81 offen offset:1024
    buffer_load_dwordx2 a[36:37], v38, s[52:55], s81 offen offset:512
    buffer_load_dwordx2 a[38:39], v38, s[52:55], s81 offen offset:1536
    s_waitcnt vmcnt(10) lgkmcnt(0)
    v_mfma_f32_16x16x32_bf16 v[216:219], a[160:163], a[0:3], 0
    ds_read_b64_tr_b16 a[180:181], v40 offset:18432
    ds_read_b64_tr_b16 a[182:183], v40 offset:18688
    v_mfma_f32_16x16x32_bf16 v[220:223], a[160:163], a[4:7], 0
    ds_read_b64_tr_b16 a[184:185], v43 offset:18432
    ds_read_b64_tr_b16 a[186:187], v43 offset:18688
    v_mfma_f32_16x16x32_bf16 v[224:227], a[164:167], a[0:3], 0
    ds_read_b64_tr_b16 a[188:189], v40 offset:19456
    ds_read_b64_tr_b16 a[190:191], v40 offset:19712
    v_mfma_f32_16x16x32_bf16 v[228:231], a[164:167], a[4:7], 0
    ds_read_b64_tr_b16 a[192:193], v43 offset:19456
    ds_read_b64_tr_b16 a[194:195], v43 offset:19712
    v_mfma_f32_16x16x32_bf16 v[232:235], a[168:171], a[0:3], 0
    ds_read_b64_tr_b16 a[196:197], v40 offset:20480
    ds_read_b64_tr_b16 a[198:199], v40 offset:20736
    v_mfma_f32_16x16x32_bf16 v[236:239], a[168:171], a[4:7], 0
    s_mov_b32 s81, 20480
    buffer_load_dwordx4 a[40:43], v16, s[52:55], s81 offen offset:0
    v_mfma_f32_16x16x32_bf16 v[240:243], a[172:175], a[0:3], 0
    v_mfma_f32_16x16x32_bf16 v[244:247], a[172:175], a[4:7], 0
    buffer_load_dwordx4 a[44:47], v16, s[52:55], s81 offen offset:1024
    v_mfma_f32_16x16x32_bf16 v[248:251], a[176:179], a[0:3], 0
    v_mfma_f32_16x16x32_bf16 v[252:255], a[176:179], a[4:7], 0
    s_waitcnt vmcnt(10) lgkmcnt(0)
    v_mfma_f32_16x16x32_bf16 v[216:219], a[180:183], a[8:11], v[216:219]
    ds_read_b64_tr_b16 a[160:161], v43 offset:10240
    ds_read_b64_tr_b16 a[162:163], v43 offset:10496
    v_mfma_f32_16x16x32_bf16 v[220:223], a[180:183], a[12:15], v[220:223]
    ds_read_b64_tr_b16 a[164:165], v40 offset:11264
    ds_read_b64_tr_b16 a[166:167], v40 offset:11520
    v_mfma_f32_16x16x32_bf16 v[224:227], a[184:187], a[8:11], v[224:227]
    ds_read_b64_tr_b16 a[168:169], v43 offset:11264
    ds_read_b64_tr_b16 a[170:171], v43 offset:11520
    v_mfma_f32_16x16x32_bf16 v[228:231], a[184:187], a[12:15], v[228:231]
    ds_read_b64_tr_b16 a[172:173], v40 offset:12288
    ds_read_b64_tr_b16 a[174:175], v40 offset:12544
    v_mfma_f32_16x16x32_bf16 v[232:235], a[188:191], a[8:11], v[232:235]
    ds_read_b64_tr_b16 a[176:177], v43 offset:12288
    ds_read_b64_tr_b16 a[178:179], v43 offset:12544
    v_mfma_f32_16x16x32_bf16 v[236:239], a[188:191], a[12:15], v[236:239]
    buffer_load_dwordx4 a[48:51], v17, s[52:55], s81 offen offset:0
    v_mfma_f32_16x16x32_bf16 v[240:243], a[192:195], a[8:11], v[240:243]
    v_mfma_f32_16x16x32_bf16 v[244:247], a[192:195], a[12:15], v[244:247]
    buffer_load_dwordx4 a[52:55], v18, s[52:55], s81 offen offset:0
    v_mfma_f32_16x16x32_bf16 v[248:251], a[196:199], a[8:11], v[248:251]
    v_mfma_f32_16x16x32_bf16 v[252:255], a[196:199], a[12:15], v[252:255]
    s_waitcnt vmcnt(10) lgkmcnt(0)
    v_mfma_f32_16x16x32_bf16 v[216:219], a[160:163], a[16:19], v[216:219]
    ds_read_b64_tr_b16 a[180:181], v43 offset:20480
    ds_read_b64_tr_b16 a[182:183], v43 offset:20736
    v_mfma_f32_16x16x32_bf16 v[220:223], a[160:163], a[20:23], v[220:223]
    ds_read_b64_tr_b16 a[184:185], v40 offset:21504
    ds_read_b64_tr_b16 a[186:187], v40 offset:21760
    v_mfma_f32_16x16x32_bf16 v[224:227], a[164:167], a[16:19], v[224:227]
    ds_read_b64_tr_b16 a[188:189], v43 offset:21504
    ds_read_b64_tr_b16 a[190:191], v43 offset:21760
    v_mfma_f32_16x16x32_bf16 v[228:231], a[164:167], a[20:23], v[228:231]
    ds_read_b64_tr_b16 a[192:193], v40 offset:22528
    ds_read_b64_tr_b16 a[194:195], v40 offset:22784
    v_mfma_f32_16x16x32_bf16 v[232:235], a[168:171], a[16:19], v[232:235]
    ds_read_b64_tr_b16 a[196:197], v43 offset:22528
    ds_read_b64_tr_b16 a[198:199], v43 offset:22784
    v_mfma_f32_16x16x32_bf16 v[236:239], a[168:171], a[20:23], v[236:239]
    buffer_load_dwordx4 a[56:59], v18, s[52:55], s81 offen offset:1024
    v_mfma_f32_16x16x32_bf16 v[240:243], a[172:175], a[16:19], v[240:243]
    v_mfma_f32_16x16x32_bf16 v[244:247], a[172:175], a[20:23], v[244:247]
    buffer_load_dwordx4 a[60:63], v19, s[52:55], s81 offen offset:0
    v_mfma_f32_16x16x32_bf16 v[248:251], a[176:179], a[16:19], v[248:251]
    v_mfma_f32_16x16x32_bf16 v[252:255], a[176:179], a[20:23], v[252:255]
    s_waitcnt vmcnt(10) lgkmcnt(0)
    v_mfma_f32_16x16x32_bf16 v[216:219], a[180:183], a[24:27], v[216:219]
    ds_read_b64_tr_b16 a[160:161], v39 offset:49152
    ds_read_b64_tr_b16 a[162:163], v39 offset:49408
    v_mfma_f32_16x16x32_bf16 v[220:223], a[180:183], a[28:31], v[220:223]
    ds_read_b64_tr_b16 a[164:165], v42 offset:49152
    ds_read_b64_tr_b16 a[166:167], v42 offset:49408
    v_mfma_f32_16x16x32_bf16 v[224:227], a[184:187], a[24:27], v[224:227]
    ds_read_b64_tr_b16 a[168:169], v39 offset:50176
    ds_read_b64_tr_b16 a[170:171], v39 offset:50432
    v_mfma_f32_16x16x32_bf16 v[228:231], a[184:187], a[28:31], v[228:231]
    ds_read_b64_tr_b16 a[172:173], v42 offset:50176
    ds_read_b64_tr_b16 a[174:175], v42 offset:50432
    v_mfma_f32_16x16x32_bf16 v[232:235], a[188:191], a[24:27], v[232:235]
    ds_read_b64_tr_b16 a[176:177], v39 offset:51200
    ds_read_b64_tr_b16 a[178:179], v39 offset:51456
    v_mfma_f32_16x16x32_bf16 v[236:239], a[188:191], a[28:31], v[236:239]
    buffer_load_dwordx4 a[64:67], v19, s[52:55], s81 offen offset:1024
    v_mfma_f32_16x16x32_bf16 v[240:243], a[192:195], a[24:27], v[240:243]
    v_mfma_f32_16x16x32_bf16 v[244:247], a[192:195], a[28:31], v[244:247]
    buffer_load_dwordx4 a[68:71], v20, s[52:55], s81 offen offset:0
    v_mfma_f32_16x16x32_bf16 v[248:251], a[196:199], a[24:27], v[248:251]
    v_mfma_f32_16x16x32_bf16 v[252:255], a[196:199], a[28:31], v[252:255]
    s_waitcnt vmcnt(8) lgkmcnt(0)
    v_mfma_f32_16x16x32_bf16 v[216:219], a[160:163], a[32:35], v[216:219]
    ds_read_b64_tr_b16 a[180:181], v40 offset:28672
    ds_read_b64_tr_b16 a[182:183], v40 offset:28928
    v_mfma_f32_16x16x32_bf16 v[220:223], a[160:163], a[36:39], v[220:223]
    ds_read_b64_tr_b16 a[184:185], v43 offset:28672
    ds_read_b64_tr_b16 a[186:187], v43 offset:28928
    v_mfma_f32_16x16x32_bf16 v[224:227], a[164:167], a[32:35], v[224:227]
    ds_read_b64_tr_b16 a[188:189], v40 offset:29696
    ds_read_b64_tr_b16 a[190:191], v40 offset:29952
    v_mfma_f32_16x16x32_bf16 v[228:231], a[164:167], a[36:39], v[228:231]
    ds_read_b64_tr_b16 a[192:193], v43 offset:29696
    ds_read_b64_tr_b16 a[194:195], v43 offset:29952
    v_mfma_f32_16x16x32_bf16 v[232:235], a[168:171], a[32:35], v[232:235]
    ds_read_b64_tr_b16 a[196:197], v40 offset:30720
    ds_read_b64_tr_b16 a[198:199], v40 offset:30976
    v_mfma_f32_16x16x32_bf16 v[236:239], a[168:171], a[36:39], v[236:239]
    buffer_load_dwordx2 a[72:73], v38, s[52:55], s81 offen offset:0
    buffer_load_dwordx2 a[74:75], v38, s[52:55], s81 offen offset:1024
    v_mfma_f32_16x16x32_bf16 v[240:243], a[172:175], a[32:35], v[240:243]
    v_mfma_f32_16x16x32_bf16 v[244:247], a[172:175], a[36:39], v[244:247]
    buffer_load_dwordx2 a[76:77], v38, s[52:55], s81 offen offset:512
    buffer_load_dwordx2 a[78:79], v38, s[52:55], s81 offen offset:1536
    v_mfma_f32_16x16x32_bf16 v[248:251], a[176:179], a[32:35], v[248:251]
    v_mfma_f32_16x16x32_bf16 v[252:255], a[176:179], a[36:39], v[252:255]
    s_waitcnt vmcnt(10) lgkmcnt(0)
    v_mfma_f32_16x16x32_bf16 v[216:219], a[180:183], a[40:43], v[216:219]
    ds_read_b64_tr_b16 a[160:161], v40 offset:38912
    ds_read_b64_tr_b16 a[162:163], v40 offset:39168
    v_mfma_f32_16x16x32_bf16 v[220:223], a[180:183], a[44:47], v[220:223]
    ds_read_b64_tr_b16 a[164:165], v43 offset:38912
    ds_read_b64_tr_b16 a[166:167], v43 offset:39168
    v_mfma_f32_16x16x32_bf16 v[224:227], a[184:187], a[40:43], v[224:227]
    ds_read_b64_tr_b16 a[168:169], v40 offset:39936
    ds_read_b64_tr_b16 a[170:171], v40 offset:40192
    v_mfma_f32_16x16x32_bf16 v[228:231], a[184:187], a[44:47], v[228:231]
    ds_read_b64_tr_b16 a[172:173], v43 offset:39936
    ds_read_b64_tr_b16 a[174:175], v43 offset:40192
    v_mfma_f32_16x16x32_bf16 v[232:235], a[188:191], a[40:43], v[232:235]
    ds_read_b64_tr_b16 a[176:177], v40 offset:40960
    ds_read_b64_tr_b16 a[178:179], v40 offset:41216
    v_mfma_f32_16x16x32_bf16 v[236:239], a[188:191], a[44:47], v[236:239]
    s_mov_b32 s81, 40960
    buffer_load_dwordx4 a[80:83], v16, s[52:55], s81 offen offset:0
    v_mfma_f32_16x16x32_bf16 v[240:243], a[192:195], a[40:43], v[240:243]
    v_mfma_f32_16x16x32_bf16 v[244:247], a[192:195], a[44:47], v[244:247]
    buffer_load_dwordx4 a[84:87], v16, s[52:55], s81 offen offset:1024
    v_mfma_f32_16x16x32_bf16 v[248:251], a[196:199], a[40:43], v[248:251]
    v_mfma_f32_16x16x32_bf16 v[252:255], a[196:199], a[44:47], v[252:255]
    s_waitcnt vmcnt(10) lgkmcnt(0)
    v_mfma_f32_16x16x32_bf16 v[216:219], a[160:163], a[48:51], v[216:219]
    ds_read_b64_tr_b16 a[180:181], v43 offset:30720
    ds_read_b64_tr_b16 a[182:183], v43 offset:30976
    v_mfma_f32_16x16x32_bf16 v[220:223], a[160:163], a[52:55], v[220:223]
    ds_read_b64_tr_b16 a[184:185], v40 offset:31744
    ds_read_b64_tr_b16 a[186:187], v40 offset:32000
    v_mfma_f32_16x16x32_bf16 v[224:227], a[164:167], a[48:51], v[224:227]
    ds_read_b64_tr_b16 a[188:189], v43 offset:31744
    ds_read_b64_tr_b16 a[190:191], v43 offset:32000
    v_mfma_f32_16x16x32_bf16 v[228:231], a[164:167], a[52:55], v[228:231]
    ds_read_b64_tr_b16 a[192:193], v40 offset:32768
    ds_read_b64_tr_b16 a[194:195], v40 offset:33024
    v_mfma_f32_16x16x32_bf16 v[232:235], a[168:171], a[48:51], v[232:235]
    ds_read_b64_tr_b16 a[196:197], v43 offset:32768
    ds_read_b64_tr_b16 a[198:199], v43 offset:33024
    v_mfma_f32_16x16x32_bf16 v[236:239], a[168:171], a[52:55], v[236:239]
    buffer_load_dwordx4 a[88:91], v17, s[52:55], s81 offen offset:0
    v_mfma_f32_16x16x32_bf16 v[240:243], a[172:175], a[48:51], v[240:243]
    v_mfma_f32_16x16x32_bf16 v[244:247], a[172:175], a[52:55], v[244:247]
    buffer_load_dwordx4 a[92:95], v18, s[52:55], s81 offen offset:0
    v_mfma_f32_16x16x32_bf16 v[248:251], a[176:179], a[48:51], v[248:251]
    v_mfma_f32_16x16x32_bf16 v[252:255], a[176:179], a[52:55], v[252:255]
    s_waitcnt vmcnt(10) lgkmcnt(0)
    v_mfma_f32_16x16x32_bf16 v[216:219], a[180:183], a[56:59], v[216:219]
    ds_read_b64_tr_b16 a[160:161], v43 offset:40960
    ds_read_b64_tr_b16 a[162:163], v43 offset:41216
    v_mfma_f32_16x16x32_bf16 v[220:223], a[180:183], a[60:63], v[220:223]
    ds_read_b64_tr_b16 a[164:165], v40 offset:41984
    ds_read_b64_tr_b16 a[166:167], v40 offset:42240
    v_mfma_f32_16x16x32_bf16 v[224:227], a[184:187], a[56:59], v[224:227]
    ds_read_b64_tr_b16 a[168:169], v43 offset:41984
    ds_read_b64_tr_b16 a[170:171], v43 offset:42240
    v_mfma_f32_16x16x32_bf16 v[228:231], a[184:187], a[60:63], v[228:231]
    ds_read_b64_tr_b16 a[172:173], v40 offset:43008
    ds_read_b64_tr_b16 a[174:175], v40 offset:43264
    v_mfma_f32_16x16x32_bf16 v[232:235], a[188:191], a[56:59], v[232:235]
    ds_read_b64_tr_b16 a[176:177], v43 offset:43008
    ds_read_b64_tr_b16 a[178:179], v43 offset:43264
    v_mfma_f32_16x16x32_bf16 v[236:239], a[188:191], a[60:63], v[236:239]
    buffer_load_dwordx4 a[96:99], v18, s[52:55], s81 offen offset:1024
    v_mfma_f32_16x16x32_bf16 v[240:243], a[192:195], a[56:59], v[240:243]
    v_mfma_f32_16x16x32_bf16 v[244:247], a[192:195], a[60:63], v[244:247]
    buffer_load_dwordx4 a[100:103], v19, s[52:55], s81 offen offset:0
    v_mfma_f32_16x16x32_bf16 v[248:251], a[196:199], a[56:59], v[248:251]
    v_mfma_f32_16x16x32_bf16 v[252:255], a[196:199], a[60:63], v[252:255]
    s_waitcnt vmcnt(10) lgkmcnt(0)
    v_mfma_f32_16x16x32_bf16 v[216:219], a[160:163], a[64:67], v[216:219]
    ds_read_b64_tr_b16 a[180:181], v39 offset:59392
    ds_read_b64_tr_b16 a[182:183], v39 offset:59648
    v_mfma_f32_16x16x32_bf16 v[220:223], a[160:163], a[68:71], v[220:223]
    ds_read_b64_tr_b16 a[184:185], v42 offset:59392
    ds_read_b64_tr_b16 a[186:187], v42 offset:59648
    v_mfma_f32_16x16x32_bf16 v[224:227], a[164:167], a[64:67], v[224:227]
    ds_read_b64_tr_b16 a[188:189], v39 offset:60416
    ds_read_b64_tr_b16 a[190:191], v39 offset:60672
    v_mfma_f32_16x16x32_bf16 v[228:231], a[164:167], a[68:71], v[228:231]
    ds_read_b64_tr_b16 a[192:193], v42 offset:60416
    ds_read_b64_tr_b16 a[194:195], v42 offset:60672
    v_mfma_f32_16x16x32_bf16 v[232:235], a[168:171], a[64:67], v[232:235]
    ds_read_b64_tr_b16 a[196:197], v39 offset:61440
    ds_read_b64_tr_b16 a[198:199], v39 offset:61696
    v_mfma_f32_16x16x32_bf16 v[236:239], a[168:171], a[68:71], v[236:239]
    buffer_load_dwordx4 a[104:107], v19, s[52:55], s81 offen offset:1024
    v_mfma_f32_16x16x32_bf16 v[240:243], a[172:175], a[64:67], v[240:243]
    v_mfma_f32_16x16x32_bf16 v[244:247], a[172:175], a[68:71], v[244:247]
    buffer_load_dwordx4 a[108:111], v20, s[52:55], s81 offen offset:0
    v_mfma_f32_16x16x32_bf16 v[248:251], a[176:179], a[64:67], v[248:251]
    v_mfma_f32_16x16x32_bf16 v[252:255], a[176:179], a[68:71], v[252:255]
    s_waitcnt vmcnt(8) lgkmcnt(0)
    v_mfma_f32_16x16x32_bf16 v[216:219], a[180:183], a[72:75], v[216:219]
    ds_read_b64_tr_b16 a[160:161], v40 offset:49152
    ds_read_b64_tr_b16 a[162:163], v40 offset:49408
    v_mfma_f32_16x16x32_bf16 v[220:223], a[180:183], a[76:79], v[220:223]
    ds_read_b64_tr_b16 a[164:165], v43 offset:49152
    ds_read_b64_tr_b16 a[166:167], v43 offset:49408
    v_mfma_f32_16x16x32_bf16 v[224:227], a[184:187], a[72:75], v[224:227]
    ds_read_b64_tr_b16 a[168:169], v40 offset:50176
    ds_read_b64_tr_b16 a[170:171], v40 offset:50432
    v_mfma_f32_16x16x32_bf16 v[228:231], a[184:187], a[76:79], v[228:231]
    ds_read_b64_tr_b16 a[172:173], v43 offset:50176
    ds_read_b64_tr_b16 a[174:175], v43 offset:50432
    v_mfma_f32_16x16x32_bf16 v[232:235], a[188:191], a[72:75], v[232:235]
    ds_read_b64_tr_b16 a[176:177], v40 offset:51200
    ds_read_b64_tr_b16 a[178:179], v40 offset:51456
    v_mfma_f32_16x16x32_bf16 v[236:239], a[188:191], a[76:79], v[236:239]
    buffer_load_dwordx2 a[112:113], v38, s[52:55], s81 offen offset:0
    buffer_load_dwordx2 a[114:115], v38, s[52:55], s81 offen offset:1024
    v_mfma_f32_16x16x32_bf16 v[240:243], a[192:195], a[72:75], v[240:243]
    v_mfma_f32_16x16x32_bf16 v[244:247], a[192:195], a[76:79], v[244:247]
    buffer_load_dwordx2 a[116:117], v38, s[52:55], s81 offen offset:512
    buffer_load_dwordx2 a[118:119], v38, s[52:55], s81 offen offset:1536
    v_mfma_f32_16x16x32_bf16 v[248:251], a[196:199], a[72:75], v[248:251]
    v_mfma_f32_16x16x32_bf16 v[252:255], a[196:199], a[76:79], v[252:255]
    s_waitcnt vmcnt(10) lgkmcnt(0)
    v_mfma_f32_16x16x32_bf16 v[216:219], a[160:163], a[80:83], v[216:219]
    ds_read_b64_tr_b16 a[180:181], v40 offset:59392
    ds_read_b64_tr_b16 a[182:183], v40 offset:59648
    v_mfma_f32_16x16x32_bf16 v[220:223], a[160:163], a[84:87], v[220:223]
    ds_read_b64_tr_b16 a[184:185], v43 offset:59392
    ds_read_b64_tr_b16 a[186:187], v43 offset:59648
    v_mfma_f32_16x16x32_bf16 v[224:227], a[164:167], a[80:83], v[224:227]
    ds_read_b64_tr_b16 a[188:189], v40 offset:60416
    ds_read_b64_tr_b16 a[190:191], v40 offset:60672
    v_mfma_f32_16x16x32_bf16 v[228:231], a[164:167], a[84:87], v[228:231]
    ds_read_b64_tr_b16 a[192:193], v43 offset:60416
    ds_read_b64_tr_b16 a[194:195], v43 offset:60672
    v_mfma_f32_16x16x32_bf16 v[232:235], a[168:171], a[80:83], v[232:235]
    ds_read_b64_tr_b16 a[196:197], v40 offset:61440
    ds_read_b64_tr_b16 a[198:199], v40 offset:61696
    v_mfma_f32_16x16x32_bf16 v[236:239], a[168:171], a[84:87], v[236:239]
    s_mov_b32 s81, 61440
    buffer_load_dwordx4 a[120:123], v16, s[52:55], s81 offen offset:0
    v_mfma_f32_16x16x32_bf16 v[240:243], a[172:175], a[80:83], v[240:243]
    v_mfma_f32_16x16x32_bf16 v[244:247], a[172:175], a[84:87], v[244:247]
    buffer_load_dwordx4 a[124:127], v16, s[52:55], s81 offen offset:1024
    v_mfma_f32_16x16x32_bf16 v[248:251], a[176:179], a[80:83], v[248:251]
    v_mfma_f32_16x16x32_bf16 v[252:255], a[176:179], a[84:87], v[252:255]
    s_waitcnt vmcnt(10) lgkmcnt(0)
    v_mfma_f32_16x16x32_bf16 v[216:219], a[180:183], a[88:91], v[216:219]
    ds_read_b64_tr_b16 a[160:161], v43 offset:51200
    ds_read_b64_tr_b16 a[162:163], v43 offset:51456
    v_mfma_f32_16x16x32_bf16 v[220:223], a[180:183], a[92:95], v[220:223]
    ds_read_b64_tr_b16 a[164:165], v40 offset:52224
    ds_read_b64_tr_b16 a[166:167], v40 offset:52480
    v_mfma_f32_16x16x32_bf16 v[224:227], a[184:187], a[88:91], v[224:227]
    ds_read_b64_tr_b16 a[168:169], v43 offset:52224
    ds_read_b64_tr_b16 a[170:171], v43 offset:52480
    v_mfma_f32_16x16x32_bf16 v[228:231], a[184:187], a[92:95], v[228:231]
    ds_read_b64_tr_b16 a[172:173], v40 offset:53248
    ds_read_b64_tr_b16 a[174:175], v40 offset:53504
    v_mfma_f32_16x16x32_bf16 v[232:235], a[188:191], a[88:91], v[232:235]
    ds_read_b64_tr_b16 a[176:177], v43 offset:53248
    ds_read_b64_tr_b16 a[178:179], v43 offset:53504
    v_mfma_f32_16x16x32_bf16 v[236:239], a[188:191], a[92:95], v[236:239]
    buffer_load_dwordx4 a[128:131], v17, s[52:55], s81 offen offset:0
    v_mfma_f32_16x16x32_bf16 v[240:243], a[192:195], a[88:91], v[240:243]
    v_mfma_f32_16x16x32_bf16 v[244:247], a[192:195], a[92:95], v[244:247]
    buffer_load_dwordx4 a[132:135], v18, s[52:55], s81 offen offset:0
    v_mfma_f32_16x16x32_bf16 v[248:251], a[196:199], a[88:91], v[248:251]
    v_mfma_f32_16x16x32_bf16 v[252:255], a[196:199], a[92:95], v[252:255]
    s_waitcnt vmcnt(10) lgkmcnt(0)
    v_mfma_f32_16x16x32_bf16 v[216:219], a[160:163], a[96:99], v[216:219]
    ds_read_b64_tr_b16 a[180:181], v43 offset:61440
    ds_read_b64_tr_b16 a[182:183], v43 offset:61696
    v_mfma_f32_16x16x32_bf16 v[220:223], a[160:163], a[100:103], v[220:223]
    ds_read_b64_tr_b16 a[184:185], v40 offset:62464
    ds_read_b64_tr_b16 a[186:187], v40 offset:62720
    v_mfma_f32_16x16x32_bf16 v[224:227], a[164:167], a[96:99], v[224:227]
    ds_read_b64_tr_b16 a[188:189], v43 offset:62464
    ds_read_b64_tr_b16 a[190:191], v43 offset:62720
    v_mfma_f32_16x16x32_bf16 v[228:231], a[164:167], a[100:103], v[228:231]
    ds_read_b64_tr_b16 a[192:193], v40 offset:63488
    ds_read_b64_tr_b16 a[194:195], v40 offset:63744
    v_mfma_f32_16x16x32_bf16 v[232:235], a[168:171], a[96:99], v[232:235]
    ds_read_b64_tr_b16 a[196:197], v43 offset:63488
    ds_read_b64_tr_b16 a[198:199], v43 offset:63744
    v_mfma_f32_16x16x32_bf16 v[236:239], a[168:171], a[100:103], v[236:239]
    buffer_load_dwordx4 a[136:139], v18, s[52:55], s81 offen offset:1024
    v_mfma_f32_16x16x32_bf16 v[240:243], a[172:175], a[96:99], v[240:243]
    v_mfma_f32_16x16x32_bf16 v[244:247], a[172:175], a[100:103], v[244:247]
    buffer_load_dwordx4 a[140:143], v19, s[52:55], s81 offen offset:0
    v_mfma_f32_16x16x32_bf16 v[248:251], a[176:179], a[96:99], v[248:251]
    v_mfma_f32_16x16x32_bf16 v[252:255], a[176:179], a[100:103], v[252:255]
    s_waitcnt vmcnt(10) lgkmcnt(0)
    v_mfma_f32_16x16x32_bf16 v[216:219], a[180:183], a[104:107], v[216:219]
    ds_read_b64_tr_b16 a[160:161], v42 offset:51200
    ds_read_b64_tr_b16 a[162:163], v42 offset:51456
    v_mfma_f32_16x16x32_bf16 v[220:223], a[180:183], a[108:111], v[220:223]
    ds_read_b64_tr_b16 a[164:165], v39 offset:52224
    ds_read_b64_tr_b16 a[166:167], v39 offset:52480
    v_mfma_f32_16x16x32_bf16 v[224:227], a[184:187], a[104:107], v[224:227]
    ds_read_b64_tr_b16 a[168:169], v42 offset:52224
    ds_read_b64_tr_b16 a[170:171], v42 offset:52480
    v_mfma_f32_16x16x32_bf16 v[228:231], a[184:187], a[108:111], v[228:231]
    ds_read_b64_tr_b16 a[172:173], v39 offset:53248
    ds_read_b64_tr_b16 a[174:175], v39 offset:53504
    v_mfma_f32_16x16x32_bf16 v[232:235], a[188:191], a[104:107], v[232:235]
    ds_read_b64_tr_b16 a[176:177], v42 offset:53248
    ds_read_b64_tr_b16 a[178:179], v42 offset:53504
    v_mfma_f32_16x16x32_bf16 v[236:239], a[188:191], a[108:111], v[236:239]
    buffer_load_dwordx4 a[144:147], v19, s[52:55], s81 offen offset:1024
    v_mfma_f32_16x16x32_bf16 v[240:243], a[192:195], a[104:107], v[240:243]
    v_mfma_f32_16x16x32_bf16 v[244:247], a[192:195], a[108:111], v[244:247]
    buffer_load_dwordx4 a[148:151], v20, s[52:55], s81 offen offset:0
    v_mfma_f32_16x16x32_bf16 v[248:251], a[196:199], a[104:107], v[248:251]
    v_mfma_f32_16x16x32_bf16 v[252:255], a[196:199], a[108:111], v[252:255]
    s_waitcnt vmcnt(8) lgkmcnt(0)
    v_mfma_f32_16x16x32_bf16 v[216:219], a[160:163], a[112:115], v[216:219]
    ds_read_b64_tr_b16 a[180:181], v41 offset:4096
    ds_read_b64_tr_b16 a[182:183], v41 offset:4352
    v_mfma_f32_16x16x32_bf16 v[220:223], a[160:163], a[116:119], v[220:223]
    ds_read_b64_tr_b16 a[184:185], v44 offset:4096
    ds_read_b64_tr_b16 a[186:187], v44 offset:4352
    v_mfma_f32_16x16x32_bf16 v[224:227], a[164:167], a[112:115], v[224:227]
    ds_read_b64_tr_b16 a[188:189], v41 offset:5120
    ds_read_b64_tr_b16 a[190:191], v41 offset:5376
    v_mfma_f32_16x16x32_bf16 v[228:231], a[164:167], a[116:119], v[228:231]
    ds_read_b64_tr_b16 a[192:193], v44 offset:5120
    ds_read_b64_tr_b16 a[194:195], v44 offset:5376
    v_mfma_f32_16x16x32_bf16 v[232:235], a[168:171], a[112:115], v[232:235]
    ds_read_b64_tr_b16 a[196:197], v41 offset:6144
    ds_read_b64_tr_b16 a[198:199], v41 offset:6400
    v_mfma_f32_16x16x32_bf16 v[236:239], a[168:171], a[116:119], v[236:239]
    buffer_load_dwordx2 a[152:153], v38, s[52:55], s81 offen offset:0
    buffer_load_dwordx2 a[154:155], v38, s[52:55], s81 offen offset:1024
    v_mfma_f32_16x16x32_bf16 v[240:243], a[172:175], a[112:115], v[240:243]
    v_mfma_f32_16x16x32_bf16 v[244:247], a[172:175], a[116:119], v[244:247]
    buffer_load_dwordx2 a[156:157], v38, s[52:55], s81 offen offset:512
    buffer_load_dwordx2 a[158:159], v38, s[52:55], s81 offen offset:1536
    v_mfma_f32_16x16x32_bf16 v[248:251], a[176:179], a[112:115], v[248:251]
    v_mfma_f32_16x16x32_bf16 v[252:255], a[176:179], a[116:119], v[252:255]
    s_waitcnt vmcnt(10) lgkmcnt(0)
    v_mfma_f32_16x16x32_bf16 v[216:219], a[180:183], a[120:123], v[216:219]
    ds_read_b64_tr_b16 a[160:161], v41 offset:14336
    ds_read_b64_tr_b16 a[162:163], v41 offset:14592
    v_mfma_f32_16x16x32_bf16 v[220:223], a[180:183], a[124:127], v[220:223]
    ds_read_b64_tr_b16 a[164:165], v44 offset:14336
    ds_read_b64_tr_b16 a[166:167], v44 offset:14592
    v_mfma_f32_16x16x32_bf16 v[224:227], a[184:187], a[120:123], v[224:227]
    ds_read_b64_tr_b16 a[168:169], v41 offset:15360
    ds_read_b64_tr_b16 a[170:171], v41 offset:15616
    v_mfma_f32_16x16x32_bf16 v[228:231], a[184:187], a[124:127], v[228:231]
    ds_read_b64_tr_b16 a[172:173], v44 offset:15360
    ds_read_b64_tr_b16 a[174:175], v44 offset:15616
    v_mfma_f32_16x16x32_bf16 v[232:235], a[188:191], a[120:123], v[232:235]
    ds_read_b64_tr_b16 a[176:177], v41 offset:16384
    ds_read_b64_tr_b16 a[178:179], v41 offset:16640
    v_mfma_f32_16x16x32_bf16 v[236:239], a[188:191], a[124:127], v[236:239]
    v_mfma_f32_16x16x32_bf16 v[240:243], a[192:195], a[120:123], v[240:243]
    v_mfma_f32_16x16x32_bf16 v[244:247], a[192:195], a[124:127], v[244:247]
    v_mfma_f32_16x16x32_bf16 v[248:251], a[196:199], a[120:123], v[248:251]
    v_mfma_f32_16x16x32_bf16 v[252:255], a[196:199], a[124:127], v[252:255]
    s_waitcnt vmcnt(8) lgkmcnt(0)
    v_mfma_f32_16x16x32_bf16 v[216:219], a[160:163], a[128:131], v[216:219]
    ds_read_b64_tr_b16 a[180:181], v44 offset:6144
    ds_read_b64_tr_b16 a[182:183], v44 offset:6400
    v_mfma_f32_16x16x32_bf16 v[220:223], a[160:163], a[132:135], v[220:223]
    ds_read_b64_tr_b16 a[184:185], v41 offset:7168
    ds_read_b64_tr_b16 a[186:187], v41 offset:7424
    v_mfma_f32_16x16x32_bf16 v[224:227], a[164:167], a[128:131], v[224:227]
    ds_read_b64_tr_b16 a[188:189], v44 offset:7168
    ds_read_b64_tr_b16 a[190:191], v44 offset:7424
    v_mfma_f32_16x16x32_bf16 v[228:231], a[164:167], a[132:135], v[228:231]
    ds_read_b64_tr_b16 a[192:193], v41 offset:8192
    ds_read_b64_tr_b16 a[194:195], v41 offset:8448
    v_mfma_f32_16x16x32_bf16 v[232:235], a[168:171], a[128:131], v[232:235]
    ds_read_b64_tr_b16 a[196:197], v44 offset:8192
    ds_read_b64_tr_b16 a[198:199], v44 offset:8448
    v_mfma_f32_16x16x32_bf16 v[236:239], a[168:171], a[132:135], v[236:239]
    v_mfma_f32_16x16x32_bf16 v[240:243], a[172:175], a[128:131], v[240:243]
    v_mfma_f32_16x16x32_bf16 v[244:247], a[172:175], a[132:135], v[244:247]
    v_mfma_f32_16x16x32_bf16 v[248:251], a[176:179], a[128:131], v[248:251]
    v_mfma_f32_16x16x32_bf16 v[252:255], a[176:179], a[132:135], v[252:255]
    s_mov_b32 s101, 393216
    v_mov_b32 v12, s79
    s_waitcnt vmcnt(0)
    s_cmp_eq_u32 s34, 0
    s_cbranch_scc1 L_wt_14
    buffer_store_dword v12, v77, s[48:51], s101 offen
    s_branch L_j_15
L_wt_14:
    buffer_store_dword v12, v77, s[48:51], s101 offen sc1
L_j_15:
    s_waitcnt lgkmcnt(0)
    v_mfma_f32_16x16x32_bf16 v[216:219], a[180:183], a[136:139], v[216:219]
    ds_read_b64_tr_b16 a[160:161], v44 offset:16384
    ds_read_b64_tr_b16 a[162:163], v44 offset:16640
    v_mfma_f32_16x16x32_bf16 v[220:223], a[180:183], a[140:143], v[220:223]
    ds_read_b64_tr_b16 a[164:165], v41 offset:17408
    ds_read_b64_tr_b16 a[166:167], v41 offset:17664
    v_mfma_f32_16x16x32_bf16 v[224:227], a[184:187], a[136:139], v[224:227]
    ds_read_b64_tr_b16 a[168:169], v44 offset:17408
    ds_read_b64_tr_b16 a[170:171], v44 offset:17664
    v_mfma_f32_16x16x32_bf16 v[228:231], a[184:187], a[140:143], v[228:231]
    ds_read_b64_tr_b16 a[172:173], v41 offset:18432
    ds_read_b64_tr_b16 a[174:175], v41 offset:18688
    v_mfma_f32_16x16x32_bf16 v[232:235], a[188:191], a[136:139], v[232:235]
    ds_read_b64_tr_b16 a[176:177], v44 offset:18432
    ds_read_b64_tr_b16 a[178:179], v44 offset:18688
    v_mfma_f32_16x16x32_bf16 v[236:239], a[188:191], a[140:143], v[236:239]
    v_mfma_f32_16x16x32_bf16 v[240:243], a[192:195], a[136:139], v[240:243]
    v_mfma_f32_16x16x32_bf16 v[244:247], a[192:195], a[140:143], v[244:247]
    v_mfma_f32_16x16x32_bf16 v[248:251], a[196:199], a[136:139], v[248:251]
    v_mfma_f32_16x16x32_bf16 v[252:255], a[196:199], a[140:143], v[252:255]
    s_waitcnt lgkmcnt(0)
    v_mfma_f32_16x16x32_bf16 v[216:219], a[160:163], a[144:147], v[216:219]
    ds_read_b64_tr_b16 a[180:181], v42 offset:61440
    ds_read_b64_tr_b16 a[182:183], v42 offset:61696
    v_mfma_f32_16x16x32_bf16 v[224:227], a[164:167], a[144:147], v[224:227]
    ds_read_b64_tr_b16 a[184:185], v39 offset:62464
    ds_read_b64_tr_b16 a[186:187], v39 offset:62720
    v_mfma_f32_16x16x32_bf16 v[232:235], a[168:171], a[144:147], v[232:235]
    ds_read_b64_tr_b16 a[188:189], v42 offset:62464
    ds_read_b64_tr_b16 a[190:191], v42 offset:62720
    v_mfma_f32_16x16x32_bf16 v[240:243], a[172:175], a[144:147], v[240:243]
    ds_read_b64_tr_b16 a[192:193], v39 offset:63488
    ds_read_b64_tr_b16 a[194:195], v39 offset:63744
    v_mfma_f32_16x16x32_bf16 v[248:251], a[176:179], a[144:147], v[248:251]
    ds_read_b64_tr_b16 a[196:197], v42 offset:63488
    ds_read_b64_tr_b16 a[198:199], v42 offset:63744
    buffer_load_dword v13, v78, s[48:51], s101 offen sc1
    s_waitcnt lgkmcnt(0)
    v_mfma_f32_16x16x32_bf16 v[216:219], a[180:183], a[152:155], v[216:219]
    v_mfma_f32_16x16x32_bf16 v[224:227], a[184:187], a[152:155], v[224:227]
    v_mfma_f32_16x16x32_bf16 v[232:235], a[188:191], a[152:155], v[232:235]
    v_mfma_f32_16x16x32_bf16 v[240:243], a[192:195], a[152:155], v[240:243]
    v_mfma_f32_16x16x32_bf16 v[248:251], a[196:199], a[152:155], v[248:251]
    v_mfma_f32_16x16x32_bf16 v[220:223], a[160:163], a[148:151], v[220:223]
    v_mfma_f32_16x16x32_bf16 v[228:231], a[164:167], a[148:151], v[228:231]
    v_mfma_f32_16x16x32_bf16 v[236:239], a[168:171], a[148:151], v[236:239]
    s_nop 0
    ds_write_b128 v48, v[216:219] offset:0
    v_mfma_f32_16x16x32_bf16 v[244:247], a[172:175], a[148:151], v[244:247]
    ds_write_b128 v48, v[224:227] offset:64
    v_mfma_f32_16x16x32_bf16 v[252:255], a[176:179], a[148:151], v[252:255]
    v_mfma_f32_16x16x32_bf16 v[220:223], a[180:183], a[156:159], v[220:223]
    ds_write_b128 v48, v[232:235] offset:128
    v_mfma_f32_16x16x32_bf16 v[228:231], a[184:187], a[156:159], v[228:231]
    ds_write_b128 v48, v[240:243] offset:192
    v_mfma_f32_16x16x32_bf16 v[236:239], a[188:191], a[156:159], v[236:239]
    v_mfma_f32_16x16x32_bf16 v[244:247], a[192:195], a[156:159], v[244:247]
    ds_write_b128 v48, v[248:251] offset:256
    v_mfma_f32_16x16x32_bf16 v[252:255], a[196:199], a[156:159], v[252:255]
    ds_read_b128 v[176:179], v55 offset:0
    ds_read_b128 v[180:183], v56 offset:0
    ds_read_b128 v[184:187], v57 offset:0
    ds_read_b128 v[188:191], v58 offset:0
    ds_read_b128 v[192:195], v59 offset:0
    ds_write_b128 v48, v[220:223] offset:5376
    ds_write_b128 v48, v[228:231] offset:5440
    ds_write_b128 v48, v[236:239] offset:5504
    ds_write_b128 v48, v[244:247] offset:5568
    ds_write_b128 v48, v[252:255] offset:5632
    ds_read_b128 v[196:199], v55 offset:5376
    ds_read_b128 v[200:203], v56 offset:5376
    ds_read_b128 v[204:207], v57 offset:5376
    ds_read_b128 v[208:211], v58 offset:5376
    ds_read_b128 v[212:215], v59 offset:5376
    s_waitcnt vmcnt(0)
    v_cmp_ne_u32 vcc, v12, v13
    s_nop 3
    s_cbranch_vccz L_rd_17
    s_mov_b32 s82, 0x40000
L_rp_16:
    buffer_load_dword v13, v78, s[48:51], s101 offen sc1
    s_waitcnt vmcnt(0)
    v_cmp_ne_u32 vcc, v12, v13
    s_nop 3
    s_cbranch_vccz L_rd_17
    s_sub_u32 s82, s82, 1
    s_cbranch_scc0 L_rp_16
L_rd_17:
    s_waitcnt lgkmcnt(14)
    buffer_store_dwordx4 v[176:179], v50, s[52:55], 0 offen nt
    s_waitcnt lgkmcnt(13)
    buffer_store_dwordx4 v[180:183], v51, s[52:55], 0 offen nt
    s_waitcnt lgkmcnt(12)
    buffer_store_dwordx4 v[184:187], v52, s[52:55], 0 offen nt
    s_waitcnt lgkmcnt(11)
    buffer_store_dwordx4 v[188:191], v53, s[52:55], 0 offen nt
    s_waitcnt lgkmcnt(10)
    buffer_store_dwordx4 v[192:195], v54, s[52:55], 0 offen nt
    s_waitcnt lgkmcnt(4)
    buffer_store_dwordx4 v[196:199], v50, s[52:55], s93 offen nt
    s_waitcnt lgkmcnt(3)
    buffer_store_dwordx4 v[200:203], v51, s[52:55], s93 offen nt
    s_waitcnt lgkmcnt(2)
    buffer_store_dwordx4 v[204:207], v52, s[52:55], s93 offen nt
    s_waitcnt lgkmcnt(1)
    buffer_store_dwordx4 v[208:211], v53, s[52:55], s93 offen nt
    s_waitcnt lgkmcnt(0)
    buffer_store_dwordx4 v[212:215], v54, s[52:55], s93 offen nt
    s_endpgm
L_sideB:
    s_and_b32 s101, s76, 1
    s_lshl_b32 s81, s101, 6
    v_xor_b32 v7, s81, v5
    s_mul_i32 s101, s101, 40
    s_mul_i32 s81, s78, 80
    s_add_u32 s101, s101, s81
    s_mul_i32 s101, s101, 1280
    v_mul_u32_u24 v8, 1280, v2
    v_add3_u32 v20, v7, v8, s101
    v_xor_b32 v8, 64, v20
    v_add_u32 v21, 9216, v8
    v_add_u32 v22, 18432, v20
    v_add_u32 v23, 27648, v8
    v_add_u32 v24, 40960, v20
    s_cmp_ge_u32 s76, 2
    s_cselect_b32 s40, s18, s16
    s_cselect_b32 s41, s19, s17
    s_cselect_b32 s44, s22, s20
    s_cselect_b32 s45, s23, s21
    s_mov_b32 s42, 819200
    s_mov_b32 s43, 0x20000
    s_add_u32 m0, s98, 16384
    s_nop 0
    buffer_load_dwordx4 v20, s[40:43], s80 offen offset:0 lds
    buffer_load_dwordx4 v21, s[40:43], s80 offen offset:1024 lds
    buffer_load_dwordx4 v22, s[40:43], s80 offen offset:2048 lds
    buffer_load_dwordx4 v23, s[40:43], s80 offen offset:3072 lds
    s_add_u32 m0, s98, 20480
    s_nop 0
    buffer_load_dwordx4 v24, s[40:43], s80 offen offset:0 lds
L_bodyB:
    s_sub_u32 s81, s3, 5
    s_cselect_b32 s3, s3, s81
    s_cselect_b32 s99, 0, 1
    s_add_u32 s101, s3, 0
    s_sub_u32 s81, s101, 5
    s_cselect_b32 s101, s101, s81
    s_lshl_b32 s83, s101, 7
    s_add_u32 s101, s3, 1
    s_sub_u32 s81, s101, 5
    s_cselect_b32 s101, s101, s81
    s_lshl_b32 s84, s101, 7
    s_add_u32 s101, s3, 2
    s_sub_u32 s81, s101, 5
    s_cselect_b32 s101, s101, s81
    s_lshl_b32 s85, s101, 7
    s_add_u32 s101, s3, 3
    s_sub_u32 s81, s101, 5
    s_cselect_b32 s101, s101, s81
    s_lshl_b32 s86, s101, 7
    s_add_u32 s101, s3, 4
    s_sub_u32 s81, s101, 5
    s_cselect_b32 s101, s101, s81
    s_lshl_b32 s87, s101, 7
    s_mul_i32 s93, s99, 640
    s_sub_u32 s94, 640, s93
    v_and_b32 v4, 15, v1
    v_lshlrev_b32 v45, 4, v1
    v_lshrrev_b32 v6, 1, v4
    v_xor_b32 v6, v6, v3
    v_lshlrev_b32 v6, 4, v6
    v_lshl_add_u32 v6, v4, 7, v6
    v_add_u32 v98, s97, v6
    v_xor_b32 v101, 64, v98
    v_add_u32 v99, 0x10000, v98
    v_add_u32 v102, 0x10000, v101
    s_lshl_b32 s3, s2, 8
    v_or_b32 v7, s3, v0
    v_mov_b32 v8, 2147483648
    v_cmp_eq_u32 vcc, 0, v7
    s_nop 1
    v_cndmask_b32_e64 v46, v8, 0, vcc
    v_subrev_u32 v39, s97, v98
    v_xor_b32 v42, 64, v39
    v_add_u32 v40, 0x10000, v39
    v_add_u32 v43, 0x10000, v42
    s_mul_i32 s80, s78, 160
    v_lshl_add_u32 v9, v4, 1, s80
    v_min_u32 v11, 59, v1
    v_mul_u32_u24 v129, 205, v11
    v_lshrrev_b32 v129, 12, v129
    v_mul_u32_u24 v8, 20, v129
    v_sub_u32 v11, v11, v8
    s_mul_i32 s81, s76, 20
    v_add_u32 v11, s81, v11
    v_lshl_add_u32 v10, v11, 1, s80
    s_mov_b32 s48, s32
    s_mov_b32 s49, s33
    s_mov_b32 s50, 0x10000000
    s_mov_b32 s51, 0x20000
    s_mov_b32 s52, s28
    s_mov_b32 s53, s29
    s_mov_b32 s54, 10485760
    s_mov_b32 s55, 0x20000
    s_mov_b32 s56, s30
    s_mov_b32 s57, s31
    s_mov_b32 s58, 256
    s_mov_b32 s59, 0x20000
    s_mov_b32 s46, 819200
    s_mov_b32 s47, 0x20000
    s_mov_b32 s60, s12
    s_mov_b32 s61, s13
    s_mov_b32 s62, 1280
    s_mov_b32 s63, 0x20000
    s_mov_b32 s64, s14
    s_mov_b32 s65, s15
    s_mov_b32 s66, 1280
    s_mov_b32 s67, 0x20000
    s_mov_b32 s68, s24
    s_mov_b32 s69, s25
    s_mov_b32 s70, 1280
    s_mov_b32 s71, 0x20000
    s_mov_b32 s72, s26
    s_mov_b32 s73, s27
    s_mov_b32 s74, 1280
    s_mov_b32 s75, 0x20000
    s_and_b32 s81, s77, 0
    s_lshl_b32 s81, s81, 1
    s_add_u32 s81, s81, s78
    s_mul_i32 s90, s81, 5
    s_lshr_b32 s90, s90, 2
    s_sub_u32 s81, s90, 10
    s_cselect_b32 s90, s90, s81
    buffer_load_dword v47, v46, s[48:51], 0 offen sc1
    buffer_load_ushort v136, v9, s[60:63], 0 offen offset:0
    buffer_load_ushort v137, v9, s[64:67], 0 offen offset:0
    buffer_load_ushort v138, v9, s[68:71], 0 offen offset:0
    buffer_load_ushort v139, v9, s[60:63], 0 offen offset:32
    buffer_load_ushort v140, v9, s[64:67], 0 offen offset:32
    buffer_load_ushort v141, v9, s[68:71], 0 offen offset:32
    buffer_load_ushort v142, v9, s[60:63], 0 offen offset:64
    buffer_load_ushort v143, v9, s[64:67], 0 offen offset:64
    buffer_load_ushort v144, v9, s[68:71], 0 offen offset:64
    buffer_load_ushort v145, v9, s[60:63], 0 offen offset:96
    buffer_load_ushort v146, v9, s[64:67], 0 offen offset:96
    buffer_load_ushort v147, v9, s[68:71], 0 offen offset:96
    buffer_load_ushort v148, v9, s[60:63], 0 offen offset:128
    buffer_load_ushort v149, v9, s[64:67], 0 offen offset:128
    buffer_load_ushort v150, v9, s[68:71], 0 offen offset:128
    buffer_load_ushort v151, v10, s[60:63], 0 offen offset:0
    buffer_load_ushort v152, v10, s[64:67], 0 offen offset:0
    buffer_load_ushort v153, v10, s[68:71], 0 offen offset:0
    s_add_u32 m0, s97, 36864
    s_add_u32 s80, s84, s93
    buffer_load_dwordx4 v16, s[36:39], s80 offen offset:0 lds
    buffer_load_dwordx4 v17, s[36:39], s80 offen offset:1024 lds
    v_add_u32 v100, 0x20000, v98
    v_add_u32 v103, 0x20000, v101
    v_add_u32 v41, 0x20000, v39
    v_add_u32 v44, 0x20000, v42
    s_lshr_b32 s3, s100, 2
    s_lshl_b32 s3, s3, 4
    s_add_u32 s3, s3, s77
    s_lshl_b32 s3, s3, 10
    s_add_u32 s3, s3, 786432
    v_lshrrev_b32 v7, 3, v1
    v_lshl_add_u32 v105, v7, 7, s3
    s_lshl_b32 s34, s78, 7
    s_add_u32 s3, s3, s34
    v_mov_b32 v7, s3
    v_mov_b32 v8, 2147483648
    v_cmp_eq_u32 vcc, 0, v0
    s_nop 1
    v_cndmask_b32 v104, v8, v7, vcc
    s_getreg_b32 s3, hwreg(HW_REG_XCC_ID, 0, 4)
    v_mov_b32 v107, s3
    s_lshr_b32 s3, s2, 3
    s_mul_i32 s3, s3, 200
    s_and_b32 s35, s76, 1
    s_mul_i32 s35, s35, 100
    s_add_u32 s3, s3, s35
    v_add_u32 v35, s3, v1
    v_lshlrev_b32 v35, 7, v35
    v_add_u32 v36, 8192, v35
    s_and_b32 s3, s100, 3
    s_mul_i32 s3, s3, 3200
    v_add_u32 v2, s3, v35
    v_mov_b32 v5, 2147483648
    v_cmp_gt_u32 vcc, 25, v1
    s_nop 1
    v_cndmask_b32 v37, v5, v2, vcc
    s_lshl_b32 s3, s76, 2
    v_add_u32 v94, s3, v3
    v_mul_u32_u24 v2, 640, v94
    v_lshl_add_u32 v2, v4, 3, v2
    v_add_u32 v25, 143360, v2
    v_lshlrev_b32 v2, 3, v11
    v_add_u32 v26, 143360, v2
    v_mul_u32_u24 v5, 640, v129
    v_add_u32 v128, v26, v5
    v_lshlrev_b32 v2, 3, v4
    v_add_u32 v27, 153600, v2
    v_lshlrev_b32 v94, 3, v94
    v_cvt_f32_u32 v94, v94
    s_mul_i32 s3, s78, 1280
    s_mul_i32 s35, s77, 10240
    s_add_u32 s3, s3, s35
    v_lshl_add_u32 v2, v11, 4, s3
    v_mov_b32 v5, 2147483648
    v_cmp_gt_u32 vcc, 20, v1
    s_nop 1
    v_cndmask_b32 v28, v5, v2, vcc
    v_mul_u32_u24 v5, 51200, v129
    v_add_u32 v2, v2, v5
    v_add_u32 v118, 0xfffda800, v2
    v_add_u32 v119, 0xfffdd000, v2
    v_add_u32 v120, 0xfffdf800, v2
    v_add_u32 v121, 0xfffe2000, v2
    v_add_u32 v122, 0xfffe4800, v2
    s_lshl_b32 s3, s76, 11
    s_add_u32 s3, s3, 143360
    v_bfe_u32 v2, v4, 1, 2
    v_lshrrev_b32 v5, 3, v4
    v_lshlrev_b32 v5, 1, v5
    v_xor_b32 v2, v2, v5
    v_xor_b32 v2, v2, v3
    v_lshlrev_b32 v2, 4, v2
    v_lshl_add_u32 v2, v4, 6, v2
    v_add_u32 v29, s3, v2
    v_and_b32 v2, 1, v3
    v_bfe_u32 v5, v1, 2, 2
    v_lshl_add_u32 v6, v2, 3, v5
    v_lshlrev_b32 v6, 6, v6
    v_lshrrev_b32 v5, 1, v5
    v_bfe_u32 v7, v1, 1, 1
    v_xor_b32 v5, v5, v7
    v_lshl_add_u32 v5, v2, 1, v5
    v_lshl_add_u32 v6, v5, 4, v6
    v_and_b32 v5, 1, v1
    v_lshl_add_u32 v6, v5, 3, v6
    v_lshrrev_b32 v5, 1, v3
    v_lshl_add_u32 v6, v5, 10, v6
    v_add_u32 v30, s3, v6
    v_xor_b32 v31, 32, v30
    s_lshl_b32 s3, s77, 2
    s_add_u32 s3, s3, s76
    s_mul_i32 s88, s3, 163840
    s_add_u32 s88, s88, 2560
    s_mul_i32 s89, s78, 20480
    s_add_u32 s35, s89, s88
    v_add_u32 v32, s35, v45
    s_lshl_b32 s3, s3, 10
    s_add_u32 s3, s3, 262144
    v_lshrrev_b32 v2, 3, v1
    v_lshlrev_b32 v2, 7, v2
    v_add_u32 v34, s3, v2
    s_lshl_b32 s35, s78, 7
    s_add_u32 s3, s3, s35
    v_mov_b32 v2, s3
    v_mov_b32 v5, 2147483648
    v_cmp_eq_u32 vcc, 0, v1
    s_nop 1
    v_cndmask_b32 v33, v5, v2, vcc
    v_and_b32 v2, 1, v3
    v_lshrrev_b32 v5, 1, v4
    v_xor_b32 v2, v2, v5
    v_lshlrev_b32 v2, 4, v2
    v_lshl_add_u32 v2, v4, 7, v2
    v_lshrrev_b32 v5, 1, v3
    v_mul_u32_u24 v5, 10240, v5
    v_add_u32 v132, v5, v2
    v_xor_b32 v133, 32, v132
    v_xor_b32 v134, 64, v132
    v_xor_b32 v135, 96, v132
    s_lshl_b32 s3, s77, 7
    s_lshl_b32 s35, s76, 5
    s_add_u32 s3, s3, s35
    s_mul_i32 s3, s3, 1280
    s_mul_i32 s35, s78, 160
    v_lshl_add_u32 v131, v3, 3, s35
    s_add_u32 s3, s3, s35
    s_mul_i32 s35, s76, 5120
    s_add_u32 s92, s35, 73728
    v_mul_u32_u24 v2, 160, v4
    v_lshl_add_u32 v2, v3, 3, v2
    v_add_u32 v95, s92, v2
    v_add_u32 v2, 0, v1
    v_mul_u32_u24 v5, 6554, v2
    v_lshrrev_b32 v5, 16, v5
    v_mul_u32_u24 v5, 1120, v5
    v_lshl_add_u32 v5, v2, 4, v5
    v_add_u32 v5, 0x0, v5
    v_add_u32 v108, s3, v5
    v_add_u32 v2, 64, v1
    v_mul_u32_u24 v5, 6554, v2
    v_lshrrev_b32 v5, 16, v5
    v_mul_u32_u24 v5, 1120, v5
    v_lshl_add_u32 v5, v2, 4, v5
    v_add_u32 v5, 0xfffffc00, v5
    v_add_u32 v109, s3, v5
    v_add_u32 v2, 128, v1
    v_mul_u32_u24 v5, 6554, v2
    v_lshrrev_b32 v5, 16, v5
    v_mul_u32_u24 v5, 1120, v5
    v_lshl_add_u32 v5, v2, 4, v5
    v_add_u32 v5, 0xfffff800, v5
    v_add_u32 v110, s3, v5
    v_add_u32 v2, 192, v1
    v_mul_u32_u24 v5, 6554, v2
    v_lshrrev_b32 v5, 16, v5
    v_mul_u32_u24 v5, 1120, v5
    v_lshl_add_u32 v5, v2, 4, v5
    v_add_u32 v5, 0xfffff400, v5
    v_add_u32 v111, s3, v5
    v_add_u32 v2, 256, v1
    v_mul_u32_u24 v5, 6554, v2
    v_lshrrev_b32 v5, 16, v5
    v_mul_u32_u24 v5, 1120, v5
    v_lshl_add_u32 v5, v2, 4, v5
    v_add_u32 v5, 0x0, v5
    v_add_u32 v112, s3, v5
    buffer_load_dwordx2 a[240:241], v131, s[72:75], 0 offen offset:0
    buffer_load_dwordx2 a[242:243], v131, s[72:75], 0 offen offset:32
    buffer_load_dwordx2 a[244:245], v131, s[72:75], 0 offen offset:64
    buffer_load_dwordx2 a[246:247], v131, s[72:75], 0 offen offset:96
    buffer_load_dwordx2 a[248:249], v131, s[72:75], 0 offen offset:128
    v_mul_u32_u24 v2, 112, v1
    v_add_u32 v123, v32, v2
    v_add_u32 v124, 15872, v123
    v_mul_u32_u24 v2, 205, v1
    v_lshrrev_b32 v2, 12, v2
    v_mul_u32_u24 v2, 2560, v2
    v_add_u32 v123, v123, v2
    v_mov_b32 v5, 2147483648
    v_cmp_gt_u32 vcc, 16, v1
    s_nop 1
    v_cndmask_b32 v124, v5, v124, vcc
    s_lshl_b32 s3, s77, 3
    s_add_u32 s3, s3, s78
    s_mul_i32 s3, s3, 1280
    s_mul_i32 s35, s76, 320
    s_add_u32 s3, s3, s35
    s_add_u32 s3, s3, 65430
    v_mul_u32_u24 v2, 106, v1
    v_add_u32 v2, s3, v2
    v_and_b32 v2, -4, v2
    v_mov_b32 v5, 2147483648
    v_cmp_gt_u32 vcc, 5, v1
    s_nop 1
    v_cndmask_b32 v2, v5, v2, vcc
    v_cmp_eq_u32 vcc, 0, v1
    s_nop 1
    v_cndmask_b32 v38, v2, v33, vcc
    buffer_load_dwordx4 v18, s[36:39], s80 offen offset:2048 lds
    buffer_load_dwordx4 v19, s[36:39], s80 offen offset:3072 lds
    s_add_u32 m0, s98, 53248
    s_nop 0
    buffer_load_dwordx4 v20, s[40:43], s80 offen offset:0 lds
    buffer_load_dwordx4 v21, s[40:43], s80 offen offset:1024 lds
    buffer_load_dwordx4 v22, s[40:43], s80 offen offset:2048 lds
    buffer_load_dwordx4 v23, s[40:43], s80 offen offset:3072 lds
    s_add_u32 m0, s98, 57344
    s_nop 0
    buffer_load_dwordx4 v24, s[40:43], s80 offen offset:0 lds
    s_waitcnt vmcnt(33)
    s_barrier
    ds_read_b128 a[0:3], v98 offset:0
    ds_read_b128 a[4:7], v98 offset:2048
    ds_read_b128 a[160:163], v39 offset:16384
    ds_read_b128 a[164:167], v39 offset:18432
    ds_read_b128 a[168:171], v39 offset:20480
    ds_read_b128 a[172:175], v39 offset:22528
    ds_read_b128 a[176:179], v39 offset:24576
    ds_read_b128 a[180:183], v39 offset:26624
    ds_read_b128 a[184:187], v39 offset:28672
    ds_read_b128 a[188:191], v39 offset:30720
    ds_read_b128 a[192:195], v39 offset:32768
    ds_read_b128 a[196:199], v39 offset:34816
    s_waitcnt lgkmcnt(0)
    v_mfma_f32_16x16x32_bf16 v[176:179], a[0:3], a[160:163], 0
    ds_read_b128 a[8:11], v101 offset:0
    v_mfma_f32_16x16x32_bf16 v[180:183], a[4:7], a[160:163], 0
    ds_read_b128 a[12:15], v101 offset:2048
    s_add_u32 m0, s97, 73728
    s_add_u32 s80, s85, s93
    buffer_load_dwordx4 v16, s[36:39], s80 offen offset:0 lds
    v_mfma_f32_16x16x32_bf16 v[184:187], a[0:3], a[164:167], 0
    ds_read_b128 a[200:203], v42 offset:16384
    s_waitcnt vmcnt(30)
    v_lshlrev_b32 v138, 16, v138
    v_lshlrev_b32 v136, 16, v136
    v_lshlrev_b32 v137, 16, v137
    v_mul_f32 v2, 0x3fb8aa3b, v138
    v_exp_f32 v2, v2
    s_nop 0
    v_cvt_pk_bf16_f32 v2, v2, v2
    v_and_b32 v2, 0xffff0000, v2
    v_mul_f32 v8, v2, v136
    v_mul_f32 v9, v2, v137
    v_mul_f32 v8, 0x3fb8aa3b, v8
    v_mul_f32 v9, 0.15915494, v9
    v_mov_b32 v12, v8
    v_mov_b32 v13, v9
    v_exp_f32 v12, v12
    v_fract_f32 v13, v13
    v_cos_f32 v14, v13
    v_mfma_f32_16x16x32_bf16 v[188:191], a[4:7], a[164:167], 0
    ds_read_b128 a[204:207], v42 offset:18432
    buffer_load_dwordx4 v17, s[36:39], s80 offen offset:1024 lds
    v_sin_f32 v15, v13
    v_mul_f32 v48, v12, v14
    v_mul_f32 v50, v12, v15
    v_add_f32 v2, -1.0, v48
    v_mul_f32 v5, v136, v136
    v_fmac_f32 v5, v137, v137
    v_rcp_f32 v5, v5
    v_mul_f32 v10, v2, v136
    v_fmac_f32 v10, v50, v137
    v_add_f32 v5, v5, v5
    v_mul_f32 v52, v10, v5
    v_mul_f32 v10, v50, v136
    v_fma_f32 v10, -v2, v137, v10
    v_mul_f32 v53, v10, v5
    v_mul_f32 v2, v50, v50
    v_mfma_f32_16x16x32_bf16 v[192:195], a[0:3], a[168:171], 0
    ds_read_b128 a[208:211], v42 offset:20480
    v_fma_f32 v49, v48, v48, -v2
    v_mul_f32 v2, v48, v50
    v_add_f32 v51, v2, v2
    v_mul_f32 v12, v94, v8
    v_mul_f32 v13, v94, v9
    v_exp_f32 v12, v12
    v_fract_f32 v13, v13
    v_cos_f32 v14, v13
    v_sin_f32 v15, v13
    v_mul_f32 v54, v12, v14
    v_mul_f32 v55, v12, v15
    s_waitcnt vmcnt(28)
    v_lshlrev_b32 v141, 16, v141
    v_lshlrev_b32 v139, 16, v139
    v_lshlrev_b32 v140, 16, v140
    v_mul_f32 v2, 0x3fb8aa3b, v141
    v_mfma_f32_16x16x32_bf16 v[196:199], a[4:7], a[168:171], 0
    ds_read_b128 a[212:215], v42 offset:22528
    buffer_load_dwordx4 v18, s[36:39], s80 offen offset:2048 lds
    v_exp_f32 v2, v2
    s_nop 0
    v_cvt_pk_bf16_f32 v2, v2, v2
    v_and_b32 v2, 0xffff0000, v2
    v_mul_f32 v8, v2, v139
    v_mul_f32 v9, v2, v140
    v_mul_f32 v8, 0x3fb8aa3b, v8
    v_mul_f32 v9, 0.15915494, v9
    v_mov_b32 v12, v8
    v_mov_b32 v13, v9
    v_exp_f32 v12, v12
    v_fract_f32 v13, v13
    v_cos_f32 v14, v13
    v_sin_f32 v15, v13
    v_mul_f32 v56, v12, v14
    v_mul_f32 v58, v12, v15
    v_mfma_f32_16x16x32_bf16 v[200:203], a[0:3], a[172:175], 0
    ds_read_b128 a[216:219], v42 offset:24576
    v_add_f32 v2, -1.0, v56
    v_mul_f32 v5, v139, v139
    v_fmac_f32 v5, v140, v140
    v_rcp_f32 v5, v5
    v_mul_f32 v10, v2, v139
    v_fmac_f32 v10, v58, v140
    v_add_f32 v5, v5, v5
    v_mul_f32 v60, v10, v5
    v_mul_f32 v10, v58, v139
    v_fma_f32 v10, -v2, v140, v10
    v_mul_f32 v61, v10, v5
    v_mul_f32 v2, v58, v58
    v_fma_f32 v57, v56, v56, -v2
    v_mul_f32 v2, v56, v58
    v_add_f32 v59, v2, v2
    v_mfma_f32_16x16x32_bf16 v[204:207], a[4:7], a[172:175], 0
    ds_read_b128 a[220:223], v42 offset:26624
    buffer_load_dwordx4 v19, s[36:39], s80 offen offset:3072 lds
    v_mul_f32 v12, v94, v8
    v_mul_f32 v13, v94, v9
    v_exp_f32 v12, v12
    v_fract_f32 v13, v13
    v_cos_f32 v14, v13
    v_sin_f32 v15, v13
    v_mul_f32 v62, v12, v14
    v_mul_f32 v63, v12, v15
    s_waitcnt vmcnt(27)
    v_lshlrev_b32 v144, 16, v144
    v_lshlrev_b32 v142, 16, v142
    v_lshlrev_b32 v143, 16, v143
    v_mul_f32 v2, 0x3fb8aa3b, v144
    v_exp_f32 v2, v2
    s_nop 0
    v_cvt_pk_bf16_f32 v2, v2, v2
    v_and_b32 v2, 0xffff0000, v2
    v_mfma_f32_16x16x32_bf16 v[208:211], a[0:3], a[176:179], 0
    ds_read_b128 a[224:227], v42 offset:28672
    v_mul_f32 v8, v2, v142
    v_mul_f32 v9, v2, v143
    v_mul_f32 v8, 0x3fb8aa3b, v8
    v_mul_f32 v9, 0.15915494, v9
    v_mov_b32 v12, v8
    v_mov_b32 v13, v9
    v_exp_f32 v12, v12
    v_fract_f32 v13, v13
    v_cos_f32 v14, v13
    v_sin_f32 v15, v13
    v_mul_f32 v64, v12, v14
    v_mul_f32 v66, v12, v15
    v_add_f32 v2, -1.0, v64
    v_mul_f32 v5, v142, v142
    v_fmac_f32 v5, v143, v143
    v_rcp_f32 v5, v5
    v_mfma_f32_16x16x32_bf16 v[212:215], a[4:7], a[176:179], 0
    ds_read_b128 a[228:231], v42 offset:30720
    s_add_u32 m0, s98, 90112
    s_nop 0
    buffer_load_dwordx4 v20, s[40:43], s80 offen offset:0 lds
    v_mul_f32 v10, v2, v142
    v_fmac_f32 v10, v66, v143
    v_add_f32 v5, v5, v5
    v_mul_f32 v68, v10, v5
    v_mul_f32 v10, v66, v142
    v_fma_f32 v10, -v2, v143, v10
    v_mul_f32 v69, v10, v5
    v_mul_f32 v2, v66, v66
    v_fma_f32 v65, v64, v64, -v2
    v_mul_f32 v2, v64, v66
    v_add_f32 v67, v2, v2
    v_mul_f32 v12, v94, v8
    v_mul_f32 v13, v94, v9
    v_exp_f32 v12, v12
    v_fract_f32 v13, v13
    v_mfma_f32_16x16x32_bf16 v[216:219], a[0:3], a[180:183], 0
    ds_read_b128 a[232:235], v42 offset:32768
    v_cos_f32 v14, v13
    v_sin_f32 v15, v13
    v_mul_f32 v70, v12, v14
    v_mul_f32 v71, v12, v15
    s_waitcnt vmcnt(25)
    v_lshlrev_b32 v147, 16, v147
    v_lshlrev_b32 v145, 16, v145
    v_lshlrev_b32 v146, 16, v146
    v_mul_f32 v2, 0x3fb8aa3b, v147
    v_exp_f32 v2, v2
    s_nop 0
    v_cvt_pk_bf16_f32 v2, v2, v2
    v_and_b32 v2, 0xffff0000, v2
    v_mul_f32 v8, v2, v145
    v_mul_f32 v9, v2, v146
    v_mul_f32 v8, 0x3fb8aa3b, v8
    v_mul_f32 v9, 0.15915494, v9
    v_mfma_f32_16x16x32_bf16 v[220:223], a[4:7], a[180:183], 0
    ds_read_b128 a[236:239], v42 offset:34816
    buffer_load_dwordx4 v21, s[40:43], s80 offen offset:1024 lds
    v_mov_b32 v12, v8
    v_mov_b32 v13, v9
    v_exp_f32 v12, v12
    v_fract_f32 v13, v13
    v_cos_f32 v14, v13
    v_sin_f32 v15, v13
    v_mul_f32 v72, v12, v14
    v_mul_f32 v74, v12, v15
    v_add_f32 v2, -1.0, v72
    v_mul_f32 v5, v145, v145
    v_fmac_f32 v5, v146, v146
    v_rcp_f32 v5, v5
    v_mul_f32 v10, v2, v145
    v_fmac_f32 v10, v74, v146
    v_add_f32 v5, v5, v5
    v_mfma_f32_16x16x32_bf16 v[224:227], a[0:3], a[184:187], 0
    v_mul_f32 v76, v10, v5
    v_mul_f32 v10, v74, v145
    v_fma_f32 v10, -v2, v146, v10
    v_mul_f32 v77, v10, v5
    v_mul_f32 v2, v74, v74
    v_fma_f32 v73, v72, v72, -v2
    v_mul_f32 v2, v72, v74
    v_add_f32 v75, v2, v2
    v_mul_f32 v12, v94, v8
    v_mul_f32 v13, v94, v9
    v_exp_f32 v12, v12
    v_fract_f32 v13, v13
    v_cos_f32 v14, v13
    v_sin_f32 v15, v13
    v_mul_f32 v78, v12, v14
    v_mfma_f32_16x16x32_bf16 v[228:231], a[4:7], a[184:187], 0
    buffer_load_dwordx4 v22, s[40:43], s80 offen offset:2048 lds
    v_mul_f32 v79, v12, v15
    s_waitcnt vmcnt(24)
    v_lshlrev_b32 v150, 16, v150
    v_lshlrev_b32 v148, 16, v148
    v_lshlrev_b32 v149, 16, v149
    v_mul_f32 v2, 0x3fb8aa3b, v150
    v_exp_f32 v2, v2
    s_nop 0
    v_cvt_pk_bf16_f32 v2, v2, v2
    v_and_b32 v2, 0xffff0000, v2
    v_mul_f32 v8, v2, v148
    v_mul_f32 v9, v2, v149
    v_mul_f32 v8, 0x3fb8aa3b, v8
    v_mul_f32 v9, 0.15915494, v9
    v_mov_b32 v12, v8
    v_mov_b32 v13, v9
    v_exp_f32 v12, v12
    v_mfma_f32_16x16x32_bf16 v[232:235], a[0:3], a[188:191], 0
    v_fract_f32 v13, v13
    v_cos_f32 v14, v13
    v_sin_f32 v15, v13
    v_mul_f32 v80, v12, v14
    v_mul_f32 v82, v12, v15
    v_add_f32 v2, -1.0, v80
    v_mul_f32 v5, v148, v148
    v_fmac_f32 v5, v149, v149
    v_rcp_f32 v5, v5
    v_mul_f32 v10, v2, v148
    v_fmac_f32 v10, v82, v149
    v_add_f32 v5, v5, v5
    v_mul_f32 v84, v10, v5
    v_mul_f32 v10, v82, v148
    v_fma_f32 v10, -v2, v149, v10
    v_mul_f32 v85, v10, v5
    v_mfma_f32_16x16x32_bf16 v[236:239], a[4:7], a[188:191], 0
    buffer_load_dwordx4 v23, s[40:43], s80 offen offset:3072 lds
    v_mul_f32 v2, v82, v82
    v_fma_f32 v81, v80, v80, -v2
    v_mul_f32 v2, v80, v82
    v_add_f32 v83, v2, v2
    v_mul_f32 v12, v94, v8
    v_mul_f32 v13, v94, v9
    v_exp_f32 v12, v12
    v_fract_f32 v13, v13
    v_cos_f32 v14, v13
    v_sin_f32 v15, v13
    v_mul_f32 v86, v12, v14
    v_mul_f32 v87, v12, v15
    s_waitcnt vmcnt(22)
    v_lshlrev_b32 v153, 16, v153
    v_lshlrev_b32 v151, 16, v151
    v_lshlrev_b32 v152, 16, v152
    v_mfma_f32_16x16x32_bf16 v[240:243], a[0:3], a[192:195], 0
    v_mul_f32 v2, 0x3fb8aa3b, v153
    v_exp_f32 v2, v2
    s_nop 0
    v_cvt_pk_bf16_f32 v2, v2, v2
    v_and_b32 v2, 0xffff0000, v2
    v_mul_f32 v8, v2, v151
    v_mul_f32 v9, v2, v152
    v_mul_f32 v8, 0x3fb8aa3b, v8
    v_mul_f32 v9, 0.15915494, v9
    v_mov_b32 v12, v8
    v_mov_b32 v13, v9
    v_exp_f32 v12, v12
    v_fract_f32 v13, v13
    v_cos_f32 v14, v13
    v_sin_f32 v15, v13
    v_mul_f32 v6, v12, v14
    v_mfma_f32_16x16x32_bf16 v[244:247], a[4:7], a[192:195], 0
    s_add_u32 m0, s98, 94208
    s_nop 0
    buffer_load_dwordx4 v24, s[40:43], s80 offen offset:0 lds
    v_mul_f32 v7, v12, v15
    v_add_f32 v2, -1.0, v6
    v_mul_f32 v5, v151, v151
    v_fmac_f32 v5, v152, v152
    v_rcp_f32 v5, v5
    v_mul_f32 v10, v2, v151
    v_fmac_f32 v10, v7, v152
    v_add_f32 v5, v5, v5
    v_mul_f32 v92, v10, v5
    v_mul_f32 v10, v7, v151
    v_fma_f32 v10, -v2, v152, v10
    v_mul_f32 v93, v10, v5
    v_mul_f32 v12, 0x41000000, v8
    v_mul_f32 v13, 0x41000000, v9
    v_exp_f32 v12, v12
    v_mfma_f32_16x16x32_bf16 v[248:251], a[0:3], a[196:199], 0
    v_fract_f32 v13, v13
    v_cos_f32 v14, v13
    v_sin_f32 v15, v13
    v_mul_f32 v88, v12, v14
    v_mul_f32 v89, v12, v15
    v_mul_f32 v12, 0x43000000, v8
    v_mul_f32 v13, 0x43000000, v9
    v_exp_f32 v12, v12
    v_fract_f32 v13, v13
    v_cos_f32 v14, v13
    v_sin_f32 v15, v13
    v_mul_f32 v90, v12, v14
    v_mul_f32 v91, v12, v15
    v_sub_u32 v10, 2, v129
    v_mul_u32_u24 v10, 640, v10
    v_mfma_f32_16x16x32_bf16 v[252:255], a[4:7], a[196:199], 0
    v_cvt_f32_u32 v10, v10
    v_mul_f32 v12, v10, v8
    v_mul_f32 v13, v10, v9
    v_exp_f32 v12, v12
    v_fract_f32 v13, v13
    v_cos_f32 v14, v13
    v_sin_f32 v15, v13
    v_mul_f32 v6, v12, v14
    v_mul_f32 v7, v12, v15
    v_mul_f32 v126, v92, v6
    v_mul_f32 v127, v92, v7
    v_fma_f32 v126, -v93, v7, v126
    v_fmac_f32 v127, v93, v6
    s_add_u32 s60, s48, 65536
    s_addc_u32 s61, s49, 0
    s_mov_b32 s62, 163840
    s_waitcnt vmcnt(9)
    s_barrier
    s_waitcnt lgkmcnt(0)
    v_mfma_f32_16x16x32_bf16 v[176:179], a[8:11], a[200:203], v[176:179]
    ds_read_b128 a[16:19], v98 offset:36864
    v_mfma_f32_16x16x32_bf16 v[180:183], a[12:15], a[200:203], v[180:183]
    ds_read_b128 a[20:23], v98 offset:38912
    v_add_u32 v47, 0x9E3779B1, v47
    v_cmp_eq_u32 vcc, 0, v47
    s_nop 1
    v_cndmask_b32_e64 v47, v47, 1, vcc
    buffer_store_dword v47, v46, s[48:51], 0 offen sc1
    buffer_store_dword v47, v46, s[56:59], 0 offen sc1
    v_mfma_f32_16x16x32_bf16 v[184:187], a[8:11], a[204:207], v[184:187]
    ds_read_b128 a[160:163], v39 offset:53248
    v_mfma_f32_16x16x32_bf16 v[188:191], a[12:15], a[204:207], v[188:191]
    ds_read_b128 a[164:167], v39 offset:55296
    v_mfma_f32_16x16x32_bf16 v[192:195], a[8:11], a[208:211], v[192:195]
    ds_read_b128 a[168:171], v39 offset:57344
    s_add_u32 m0, s97, 110592
    s_add_u32 s80, s86, s93
    buffer_load_dwordx4 v16, s[36:39], s80 offen offset:0 lds
    v_mfma_f32_16x16x32_bf16 v[196:199], a[12:15], a[208:211], v[196:199]
    ds_read_b128 a[172:175], v39 offset:59392
    v_mfma_f32_16x16x32_bf16 v[200:203], a[8:11], a[212:215], v[200:203]
    ds_read_b128 a[176:179], v39 offset:61440
    v_mfma_f32_16x16x32_bf16 v[204:207], a[12:15], a[212:215], v[204:207]
    ds_read_b128 a[180:183], v39 offset:63488
    buffer_load_dwordx4 v17, s[36:39], s80 offen offset:1024 lds
    v_mfma_f32_16x16x32_bf16 v[208:211], a[8:11], a[216:219], v[208:211]
    ds_read_b128 a[184:187], v40 offset:0
    v_mfma_f32_16x16x32_bf16 v[212:215], a[12:15], a[216:219], v[212:215]
    ds_read_b128 a[188:191], v40 offset:2048
    v_mfma_f32_16x16x32_bf16 v[216:219], a[8:11], a[220:223], v[216:219]
    ds_read_b128 a[192:195], v40 offset:4096
    buffer_load_dwordx4 v18, s[36:39], s80 offen offset:2048 lds
    v_mfma_f32_16x16x32_bf16 v[220:223], a[12:15], a[220:223], v[220:223]
    ds_read_b128 a[196:199], v40 offset:6144
    v_mfma_f32_16x16x32_bf16 v[224:227], a[8:11], a[224:227], v[224:227]
    v_mfma_f32_16x16x32_bf16 v[228:231], a[12:15], a[224:227], v[228:231]
    buffer_load_dwordx4 v19, s[36:39], s80 offen offset:3072 lds
    v_mfma_f32_16x16x32_bf16 v[232:235], a[8:11], a[228:231], v[232:235]
    v_mfma_f32_16x16x32_bf16 v[236:239], a[12:15], a[228:231], v[236:239]
    v_mfma_f32_16x16x32_bf16 v[240:243], a[8:11], a[232:235], v[240:243]
    s_add_u32 m0, s98, 126976
    s_nop 0
    buffer_load_dwordx4 v20, s[40:43], s80 offen offset:0 lds
    v_mfma_f32_16x16x32_bf16 v[244:247], a[12:15], a[232:235], v[244:247]
    v_mfma_f32_16x16x32_bf16 v[248:251], a[8:11], a[236:239], v[248:251]
    v_mfma_f32_16x16x32_bf16 v[252:255], a[12:15], a[236:239], v[252:255]
    s_waitcnt lgkmcnt(0)
    v_mfma_f32_16x16x32_bf16 v[176:179], a[16:19], a[160:163], v[176:179]
    ds_read_b128 a[24:27], v101 offset:36864
    v_mfma_f32_16x16x32_bf16 v[180:183], a[20:23], a[160:163], v[180:183]
    ds_read_b128 a[28:31], v101 offset:38912
    buffer_load_dwordx4 v21, s[40:43], s80 offen offset:1024 lds
    v_mfma_f32_16x16x32_bf16 v[184:187], a[16:19], a[164:167], v[184:187]
    ds_read_b128 a[200:203], v42 offset:53248
    v_mfma_f32_16x16x32_bf16 v[188:191], a[20:23], a[164:167], v[188:191]
    ds_read_b128 a[204:207], v42 offset:55296
    buffer_load_dwordx4 v22, s[40:43], s80 offen offset:2048 lds
    v_mfma_f32_16x16x32_bf16 v[192:195], a[16:19], a[168:171], v[192:195]
    ds_read_b128 a[208:211], v42 offset:57344
    v_mfma_f32_16x16x32_bf16 v[196:199], a[20:23], a[168:171], v[196:199]
    ds_read_b128 a[212:215], v42 offset:59392
    v_mfma_f32_16x16x32_bf16 v[200:203], a[16:19], a[172:175], v[200:203]
    ds_read_b128 a[216:219], v42 offset:61440
    buffer_load_dwordx4 v23, s[40:43], s80 offen offset:3072 lds
    v_mfma_f32_16x16x32_bf16 v[204:207], a[20:23], a[172:175], v[204:207]
    ds_read_b128 a[220:223], v42 offset:63488
    v_mfma_f32_16x16x32_bf16 v[208:211], a[16:19], a[176:179], v[208:211]
    ds_read_b128 a[224:227], v43 offset:0
    v_mfma_f32_16x16x32_bf16 v[212:215], a[20:23], a[176:179], v[212:215]
    ds_read_b128 a[228:231], v43 offset:2048
    s_add_u32 m0, s98, 131072
    s_nop 0
    buffer_load_dwordx4 v24, s[40:43], s80 offen offset:0 lds
    v_mfma_f32_16x16x32_bf16 v[216:219], a[16:19], a[180:183], v[216:219]
    ds_read_b128 a[232:235], v43 offset:4096
    v_mfma_f32_16x16x32_bf16 v[220:223], a[20:23], a[180:183], v[220:223]
    ds_read_b128 a[236:239], v43 offset:6144
    buffer_load_dword v37, v37, s[44:47], 0 offen
    v_mfma_f32_16x16x32_bf16 v[224:227], a[16:19], a[184:187], v[224:227]
    v_mfma_f32_16x16x32_bf16 v[228:231], a[20:23], a[184:187], v[228:231]
    v_mfma_f32_16x16x32_bf16 v[232:235], a[16:19], a[188:191], v[232:235]
    buffer_load_dword v38, v38, s[48:51], 0 offen
    v_mfma_f32_16x16x32_bf16 v[236:239], a[20:23], a[188:191], v[236:239]
    v_mfma_f32_16x16x32_bf16 v[240:243], a[16:19], a[192:195], v[240:243]
    v_mfma_f32_16x16x32_bf16 v[244:247], a[20:23], a[192:195], v[244:247]
    s_mov_b32 s95, 589824
    buffer_load_dword v35, v33, s[48:51], s95 offen
    v_mfma_f32_16x16x32_bf16 v[248:251], a[16:19], a[196:199], v[248:251]
    v_mfma_f32_16x16x32_bf16 v[252:255], a[20:23], a[196:199], v[252:255]
    s_waitcnt vmcnt(14)
    s_barrier
    s_waitcnt lgkmcnt(0)
    v_mfma_f32_16x16x32_bf16 v[176:179], a[24:27], a[200:203], v[176:179]
    ds_read_b128 a[32:35], v99 offset:8192
    v_mfma_f32_16x16x32_bf16 v[180:183], a[28:31], a[200:203], v[180:183]
    ds_read_b128 a[36:39], v99 offset:10240
    s_add_u32 m0, s97, 0
    s_add_u32 s80, s87, s93
    buffer_load_dwordx4 v16, s[36:39], s80 offen offset:0 lds
    v_mfma_f32_16x16x32_bf16 v[184:187], a[24:27], a[204:207], v[184:187]
    ds_read_b128 a[160:163], v40 offset:24576
    v_mfma_f32_16x16x32_bf16 v[188:191], a[28:31], a[204:207], v[188:191]
    ds_read_b128 a[164:167], v40 offset:26624
    v_mfma_f32_16x16x32_bf16 v[192:195], a[24:27], a[208:211], v[192:195]
    ds_read_b128 a[168:171], v40 offset:28672
    buffer_load_dwordx4 v17, s[36:39], s80 offen offset:1024 lds
    v_mfma_f32_16x16x32_bf16 v[196:199], a[28:31], a[208:211], v[196:199]
    ds_read_b128 a[172:175], v40 offset:30720
    v_mfma_f32_16x16x32_bf16 v[200:203], a[24:27], a[212:215], v[200:203]
    ds_read_b128 a[176:179], v40 offset:32768
    v_mfma_f32_16x16x32_bf16 v[204:207], a[28:31], a[212:215], v[204:207]
    ds_read_b128 a[180:183], v40 offset:34816
    v_mfma_f32_16x16x32_bf16 v[208:211], a[24:27], a[216:219], v[208:211]
    ds_read_b128 a[184:187], v40 offset:36864
    buffer_load_dwordx4 v18, s[36:39], s80 offen offset:2048 lds
    v_mfma_f32_16x16x32_bf16 v[212:215], a[28:31], a[216:219], v[212:215]
    ds_read_b128 a[188:191], v40 offset:38912
    v_mfma_f32_16x16x32_bf16 v[216:219], a[24:27], a[220:223], v[216:219]
    ds_read_b128 a[192:195], v40 offset:40960
    v_mfma_f32_16x16x32_bf16 v[220:223], a[28:31], a[220:223], v[220:223]
    ds_read_b128 a[196:199], v40 offset:43008
    v_mfma_f32_16x16x32_bf16 v[224:227], a[24:27], a[224:227], v[224:227]
    buffer_load_dwordx4 v19, s[36:39], s80 offen offset:3072 lds
    v_mfma_f32_16x16x32_bf16 v[228:231], a[28:31], a[224:227], v[228:231]
    v_mfma_f32_16x16x32_bf16 v[232:235], a[24:27], a[228:231], v[232:235]
    v_mfma_f32_16x16x32_bf16 v[236:239], a[28:31], a[228:231], v[236:239]
    v_mfma_f32_16x16x32_bf16 v[240:243], a[24:27], a[232:235], v[240:243]
    s_add_u32 m0, s98, 16384
    s_nop 0
    buffer_load_dwordx4 v20, s[40:43], s80 offen offset:0 lds
    v_mfma_f32_16x16x32_bf16 v[244:247], a[28:31], a[232:235], v[244:247]
    v_mfma_f32_16x16x32_bf16 v[248:251], a[24:27], a[236:239], v[248:251]
    v_mfma_f32_16x16x32_bf16 v[252:255], a[28:31], a[236:239], v[252:255]
    s_waitcnt lgkmcnt(0)
    v_mfma_f32_16x16x32_bf16 v[176:179], a[32:35], a[160:163], v[176:179]
    ds_read_b128 a[40:43], v102 offset:8192
    v_mfma_f32_16x16x32_bf16 v[180:183], a[36:39], a[160:163], v[180:183]
    ds_read_b128 a[44:47], v102 offset:10240
    buffer_load_dwordx4 v21, s[40:43], s80 offen offset:1024 lds
    v_mfma_f32_16x16x32_bf16 v[184:187], a[32:35], a[164:167], v[184:187]
    ds_read_b128 a[200:203], v43 offset:24576
    v_mfma_f32_16x16x32_bf16 v[188:191], a[36:39], a[164:167], v[188:191]
    ds_read_b128 a[204:207], v43 offset:26624
    v_mfma_f32_16x16x32_bf16 v[192:195], a[32:35], a[168:171], v[192:195]
    ds_read_b128 a[208:211], v43 offset:28672
    v_mfma_f32_16x16x32_bf16 v[196:199], a[36:39], a[168:171], v[196:199]
    ds_read_b128 a[212:215], v43 offset:30720
    buffer_load_dwordx4 v22, s[40:43], s80 offen offset:2048 lds
    v_mfma_f32_16x16x32_bf16 v[200:203], a[32:35], a[172:175], v[200:203]
    ds_read_b128 a[216:219], v43 offset:32768
    v_mfma_f32_16x16x32_bf16 v[204:207], a[36:39], a[172:175], v[204:207]
    ds_read_b128 a[220:223], v43 offset:34816
    v_mfma_f32_16x16x32_bf16 v[208:211], a[32:35], a[176:179], v[208:211]
    ds_read_b128 a[224:227], v43 offset:36864
    v_mfma_f32_16x16x32_bf16 v[212:215], a[36:39], a[176:179], v[212:215]
    ds_read_b128 a[228:231], v43 offset:38912
    v_mfma_f32_16x16x32_bf16 v[216:219], a[32:35], a[180:183], v[216:219]
    ds_read_b128 a[232:235], v43 offset:40960
    buffer_load_dwordx4 v23, s[40:43], s80 offen offset:3072 lds
    v_mfma_f32_16x16x32_bf16 v[220:223], a[36:39], a[180:183], v[220:223]
    ds_read_b128 a[236:239], v43 offset:43008
    v_mfma_f32_16x16x32_bf16 v[224:227], a[32:35], a[184:187], v[224:227]
    v_mfma_f32_16x16x32_bf16 v[228:231], a[36:39], a[184:187], v[228:231]
    v_mfma_f32_16x16x32_bf16 v[232:235], a[32:35], a[188:191], v[232:235]
    v_mfma_f32_16x16x32_bf16 v[236:239], a[36:39], a[188:191], v[236:239]
    s_add_u32 m0, s98, 20480
    s_nop 0
    buffer_load_dwordx4 v24, s[40:43], s80 offen offset:0 lds
    v_mfma_f32_16x16x32_bf16 v[240:243], a[32:35], a[192:195], v[240:243]
    v_mfma_f32_16x16x32_bf16 v[244:247], a[36:39], a[192:195], v[244:247]
    v_mfma_f32_16x16x32_bf16 v[248:251], a[32:35], a[196:199], v[248:251]
    v_mfma_f32_16x16x32_bf16 v[252:255], a[36:39], a[196:199], v[252:255]
    s_waitcnt vmcnt(12)
    s_barrier
    s_waitcnt lgkmcnt(0)
    v_mfma_f32_16x16x32_bf16 v[176:179], a[40:43], a[200:203], v[176:179]
    ds_read_b128 a[48:51], v99 offset:45056
    v_mfma_f32_16x16x32_bf16 v[180:183], a[44:47], a[200:203], v[180:183]
    ds_read_b128 a[52:55], v99 offset:47104
    s_add_u32 m0, s97, 36864
    s_add_u32 s80, s83, s94
    buffer_load_dwordx4 v16, s[36:39], s80 offen offset:0 lds
    v_mfma_f32_16x16x32_bf16 v[184:187], a[40:43], a[204:207], v[184:187]
    ds_read_b128 a[160:163], v40 offset:61440
    v_mfma_f32_16x16x32_bf16 v[188:191], a[44:47], a[204:207], v[188:191]
    ds_read_b128 a[164:167], v40 offset:63488
    v_mfma_f32_16x16x32_bf16 v[192:195], a[40:43], a[208:211], v[192:195]
    ds_read_b128 a[168:171], v41 offset:0
    buffer_load_dwordx4 v17, s[36:39], s80 offen offset:1024 lds
    v_mfma_f32_16x16x32_bf16 v[196:199], a[44:47], a[208:211], v[196:199]
    ds_read_b128 a[172:175], v41 offset:2048
    v_mfma_f32_16x16x32_bf16 v[200:203], a[40:43], a[212:215], v[200:203]
    ds_read_b128 a[176:179], v41 offset:4096
    v_mfma_f32_16x16x32_bf16 v[204:207], a[44:47], a[212:215], v[204:207]
    ds_read_b128 a[180:183], v41 offset:6144
    v_mfma_f32_16x16x32_bf16 v[208:211], a[40:43], a[216:219], v[208:211]
    ds_read_b128 a[184:187], v41 offset:8192
    buffer_load_dwordx4 v18, s[36:39], s80 offen offset:2048 lds
    v_mfma_f32_16x16x32_bf16 v[212:215], a[44:47], a[216:219], v[212:215]
    ds_read_b128 a[188:191], v41 offset:10240
    v_mfma_f32_16x16x32_bf16 v[216:219], a[40:43], a[220:223], v[216:219]
    ds_read_b128 a[192:195], v41 offset:12288
    v_mfma_f32_16x16x32_bf16 v[220:223], a[44:47], a[220:223], v[220:223]
    ds_read_b128 a[196:199], v41 offset:14336
    v_mfma_f32_16x16x32_bf16 v[224:227], a[40:43], a[224:227], v[224:227]
    buffer_load_dwordx4 v19, s[36:39], s80 offen offset:3072 lds
    v_mfma_f32_16x16x32_bf16 v[228:231], a[44:47], a[224:227], v[228:231]
    v_mfma_f32_16x16x32_bf16 v[232:235], a[40:43], a[228:231], v[232:235]
    v_mfma_f32_16x16x32_bf16 v[236:239], a[44:47], a[228:231], v[236:239]
    v_mfma_f32_16x16x32_bf16 v[240:243], a[40:43], a[232:235], v[240:243]
    s_add_u32 m0, s98, 53248
    s_nop 0
    buffer_load_dwordx4 v20, s[40:43], s80 offen offset:0 lds
    v_mfma_f32_16x16x32_bf16 v[244:247], a[44:47], a[232:235], v[244:247]
    v_mfma_f32_16x16x32_bf16 v[248:251], a[40:43], a[236:239], v[248:251]
    v_mfma_f32_16x16x32_bf16 v[252:255], a[44:47], a[236:239], v[252:255]
    s_waitcnt lgkmcnt(0)
    v_mfma_f32_16x16x32_bf16 v[176:179], a[48:51], a[160:163], v[176:179]
    ds_read_b128 a[56:59], v102 offset:45056
    v_mfma_f32_16x16x32_bf16 v[180:183], a[52:55], a[160:163], v[180:183]
    ds_read_b128 a[60:63], v102 offset:47104
    buffer_load_dwordx4 v21, s[40:43], s80 offen offset:1024 lds
    v_mfma_f32_16x16x32_bf16 v[184:187], a[48:51], a[164:167], v[184:187]
    ds_read_b128 a[200:203], v43 offset:61440
    v_mfma_f32_16x16x32_bf16 v[188:191], a[52:55], a[164:167], v[188:191]
    ds_read_b128 a[204:207], v43 offset:63488
    v_mfma_f32_16x16x32_bf16 v[192:195], a[48:51], a[168:171], v[192:195]
    ds_read_b128 a[208:211], v44 offset:0
    v_mfma_f32_16x16x32_bf16 v[196:199], a[52:55], a[168:171], v[196:199]
    ds_read_b128 a[212:215], v44 offset:2048
    buffer_load_dwordx4 v22, s[40:43], s80 offen offset:2048 lds
    v_mfma_f32_16x16x32_bf16 v[200:203], a[48:51], a[172:175], v[200:203]
    ds_read_b128 a[216:219], v44 offset:4096
    v_mfma_f32_16x16x32_bf16 v[204:207], a[52:55], a[172:175], v[204:207]
    ds_read_b128 a[220:223], v44 offset:6144
    v_mfma_f32_16x16x32_bf16 v[208:211], a[48:51], a[176:179], v[208:211]
    ds_read_b128 a[224:227], v44 offset:8192
    v_mfma_f32_16x16x32_bf16 v[212:215], a[52:55], a[176:179], v[212:215]
    ds_read_b128 a[228:231], v44 offset:10240
    v_mfma_f32_16x16x32_bf16 v[216:219], a[48:51], a[180:183], v[216:219]
    ds_read_b128 a[232:235], v44 offset:12288
    buffer_load_dwordx4 v23, s[40:43], s80 offen offset:3072 lds
    v_mfma_f32_16x16x32_bf16 v[220:223], a[52:55], a[180:183], v[220:223]
    ds_read_b128 a[236:239], v44 offset:14336
    v_mfma_f32_16x16x32_bf16 v[224:227], a[48:51], a[184:187], v[224:227]
    v_mfma_f32_16x16x32_bf16 v[228:231], a[52:55], a[184:187], v[228:231]
    v_mfma_f32_16x16x32_bf16 v[232:235], a[48:51], a[188:191], v[232:235]
    v_mfma_f32_16x16x32_bf16 v[236:239], a[52:55], a[188:191], v[236:239]
    s_add_u32 m0, s98, 57344
    s_nop 0
    buffer_load_dwordx4 v24, s[40:43], s80 offen offset:0 lds
    v_mfma_f32_16x16x32_bf16 v[240:243], a[48:51], a[192:195], v[240:243]
    v_mfma_f32_16x16x32_bf16 v[244:247], a[52:55], a[192:195], v[244:247]
    v_mfma_f32_16x16x32_bf16 v[248:251], a[48:51], a[196:199], v[248:251]
    v_mfma_f32_16x16x32_bf16 v[252:255], a[52:55], a[196:199], v[252:255]
    s_waitcnt vmcnt(9)
    s_barrier
    s_waitcnt lgkmcnt(0)
    v_mfma_f32_16x16x32_bf16 v[176:179], a[56:59], a[200:203], v[176:179]
    ds_read_b128 a[64:67], v98 offset:0
    v_mfma_f32_16x16x32_bf16 v[180:183], a[60:63], a[200:203], v[180:183]
    ds_read_b128 a[68:71], v98 offset:2048
    s_add_u32 m0, s97, 73728
    s_add_u32 s80, s84, s94
    buffer_load_dwordx4 v16, s[36:39], s80 offen offset:0 lds
    v_mfma_f32_16x16x32_bf16 v[184:187], a[56:59], a[204:207], v[184:187]
    ds_read_b128 a[160:163], v39 offset:16384
    v_mfma_f32_16x16x32_bf16 v[188:191], a[60:63], a[204:207], v[188:191]
    ds_read_b128 a[164:167], v39 offset:18432
    v_mfma_f32_16x16x32_bf16 v[192:195], a[56:59], a[208:211], v[192:195]
    ds_read_b128 a[168:171], v39 offset:20480
    buffer_load_dwordx4 v17, s[36:39], s80 offen offset:1024 lds
    v_mfma_f32_16x16x32_bf16 v[196:199], a[60:63], a[208:211], v[196:199]
    ds_read_b128 a[172:175], v39 offset:22528
    v_mfma_f32_16x16x32_bf16 v[200:203], a[56:59], a[212:215], v[200:203]
    ds_read_b128 a[176:179], v39 offset:24576
    v_mfma_f32_16x16x32_bf16 v[204:207], a[60:63], a[212:215], v[204:207]
    ds_read_b128 a[180:183], v39 offset:26624
    v_mfma_f32_16x16x32_bf16 v[208:211], a[56:59], a[216:219], v[208:211]
    ds_read_b128 a[184:187], v39 offset:28672
    buffer_load_dwordx4 v18, s[36:39], s80 offen offset:2048 lds
    v_mfma_f32_16x16x32_bf16 v[212:215], a[60:63], a[216:219], v[212:215]
    ds_read_b128 a[188:191], v39 offset:30720
    v_mfma_f32_16x16x32_bf16 v[216:219], a[56:59], a[220:223], v[216:219]
    ds_read_b128 a[192:195], v39 offset:32768
    v_mfma_f32_16x16x32_bf16 v[220:223], a[60:63], a[220:223], v[220:223]
    ds_read_b128 a[196:199], v39 offset:34816
    v_mfma_f32_16x16x32_bf16 v[224:227], a[56:59], a[224:227], v[224:227]
    buffer_load_dwordx4 v19, s[36:39], s80 offen offset:3072 lds
    v_mfma_f32_16x16x32_bf16 v[228:231], a[60:63], a[224:227], v[228:231]
    v_mfma_f32_16x16x32_bf16 v[232:235], a[56:59], a[228:231], v[232:235]
    v_mfma_f32_16x16x32_bf16 v[236:239], a[60:63], a[228:231], v[236:239]
    v_mfma_f32_16x16x32_bf16 v[240:243], a[56:59], a[232:235], v[240:243]
    s_add_u32 m0, s98, 90112
    s_nop 0
    buffer_load_dwordx4 v20, s[40:43], s80 offen offset:0 lds
    v_mfma_f32_16x16x32_bf16 v[244:247], a[60:63], a[232:235], v[244:247]
    v_mfma_f32_16x16x32_bf16 v[248:251], a[56:59], a[236:239], v[248:251]
    v_mfma_f32_16x16x32_bf16 v[252:255], a[60:63], a[236:239], v[252:255]
    s_waitcnt lgkmcnt(0)
    v_mfma_f32_16x16x32_bf16 v[176:179], a[64:67], a[160:163], v[176:179]
    ds_read_b128 a[72:75], v101 offset:0
    v_mfma_f32_16x16x32_bf16 v[180:183], a[68:71], a[160:163], v[180:183]
    ds_read_b128 a[76:79], v101 offset:2048
    buffer_load_dwordx4 v21, s[40:43], s80 offen offset:1024 lds
    v_mfma_f32_16x16x32_bf16 v[184:187], a[64:67], a[164:167], v[184:187]
    ds_read_b128 a[200:203], v42 offset:16384
    v_mfma_f32_16x16x32_bf16 v[188:191], a[68:71], a[164:167], v[188:191]
    ds_read_b128 a[204:207], v42 offset:18432
    v_mfma_f32_16x16x32_bf16 v[192:195], a[64:67], a[168:171], v[192:195]
    ds_read_b128 a[208:211], v42 offset:20480
    v_mfma_f32_16x16x32_bf16 v[196:199], a[68:71], a[168:171], v[196:199]
    ds_read_b128 a[212:215], v42 offset:22528
    buffer_load_dwordx4 v22, s[40:43], s80 offen offset:2048 lds
    v_mfma_f32_16x16x32_bf16 v[200:203], a[64:67], a[172:175], v[200:203]
    ds_read_b128 a[216:219], v42 offset:24576
    v_mfma_f32_16x16x32_bf16 v[204:207], a[68:71], a[172:175], v[204:207]
    ds_read_b128 a[220:223], v42 offset:26624
    v_mfma_f32_16x16x32_bf16 v[208:211], a[64:67], a[176:179], v[208:211]
    ds_read_b128 a[224:227], v42 offset:28672
    v_mfma_f32_16x16x32_bf16 v[212:215], a[68:71], a[176:179], v[212:215]
    ds_read_b128 a[228:231], v42 offset:30720
    v_mfma_f32_16x16x32_bf16 v[216:219], a[64:67], a[180:183], v[216:219]
    ds_read_b128 a[232:235], v42 offset:32768
    buffer_load_dwordx4 v23, s[40:43], s80 offen offset:3072 lds
    v_mfma_f32_16x16x32_bf16 v[220:223], a[68:71], a[180:183], v[220:223]
    ds_read_b128 a[236:239], v42 offset:34816
    v_mfma_f32_16x16x32_bf16 v[224:227], a[64:67], a[184:187], v[224:227]
    v_mfma_f32_16x16x32_bf16 v[228:231], a[68:71], a[184:187], v[228:231]
    v_mfma_f32_16x16x32_bf16 v[232:235], a[64:67], a[188:191], v[232:235]
    v_mfma_f32_16x16x32_bf16 v[236:239], a[68:71], a[188:191], v[236:239]
    s_add_u32 m0, s98, 94208
    s_nop 0
    buffer_load_dwordx4 v24, s[40:43], s80 offen offset:0 lds
    v_mfma_f32_16x16x32_bf16 v[240:243], a[64:67], a[192:195], v[240:243]
    v_mfma_f32_16x16x32_bf16 v[244:247], a[68:71], a[192:195], v[244:247]
    v_mfma_f32_16x16x32_bf16 v[248:251], a[64:67], a[196:199], v[248:251]
    v_mfma_f32_16x16x32_bf16 v[252:255], a[68:71], a[196:199], v[252:255]
    s_waitcnt vmcnt(9)
    s_barrier
    s_waitcnt lgkmcnt(0)
    v_mfma_f32_16x16x32_bf16 v[176:179], a[72:75], a[200:203], v[176:179]
    ds_read_b128 a[80:83], v98 offset:36864
    v_mfma_f32_16x16x32_bf16 v[180:183], a[76:79], a[200:203], v[180:183]
    ds_read_b128 a[84:87], v98 offset:38912
    s_add_u32 m0, s97, 110592
    s_add_u32 s80, s85, s94
    buffer_load_dwordx4 v16, s[36:39], s80 offen offset:0 lds
    v_mfma_f32_16x16x32_bf16 v[184:187], a[72:75], a[204:207], v[184:187]
    ds_read_b128 a[160:163], v39 offset:53248
    v_mfma_f32_16x16x32_bf16 v[188:191], a[76:79], a[204:207], v[188:191]
    ds_read_b128 a[164:167], v39 offset:55296
    v_mfma_f32_16x16x32_bf16 v[192:195], a[72:75], a[208:211], v[192:195]
    ds_read_b128 a[168:171], v39 offset:57344
    buffer_load_dwordx4 v17, s[36:39], s80 offen offset:1024 lds
    v_mfma_f32_16x16x32_bf16 v[196:199], a[76:79], a[208:211], v[196:199]
    ds_read_b128 a[172:175], v39 offset:59392
    v_mfma_f32_16x16x32_bf16 v[200:203], a[72:75], a[212:215], v[200:203]
    ds_read_b128 a[176:179], v39 offset:61440
    v_mfma_f32_16x16x32_bf16 v[204:207], a[76:79], a[212:215], v[204:207]
    ds_read_b128 a[180:183], v39 offset:63488
    v_mfma_f32_16x16x32_bf16 v[208:211], a[72:75], a[216:219], v[208:211]
    ds_read_b128 a[184:187], v40 offset:0
    buffer_load_dwordx4 v18, s[36:39], s80 offen offset:2048 lds
    v_mfma_f32_16x16x32_bf16 v[212:215], a[76:79], a[216:219], v[212:215]
    ds_read_b128 a[188:191], v40 offset:2048
    v_mfma_f32_16x16x32_bf16 v[216:219], a[72:75], a[220:223], v[216:219]
    ds_read_b128 a[192:195], v40 offset:4096
    v_mfma_f32_16x16x32_bf16 v[220:223], a[76:79], a[220:223], v[220:223]
    ds_read_b128 a[196:199], v40 offset:6144
    v_mfma_f32_16x16x32_bf16 v[224:227], a[72:75], a[224:227], v[224:227]
    buffer_load_dwordx4 v19, s[36:39], s80 offen offset:3072 lds
    v_mfma_f32_16x16x32_bf16 v[228:231], a[76:79], a[224:227], v[228:231]
    v_mfma_f32_16x16x32_bf16 v[232:235], a[72:75], a[228:231], v[232:235]
    v_mfma_f32_16x16x32_bf16 v[236:239], a[76:79], a[228:231], v[236:239]
    v_mfma_f32_16x16x32_bf16 v[240:243], a[72:75], a[232:235], v[240:243]
    s_add_u32 m0, s98, 126976
    s_nop 0
    buffer_load_dwordx4 v20, s[40:43], s80 offen offset:0 lds
    v_mfma_f32_16x16x32_bf16 v[244:247], a[76:79], a[232:235], v[244:247]
    v_mfma_f32_16x16x32_bf16 v[248:251], a[72:75], a[236:239], v[248:251]
    v_mfma_f32_16x16x32_bf16 v[252:255], a[76:79], a[236:239], v[252:255]
    s_waitcnt lgkmcnt(0)
    v_mfma_f32_16x16x32_bf16 v[176:179], a[80:83], a[160:163], v[176:179]
    ds_read_b128 a[88:91], v101 offset:36864
    v_mfma_f32_16x16x32_bf16 v[180:183], a[84:87], a[160:163], v[180:183]
    ds_read_b128 a[92:95], v101 offset:38912
    buffer_load_dwordx4 v21, s[40:43], s80 offen offset:1024 lds
    v_mfma_f32_16x16x32_bf16 v[184:187], a[80:83], a[164:167], v[184:187]
    ds_read_b128 a[200:203], v42 offset:53248
    v_mfma_f32_16x16x32_bf16 v[188:191], a[84:87], a[164:167], v[188:191]
    ds_read_b128 a[204:207], v42 offset:55296
    v_mfma_f32_16x16x32_bf16 v[192:195], a[80:83], a[168:171], v[192:195]
    ds_read_b128 a[208:211], v42 offset:57344
    v_mfma_f32_16x16x32_bf16 v[196:199], a[84:87], a[168:171], v[196:199]
    ds_read_b128 a[212:215], v42 offset:59392
    buffer_load_dwordx4 v22, s[40:43], s80 offen offset:2048 lds
    v_mfma_f32_16x16x32_bf16 v[200:203], a[80:83], a[172:175], v[200:203]
    ds_read_b128 a[216:219], v42 offset:61440
    v_mfma_f32_16x16x32_bf16 v[204:207], a[84:87], a[172:175], v[204:207]
    ds_read_b128 a[220:223], v42 offset:63488
    v_mfma_f32_16x16x32_bf16 v[208:211], a[80:83], a[176:179], v[208:211]
    ds_read_b128 a[224:227], v43 offset:0
    v_mfma_f32_16x16x32_bf16 v[212:215], a[84:87], a[176:179], v[212:215]
    ds_read_b128 a[228:231], v43 offset:2048
    v_mfma_f32_16x16x32_bf16 v[216:219], a[80:83], a[180:183], v[216:219]
    ds_read_b128 a[232:235], v43 offset:4096
    buffer_load_dwordx4 v23, s[40:43], s80 offen offset:3072 lds
    v_mfma_f32_16x16x32_bf16 v[220:223], a[84:87], a[180:183], v[220:223]
    ds_read_b128 a[236:239], v43 offset:6144
    v_mfma_f32_16x16x32_bf16 v[224:227], a[80:83], a[184:187], v[224:227]
    v_mfma_f32_16x16x32_bf16 v[228:231], a[84:87], a[184:187], v[228:231]
    v_mfma_f32_16x16x32_bf16 v[232:235], a[80:83], a[188:191], v[232:235]
    v_mfma_f32_16x16x32_bf16 v[236:239], a[84:87], a[188:191], v[236:239]
    s_add_u32 m0, s98, 131072
    s_nop 0
    buffer_load_dwordx4 v24, s[40:43], s80 offen offset:0 lds
    v_mfma_f32_16x16x32_bf16 v[240:243], a[80:83], a[192:195], v[240:243]
    v_mfma_f32_16x16x32_bf16 v[244:247], a[84:87], a[192:195], v[244:247]
    v_mfma_f32_16x16x32_bf16 v[248:251], a[80:83], a[196:199], v[248:251]
    v_mfma_f32_16x16x32_bf16 v[252:255], a[84:87], a[196:199], v[252:255]
    s_waitcnt vmcnt(9)
    s_barrier
    s_waitcnt lgkmcnt(0)
    v_mfma_f32_16x16x32_bf16 v[176:179], a[88:91], a[200:203], v[176:179]
    ds_read_b128 a[96:99], v99 offset:8192
    v_mfma_f32_16x16x32_bf16 v[180:183], a[92:95], a[200:203], v[180:183]
    ds_read_b128 a[100:103], v99 offset:10240
    s_add_u32 m0, s97, 0
    s_add_u32 s80, s86, s94
    buffer_load_dwordx4 v16, s[36:39], s80 offen offset:0 lds
    v_mfma_f32_16x16x32_bf16 v[184:187], a[88:91], a[204:207], v[184:187]
    ds_read_b128 a[160:163], v40 offset:24576
    v_mfma_f32_16x16x32_bf16 v[188:191], a[92:95], a[204:207], v[188:191]
    ds_read_b128 a[164:167], v40 offset:26624
    v_mfma_f32_16x16x32_bf16 v[192:195], a[88:91], a[208:211], v[192:195]
    ds_read_b128 a[168:171], v40 offset:28672
    buffer_load_dwordx4 v17, s[36:39], s80 offen offset:1024 lds
    v_mfma_f32_16x16x32_bf16 v[196:199], a[92:95], a[208:211], v[196:199]
    ds_read_b128 a[172:175], v40 offset:30720
    v_mfma_f32_16x16x32_bf16 v[200:203], a[88:91], a[212:215], v[200:203]
    ds_read_b128 a[176:179], v40 offset:32768
    v_mfma_f32_16x16x32_bf16 v[204:207], a[92:95], a[212:215], v[204:207]
    ds_read_b128 a[180:183], v40 offset:34816
    v_mfma_f32_16x16x32_bf16 v[208:211], a[88:91], a[216:219], v[208:211]
    ds_read_b128 a[184:187], v40 offset:36864
    buffer_load_dwordx4 v18, s[36:39], s80 offen offset:2048 lds
    v_mfma_f32_16x16x32_bf16 v[212:215], a[92:95], a[216:219], v[212:215]
    ds_read_b128 a[188:191], v40 offset:38912
    v_mfma_f32_16x16x32_bf16 v[216:219], a[88:91], a[220:223], v[216:219]
    ds_read_b128 a[192:195], v40 offset:40960
    v_mfma_f32_16x16x32_bf16 v[220:223], a[92:95], a[220:223], v[220:223]
    ds_read_b128 a[196:199], v40 offset:43008
    v_mfma_f32_16x16x32_bf16 v[224:227], a[88:91], a[224:227], v[224:227]
    buffer_load_dwordx4 v19, s[36:39], s80 offen offset:3072 lds
    v_mfma_f32_16x16x32_bf16 v[228:231], a[92:95], a[224:227], v[228:231]
    v_mfma_f32_16x16x32_bf16 v[232:235], a[88:91], a[228:231], v[232:235]
    v_mfma_f32_16x16x32_bf16 v[236:239], a[92:95], a[228:231], v[236:239]
    v_mfma_f32_16x16x32_bf16 v[240:243], a[88:91], a[232:235], v[240:243]
    s_add_u32 m0, s98, 16384
    s_nop 0
    buffer_load_dwordx4 v20, s[40:43], s80 offen offset:0 lds
    v_mfma_f32_16x16x32_bf16 v[244:247], a[92:95], a[232:235], v[244:247]
    v_mfma_f32_16x16x32_bf16 v[248:251], a[88:91], a[236:239], v[248:251]
    v_mfma_f32_16x16x32_bf16 v[252:255], a[92:95], a[236:239], v[252:255]
    s_waitcnt lgkmcnt(0)
    v_mfma_f32_16x16x32_bf16 v[176:179], a[96:99], a[160:163], v[176:179]
    ds_read_b128 a[104:107], v102 offset:8192
    v_mfma_f32_16x16x32_bf16 v[180:183], a[100:103], a[160:163], v[180:183]
    ds_read_b128 a[108:111], v102 offset:10240
    buffer_load_dwordx4 v21, s[40:43], s80 offen offset:1024 lds
    v_mfma_f32_16x16x32_bf16 v[184:187], a[96:99], a[164:167], v[184:187]
    ds_read_b128 a[200:203], v43 offset:24576
    v_mfma_f32_16x16x32_bf16 v[188:191], a[100:103], a[164:167], v[188:191]
    ds_read_b128 a[204:207], v43 offset:26624
    v_mfma_f32_16x16x32_bf16 v[192:195], a[96:99], a[168:171], v[192:195]
    ds_read_b128 a[208:211], v43 offset:28672
    buffer_load_dwordx4 v22, s[40:43], s80 offen offset:2048 lds
    v_mfma_f32_16x16x32_bf16 v[196:199], a[100:103], a[168:171], v[196:199]
    ds_read_b128 a[212:215], v43 offset:30720
    v_mfma_f32_16x16x32_bf16 v[200:203], a[96:99], a[172:175], v[200:203]
    ds_read_b128 a[216:219], v43 offset:32768
    v_mfma_f32_16x16x32_bf16 v[204:207], a[100:103], a[172:175], v[204:207]
    ds_read_b128 a[220:223], v43 offset:34816
    v_mfma_f32_16x16x32_bf16 v[208:211], a[96:99], a[176:179], v[208:211]
    ds_read_b128 a[224:227], v43 offset:36864
    buffer_load_dwordx4 v23, s[40:43], s80 offen offset:3072 lds
    v_mfma_f32_16x16x32_bf16 v[212:215], a[100:103], a[176:179], v[212:215]
    ds_read_b128 a[228:231], v43 offset:38912
    v_mfma_f32_16x16x32_bf16 v[216:219], a[96:99], a[180:183], v[216:219]
    ds_read_b128 a[232:235], v43 offset:40960
    v_mfma_f32_16x16x32_bf16 v[220:223], a[100:103], a[180:183], v[220:223]
    ds_read_b128 a[236:239], v43 offset:43008
    v_mfma_f32_16x16x32_bf16 v[224:227], a[96:99], a[184:187], v[224:227]
    s_add_u32 m0, s98, 20480
    s_nop 0
    buffer_load_dwordx4 v24, s[40:43], s80 offen offset:0 lds
    v_mfma_f32_16x16x32_bf16 v[228:231], a[100:103], a[184:187], v[228:231]
    v_mfma_f32_16x16x32_bf16 v[232:235], a[96:99], a[188:191], v[232:235]
    v_mfma_f32_16x16x32_bf16 v[236:239], a[100:103], a[188:191], v[236:239]
    v_mfma_f32_16x16x32_bf16 v[240:243], a[96:99], a[192:195], v[240:243]
    buffer_load_dword v47, off, s[56:59], 0 sc1
    v_mfma_f32_16x16x32_bf16 v[244:247], a[100:103], a[192:195], v[244:247]
    v_mfma_f32_16x16x32_bf16 v[248:251], a[96:99], a[196:199], v[248:251]
    v_mfma_f32_16x16x32_bf16 v[252:255], a[100:103], a[196:199], v[252:255]
    s_waitcnt vmcnt(10)
    s_barrier
    s_waitcnt lgkmcnt(0)
    v_mfma_f32_16x16x32_bf16 v[176:179], a[104:107], a[200:203], v[176:179]
    ds_read_b128 a[112:115], v99 offset:45056
    v_mfma_f32_16x16x32_bf16 v[180:183], a[108:111], a[200:203], v[180:183]
    ds_read_b128 a[116:119], v99 offset:47104
    s_add_u32 m0, s97, 36864
    s_add_u32 s80, s87, s94
    buffer_load_dwordx4 v16, s[36:39], s80 offen offset:0 lds
    v_mfma_f32_16x16x32_bf16 v[184:187], a[104:107], a[204:207], v[184:187]
    ds_read_b128 a[160:163], v40 offset:61440
    v_mfma_f32_16x16x32_bf16 v[188:191], a[108:111], a[204:207], v[188:191]
    ds_read_b128 a[164:167], v40 offset:63488
    v_mfma_f32_16x16x32_bf16 v[192:195], a[104:107], a[208:211], v[192:195]
    ds_read_b128 a[168:171], v41 offset:0
    buffer_load_dwordx4 v17, s[36:39], s80 offen offset:1024 lds
    v_mfma_f32_16x16x32_bf16 v[196:199], a[108:111], a[208:211], v[196:199]
    ds_read_b128 a[172:175], v41 offset:2048
    v_mfma_f32_16x16x32_bf16 v[200:203], a[104:107], a[212:215], v[200:203]
    ds_read_b128 a[176:179], v41 offset:4096
    v_mfma_f32_16x16x32_bf16 v[204:207], a[108:111], a[212:215], v[204:207]
    ds_read_b128 a[180:183], v41 offset:6144
    v_mfma_f32_16x16x32_bf16 v[208:211], a[104:107], a[216:219], v[208:211]
    ds_read_b128 a[184:187], v41 offset:8192
    buffer_load_dwordx4 v18, s[36:39], s80 offen offset:2048 lds
    v_mfma_f32_16x16x32_bf16 v[212:215], a[108:111], a[216:219], v[212:215]
    ds_read_b128 a[188:191], v41 offset:10240
    v_mfma_f32_16x16x32_bf16 v[216:219], a[104:107], a[220:223], v[216:219]
    ds_read_b128 a[192:195], v41 offset:12288
    v_mfma_f32_16x16x32_bf16 v[220:223], a[108:111], a[220:223], v[220:223]
    ds_read_b128 a[196:199], v41 offset:14336
    v_mfma_f32_16x16x32_bf16 v[224:227], a[104:107], a[224:227], v[224:227]
    buffer_load_dwordx4 v19, s[36:39], s80 offen offset:3072 lds
    v_mfma_f32_16x16x32_bf16 v[228:231], a[108:111], a[224:227], v[228:231]
    v_mfma_f32_16x16x32_bf16 v[232:235], a[104:107], a[228:231], v[232:235]
    v_mfma_f32_16x16x32_bf16 v[236:239], a[108:111], a[228:231], v[236:239]
    v_mfma_f32_16x16x32_bf16 v[240:243], a[104:107], a[232:235], v[240:243]
    s_add_u32 m0, s98, 53248
    s_nop 0
    buffer_load_dwordx4 v20, s[40:43], s80 offen offset:0 lds
    v_mfma_f32_16x16x32_bf16 v[244:247], a[108:111], a[232:235], v[244:247]
    v_mfma_f32_16x16x32_bf16 v[248:251], a[104:107], a[236:239], v[248:251]
    v_mfma_f32_16x16x32_bf16 v[252:255], a[108:111], a[236:239], v[252:255]
    s_waitcnt lgkmcnt(0)
    v_mfma_f32_16x16x32_bf16 v[176:179], a[112:115], a[160:163], v[176:179]
    ds_read_b128 a[120:123], v102 offset:45056
    v_mfma_f32_16x16x32_bf16 v[180:183], a[116:119], a[160:163], v[180:183]
    ds_read_b128 a[124:127], v102 offset:47104
    buffer_load_dwordx4 v21, s[40:43], s80 offen offset:1024 lds
    v_mfma_f32_16x16x32_bf16 v[184:187], a[112:115], a[164:167], v[184:187]
    ds_read_b128 a[200:203], v43 offset:61440
    v_mfma_f32_16x16x32_bf16 v[188:191], a[116:119], a[164:167], v[188:191]
    ds_read_b128 a[204:207], v43 offset:63488
    v_mfma_f32_16x16x32_bf16 v[192:195], a[112:115], a[168:171], v[192:195]
    ds_read_b128 a[208:211], v44 offset:0
    v_mfma_f32_16x16x32_bf16 v[196:199], a[116:119], a[168:171], v[196:199]
    ds_read_b128 a[212:215], v44 offset:2048
    buffer_load_dwordx4 v22, s[40:43], s80 offen offset:2048 lds
    v_mfma_f32_16x16x32_bf16 v[200:203], a[112:115], a[172:175], v[200:203]
    ds_read_b128 a[216:219], v44 offset:4096
    v_mfma_f32_16x16x32_bf16 v[204:207], a[116:119], a[172:175], v[204:207]
    ds_read_b128 a[220:223], v44 offset:6144
    v_mfma_f32_16x16x32_bf16 v[208:211], a[112:115], a[176:179], v[208:211]
    ds_read_b128 a[224:227], v44 offset:8192
    v_mfma_f32_16x16x32_bf16 v[212:215], a[116:119], a[176:179], v[212:215]
    ds_read_b128 a[228:231], v44 offset:10240
    v_mfma_f32_16x16x32_bf16 v[216:219], a[112:115], a[180:183], v[216:219]
    ds_read_b128 a[232:235], v44 offset:12288
    buffer_load_dwordx4 v23, s[40:43], s80 offen offset:3072 lds
    v_mfma_f32_16x16x32_bf16 v[220:223], a[116:119], a[180:183], v[220:223]
    ds_read_b128 a[236:239], v44 offset:14336
    v_mfma_f32_16x16x32_bf16 v[224:227], a[112:115], a[184:187], v[224:227]
    v_mfma_f32_16x16x32_bf16 v[228:231], a[116:119], a[184:187], v[228:231]
    v_mfma_f32_16x16x32_bf16 v[232:235], a[112:115], a[188:191], v[232:235]
    v_mfma_f32_16x16x32_bf16 v[236:239], a[116:119], a[188:191], v[236:239]
    s_add_u32 m0, s98, 57344
    s_nop 0
    buffer_load_dwordx4 v24, s[40:43], s80 offen offset:0 lds
    v_mfma_f32_16x16x32_bf16 v[240:243], a[112:115], a[192:195], v[240:243]
    v_mfma_f32_16x16x32_bf16 v[244:247], a[116:119], a[192:195], v[244:247]
    v_mfma_f32_16x16x32_bf16 v[248:251], a[112:115], a[196:199], v[248:251]
    v_mfma_f32_16x16x32_bf16 v[252:255], a[116:119], a[196:199], v[252:255]
    s_waitcnt vmcnt(10)
    s_barrier
    s_waitcnt vmcnt(9)
    v_readfirstlane_b32 s79, v47
    s_nop 3
    s_cmp_lg_u32 s79, 0
    s_cbranch_scc1 L_nonce_18
    s_mov_b32 s82, 0x40000
L_nlp_19:
    buffer_load_dword v47, off, s[56:59], 0 sc1
    s_waitcnt vmcnt(0)
    v_readfirstlane_b32 s79, v47
    s_nop 3
    s_cmp_lg_u32 s79, 0
    s_cbranch_scc1 L_nonce_18
    s_sub_u32 s82, s82, 1
    s_cbranch_scc0 L_nlp_19
L_nonce_18:
    s_waitcnt lgkmcnt(0)
    v_mfma_f32_16x16x32_bf16 v[176:179], a[120:123], a[200:203], v[176:179]
    ds_read_b128 a[128:131], v98 offset:0
    v_mfma_f32_16x16x32_bf16 v[180:183], a[124:127], a[200:203], v[180:183]
    ds_read_b128 a[132:135], v98 offset:2048
    v_mov_b32 v106, s79
    buffer_store_dwordx2 v[106:107], v104, s[48:51], 0 offen sc1
    v_mfma_f32_16x16x32_bf16 v[184:187], a[120:123], a[204:207], v[184:187]
    ds_read_b128 a[160:163], v39 offset:16384
    v_mfma_f32_16x16x32_bf16 v[188:191], a[124:127], a[204:207], v[188:191]
    ds_read_b128 a[164:167], v39 offset:18432
    v_mfma_f32_16x16x32_bf16 v[192:195], a[120:123], a[208:211], v[192:195]
    ds_read_b128 a[168:171], v39 offset:20480
    s_add_u32 m0, s92, 0
    s_nop 0
    buffer_load_dwordx4 v108, s[36:39], 0 offen offset:0 lds
    v_mfma_f32_16x16x32_bf16 v[196:199], a[124:127], a[208:211], v[196:199]
    ds_read_b128 a[172:175], v39 offset:22528
    v_mfma_f32_16x16x32_bf16 v[200:203], a[120:123], a[212:215], v[200:203]
    ds_read_b128 a[176:179], v39 offset:24576
    v_mfma_f32_16x16x32_bf16 v[204:207], a[124:127], a[212:215], v[204:207]
    ds_read_b128 a[180:183], v39 offset:26624
    buffer_load_dwordx4 v109, s[36:39], 0 offen offset:1024 lds
    v_mfma_f32_16x16x32_bf16 v[208:211], a[120:123], a[216:219], v[208:211]
    ds_read_b128 a[184:187], v39 offset:28672
    v_mfma_f32_16x16x32_bf16 v[212:215], a[124:127], a[216:219], v[212:215]
    ds_read_b128 a[188:191], v39 offset:30720
    v_mfma_f32_16x16x32_bf16 v[216:219], a[120:123], a[220:223], v[216:219]
    ds_read_b128 a[192:195], v39 offset:32768
    buffer_load_dwordx4 v110, s[36:39], 0 offen offset:2048 lds
    v_mfma_f32_16x16x32_bf16 v[220:223], a[124:127], a[220:223], v[220:223]
    ds_read_b128 a[196:199], v39 offset:34816
    v_mfma_f32_16x16x32_bf16 v[224:227], a[120:123], a[224:227], v[224:227]
    v_mfma_f32_16x16x32_bf16 v[228:231], a[124:127], a[224:227], v[228:231]
    buffer_load_dwordx4 v111, s[36:39], 0 offen offset:3072 lds
    v_mfma_f32_16x16x32_bf16 v[232:235], a[120:123], a[228:231], v[232:235]
    v_mfma_f32_16x16x32_bf16 v[236:239], a[124:127], a[228:231], v[236:239]
    v_mfma_f32_16x16x32_bf16 v[240:243], a[120:123], a[232:235], v[240:243]
    s_add_u32 m0, s92, 4096
    s_nop 0
    buffer_load_dwordx4 v112, s[36:39], 0 offen offset:0 lds
    v_mfma_f32_16x16x32_bf16 v[244:247], a[124:127], a[232:235], v[244:247]
    v_mfma_f32_16x16x32_bf16 v[248:251], a[120:123], a[236:239], v[248:251]
    v_mfma_f32_16x16x32_bf16 v[252:255], a[124:127], a[236:239], v[252:255]
    s_waitcnt lgkmcnt(0)
    v_mfma_f32_16x16x32_bf16 v[176:179], a[128:131], a[160:163], v[176:179]
    ds_read_b128 a[136:139], v101 offset:0
    v_mfma_f32_16x16x32_bf16 v[180:183], a[132:135], a[160:163], v[180:183]
    ds_read_b128 a[140:143], v101 offset:2048
    v_mfma_f32_16x16x32_bf16 v[184:187], a[128:131], a[164:167], v[184:187]
    ds_read_b128 a[200:203], v42 offset:16384
    v_mfma_f32_16x16x32_bf16 v[188:191], a[132:135], a[164:167], v[188:191]
    ds_read_b128 a[204:207], v42 offset:18432
    v_mfma_f32_16x16x32_bf16 v[192:195], a[128:131], a[168:171], v[192:195]
    ds_read_b128 a[208:211], v42 offset:20480
    v_mfma_f32_16x16x32_bf16 v[196:199], a[132:135], a[168:171], v[196:199]
    ds_read_b128 a[212:215], v42 offset:22528
    v_mfma_f32_16x16x32_bf16 v[200:203], a[128:131], a[172:175], v[200:203]
    ds_read_b128 a[216:219], v42 offset:24576
    v_mfma_f32_16x16x32_bf16 v[204:207], a[132:135], a[172:175], v[204:207]
    ds_read_b128 a[220:223], v42 offset:26624
    v_mfma_f32_16x16x32_bf16 v[208:211], a[128:131], a[176:179], v[208:211]
    ds_read_b128 a[224:227], v42 offset:28672
    v_mfma_f32_16x16x32_bf16 v[212:215], a[132:135], a[176:179], v[212:215]
    ds_read_b128 a[228:231], v42 offset:30720
    v_mfma_f32_16x16x32_bf16 v[216:219], a[128:131], a[180:183], v[216:219]
    ds_read_b128 a[232:235], v42 offset:32768
    v_mfma_f32_16x16x32_bf16 v[220:223], a[132:135], a[180:183], v[220:223]
    ds_read_b128 a[236:239], v42 offset:34816
    v_mfma_f32_16x16x32_bf16 v[224:227], a[128:131], a[184:187], v[224:227]
    v_mfma_f32_16x16x32_bf16 v[228:231], a[132:135], a[184:187], v[228:231]
    v_mfma_f32_16x16x32_bf16 v[232:235], a[128:131], a[188:191], v[232:235]
    v_mfma_f32_16x16x32_bf16 v[236:239], a[132:135], a[188:191], v[236:239]
    v_mfma_f32_16x16x32_bf16 v[240:243], a[128:131], a[192:195], v[240:243]
    v_mfma_f32_16x16x32_bf16 v[244:247], a[132:135], a[192:195], v[244:247]
    v_mfma_f32_16x16x32_bf16 v[248:251], a[128:131], a[196:199], v[248:251]
    v_mfma_f32_16x16x32_bf16 v[252:255], a[132:135], a[196:199], v[252:255]
    s_waitcnt vmcnt(6)
    s_barrier
    s_waitcnt lgkmcnt(0)
    v_mfma_f32_16x16x32_bf16 v[176:179], a[136:139], a[200:203], v[176:179]
    ds_read_b128 a[144:147], v98 offset:36864
    v_mfma_f32_16x16x32_bf16 v[180:183], a[140:143], a[200:203], v[180:183]
    ds_read_b128 a[148:151], v98 offset:38912
    s_add_u32 m0, s98, 102400
    s_add_u32 s81, s90, 0
    s_sub_u32 s101, s81, 10
    s_cselect_b32 s81, s81, s101
    s_lshl_b32 s81, s81, 7
    buffer_load_dwordx4 v20, s[44:47], s81 offen offset:0 lds
    v_mfma_f32_16x16x32_bf16 v[184:187], a[136:139], a[204:207], v[184:187]
    ds_read_b128 a[160:163], v39 offset:53248
    v_mfma_f32_16x16x32_bf16 v[188:191], a[140:143], a[204:207], v[188:191]
    ds_read_b128 a[164:167], v39 offset:55296
    v_mfma_f32_16x16x32_bf16 v[192:195], a[136:139], a[208:211], v[192:195]
    ds_read_b128 a[168:171], v39 offset:57344
    v_mfma_f32_16x16x32_bf16 v[196:199], a[140:143], a[208:211], v[196:199]
    ds_read_b128 a[172:175], v39 offset:59392
    buffer_load_dwordx4 v21, s[44:47], s81 offen offset:1024 lds
    v_mfma_f32_16x16x32_bf16 v[200:203], a[136:139], a[212:215], v[200:203]
    ds_read_b128 a[176:179], v39 offset:61440
    v_mfma_f32_16x16x32_bf16 v[204:207], a[140:143], a[212:215], v[204:207]
    ds_read_b128 a[180:183], v39 offset:63488
    v_mfma_f32_16x16x32_bf16 v[208:211], a[136:139], a[216:219], v[208:211]
    ds_read_b128 a[184:187], v40 offset:0
    v_mfma_f32_16x16x32_bf16 v[212:215], a[140:143], a[216:219], v[212:215]
    ds_read_b128 a[188:191], v40 offset:2048
    v_mfma_f32_16x16x32_bf16 v[216:219], a[136:139], a[220:223], v[216:219]
    ds_read_b128 a[192:195], v40 offset:4096
    buffer_load_dwordx4 v22, s[44:47], s81 offen offset:2048 lds
    v_mfma_f32_16x16x32_bf16 v[220:223], a[140:143], a[220:223], v[220:223]
    ds_read_b128 a[196:199], v40 offset:6144
    v_mfma_f32_16x16x32_bf16 v[224:227], a[136:139], a[224:227], v[224:227]
    v_mfma_f32_16x16x32_bf16 v[228:231], a[140:143], a[224:227], v[228:231]
    v_mfma_f32_16x16x32_bf16 v[232:235], a[136:139], a[228:231], v[232:235]
    v_mfma_f32_16x16x32_bf16 v[236:239], a[140:143], a[228:231], v[236:239]
    buffer_load_dwordx4 v23, s[44:47], s81 offen offset:3072 lds
    v_mfma_f32_16x16x32_bf16 v[240:243], a[136:139], a[232:235], v[240:243]
    v_mfma_f32_16x16x32_bf16 v[244:247], a[140:143], a[232:235], v[244:247]
    v_mfma_f32_16x16x32_bf16 v[248:251], a[136:139], a[236:239], v[248:251]
    v_mfma_f32_16x16x32_bf16 v[252:255], a[140:143], a[236:239], v[252:255]
    s_waitcnt lgkmcnt(0)
    v_mfma_f32_16x16x32_bf16 v[176:179], a[144:147], a[160:163], v[176:179]
    ds_read_b128 a[152:155], v101 offset:36864
    v_mfma_f32_16x16x32_bf16 v[180:183], a[148:151], a[160:163], v[180:183]
    ds_read_b128 a[156:159], v101 offset:38912
    s_add_u32 m0, s98, 106496
    s_nop 0
    buffer_load_dwordx4 v24, s[44:47], s81 offen offset:0 lds
    v_mfma_f32_16x16x32_bf16 v[184:187], a[144:147], a[164:167], v[184:187]
    ds_read_b128 a[200:203], v42 offset:53248
    v_mfma_f32_16x16x32_bf16 v[188:191], a[148:151], a[164:167], v[188:191]
    ds_read_b128 a[204:207], v42 offset:55296
    v_mfma_f32_16x16x32_bf16 v[192:195], a[144:147], a[168:171], v[192:195]
    ds_read_b128 a[208:211], v42 offset:57344
    v_mfma_f32_16x16x32_bf16 v[196:199], a[148:151], a[168:171], v[196:199]
    ds_read_b128 a[212:215], v42 offset:59392
    s_add_u32 m0, s98, 122880
    s_add_u32 s81, s90, 1
    s_sub_u32 s101, s81, 10
    s_cselect_b32 s81, s81, s101
    s_lshl_b32 s81, s81, 7
    buffer_load_dwordx4 v20, s[44:47], s81 offen offset:0 lds
    v_mfma_f32_16x16x32_bf16 v[200:203], a[144:147], a[172:175], v[200:203]
    ds_read_b128 a[216:219], v42 offset:61440
    v_mfma_f32_16x16x32_bf16 v[204:207], a[148:151], a[172:175], v[204:207]
    ds_read_b128 a[220:223], v42 offset:63488
    v_mfma_f32_16x16x32_bf16 v[208:211], a[144:147], a[176:179], v[208:211]
    ds_read_b128 a[224:227], v43 offset:0
    v_mfma_f32_16x16x32_bf16 v[212:215], a[148:151], a[176:179], v[212:215]
    ds_read_b128 a[228:231], v43 offset:2048
    v_mfma_f32_16x16x32_bf16 v[216:219], a[144:147], a[180:183], v[216:219]
    ds_read_b128 a[232:235], v43 offset:4096
    buffer_load_dwordx4 v21, s[44:47], s81 offen offset:1024 lds
    v_mfma_f32_16x16x32_bf16 v[220:223], a[148:151], a[180:183], v[220:223]
    ds_read_b128 a[236:239], v43 offset:6144
    v_mfma_f32_16x16x32_bf16 v[224:227], a[144:147], a[184:187], v[224:227]
    v_mfma_f32_16x16x32_bf16 v[228:231], a[148:151], a[184:187], v[228:231]
    v_mfma_f32_16x16x32_bf16 v[232:235], a[144:147], a[188:191], v[232:235]
    v_mfma_f32_16x16x32_bf16 v[236:239], a[148:151], a[188:191], v[236:239]
    buffer_load_dwordx4 v22, s[44:47], s81 offen offset:2048 lds
    v_mfma_f32_16x16x32_bf16 v[240:243], a[144:147], a[192:195], v[240:243]
    v_mfma_f32_16x16x32_bf16 v[244:247], a[148:151], a[192:195], v[244:247]
    v_mfma_f32_16x16x32_bf16 v[248:251], a[144:147], a[196:199], v[248:251]
    v_mfma_f32_16x16x32_bf16 v[252:255], a[148:151], a[196:199], v[252:255]
    s_waitcnt lgkmcnt(0)
    s_barrier
    v_mfma_f32_16x16x32_bf16 v[176:179], a[152:155], a[200:203], v[176:179]
    v_mfma_f32_16x16x32_bf16 v[180:183], a[156:159], a[200:203], v[180:183]
    s_waitcnt vmcnt(8)
    v_mfma_f32_16x16x32_bf16 v[184:187], a[152:155], a[204:207], v[184:187]
    ds_read_b64 a[0:1], v95 offset:0
    v_mfma_f32_16x16x32_bf16 v[188:191], a[156:159], a[204:207], v[188:191]
    ds_read_b64 a[2:3], v95 offset:32
    v_mfma_f32_16x16x32_bf16 v[192:195], a[152:155], a[208:211], v[192:195]
    v_mfma_f32_16x16x32_bf16 v[196:199], a[156:159], a[208:211], v[196:199]
    ds_read_b64 a[4:5], v95 offset:64
    v_mfma_f32_16x16x32_bf16 v[200:203], a[152:155], a[212:215], v[200:203]
    ds_read_b64 a[6:7], v95 offset:96
    v_mfma_f32_16x16x32_bf16 v[204:207], a[156:159], a[212:215], v[204:207]
    v_mfma_f32_16x16x32_bf16 v[208:211], a[152:155], a[216:219], v[208:211]
    ds_read_b64 a[8:9], v95 offset:128
    v_mfma_f32_16x16x32_bf16 v[212:215], a[156:159], a[216:219], v[212:215]
    ds_read_b64 a[10:11], v95 offset:2560
    v_mfma_f32_16x16x32_bf16 v[216:219], a[152:155], a[220:223], v[216:219]
    v_mfma_f32_16x16x32_bf16 v[220:223], a[156:159], a[220:223], v[220:223]
    ds_read_b64 a[12:13], v95 offset:2592
    v_mfma_f32_16x16x32_bf16 v[224:227], a[152:155], a[224:227], v[224:227]
    ds_read_b64 a[14:15], v95 offset:2624
    v_mfma_f32_16x16x32_bf16 v[228:231], a[156:159], a[224:227], v[228:231]
    v_mfma_f32_16x16x32_bf16 v[232:235], a[152:155], a[228:231], v[232:235]
    ds_read_b64 a[16:17], v95 offset:2656
    v_mfma_f32_16x16x32_bf16 v[236:239], a[156:159], a[228:231], v[236:239]
    ds_read_b64 a[18:19], v95 offset:2688
    v_mfma_f32_16x16x32_bf16 v[240:243], a[152:155], a[232:235], v[240:243]
    v_mfma_f32_16x16x32_bf16 v[244:247], a[156:159], a[232:235], v[244:247]
    buffer_load_dwordx4 v23, s[44:47], s81 offen offset:3072 lds
    v_mfma_f32_16x16x32_bf16 v[248:251], a[152:155], a[236:239], v[248:251]
    s_add_u32 m0, s98, 126976
    s_nop 0
    buffer_load_dwordx4 v24, s[44:47], s81 offen offset:0 lds
    v_mfma_f32_16x16x32_bf16 v[252:255], a[156:159], a[236:239], v[252:255]
    v_pk_fma_f32 v[136:137], v[48:49], v[176:177], v[178:179] op_sel:[1,0,0] op_sel_hi:[1,1,1]
    v_pk_fma_f32 v[138:139], v[48:49], v[216:217], v[218:219] op_sel:[1,0,0] op_sel_hi:[1,1,1]
    v_pk_fma_f32 v[140:141], v[56:57], v[184:185], v[186:187] op_sel:[1,0,0] op_sel_hi:[1,1,1]
    v_pk_fma_f32 v[142:143], v[56:57], v[224:225], v[226:227] op_sel:[1,0,0] op_sel_hi:[1,1,1]
    v_pk_fma_f32 v[144:145], v[64:65], v[192:193], v[194:195] op_sel:[1,0,0] op_sel_hi:[1,1,1]
    v_pk_fma_f32 v[146:147], v[64:65], v[232:233], v[234:235] op_sel:[1,0,0] op_sel_hi:[1,1,1]
    v_pk_fma_f32 v[148:149], v[72:73], v[200:201], v[202:203] op_sel:[1,0,0] op_sel_hi:[1,1,1]
    v_pk_fma_f32 v[150:151], v[72:73], v[240:241], v[242:243] op_sel:[1,0,0] op_sel_hi:[1,1,1]
    v_pk_fma_f32 v[152:153], v[80:81], v[208:209], v[210:211] op_sel:[1,0,0] op_sel_hi:[1,1,1]
    v_pk_fma_f32 v[154:155], v[80:81], v[248:249], v[250:251] op_sel:[1,0,0] op_sel_hi:[1,1,1]
    v_pk_fma_f32 v[136:137], v[50:51], v[216:217], v[136:137] op_sel:[1,0,0] op_sel_hi:[1,1,1] neg_lo:[1,0,0] neg_hi:[1,0,0]
    v_pk_fma_f32 v[138:139], v[50:51], v[176:177], v[138:139] op_sel:[1,0,0] op_sel_hi:[1,1,1]
    v_pk_fma_f32 v[140:141], v[58:59], v[224:225], v[140:141] op_sel:[1,0,0] op_sel_hi:[1,1,1] neg_lo:[1,0,0] neg_hi:[1,0,0]
    v_pk_fma_f32 v[142:143], v[58:59], v[184:185], v[142:143] op_sel:[1,0,0] op_sel_hi:[1,1,1]
    v_pk_fma_f32 v[144:145], v[66:67], v[232:233], v[144:145] op_sel:[1,0,0] op_sel_hi:[1,1,1] neg_lo:[1,0,0] neg_hi:[1,0,0]
    v_pk_fma_f32 v[146:147], v[66:67], v[192:193], v[146:147] op_sel:[1,0,0] op_sel_hi:[1,1,1]
    v_pk_fma_f32 v[148:149], v[74:75], v[240:241], v[148:149] op_sel:[1,0,0] op_sel_hi:[1,1,1] neg_lo:[1,0,0] neg_hi:[1,0,0]
    v_pk_fma_f32 v[150:151], v[74:75], v[200:201], v[150:151] op_sel:[1,0,0] op_sel_hi:[1,1,1]
    v_pk_fma_f32 v[152:153], v[82:83], v[248:249], v[152:153] op_sel:[1,0,0] op_sel_hi:[1,1,1] neg_lo:[1,0,0] neg_hi:[1,0,0]
    v_pk_fma_f32 v[154:155], v[82:83], v[208:209], v[154:155] op_sel:[1,0,0] op_sel_hi:[1,1,1]
    v_pk_fma_f32 v[156:157], v[48:49], v[136:137], v[180:181] op_sel:[1,0,0] op_sel_hi:[1,1,1]
    v_pk_fma_f32 v[158:159], v[48:49], v[138:139], v[220:221] op_sel:[1,0,0] op_sel_hi:[1,1,1]
    v_pk_fma_f32 v[160:161], v[56:57], v[140:141], v[188:189] op_sel:[1,0,0] op_sel_hi:[1,1,1]
    v_pk_fma_f32 v[162:163], v[56:57], v[142:143], v[228:229] op_sel:[1,0,0] op_sel_hi:[1,1,1]
    v_pk_fma_f32 v[164:165], v[64:65], v[144:145], v[196:197] op_sel:[1,0,0] op_sel_hi:[1,1,1]
    v_pk_fma_f32 v[166:167], v[64:65], v[146:147], v[236:237] op_sel:[1,0,0] op_sel_hi:[1,1,1]
    v_pk_fma_f32 v[168:169], v[72:73], v[148:149], v[204:205] op_sel:[1,0,0] op_sel_hi:[1,1,1]
    v_pk_fma_f32 v[170:171], v[72:73], v[150:151], v[244:245] op_sel:[1,0,0] op_sel_hi:[1,1,1]
    v_pk_fma_f32 v[172:173], v[80:81], v[152:153], v[212:213] op_sel:[1,0,0] op_sel_hi:[1,1,1]
    v_pk_fma_f32 v[174:175], v[80:81], v[154:155], v[252:253] op_sel:[1,0,0] op_sel_hi:[1,1,1]
    v_pk_fma_f32 v[156:157], v[50:51], v[138:139], v[156:157] op_sel:[1,0,0] op_sel_hi:[1,1,1] neg_lo:[1,0,0] neg_hi:[1,0,0]
    v_pk_fma_f32 v[158:159], v[50:51], v[136:137], v[158:159] op_sel:[1,0,0] op_sel_hi:[1,1,1]
    v_pk_fma_f32 v[160:161], v[58:59], v[142:143], v[160:161] op_sel:[1,0,0] op_sel_hi:[1,1,1] neg_lo:[1,0,0] neg_hi:[1,0,0]
    v_pk_fma_f32 v[162:163], v[58:59], v[140:141], v[162:163] op_sel:[1,0,0] op_sel_hi:[1,1,1]
    v_pk_fma_f32 v[164:165], v[66:67], v[146:147], v[164:165] op_sel:[1,0,0] op_sel_hi:[1,1,1] neg_lo:[1,0,0] neg_hi:[1,0,0]
    v_pk_fma_f32 v[166:167], v[66:67], v[144:145], v[166:167] op_sel:[1,0,0] op_sel_hi:[1,1,1]
    v_pk_fma_f32 v[168:169], v[74:75], v[150:151], v[168:169] op_sel:[1,0,0] op_sel_hi:[1,1,1] neg_lo:[1,0,0] neg_hi:[1,0,0]
    v_pk_fma_f32 v[170:171], v[74:75], v[148:149], v[170:171] op_sel:[1,0,0] op_sel_hi:[1,1,1]
    v_pk_fma_f32 v[172:173], v[82:83], v[154:155], v[172:173] op_sel:[1,0,0] op_sel_hi:[1,1,1] neg_lo:[1,0,0] neg_hi:[1,0,0]
    v_pk_fma_f32 v[174:175], v[82:83], v[152:153], v[174:175] op_sel:[1,0,0] op_sel_hi:[1,1,1]
    v_pk_fma_f32 v[136:137], v[48:49], v[156:157], v[182:183] op_sel:[1,0,0] op_sel_hi:[1,1,1]
    v_pk_fma_f32 v[138:139], v[48:49], v[158:159], v[222:223] op_sel:[1,0,0] op_sel_hi:[1,1,1]
    v_pk_fma_f32 v[140:141], v[56:57], v[160:161], v[190:191] op_sel:[1,0,0] op_sel_hi:[1,1,1]
    v_pk_fma_f32 v[142:143], v[56:57], v[162:163], v[230:231] op_sel:[1,0,0] op_sel_hi:[1,1,1]
    v_pk_fma_f32 v[144:145], v[64:65], v[164:165], v[198:199] op_sel:[1,0,0] op_sel_hi:[1,1,1]
    v_pk_fma_f32 v[146:147], v[64:65], v[166:167], v[238:239] op_sel:[1,0,0] op_sel_hi:[1,1,1]
    v_pk_fma_f32 v[148:149], v[72:73], v[168:169], v[206:207] op_sel:[1,0,0] op_sel_hi:[1,1,1]
    v_pk_fma_f32 v[150:151], v[72:73], v[170:171], v[246:247] op_sel:[1,0,0] op_sel_hi:[1,1,1]
    v_pk_fma_f32 v[152:153], v[80:81], v[172:173], v[214:215] op_sel:[1,0,0] op_sel_hi:[1,1,1]
    v_pk_fma_f32 v[154:155], v[80:81], v[174:175], v[254:255] op_sel:[1,0,0] op_sel_hi:[1,1,1]
    v_pk_fma_f32 v[136:137], v[50:51], v[158:159], v[136:137] op_sel:[1,0,0] op_sel_hi:[1,1,1] neg_lo:[1,0,0] neg_hi:[1,0,0]
    v_pk_fma_f32 v[138:139], v[50:51], v[156:157], v[138:139] op_sel:[1,0,0] op_sel_hi:[1,1,1]
    v_pk_fma_f32 v[140:141], v[58:59], v[162:163], v[140:141] op_sel:[1,0,0] op_sel_hi:[1,1,1] neg_lo:[1,0,0] neg_hi:[1,0,0]
    v_pk_fma_f32 v[142:143], v[58:59], v[160:161], v[142:143] op_sel:[1,0,0] op_sel_hi:[1,1,1]
    v_pk_fma_f32 v[144:145], v[66:67], v[166:167], v[144:145] op_sel:[1,0,0] op_sel_hi:[1,1,1] neg_lo:[1,0,0] neg_hi:[1,0,0]
    v_pk_fma_f32 v[146:147], v[66:67], v[164:165], v[146:147] op_sel:[1,0,0] op_sel_hi:[1,1,1]
    v_pk_fma_f32 v[148:149], v[74:75], v[170:171], v[148:149] op_sel:[1,0,0] op_sel_hi:[1,1,1] neg_lo:[1,0,0] neg_hi:[1,0,0]
    v_pk_fma_f32 v[150:151], v[74:75], v[168:169], v[150:151] op_sel:[1,0,0] op_sel_hi:[1,1,1]
    v_pk_fma_f32 v[152:153], v[82:83], v[174:175], v[152:153] op_sel:[1,0,0] op_sel_hi:[1,1,1] neg_lo:[1,0,0] neg_hi:[1,0,0]
    v_pk_fma_f32 v[154:155], v[82:83], v[172:173], v[154:155] op_sel:[1,0,0] op_sel_hi:[1,1,1]
    v_fma_f32 v156, v48, v136, v137
    v_fma_f32 v157, v48, v138, v139
    v_fma_f32 v158, v56, v140, v141
    v_fma_f32 v159, v56, v142, v143
    v_fma_f32 v160, v64, v144, v145
    v_fma_f32 v161, v64, v146, v147
    v_fma_f32 v162, v72, v148, v149
    v_fma_f32 v163, v72, v150, v151
    v_fma_f32 v164, v80, v152, v153
    v_fma_f32 v165, v80, v154, v155
    v_fma_f32 v156, -v50, v138, v156
    v_fmac_f32 v157, v50, v136
    ds_write_b64 v25, v[156:157] offset:0
    v_fma_f32 v158, -v58, v142, v158
    v_fmac_f32 v159, v58, v140
    ds_write_b64 v25, v[158:159] offset:128
    v_fma_f32 v160, -v66, v146, v160
    v_fmac_f32 v161, v66, v144
    ds_write_b64 v25, v[160:161] offset:256
    v_fma_f32 v162, -v74, v150, v162
    v_fmac_f32 v163, v74, v148
    ds_write_b64 v25, v[162:163] offset:384
    v_fma_f32 v164, -v82, v154, v164
    v_fmac_f32 v165, v82, v152
    ds_write_b64 v25, v[164:165] offset:512
    s_waitcnt lgkmcnt(0)
    s_barrier
    ds_read_b64 v[136:137], v26 offset:0
    ds_read_b64 v[138:139], v26 offset:640
    ds_read_b64 v[140:141], v26 offset:1280
    ds_read_b64 v[142:143], v26 offset:1920
    ds_read_b64 v[144:145], v26 offset:2560
    ds_read_b64 v[146:147], v26 offset:3200
    ds_read_b64 v[148:149], v26 offset:3840
    ds_read_b64 v[150:151], v26 offset:4480
    ds_read_b64 v[152:153], v26 offset:5120
    ds_read_b64 v[154:155], v26 offset:5760
    ds_read_b64 v[156:157], v26 offset:6400
    ds_read_b64 v[158:159], v26 offset:7040
    ds_read_b64 v[160:161], v26 offset:7680
    ds_read_b64 v[162:163], v26 offset:8320
    ds_read_b64 v[164:165], v26 offset:8960
    ds_read_b64 v[166:167], v26 offset:9600
    s_waitcnt lgkmcnt(14)
    v_pk_fma_f32 v[138:139], v[88:89], v[136:137], v[138:139] op_sel:[0,0,0] op_sel_hi:[0,1,1]
    v_pk_fma_f32 v[138:139], v[88:89], v[136:137], v[138:139] op_sel:[1,1,0] op_sel_hi:[1,0,1] neg_lo:[1,0,0]
    v_mov_b32 v168, s79
    v_mov_b32 v169, s79
    s_waitcnt lgkmcnt(13)
    v_pk_fma_f32 v[140:141], v[88:89], v[138:139], v[140:141] op_sel:[0,0,0] op_sel_hi:[0,1,1]
    v_pk_fma_f32 v[140:141], v[88:89], v[138:139], v[140:141] op_sel:[1,1,0] op_sel_hi:[1,0,1] neg_lo:[1,0,0]
    s_waitcnt lgkmcnt(12)
    v_pk_fma_f32 v[142:143], v[88:89], v[140:141], v[142:143] op_sel:[0,0,0] op_sel_hi:[0,1,1]
    v_pk_fma_f32 v[142:143], v[88:89], v[140:141], v[142:143] op_sel:[1,1,0] op_sel_hi:[1,0,1] neg_lo:[1,0,0]
    s_waitcnt lgkmcnt(11)
    v_pk_fma_f32 v[144:145], v[88:89], v[142:143], v[144:145] op_sel:[0,0,0] op_sel_hi:[0,1,1]
    v_pk_fma_f32 v[144:145], v[88:89], v[142:143], v[144:145] op_sel:[1,1,0] op_sel_hi:[1,0,1] neg_lo:[1,0,0]
    s_waitcnt lgkmcnt(10)
    v_pk_fma_f32 v[146:147], v[88:89], v[144:145], v[146:147] op_sel:[0,0,0] op_sel_hi:[0,1,1]
    v_pk_fma_f32 v[146:147], v[88:89], v[144:145], v[146:147] op_sel:[1,1,0] op_sel_hi:[1,0,1] neg_lo:[1,0,0]
    s_waitcnt lgkmcnt(9)
    v_pk_fma_f32 v[148:149], v[88:89], v[146:147], v[148:149] op_sel:[0,0,0] op_sel_hi:[0,1,1]
    v_pk_fma_f32 v[148:149], v[88:89], v[146:147], v[148:149] op_sel:[1,1,0] op_sel_hi:[1,0,1] neg_lo:[1,0,0]
    s_waitcnt lgkmcnt(8)
    v_pk_fma_f32 v[150:151], v[88:89], v[148:149], v[150:151] op_sel:[0,0,0] op_sel_hi:[0,1,1]
    v_pk_fma_f32 v[150:151], v[88:89], v[148:149], v[150:151] op_sel:[1,1,0] op_sel_hi:[1,0,1] neg_lo:[1,0,0]
    s_waitcnt lgkmcnt(7)
    v_pk_fma_f32 v[152:153], v[88:89], v[150:151], v[152:153] op_sel:[0,0,0] op_sel_hi:[0,1,1]
    v_pk_fma_f32 v[152:153], v[88:89], v[150:151], v[152:153] op_sel:[1,1,0] op_sel_hi:[1,0,1] neg_lo:[1,0,0]
    s_waitcnt lgkmcnt(6)
    v_pk_fma_f32 v[154:155], v[88:89], v[152:153], v[154:155] op_sel:[0,0,0] op_sel_hi:[0,1,1]
    v_pk_fma_f32 v[154:155], v[88:89], v[152:153], v[154:155] op_sel:[1,1,0] op_sel_hi:[1,0,1] neg_lo:[1,0,0]
    s_waitcnt lgkmcnt(5)
    v_pk_fma_f32 v[156:157], v[88:89], v[154:155], v[156:157] op_sel:[0,0,0] op_sel_hi:[0,1,1]
    v_pk_fma_f32 v[156:157], v[88:89], v[154:155], v[156:157] op_sel:[1,1,0] op_sel_hi:[1,0,1] neg_lo:[1,0,0]
    s_waitcnt lgkmcnt(4)
    v_pk_fma_f32 v[158:159], v[88:89], v[156:157], v[158:159] op_sel:[0,0,0] op_sel_hi:[0,1,1]
    v_pk_fma_f32 v[158:159], v[88:89], v[156:157], v[158:159] op_sel:[1,1,0] op_sel_hi:[1,0,1] neg_lo:[1,0,0]
    s_waitcnt lgkmcnt(3)
    v_pk_fma_f32 v[160:161], v[88:89], v[158:159], v[160:161] op_sel:[0,0,0] op_sel_hi:[0,1,1]
    v_pk_fma_f32 v[160:161], v[88:89], v[158:159], v[160:161] op_sel:[1,1,0] op_sel_hi:[1,0,1] neg_lo:[1,0,0]
    s_waitcnt lgkmcnt(2)
    v_pk_fma_f32 v[162:163], v[88:89], v[160:161], v[162:163] op_sel:[0,0,0] op_sel_hi:[0,1,1]
    v_pk_fma_f32 v[162:163], v[88:89], v[160:161], v[162:163] op_sel:[1,1,0] op_sel_hi:[1,0,1] neg_lo:[1,0,0]
    s_waitcnt lgkmcnt(1)
    v_pk_fma_f32 v[164:165], v[88:89], v[162:163], v[164:165] op_sel:[0,0,0] op_sel_hi:[0,1,1]
    v_pk_fma_f32 v[164:165], v[88:89], v[162:163], v[164:165] op_sel:[1,1,0] op_sel_hi:[1,0,1] neg_lo:[1,0,0]
    s_waitcnt lgkmcnt(0)
    v_pk_fma_f32 v[166:167], v[88:89], v[164:165], v[166:167] op_sel:[0,0,0] op_sel_hi:[0,1,1]
    v_pk_fma_f32 v[166:167], v[88:89], v[164:165], v[166:167] op_sel:[1,1,0] op_sel_hi:[1,0,1] neg_lo:[1,0,0]
    buffer_store_dwordx4 v[166:169], v28, s[60:63], 0 offen sc1
    v_mov_b32 v2, 0
    v_mov_b32 v3, 0
    s_add_u32 m0, s98, 0
    s_add_u32 s81, s90, 2
    s_sub_u32 s101, s81, 10
    s_cselect_b32 s81, s81, s101
    s_lshl_b32 s81, s81, 7
    buffer_load_dwordx4 v20, s[44:47], s81 offen offset:0 lds
    ds_write_b64 v26, v[2:3]
    v_pk_mul_f32 v[4:5], v[92:93], v[136:137] op_sel:[0,0] op_sel_hi:[0,1]
    v_pk_fma_f32 v[4:5], v[92:93], v[136:137], v[4:5] op_sel:[1,1,0] op_sel_hi:[1,0,1] neg_lo:[1,0,0]
    ds_write_b64 v26, v[4:5] offset:640
    v_pk_mul_f32 v[6:7], v[92:93], v[138:139] op_sel:[0,0] op_sel_hi:[0,1]
    v_pk_fma_f32 v[6:7], v[92:93], v[138:139], v[6:7] op_sel:[1,1,0] op_sel_hi:[1,0,1] neg_lo:[1,0,0]
    ds_write_b64 v26, v[6:7] offset:1280
    v_pk_mul_f32 v[8:9], v[92:93], v[140:141] op_sel:[0,0] op_sel_hi:[0,1]
    v_pk_fma_f32 v[8:9], v[92:93], v[140:141], v[8:9] op_sel:[1,1,0] op_sel_hi:[1,0,1] neg_lo:[1,0,0]
    ds_write_b64 v26, v[8:9] offset:1920
    v_pk_mul_f32 v[10:11], v[92:93], v[142:143] op_sel:[0,0] op_sel_hi:[0,1]
    v_pk_fma_f32 v[10:11], v[92:93], v[142:143], v[10:11] op_sel:[1,1,0] op_sel_hi:[1,0,1] neg_lo:[1,0,0]
    ds_write_b64 v26, v[10:11] offset:2560
    buffer_load_dwordx4 v21, s[44:47], s81 offen offset:1024 lds
    v_pk_mul_f32 v[4:5], v[92:93], v[144:145] op_sel:[0,0] op_sel_hi:[0,1]
    v_pk_fma_f32 v[4:5], v[92:93], v[144:145], v[4:5] op_sel:[1,1,0] op_sel_hi:[1,0,1] neg_lo:[1,0,0]
    ds_write_b64 v26, v[4:5] offset:3200
    v_pk_mul_f32 v[6:7], v[92:93], v[146:147] op_sel:[0,0] op_sel_hi:[0,1]
    v_pk_fma_f32 v[6:7], v[92:93], v[146:147], v[6:7] op_sel:[1,1,0] op_sel_hi:[1,0,1] neg_lo:[1,0,0]
    ds_write_b64 v26, v[6:7] offset:3840
    v_pk_mul_f32 v[8:9], v[92:93], v[148:149] op_sel:[0,0] op_sel_hi:[0,1]
    v_pk_fma_f32 v[8:9], v[92:93], v[148:149], v[8:9] op_sel:[1,1,0] op_sel_hi:[1,0,1] neg_lo:[1,0,0]
    ds_write_b64 v26, v[8:9] offset:4480
    v_pk_mul_f32 v[10:11], v[92:93], v[150:151] op_sel:[0,0] op_sel_hi:[0,1]
    v_pk_fma_f32 v[10:11], v[92:93], v[150:151], v[10:11] op_sel:[1,1,0] op_sel_hi:[1,0,1] neg_lo:[1,0,0]
    ds_write_b64 v26, v[10:11] offset:5120
    v_pk_mul_f32 v[4:5], v[92:93], v[152:153] op_sel:[0,0] op_sel_hi:[0,1]
    v_pk_fma_f32 v[4:5], v[92:93], v[152:153], v[4:5] op_sel:[1,1,0] op_sel_hi:[1,0,1] neg_lo:[1,0,0]
    buffer_load_dwordx4 v22, s[44:47], s81 offen offset:2048 lds
    ds_write_b64 v26, v[4:5] offset:5760
    v_pk_mul_f32 v[6:7], v[92:93], v[154:155] op_sel:[0,0] op_sel_hi:[0,1]
    v_pk_fma_f32 v[6:7], v[92:93], v[154:155], v[6:7] op_sel:[1,1,0] op_sel_hi:[1,0,1] neg_lo:[1,0,0]
    ds_write_b64 v26, v[6:7] offset:6400
    v_pk_mul_f32 v[8:9], v[92:93], v[156:157] op_sel:[0,0] op_sel_hi:[0,1]
    v_pk_fma_f32 v[8:9], v[92:93], v[156:157], v[8:9] op_sel:[1,1,0] op_sel_hi:[1,0,1] neg_lo:[1,0,0]
    ds_write_b64 v26, v[8:9] offset:7040
    v_pk_mul_f32 v[10:11], v[92:93], v[158:159] op_sel:[0,0] op_sel_hi:[0,1]
    v_pk_fma_f32 v[10:11], v[92:93], v[158:159], v[10:11] op_sel:[1,1,0] op_sel_hi:[1,0,1] neg_lo:[1,0,0]
    ds_write_b64 v26, v[10:11] offset:7680
    v_pk_mul_f32 v[4:5], v[92:93], v[160:161] op_sel:[0,0] op_sel_hi:[0,1]
    v_pk_fma_f32 v[4:5], v[92:93], v[160:161], v[4:5] op_sel:[1,1,0] op_sel_hi:[1,0,1] neg_lo:[1,0,0]
    ds_write_b64 v26, v[4:5] offset:8320
    v_pk_mul_f32 v[6:7], v[92:93], v[162:163] op_sel:[0,0] op_sel_hi:[0,1]
    buffer_load_dwordx4 v23, s[44:47], s81 offen offset:3072 lds
    v_pk_fma_f32 v[6:7], v[92:93], v[162:163], v[6:7] op_sel:[1,1,0] op_sel_hi:[1,0,1] neg_lo:[1,0,0]
    ds_write_b64 v26, v[6:7] offset:8960
    v_pk_mul_f32 v[8:9], v[92:93], v[164:165] op_sel:[0,0] op_sel_hi:[0,1]
    v_pk_fma_f32 v[8:9], v[92:93], v[164:165], v[8:9] op_sel:[1,1,0] op_sel_hi:[1,0,1] neg_lo:[1,0,0]
    ds_write_b64 v26, v[8:9] offset:9600
    v_pk_mul_f32 v[2:3], v[52:53], v[176:177] op_sel:[1,0] op_sel_hi:[1,1]
    v_pk_mul_f32 v[176:177], v[52:53], v[176:177] op_sel:[0,0] op_sel_hi:[0,1]
    v_pk_fma_f32 v[176:177], v[52:53], v[216:217], v[176:177] op_sel:[1,0,0] op_sel_hi:[1,1,1] neg_lo:[1,0,0] neg_hi:[1,0,0]
    v_pk_fma_f32 v[216:217], v[52:53], v[216:217], v[2:3] op_sel:[0,0,0] op_sel_hi:[0,1,1]
    v_pk_mul_f32 v[4:5], v[52:53], v[178:179] op_sel:[1,0] op_sel_hi:[1,1]
    v_pk_mul_f32 v[178:179], v[52:53], v[178:179] op_sel:[0,0] op_sel_hi:[0,1]
    v_pk_fma_f32 v[178:179], v[52:53], v[218:219], v[178:179] op_sel:[1,0,0] op_sel_hi:[1,1,1] neg_lo:[1,0,0] neg_hi:[1,0,0]
    v_pk_fma_f32 v[218:219], v[52:53], v[218:219], v[4:5] op_sel:[0,0,0] op_sel_hi:[0,1,1]
    v_pk_mul_f32 v[2:3], v[52:53], v[180:181] op_sel:[1,0] op_sel_hi:[1,1]
    s_add_u32 m0, s98, 4096
    s_nop 0
    buffer_load_dwordx4 v24, s[44:47], s81 offen offset:0 lds
    v_pk_mul_f32 v[180:181], v[52:53], v[180:181] op_sel:[0,0] op_sel_hi:[0,1]
    v_pk_fma_f32 v[180:181], v[52:53], v[220:221], v[180:181] op_sel:[1,0,0] op_sel_hi:[1,1,1] neg_lo:[1,0,0] neg_hi:[1,0,0]
    v_pk_fma_f32 v[220:221], v[52:53], v[220:221], v[2:3] op_sel:[0,0,0] op_sel_hi:[0,1,1]
    v_pk_mul_f32 v[4:5], v[52:53], v[182:183] op_sel:[1,0] op_sel_hi:[1,1]
    v_pk_mul_f32 v[182:183], v[52:53], v[182:183] op_sel:[0,0] op_sel_hi:[0,1]
    v_pk_fma_f32 v[182:183], v[52:53], v[222:223], v[182:183] op_sel:[1,0,0] op_sel_hi:[1,1,1] neg_lo:[1,0,0] neg_hi:[1,0,0]
    v_pk_fma_f32 v[222:223], v[52:53], v[222:223], v[4:5] op_sel:[0,0,0] op_sel_hi:[0,1,1]
    v_pk_mul_f32 v[2:3], v[60:61], v[184:185] op_sel:[1,0] op_sel_hi:[1,1]
    v_pk_mul_f32 v[184:185], v[60:61], v[184:185] op_sel:[0,0] op_sel_hi:[0,1]
    v_pk_fma_f32 v[184:185], v[60:61], v[224:225], v[184:185] op_sel:[1,0,0] op_sel_hi:[1,1,1] neg_lo:[1,0,0] neg_hi:[1,0,0]
    v_pk_fma_f32 v[224:225], v[60:61], v[224:225], v[2:3] op_sel:[0,0,0] op_sel_hi:[0,1,1]
    v_pk_mul_f32 v[4:5], v[60:61], v[186:187] op_sel:[1,0] op_sel_hi:[1,1]
    v_pk_mul_f32 v[186:187], v[60:61], v[186:187] op_sel:[0,0] op_sel_hi:[0,1]
    v_pk_fma_f32 v[186:187], v[60:61], v[226:227], v[186:187] op_sel:[1,0,0] op_sel_hi:[1,1,1] neg_lo:[1,0,0] neg_hi:[1,0,0]
    s_add_u32 m0, s98, 20480
    s_add_u32 s81, s90, 3
    s_sub_u32 s101, s81, 10
    s_cselect_b32 s81, s81, s101
    s_lshl_b32 s81, s81, 7
    buffer_load_dwordx4 v20, s[44:47], s81 offen offset:0 lds
    v_pk_fma_f32 v[226:227], v[60:61], v[226:227], v[4:5] op_sel:[0,0,0] op_sel_hi:[0,1,1]
    v_pk_mul_f32 v[2:3], v[60:61], v[188:189] op_sel:[1,0] op_sel_hi:[1,1]
    v_pk_mul_f32 v[188:189], v[60:61], v[188:189] op_sel:[0,0] op_sel_hi:[0,1]
    v_pk_fma_f32 v[188:189], v[60:61], v[228:229], v[188:189] op_sel:[1,0,0] op_sel_hi:[1,1,1] neg_lo:[1,0,0] neg_hi:[1,0,0]
    v_pk_fma_f32 v[228:229], v[60:61], v[228:229], v[2:3] op_sel:[0,0,0] op_sel_hi:[0,1,1]
    v_pk_mul_f32 v[4:5], v[60:61], v[190:191] op_sel:[1,0] op_sel_hi:[1,1]
    v_pk_mul_f32 v[190:191], v[60:61], v[190:191] op_sel:[0,0] op_sel_hi:[0,1]
    v_pk_fma_f32 v[190:191], v[60:61], v[230:231], v[190:191] op_sel:[1,0,0] op_sel_hi:[1,1,1] neg_lo:[1,0,0] neg_hi:[1,0,0]
    v_pk_fma_f32 v[230:231], v[60:61], v[230:231], v[4:5] op_sel:[0,0,0] op_sel_hi:[0,1,1]
    v_pk_mul_f32 v[2:3], v[68:69], v[192:193] op_sel:[1,0] op_sel_hi:[1,1]
    v_pk_mul_f32 v[192:193], v[68:69], v[192:193] op_sel:[0,0] op_sel_hi:[0,1]
    v_pk_fma_f32 v[192:193], v[68:69], v[232:233], v[192:193] op_sel:[1,0,0] op_sel_hi:[1,1,1] neg_lo:[1,0,0] neg_hi:[1,0,0]
    v_pk_fma_f32 v[232:233], v[68:69], v[232:233], v[2:3] op_sel:[0,0,0] op_sel_hi:[0,1,1]
    buffer_load_dwordx4 v21, s[44:47], s81 offen offset:1024 lds
    v_pk_mul_f32 v[4:5], v[68:69], v[194:195] op_sel:[1,0] op_sel_hi:[1,1]
    v_pk_mul_f32 v[194:195], v[68:69], v[194:195] op_sel:[0,0] op_sel_hi:[0,1]
    v_pk_fma_f32 v[194:195], v[68:69], v[234:235], v[194:195] op_sel:[1,0,0] op_sel_hi:[1,1,1] neg_lo:[1,0,0] neg_hi:[1,0,0]
    v_pk_fma_f32 v[234:235], v[68:69], v[234:235], v[4:5] op_sel:[0,0,0] op_sel_hi:[0,1,1]
    v_pk_mul_f32 v[2:3], v[68:69], v[196:197] op_sel:[1,0] op_sel_hi:[1,1]
    v_pk_mul_f32 v[196:197], v[68:69], v[196:197] op_sel:[0,0] op_sel_hi:[0,1]
    v_pk_fma_f32 v[196:197], v[68:69], v[236:237], v[196:197] op_sel:[1,0,0] op_sel_hi:[1,1,1] neg_lo:[1,0,0] neg_hi:[1,0,0]
    v_pk_fma_f32 v[236:237], v[68:69], v[236:237], v[2:3] op_sel:[0,0,0] op_sel_hi:[0,1,1]
    v_pk_mul_f32 v[4:5], v[68:69], v[198:199] op_sel:[1,0] op_sel_hi:[1,1]
    v_pk_mul_f32 v[198:199], v[68:69], v[198:199] op_sel:[0,0] op_sel_hi:[0,1]
    v_pk_fma_f32 v[198:199], v[68:69], v[238:239], v[198:199] op_sel:[1,0,0] op_sel_hi:[1,1,1] neg_lo:[1,0,0] neg_hi:[1,0,0]
    v_pk_fma_f32 v[238:239], v[68:69], v[238:239], v[4:5] op_sel:[0,0,0] op_sel_hi:[0,1,1]
    v_pk_mul_f32 v[2:3], v[76:77], v[200:201] op_sel:[1,0] op_sel_hi:[1,1]
    v_pk_mul_f32 v[200:201], v[76:77], v[200:201] op_sel:[0,0] op_sel_hi:[0,1]
    buffer_load_dwordx4 v22, s[44:47], s81 offen offset:2048 lds
    v_pk_fma_f32 v[200:201], v[76:77], v[240:241], v[200:201] op_sel:[1,0,0] op_sel_hi:[1,1,1] neg_lo:[1,0,0] neg_hi:[1,0,0]
    v_pk_fma_f32 v[240:241], v[76:77], v[240:241], v[2:3] op_sel:[0,0,0] op_sel_hi:[0,1,1]
    v_pk_mul_f32 v[4:5], v[76:77], v[202:203] op_sel:[1,0] op_sel_hi:[1,1]
    v_pk_mul_f32 v[202:203], v[76:77], v[202:203] op_sel:[0,0] op_sel_hi:[0,1]
    v_pk_fma_f32 v[202:203], v[76:77], v[242:243], v[202:203] op_sel:[1,0,0] op_sel_hi:[1,1,1] neg_lo:[1,0,0] neg_hi:[1,0,0]
    v_pk_fma_f32 v[242:243], v[76:77], v[242:243], v[4:5] op_sel:[0,0,0] op_sel_hi:[0,1,1]
    v_pk_mul_f32 v[2:3], v[76:77], v[204:205] op_sel:[1,0] op_sel_hi:[1,1]
    v_pk_mul_f32 v[204:205], v[76:77], v[204:205] op_sel:[0,0] op_sel_hi:[0,1]
    v_pk_fma_f32 v[204:205], v[76:77], v[244:245], v[204:205] op_sel:[1,0,0] op_sel_hi:[1,1,1] neg_lo:[1,0,0] neg_hi:[1,0,0]
    v_pk_fma_f32 v[244:245], v[76:77], v[244:245], v[2:3] op_sel:[0,0,0] op_sel_hi:[0,1,1]
    v_pk_mul_f32 v[4:5], v[76:77], v[206:207] op_sel:[1,0] op_sel_hi:[1,1]
    v_pk_mul_f32 v[206:207], v[76:77], v[206:207] op_sel:[0,0] op_sel_hi:[0,1]
    v_pk_fma_f32 v[206:207], v[76:77], v[246:247], v[206:207] op_sel:[1,0,0] op_sel_hi:[1,1,1] neg_lo:[1,0,0] neg_hi:[1,0,0]
    v_pk_fma_f32 v[246:247], v[76:77], v[246:247], v[4:5] op_sel:[0,0,0] op_sel_hi:[0,1,1]
    buffer_load_dwordx4 v23, s[44:47], s81 offen offset:3072 lds
    v_pk_mul_f32 v[2:3], v[84:85], v[208:209] op_sel:[1,0] op_sel_hi:[1,1]
    v_pk_mul_f32 v[208:209], v[84:85], v[208:209] op_sel:[0,0] op_sel_hi:[0,1]
    v_pk_fma_f32 v[208:209], v[84:85], v[248:249], v[208:209] op_sel:[1,0,0] op_sel_hi:[1,1,1] neg_lo:[1,0,0] neg_hi:[1,0,0]
    v_pk_fma_f32 v[248:249], v[84:85], v[248:249], v[2:3] op_sel:[0,0,0] op_sel_hi:[0,1,1]
    v_pk_mul_f32 v[4:5], v[84:85], v[210:211] op_sel:[1,0] op_sel_hi:[1,1]
    v_pk_mul_f32 v[210:211], v[84:85], v[210:211] op_sel:[0,0] op_sel_hi:[0,1]
    v_pk_fma_f32 v[210:211], v[84:85], v[250:251], v[210:211] op_sel:[1,0,0] op_sel_hi:[1,1,1] neg_lo:[1,0,0] neg_hi:[1,0,0]
    v_pk_fma_f32 v[250:251], v[84:85], v[250:251], v[4:5] op_sel:[0,0,0] op_sel_hi:[0,1,1]
    v_pk_mul_f32 v[2:3], v[84:85], v[212:213] op_sel:[1,0] op_sel_hi:[1,1]
    v_pk_mul_f32 v[212:213], v[84:85], v[212:213] op_sel:[0,0] op_sel_hi:[0,1]
    v_pk_fma_f32 v[212:213], v[84:85], v[252:253], v[212:213] op_sel:[1,0,0] op_sel_hi:[1,1,1] neg_lo:[1,0,0] neg_hi:[1,0,0]
    v_pk_fma_f32 v[252:253], v[84:85], v[252:253], v[2:3] op_sel:[0,0,0] op_sel_hi:[0,1,1]
    v_pk_mul_f32 v[4:5], v[84:85], v[214:215] op_sel:[1,0] op_sel_hi:[1,1]
    v_pk_mul_f32 v[214:215], v[84:85], v[214:215] op_sel:[0,0] op_sel_hi:[0,1]
    s_add_u32 m0, s98, 24576
    s_nop 0
    buffer_load_dwordx4 v24, s[44:47], s81 offen offset:0 lds
    v_pk_fma_f32 v[214:215], v[84:85], v[254:255], v[214:215] op_sel:[1,0,0] op_sel_hi:[1,1,1] neg_lo:[1,0,0] neg_hi:[1,0,0]
    v_pk_fma_f32 v[254:255], v[84:85], v[254:255], v[4:5] op_sel:[0,0,0] op_sel_hi:[0,1,1]
    v_fmac_f32 v183, v48, v182
    v_fmac_f32 v223, v48, v222
    v_fma_f32 v183, -v50, v222, v183
    v_fmac_f32 v223, v50, v182
    v_fmac_f32 v191, v56, v190
    v_fmac_f32 v231, v56, v230
    v_fma_f32 v191, -v58, v230, v191
    v_fmac_f32 v231, v58, v190
    v_fmac_f32 v199, v64, v198
    v_fmac_f32 v239, v64, v238
    v_fma_f32 v199, -v66, v238, v199
    v_fmac_f32 v239, v66, v198
    s_add_u32 m0, s98, 40960
    s_add_u32 s81, s90, 4
    s_sub_u32 s101, s81, 10
    s_cselect_b32 s81, s81, s101
    s_lshl_b32 s81, s81, 7
    buffer_load_dwordx4 v20, s[44:47], s81 offen offset:0 lds
    v_fmac_f32 v207, v72, v206
    v_fmac_f32 v247, v72, v246
    v_fma_f32 v207, -v74, v246, v207
    v_fmac_f32 v247, v74, v206
    v_fmac_f32 v215, v80, v214
    v_fmac_f32 v255, v80, v254
    v_fma_f32 v215, -v82, v254, v215
    v_fmac_f32 v255, v82, v214
    v_fmac_f32 v182, v48, v181
    v_fmac_f32 v222, v48, v221
    v_fma_f32 v182, -v50, v221, v182
    v_fmac_f32 v222, v50, v181
    v_fmac_f32 v190, v56, v189
    buffer_load_dwordx4 v21, s[44:47], s81 offen offset:1024 lds
    v_fmac_f32 v230, v56, v229
    v_fma_f32 v190, -v58, v229, v190
    v_fmac_f32 v230, v58, v189
    v_fmac_f32 v198, v64, v197
    v_fmac_f32 v238, v64, v237
    v_fma_f32 v198, -v66, v237, v198
    v_fmac_f32 v238, v66, v197
    v_fmac_f32 v206, v72, v205
    v_fmac_f32 v246, v72, v245
    v_fma_f32 v206, -v74, v245, v206
    v_fmac_f32 v246, v74, v205
    v_fmac_f32 v214, v80, v213
    v_fmac_f32 v254, v80, v253
    v_fma_f32 v214, -v82, v253, v214
    buffer_load_dwordx4 v22, s[44:47], s81 offen offset:2048 lds
    v_fmac_f32 v254, v82, v213
    v_fmac_f32 v181, v48, v180
    v_fmac_f32 v221, v48, v220
    v_fma_f32 v181, -v50, v220, v181
    v_fmac_f32 v221, v50, v180
    v_fmac_f32 v189, v56, v188
    v_fmac_f32 v229, v56, v228
    v_fma_f32 v189, -v58, v228, v189
    v_fmac_f32 v229, v58, v188
    v_fmac_f32 v197, v64, v196
    v_fmac_f32 v237, v64, v236
    v_fma_f32 v197, -v66, v236, v197
    v_fmac_f32 v237, v66, v196
    v_fmac_f32 v205, v72, v204
    buffer_load_dwordx4 v23, s[44:47], s81 offen offset:3072 lds
    v_fmac_f32 v245, v72, v244
    v_fma_f32 v205, -v74, v244, v205
    v_fmac_f32 v245, v74, v204
    v_fmac_f32 v213, v80, v212
    v_fmac_f32 v253, v80, v252
    v_fma_f32 v213, -v82, v252, v213
    v_fmac_f32 v253, v82, v212
    v_fmac_f32 v180, v48, v179
    v_fmac_f32 v220, v48, v219
    v_fma_f32 v180, -v50, v219, v180
    v_fmac_f32 v220, v50, v179
    v_fmac_f32 v188, v56, v187
    v_fmac_f32 v228, v56, v227
    v_fma_f32 v188, -v58, v227, v188
    s_add_u32 m0, s98, 45056
    s_nop 0
    buffer_load_dwordx4 v24, s[44:47], s81 offen offset:0 lds
    v_fmac_f32 v228, v58, v187
    v_fmac_f32 v196, v64, v195
    v_fmac_f32 v236, v64, v235
    v_fma_f32 v196, -v66, v235, v196
    v_fmac_f32 v236, v66, v195
    v_fmac_f32 v204, v72, v203
    v_fmac_f32 v244, v72, v243
    v_fma_f32 v204, -v74, v243, v204
    v_fmac_f32 v244, v74, v203
    v_fmac_f32 v212, v80, v211
    v_fmac_f32 v252, v80, v251
    v_fma_f32 v212, -v82, v251, v212
    v_fmac_f32 v252, v82, v211
    v_fmac_f32 v179, v48, v178
    buffer_load_dwordx2 v[36:37], v105, s[48:51], 0 offen sc1
    v_fmac_f32 v219, v48, v218
    v_fma_f32 v179, -v50, v218, v179
    v_fmac_f32 v219, v50, v178
    v_fmac_f32 v187, v56, v186
    v_fmac_f32 v227, v56, v226
    v_fma_f32 v187, -v58, v226, v187
    v_fmac_f32 v227, v58, v186
    v_fmac_f32 v195, v64, v194
    v_fmac_f32 v235, v64, v234
    v_fma_f32 v195, -v66, v234, v195
    v_fmac_f32 v235, v66, v194
    v_fmac_f32 v203, v72, v202
    v_fmac_f32 v243, v72, v242
    v_fma_f32 v203, -v74, v242, v203
    v_fmac_f32 v243, v74, v202
    v_fmac_f32 v211, v80, v210
    v_fmac_f32 v251, v80, v250
    v_fma_f32 v211, -v82, v250, v211
    v_fmac_f32 v251, v82, v210
    v_fmac_f32 v178, v48, v177
    v_fmac_f32 v218, v48, v217
    v_fma_f32 v178, -v50, v217, v178
    v_fmac_f32 v218, v50, v177
    v_fmac_f32 v186, v56, v185
    v_fmac_f32 v226, v56, v225
    v_fma_f32 v186, -v58, v225, v186
    v_fmac_f32 v226, v58, v185
    v_fmac_f32 v194, v64, v193
    v_fmac_f32 v234, v64, v233
    v_fma_f32 v194, -v66, v233, v194
    v_fmac_f32 v234, v66, v193
    v_fmac_f32 v202, v72, v201
    v_fmac_f32 v242, v72, v241
    buffer_load_dwordx4 v[136:139], v118, s[60:63], 0 offen sc1
    v_fma_f32 v202, -v74, v241, v202
    v_fmac_f32 v242, v74, v201
    v_fmac_f32 v210, v80, v209
    buffer_load_dwordx4 v[140:143], v119, s[60:63], 0 offen sc1
    v_fmac_f32 v250, v80, v249
    v_fma_f32 v210, -v82, v249, v210
    v_fmac_f32 v250, v82, v209
    buffer_load_dwordx4 v[144:147], v120, s[60:63], 0 offen sc1
    v_fmac_f32 v177, v48, v176
    v_fmac_f32 v217, v48, v216
    v_fma_f32 v177, -v50, v216, v177
    buffer_load_dwordx4 v[148:151], v121, s[60:63], 0 offen sc1
    v_fmac_f32 v217, v50, v176
    v_fmac_f32 v185, v56, v184
    v_fmac_f32 v225, v56, v224
    buffer_load_dwordx4 v[152:155], v122, s[60:63], 0 offen sc1
    v_fma_f32 v185, -v58, v224, v185
    v_fmac_f32 v225, v58, v184
    v_fmac_f32 v193, v64, v192
    v_fmac_f32 v233, v64, v232
    v_fma_f32 v193, -v66, v232, v193
    v_fmac_f32 v233, v66, v192
    v_fmac_f32 v201, v72, v200
    v_fmac_f32 v241, v72, v240
    v_fma_f32 v201, -v74, v240, v201
    v_fmac_f32 v241, v74, v200
    v_fmac_f32 v209, v80, v208
    v_fmac_f32 v249, v80, v248
    v_fma_f32 v209, -v82, v248, v209
    v_fmac_f32 v249, v82, v208
    v_add_u32 v39, s88, v45
    v_bfe_u32 v2, v0, 5, 1
    v_mul_u32_u24 v2, 2560, v2
    v_add3_u32 v40, v2, v39, 0
    v_add_u32 v40, 2048, v40
    v_add_u32 v41, 5632, v39
    v_add_u32 v42, 10240, v39
    v_add_u32 v43, 10240, v40
    v_add_u32 v44, 15872, v39
    v_accvgpr_read_b32 v14, a240
    v_accvgpr_read_b32 v15, a241
    v_lshlrev_b32 v4, 16, v14
    v_and_b32 v5, 0xffff0000, v14
    v_lshlrev_b32 v6, 16, v15
    v_and_b32 v7, 0xffff0000, v15
    v_accvgpr_read_b32 v2, a0
    v_accvgpr_read_b32 v3, a1
    v_lshlrev_b32 v8, 16, v2
    v_and_b32 v9, 0xffff0000, v2
    v_lshlrev_b32 v10, 16, v3
    v_and_b32 v11, 0xffff0000, v3
    v_pk_mul_f32 v[8:9], v[8:9], v[4:5]
    v_pk_mul_f32 v[10:11], v[10:11], v[6:7]
    v_cvt_pk_bf16_f32 v12, v8, v9
    v_cvt_pk_bf16_f32 v13, v10, v11
    v_lshlrev_b32 v8, 16, v12
    v_and_b32 v9, 0xffff0000, v12
    v_lshlrev_b32 v10, 16, v13
    v_and_b32 v11, 0xffff0000, v13
    v_accvgpr_write_b32 a200, v8
    v_accvgpr_write_b32 a201, v9
    v_accvgpr_write_b32 a202, v10
    v_accvgpr_write_b32 a203, v11
    v_accvgpr_read_b32 v2, a10
    v_accvgpr_read_b32 v3, a11
    v_lshlrev_b32 v8, 16, v2
    v_and_b32 v9, 0xffff0000, v2
    v_lshlrev_b32 v10, 16, v3
    v_and_b32 v11, 0xffff0000, v3
    v_pk_mul_f32 v[8:9], v[8:9], v[4:5]
    v_pk_mul_f32 v[10:11], v[10:11], v[6:7]
    v_cvt_pk_bf16_f32 v12, v8, v9
    v_cvt_pk_bf16_f32 v13, v10, v11
    v_lshlrev_b32 v8, 16, v12
    v_and_b32 v9, 0xffff0000, v12
    v_lshlrev_b32 v10, 16, v13
    v_and_b32 v11, 0xffff0000, v13
    v_accvgpr_write_b32 a204, v8
    v_accvgpr_write_b32 a205, v9
    v_accvgpr_write_b32 a206, v10
    v_accvgpr_write_b32 a207, v11
    v_accvgpr_read_b32 v14, a242
    v_accvgpr_read_b32 v15, a243
    v_lshlrev_b32 v4, 16, v14
    v_and_b32 v5, 0xffff0000, v14
    v_lshlrev_b32 v6, 16, v15
    v_and_b32 v7, 0xffff0000, v15
    v_accvgpr_read_b32 v2, a2
    v_accvgpr_read_b32 v3, a3
    v_lshlrev_b32 v8, 16, v2
    v_and_b32 v9, 0xffff0000, v2
    v_lshlrev_b32 v10, 16, v3
    v_and_b32 v11, 0xffff0000, v3
    v_pk_mul_f32 v[8:9], v[8:9], v[4:5]
    v_pk_mul_f32 v[10:11], v[10:11], v[6:7]
    v_cvt_pk_bf16_f32 v12, v8, v9
    v_cvt_pk_bf16_f32 v13, v10, v11
    v_lshlrev_b32 v8, 16, v12
    v_and_b32 v9, 0xffff0000, v12
    v_lshlrev_b32 v10, 16, v13
    v_and_b32 v11, 0xffff0000, v13
    v_accvgpr_write_b32 a208, v8
    v_accvgpr_write_b32 a209, v9
    v_accvgpr_write_b32 a210, v10
    v_accvgpr_write_b32 a211, v11
    v_accvgpr_read_b32 v2, a12
    v_accvgpr_read_b32 v3, a13
    v_lshlrev_b32 v8, 16, v2
    v_and_b32 v9, 0xffff0000, v2
    v_lshlrev_b32 v10, 16, v3
    v_and_b32 v11, 0xffff0000, v3
    v_pk_mul_f32 v[8:9], v[8:9], v[4:5]
    v_pk_mul_f32 v[10:11], v[10:11], v[6:7]
    v_cvt_pk_bf16_f32 v12, v8, v9
    v_cvt_pk_bf16_f32 v13, v10, v11
    v_lshlrev_b32 v8, 16, v12
    v_and_b32 v9, 0xffff0000, v12
    v_lshlrev_b32 v10, 16, v13
    v_and_b32 v11, 0xffff0000, v13
    v_accvgpr_write_b32 a212, v8
    v_accvgpr_write_b32 a213, v9
    v_accvgpr_write_b32 a214, v10
    v_accvgpr_write_b32 a215, v11
    s_waitcnt lgkmcnt(0)
    s_barrier
    ds_read_b64 v[108:109], v25 offset:0
    ds_read_b64 v[110:111], v25 offset:128
    ds_read_b64 v[112:113], v25 offset:256
    ds_read_b64 v[114:115], v25 offset:384
    ds_read_b64 v[116:117], v25 offset:512
    s_waitcnt vmcnt(5)
    v_cmp_ne_u64 vcc, v[36:37], v[106:107]
    s_nop 3
    s_cmp_eq_u64 vcc, 0
    s_cselect_b32 s34, 1, 0
    v_mov_b32 v2, s79
    v_cmp_le_i32 vcc, 0, v118
    s_nop 1
    v_cndmask_b32_e64 v96, 0, v2, vcc
    v_cmp_le_i32 vcc, 0, v119
    s_nop 1
    v_cndmask_b32_e64 v97, 0, v2, vcc
    v_cmp_le_i32 vcc, 0, v120
    s_nop 1
    v_cndmask_b32_e64 v98, 0, v2, vcc
    v_cmp_le_i32 vcc, 0, v121
    s_nop 1
    v_cndmask_b32_e64 v99, 0, v2, vcc
    v_cmp_le_i32 vcc, 0, v122
    s_nop 1
    v_cndmask_b32_e64 v100, 0, v2, vcc
    s_waitcnt vmcnt(4)
    v_xor_b32 v3, v138, v96
    s_waitcnt vmcnt(3)
    v_bitop3_b32 v3, v3, v142, v97 bitop3:0xf6
    s_waitcnt vmcnt(2)
    v_bitop3_b32 v3, v3, v146, v98 bitop3:0xf6
    s_waitcnt vmcnt(1)
    v_bitop3_b32 v3, v3, v150, v99 bitop3:0xf6
    s_waitcnt vmcnt(0)
    v_bitop3_b32 v3, v3, v154, v100 bitop3:0xf6
    v_cmp_ne_u32 vcc, 0, v3
    s_nop 3
    s_cbranch_vccz L_rd_21
    s_mov_b32 s82, 0x40000
L_rp_20:
    buffer_load_dwordx4 v[136:139], v118, s[60:63], 0 offen sc1
    buffer_load_dwordx4 v[140:143], v119, s[60:63], 0 offen sc1
    buffer_load_dwordx4 v[144:147], v120, s[60:63], 0 offen sc1
    buffer_load_dwordx4 v[148:151], v121, s[60:63], 0 offen sc1
    buffer_load_dwordx4 v[152:155], v122, s[60:63], 0 offen sc1
    s_waitcnt vmcnt(0)
    v_xor_b32 v3, v138, v96
    v_bitop3_b32 v3, v3, v142, v97 bitop3:0xf6
    v_bitop3_b32 v3, v3, v146, v98 bitop3:0xf6
    v_bitop3_b32 v3, v3, v150, v99 bitop3:0xf6
    v_bitop3_b32 v3, v3, v154, v100 bitop3:0xf6
    v_cmp_ne_u32 vcc, 0, v3
    s_nop 3
    s_cbranch_vccz L_rd_21
    s_sub_u32 s82, s82, 1
    s_cbranch_scc0 L_rp_20
L_rd_21:
    v_pk_fma_f32 v[140:141], v[90:91], v[136:137], v[140:141] op_sel:[0,0,0] op_sel_hi:[0,1,1]
    v_pk_fma_f32 v[140:141], v[90:91], v[136:137], v[140:141] op_sel:[1,1,0] op_sel_hi:[1,0,1] neg_lo:[1,0,0]
    v_pk_fma_f32 v[144:145], v[90:91], v[140:141], v[144:145] op_sel:[0,0,0] op_sel_hi:[0,1,1]
    v_pk_fma_f32 v[144:145], v[90:91], v[140:141], v[144:145] op_sel:[1,1,0] op_sel_hi:[1,0,1] neg_lo:[1,0,0]
    v_pk_fma_f32 v[148:149], v[90:91], v[144:145], v[148:149] op_sel:[0,0,0] op_sel_hi:[0,1,1]
    v_pk_fma_f32 v[148:149], v[90:91], v[144:145], v[148:149] op_sel:[1,1,0] op_sel_hi:[1,0,1] neg_lo:[1,0,0]
    v_pk_fma_f32 v[152:153], v[90:91], v[148:149], v[152:153] op_sel:[0,0,0] op_sel_hi:[0,1,1]
    v_pk_fma_f32 v[152:153], v[90:91], v[148:149], v[152:153] op_sel:[1,1,0] op_sel_hi:[1,0,1] neg_lo:[1,0,0]
    v_pk_mul_f32 v[4:5], v[126:127], v[152:153] op_sel:[0,0] op_sel_hi:[0,1]
    v_pk_fma_f32 v[4:5], v[126:127], v[152:153], v[4:5] op_sel:[1,1,0] op_sel_hi:[1,0,1] neg_lo:[1,0,0]
    ds_write_b64 v128, v[4:5] offset:10240
    buffer_load_dword v125, v123, s[52:55], 0 offen
    buffer_load_dword v130, v124, s[52:55], 0 offen
    s_waitcnt lgkmcnt(0)
    s_barrier
    ds_read2_b64 v[136:139], v27 offset0:0 offset1:80
    ds_read2_b64 v[140:143], v27 offset0:16 offset1:96
    ds_read2_b64 v[144:147], v27 offset0:32 offset1:112
    ds_read2_b64 v[148:151], v27 offset0:48 offset1:128
    ds_read2_b64 v[152:155], v27 offset0:64 offset1:144
    ds_read2_b64 v[156:159], v27 offset0:160 offset1:176
    ds_read2_b64 v[160:163], v27 offset0:192 offset1:208
    ds_read_b64 v[164:165], v27 offset:1792
    s_waitcnt lgkmcnt(7)
    v_pk_add_f32 v[136:137], v[136:137], v[138:139]
    s_waitcnt lgkmcnt(6)
    v_pk_add_f32 v[140:141], v[140:141], v[142:143]
    s_waitcnt lgkmcnt(5)
    v_pk_add_f32 v[144:145], v[144:145], v[146:147]
    s_waitcnt lgkmcnt(4)
    v_pk_add_f32 v[148:149], v[148:149], v[150:151]
    s_waitcnt lgkmcnt(3)
    v_pk_add_f32 v[152:153], v[152:153], v[154:155]
    s_waitcnt lgkmcnt(2)
    v_pk_add_f32 v[136:137], v[136:137], v[156:157]
    v_pk_add_f32 v[140:141], v[140:141], v[158:159]
    s_waitcnt lgkmcnt(1)
    v_pk_add_f32 v[144:145], v[144:145], v[160:161]
    v_pk_add_f32 v[148:149], v[148:149], v[162:163]
    s_waitcnt lgkmcnt(0)
    v_pk_add_f32 v[152:153], v[152:153], v[164:165]
    v_pk_fma_f32 v[108:109], v[54:55], v[136:137], v[108:109] op_sel:[0,0,0] op_sel_hi:[0,1,1]
    v_pk_fma_f32 v[110:111], v[62:63], v[140:141], v[110:111] op_sel:[0,0,0] op_sel_hi:[0,1,1]
    v_pk_fma_f32 v[112:113], v[70:71], v[144:145], v[112:113] op_sel:[0,0,0] op_sel_hi:[0,1,1]
    v_pk_fma_f32 v[114:115], v[78:79], v[148:149], v[114:115] op_sel:[0,0,0] op_sel_hi:[0,1,1]
    v_pk_fma_f32 v[116:117], v[86:87], v[152:153], v[116:117] op_sel:[0,0,0] op_sel_hi:[0,1,1]
    v_pk_fma_f32 v[108:109], v[54:55], v[136:137], v[108:109] op_sel:[1,1,0] op_sel_hi:[1,0,1] neg_lo:[1,0,0]
    v_pk_fma_f32 v[110:111], v[62:63], v[140:141], v[110:111] op_sel:[1,1,0] op_sel_hi:[1,0,1] neg_lo:[1,0,0]
    v_pk_fma_f32 v[112:113], v[70:71], v[144:145], v[112:113] op_sel:[1,1,0] op_sel_hi:[1,0,1] neg_lo:[1,0,0]
    v_pk_fma_f32 v[114:115], v[78:79], v[148:149], v[114:115] op_sel:[1,1,0] op_sel_hi:[1,0,1] neg_lo:[1,0,0]
    v_pk_fma_f32 v[116:117], v[86:87], v[152:153], v[116:117] op_sel:[1,1,0] op_sel_hi:[1,0,1] neg_lo:[1,0,0]
    v_pk_fma_f32 v[176:177], v[48:49], v[108:109], v[176:177] op_sel:[0,0,0] op_sel_hi:[1,0,1]
    v_pk_fma_f32 v[216:217], v[48:49], v[108:109], v[216:217] op_sel:[0,1,0] op_sel_hi:[1,1,1]
    v_pk_fma_f32 v[184:185], v[56:57], v[110:111], v[184:185] op_sel:[0,0,0] op_sel_hi:[1,0,1]
    v_pk_fma_f32 v[224:225], v[56:57], v[110:111], v[224:225] op_sel:[0,1,0] op_sel_hi:[1,1,1]
    v_pk_fma_f32 v[192:193], v[64:65], v[112:113], v[192:193] op_sel:[0,0,0] op_sel_hi:[1,0,1]
    v_pk_fma_f32 v[232:233], v[64:65], v[112:113], v[232:233] op_sel:[0,1,0] op_sel_hi:[1,1,1]
    v_pk_fma_f32 v[200:201], v[72:73], v[114:115], v[200:201] op_sel:[0,0,0] op_sel_hi:[1,0,1]
    v_pk_fma_f32 v[240:241], v[72:73], v[114:115], v[240:241] op_sel:[0,1,0] op_sel_hi:[1,1,1]
    v_pk_fma_f32 v[208:209], v[80:81], v[116:117], v[208:209] op_sel:[0,0,0] op_sel_hi:[1,0,1]
    v_pk_fma_f32 v[248:249], v[80:81], v[116:117], v[248:249] op_sel:[0,1,0] op_sel_hi:[1,1,1]
    v_pk_fma_f32 v[176:177], v[50:51], v[108:109], v[176:177] op_sel:[0,1,0] op_sel_hi:[1,1,1] neg_lo:[1,0,0] neg_hi:[1,0,0]
    v_pk_fma_f32 v[216:217], v[50:51], v[108:109], v[216:217] op_sel:[0,0,0] op_sel_hi:[1,0,1]
    v_pk_fma_f32 v[184:185], v[58:59], v[110:111], v[184:185] op_sel:[0,1,0] op_sel_hi:[1,1,1] neg_lo:[1,0,0] neg_hi:[1,0,0]
    v_pk_fma_f32 v[224:225], v[58:59], v[110:111], v[224:225] op_sel:[0,0,0] op_sel_hi:[1,0,1]
    v_pk_fma_f32 v[192:193], v[66:67], v[112:113], v[192:193] op_sel:[0,1,0] op_sel_hi:[1,1,1] neg_lo:[1,0,0] neg_hi:[1,0,0]
    v_pk_fma_f32 v[232:233], v[66:67], v[112:113], v[232:233] op_sel:[0,0,0] op_sel_hi:[1,0,1]
    v_pk_fma_f32 v[200:201], v[74:75], v[114:115], v[200:201] op_sel:[0,1,0] op_sel_hi:[1,1,1] neg_lo:[1,0,0] neg_hi:[1,0,0]
    v_pk_fma_f32 v[240:241], v[74:75], v[114:115], v[240:241] op_sel:[0,0,0] op_sel_hi:[1,0,1]
    v_pk_fma_f32 v[208:209], v[82:83], v[116:117], v[208:209] op_sel:[0,1,0] op_sel_hi:[1,1,1] neg_lo:[1,0,0] neg_hi:[1,0,0]
    v_pk_fma_f32 v[248:249], v[82:83], v[116:117], v[248:249] op_sel:[0,0,0] op_sel_hi:[1,0,1]
    v_pk_fma_f32 v[178:179], v[48:49], v[176:177], v[178:179] op_sel:[1,0,0] op_sel_hi:[1,1,1]
    v_pk_fma_f32 v[218:219], v[48:49], v[216:217], v[218:219] op_sel:[1,0,0] op_sel_hi:[1,1,1]
    v_pk_fma_f32 v[186:187], v[56:57], v[184:185], v[186:187] op_sel:[1,0,0] op_sel_hi:[1,1,1]
    v_pk_fma_f32 v[226:227], v[56:57], v[224:225], v[226:227] op_sel:[1,0,0] op_sel_hi:[1,1,1]
    v_pk_fma_f32 v[194:195], v[64:65], v[192:193], v[194:195] op_sel:[1,0,0] op_sel_hi:[1,1,1]
    v_pk_fma_f32 v[234:235], v[64:65], v[232:233], v[234:235] op_sel:[1,0,0] op_sel_hi:[1,1,1]
    v_pk_fma_f32 v[202:203], v[72:73], v[200:201], v[202:203] op_sel:[1,0,0] op_sel_hi:[1,1,1]
    v_pk_fma_f32 v[242:243], v[72:73], v[240:241], v[242:243] op_sel:[1,0,0] op_sel_hi:[1,1,1]
    v_pk_fma_f32 v[210:211], v[80:81], v[208:209], v[210:211] op_sel:[1,0,0] op_sel_hi:[1,1,1]
    v_pk_fma_f32 v[250:251], v[80:81], v[248:249], v[250:251] op_sel:[1,0,0] op_sel_hi:[1,1,1]
    v_pk_fma_f32 v[178:179], v[50:51], v[216:217], v[178:179] op_sel:[1,0,0] op_sel_hi:[1,1,1] neg_lo:[1,0,0] neg_hi:[1,0,0]
    v_pk_fma_f32 v[218:219], v[50:51], v[176:177], v[218:219] op_sel:[1,0,0] op_sel_hi:[1,1,1]
    v_pk_fma_f32 v[186:187], v[58:59], v[224:225], v[186:187] op_sel:[1,0,0] op_sel_hi:[1,1,1] neg_lo:[1,0,0] neg_hi:[1,0,0]
    v_pk_fma_f32 v[226:227], v[58:59], v[184:185], v[226:227] op_sel:[1,0,0] op_sel_hi:[1,1,1]
    v_pk_fma_f32 v[194:195], v[66:67], v[232:233], v[194:195] op_sel:[1,0,0] op_sel_hi:[1,1,1] neg_lo:[1,0,0] neg_hi:[1,0,0]
    v_pk_fma_f32 v[234:235], v[66:67], v[192:193], v[234:235] op_sel:[1,0,0] op_sel_hi:[1,1,1]
    v_pk_fma_f32 v[202:203], v[74:75], v[240:241], v[202:203] op_sel:[1,0,0] op_sel_hi:[1,1,1] neg_lo:[1,0,0] neg_hi:[1,0,0]
    v_pk_fma_f32 v[242:243], v[74:75], v[200:201], v[242:243] op_sel:[1,0,0] op_sel_hi:[1,1,1]
    v_pk_fma_f32 v[210:211], v[82:83], v[248:249], v[210:211] op_sel:[1,0,0] op_sel_hi:[1,1,1] neg_lo:[1,0,0] neg_hi:[1,0,0]
    v_pk_fma_f32 v[250:251], v[82:83], v[208:209], v[250:251] op_sel:[1,0,0] op_sel_hi:[1,1,1]
    v_pk_fma_f32 v[180:181], v[48:49], v[178:179], v[180:181] op_sel:[1,0,0] op_sel_hi:[1,1,1]
    v_pk_fma_f32 v[220:221], v[48:49], v[218:219], v[220:221] op_sel:[1,0,0] op_sel_hi:[1,1,1]
    v_pk_fma_f32 v[188:189], v[56:57], v[186:187], v[188:189] op_sel:[1,0,0] op_sel_hi:[1,1,1]
    v_pk_fma_f32 v[228:229], v[56:57], v[226:227], v[228:229] op_sel:[1,0,0] op_sel_hi:[1,1,1]
    v_pk_fma_f32 v[196:197], v[64:65], v[194:195], v[196:197] op_sel:[1,0,0] op_sel_hi:[1,1,1]
    v_pk_fma_f32 v[236:237], v[64:65], v[234:235], v[236:237] op_sel:[1,0,0] op_sel_hi:[1,1,1]
    v_pk_fma_f32 v[204:205], v[72:73], v[202:203], v[204:205] op_sel:[1,0,0] op_sel_hi:[1,1,1]
    v_pk_fma_f32 v[244:245], v[72:73], v[242:243], v[244:245] op_sel:[1,0,0] op_sel_hi:[1,1,1]
    v_pk_fma_f32 v[212:213], v[80:81], v[210:211], v[212:213] op_sel:[1,0,0] op_sel_hi:[1,1,1]
    v_pk_fma_f32 v[252:253], v[80:81], v[250:251], v[252:253] op_sel:[1,0,0] op_sel_hi:[1,1,1]
    v_pk_fma_f32 v[180:181], v[50:51], v[218:219], v[180:181] op_sel:[1,0,0] op_sel_hi:[1,1,1] neg_lo:[1,0,0] neg_hi:[1,0,0]
    v_pk_fma_f32 v[220:221], v[50:51], v[178:179], v[220:221] op_sel:[1,0,0] op_sel_hi:[1,1,1]
    v_pk_fma_f32 v[188:189], v[58:59], v[226:227], v[188:189] op_sel:[1,0,0] op_sel_hi:[1,1,1] neg_lo:[1,0,0] neg_hi:[1,0,0]
    v_pk_fma_f32 v[228:229], v[58:59], v[186:187], v[228:229] op_sel:[1,0,0] op_sel_hi:[1,1,1]
    v_pk_fma_f32 v[196:197], v[66:67], v[234:235], v[196:197] op_sel:[1,0,0] op_sel_hi:[1,1,1] neg_lo:[1,0,0] neg_hi:[1,0,0]
    v_pk_fma_f32 v[236:237], v[66:67], v[194:195], v[236:237] op_sel:[1,0,0] op_sel_hi:[1,1,1]
    v_pk_fma_f32 v[204:205], v[74:75], v[242:243], v[204:205] op_sel:[1,0,0] op_sel_hi:[1,1,1] neg_lo:[1,0,0] neg_hi:[1,0,0]
    v_pk_fma_f32 v[244:245], v[74:75], v[202:203], v[244:245] op_sel:[1,0,0] op_sel_hi:[1,1,1]
    v_pk_fma_f32 v[212:213], v[82:83], v[250:251], v[212:213] op_sel:[1,0,0] op_sel_hi:[1,1,1] neg_lo:[1,0,0] neg_hi:[1,0,0]
    v_pk_fma_f32 v[252:253], v[82:83], v[210:211], v[252:253] op_sel:[1,0,0] op_sel_hi:[1,1,1]
    v_pk_fma_f32 v[182:183], v[48:49], v[180:181], v[182:183] op_sel:[1,0,0] op_sel_hi:[1,1,1]
    v_pk_fma_f32 v[222:223], v[48:49], v[220:221], v[222:223] op_sel:[1,0,0] op_sel_hi:[1,1,1]
    v_pk_fma_f32 v[190:191], v[56:57], v[188:189], v[190:191] op_sel:[1,0,0] op_sel_hi:[1,1,1]
    v_pk_fma_f32 v[230:231], v[56:57], v[228:229], v[230:231] op_sel:[1,0,0] op_sel_hi:[1,1,1]
    v_pk_fma_f32 v[198:199], v[64:65], v[196:197], v[198:199] op_sel:[1,0,0] op_sel_hi:[1,1,1]
    v_pk_fma_f32 v[238:239], v[64:65], v[236:237], v[238:239] op_sel:[1,0,0] op_sel_hi:[1,1,1]
    v_pk_fma_f32 v[206:207], v[72:73], v[204:205], v[206:207] op_sel:[1,0,0] op_sel_hi:[1,1,1]
    v_pk_fma_f32 v[246:247], v[72:73], v[244:245], v[246:247] op_sel:[1,0,0] op_sel_hi:[1,1,1]
    v_pk_fma_f32 v[214:215], v[80:81], v[212:213], v[214:215] op_sel:[1,0,0] op_sel_hi:[1,1,1]
    v_pk_fma_f32 v[254:255], v[80:81], v[252:253], v[254:255] op_sel:[1,0,0] op_sel_hi:[1,1,1]
    v_pk_fma_f32 v[182:183], v[50:51], v[220:221], v[182:183] op_sel:[1,0,0] op_sel_hi:[1,1,1] neg_lo:[1,0,0] neg_hi:[1,0,0]
    v_pk_fma_f32 v[222:223], v[50:51], v[180:181], v[222:223] op_sel:[1,0,0] op_sel_hi:[1,1,1]
    v_pk_fma_f32 v[190:191], v[58:59], v[228:229], v[190:191] op_sel:[1,0,0] op_sel_hi:[1,1,1] neg_lo:[1,0,0] neg_hi:[1,0,0]
    v_pk_fma_f32 v[230:231], v[58:59], v[188:189], v[230:231] op_sel:[1,0,0] op_sel_hi:[1,1,1]
    v_pk_fma_f32 v[198:199], v[66:67], v[236:237], v[198:199] op_sel:[1,0,0] op_sel_hi:[1,1,1] neg_lo:[1,0,0] neg_hi:[1,0,0]
    v_pk_fma_f32 v[238:239], v[66:67], v[196:197], v[238:239] op_sel:[1,0,0] op_sel_hi:[1,1,1]
    v_pk_fma_f32 v[206:207], v[74:75], v[244:245], v[206:207] op_sel:[1,0,0] op_sel_hi:[1,1,1] neg_lo:[1,0,0] neg_hi:[1,0,0]
    v_pk_fma_f32 v[246:247], v[74:75], v[204:205], v[246:247] op_sel:[1,0,0] op_sel_hi:[1,1,1]
    v_pk_fma_f32 v[214:215], v[82:83], v[252:253], v[214:215] op_sel:[1,0,0] op_sel_hi:[1,1,1] neg_lo:[1,0,0] neg_hi:[1,0,0]
    v_pk_fma_f32 v[254:255], v[82:83], v[212:213], v[254:255] op_sel:[1,0,0] op_sel_hi:[1,1,1]
    v_cvt_pk_bf16_f32 v48, v176, v177
    v_cvt_pk_bf16_f32 v49, v178, v179
    v_cvt_pk_bf16_f32 v50, v180, v181
    v_cvt_pk_bf16_f32 v51, v182, v183
    ds_write_b128 v29, v[48:51] offset:0
    v_cvt_pk_bf16_f32 v52, -v216, -v217
    v_cvt_pk_bf16_f32 v53, -v218, -v219
    v_cvt_pk_bf16_f32 v54, -v220, -v221
    v_cvt_pk_bf16_f32 v55, -v222, -v223
    ds_write_b128 v29, v[52:55] offset:1024
    v_cvt_pk_bf16_f32 v56, v184, v185
    v_cvt_pk_bf16_f32 v57, v186, v187
    v_cvt_pk_bf16_f32 v58, v188, v189
    v_cvt_pk_bf16_f32 v59, v190, v191
    ds_write_b128 v29, v[56:59] offset:12288
    v_cvt_pk_bf16_f32 v60, -v224, -v225
    v_cvt_pk_bf16_f32 v61, -v226, -v227
    v_cvt_pk_bf16_f32 v62, -v228, -v229
    v_cvt_pk_bf16_f32 v63, -v230, -v231
    ds_write_b128 v29, v[60:63] offset:13312
    ds_read_b64_tr_b16 v[176:177], v30 offset:0
    ds_read_b64_tr_b16 v[178:179], v31 offset:256
    ds_read_b64_tr_b16 v[180:181], v31 offset:0
    ds_read_b64_tr_b16 v[182:183], v30 offset:256
    v_cvt_pk_bf16_f32 v64, v192, v193
    v_cvt_pk_bf16_f32 v65, v194, v195
    v_cvt_pk_bf16_f32 v66, v196, v197
    v_cvt_pk_bf16_f32 v67, v198, v199
    ds_write_b128 v29, v[64:67] offset:0
    v_cvt_pk_bf16_f32 v68, -v232, -v233
    v_cvt_pk_bf16_f32 v69, -v234, -v235
    v_cvt_pk_bf16_f32 v70, -v236, -v237
    v_cvt_pk_bf16_f32 v71, -v238, -v239
    ds_write_b128 v29, v[68:71] offset:1024
    ds_read_b64_tr_b16 v[184:185], v30 offset:12288
    ds_read_b64_tr_b16 v[186:187], v31 offset:12544
    ds_read_b64_tr_b16 v[188:189], v31 offset:12288
    ds_read_b64_tr_b16 v[190:191], v30 offset:12544
    v_cvt_pk_bf16_f32 v72, v200, v201
    v_cvt_pk_bf16_f32 v73, v202, v203
    v_cvt_pk_bf16_f32 v74, v204, v205
    v_cvt_pk_bf16_f32 v75, v206, v207
    ds_write_b128 v29, v[72:75] offset:12288
    v_cvt_pk_bf16_f32 v76, -v240, -v241
    v_cvt_pk_bf16_f32 v77, -v242, -v243
    v_cvt_pk_bf16_f32 v78, -v244, -v245
    v_cvt_pk_bf16_f32 v79, -v246, -v247
    ds_write_b128 v29, v[76:79] offset:13312
    ds_read_b64_tr_b16 v[192:193], v30 offset:0
    ds_read_b64_tr_b16 v[194:195], v31 offset:256
    ds_read_b64_tr_b16 v[196:197], v31 offset:0
    ds_read_b64_tr_b16 v[198:199], v30 offset:256
    v_cvt_pk_bf16_f32 v80, v208, v209
    v_cvt_pk_bf16_f32 v81, v210, v211
    v_cvt_pk_bf16_f32 v82, v212, v213
    v_cvt_pk_bf16_f32 v83, v214, v215
    ds_write_b128 v29, v[80:83] offset:0
    v_cvt_pk_bf16_f32 v84, -v248, -v249
    v_cvt_pk_bf16_f32 v85, -v250, -v251
    v_cvt_pk_bf16_f32 v86, -v252, -v253
    v_cvt_pk_bf16_f32 v87, -v254, -v255
    ds_write_b128 v29, v[84:87] offset:1024
    ds_read_b64_tr_b16 v[200:201], v30 offset:12288
    ds_read_b64_tr_b16 v[202:203], v31 offset:12544
    ds_read_b64_tr_b16 v[204:205], v31 offset:12288
    ds_read_b64_tr_b16 v[206:207], v30 offset:12544
    ds_read_b64_tr_b16 v[208:209], v30 offset:0
    ds_read_b64_tr_b16 v[210:211], v31 offset:256
    ds_read_b64_tr_b16 v[212:213], v31 offset:0
    ds_read_b64_tr_b16 v[214:215], v30 offset:256
    v_accvgpr_read_b32 v14, a244
    v_accvgpr_read_b32 v15, a245
    v_lshlrev_b32 v4, 16, v14
    v_and_b32 v5, 0xffff0000, v14
    v_lshlrev_b32 v6, 16, v15
    v_and_b32 v7, 0xffff0000, v15
    v_accvgpr_read_b32 v2, a4
    v_accvgpr_read_b32 v3, a5
    v_lshlrev_b32 v8, 16, v2
    v_and_b32 v9, 0xffff0000, v2
    v_lshlrev_b32 v10, 16, v3
    v_and_b32 v11, 0xffff0000, v3
    v_pk_mul_f32 v[8:9], v[8:9], v[4:5]
    v_pk_mul_f32 v[10:11], v[10:11], v[6:7]
    v_cvt_pk_bf16_f32 v12, v8, v9
    v_cvt_pk_bf16_f32 v13, v10, v11
    v_lshlrev_b32 v8, 16, v12
    v_and_b32 v9, 0xffff0000, v12
    v_lshlrev_b32 v10, 16, v13
    v_and_b32 v11, 0xffff0000, v13
    v_accvgpr_write_b32 a216, v8
    v_accvgpr_write_b32 a217, v9
    v_accvgpr_write_b32 a218, v10
    v_accvgpr_write_b32 a219, v11
    v_accvgpr_read_b32 v2, a14
    v_accvgpr_read_b32 v3, a15
    v_lshlrev_b32 v8, 16, v2
    v_and_b32 v9, 0xffff0000, v2
    v_lshlrev_b32 v10, 16, v3
    v_and_b32 v11, 0xffff0000, v3
    v_pk_mul_f32 v[8:9], v[8:9], v[4:5]
    v_pk_mul_f32 v[10:11], v[10:11], v[6:7]
    v_cvt_pk_bf16_f32 v12, v8, v9
    v_cvt_pk_bf16_f32 v13, v10, v11
    v_lshlrev_b32 v8, 16, v12
    v_and_b32 v9, 0xffff0000, v12
    v_lshlrev_b32 v10, 16, v13
    v_and_b32 v11, 0xffff0000, v13
    v_accvgpr_write_b32 a220, v8
    v_accvgpr_write_b32 a221, v9
    v_accvgpr_write_b32 a222, v10
    v_accvgpr_write_b32 a223, v11
    v_accvgpr_read_b32 v14, a246
    v_accvgpr_read_b32 v15, a247
    v_lshlrev_b32 v4, 16, v14
    v_and_b32 v5, 0xffff0000, v14
    v_lshlrev_b32 v6, 16, v15
    v_and_b32 v7, 0xffff0000, v15
    v_accvgpr_read_b32 v2, a6
    v_accvgpr_read_b32 v3, a7
    v_lshlrev_b32 v8, 16, v2
    v_and_b32 v9, 0xffff0000, v2
    v_lshlrev_b32 v10, 16, v3
    v_and_b32 v11, 0xffff0000, v3
    v_pk_mul_f32 v[8:9], v[8:9], v[4:5]
    v_pk_mul_f32 v[10:11], v[10:11], v[6:7]
    v_cvt_pk_bf16_f32 v12, v8, v9
    v_cvt_pk_bf16_f32 v13, v10, v11
    v_lshlrev_b32 v8, 16, v12
    v_and_b32 v9, 0xffff0000, v12
    v_lshlrev_b32 v10, 16, v13
    v_and_b32 v11, 0xffff0000, v13
    v_accvgpr_write_b32 a224, v8
    v_accvgpr_write_b32 a225, v9
    v_accvgpr_write_b32 a226, v10
    v_accvgpr_write_b32 a227, v11
    v_accvgpr_read_b32 v2, a16
    v_accvgpr_read_b32 v3, a17
    v_lshlrev_b32 v8, 16, v2
    v_and_b32 v9, 0xffff0000, v2
    v_lshlrev_b32 v10, 16, v3
    v_and_b32 v11, 0xffff0000, v3
    v_pk_mul_f32 v[8:9], v[8:9], v[4:5]
    v_pk_mul_f32 v[10:11], v[10:11], v[6:7]
    v_cvt_pk_bf16_f32 v12, v8, v9
    v_cvt_pk_bf16_f32 v13, v10, v11
    v_lshlrev_b32 v8, 16, v12
    v_and_b32 v9, 0xffff0000, v12
    v_lshlrev_b32 v10, 16, v13
    v_and_b32 v11, 0xffff0000, v13
    v_accvgpr_write_b32 a228, v8
    v_accvgpr_write_b32 a229, v9
    v_accvgpr_write_b32 a230, v10
    v_accvgpr_write_b32 a231, v11
    v_accvgpr_read_b32 v14, a248
    v_accvgpr_read_b32 v15, a249
    v_lshlrev_b32 v4, 16, v14
    v_and_b32 v5, 0xffff0000, v14
    v_lshlrev_b32 v6, 16, v15
    v_and_b32 v7, 0xffff0000, v15
    v_accvgpr_read_b32 v2, a8
    v_accvgpr_read_b32 v3, a9
    v_lshlrev_b32 v8, 16, v2
    v_and_b32 v9, 0xffff0000, v2
    v_lshlrev_b32 v10, 16, v3
    v_and_b32 v11, 0xffff0000, v3
    v_pk_mul_f32 v[8:9], v[8:9], v[4:5]
    v_pk_mul_f32 v[10:11], v[10:11], v[6:7]
    v_cvt_pk_bf16_f32 v12, v8, v9
    v_cvt_pk_bf16_f32 v13, v10, v11
    v_lshlrev_b32 v8, 16, v12
    v_and_b32 v9, 0xffff0000, v12
    v_lshlrev_b32 v10, 16, v13
    v_and_b32 v11, 0xffff0000, v13
    v_accvgpr_write_b32 a232, v8
    v_accvgpr_write_b32 a233, v9
    v_accvgpr_write_b32 a234, v10
    v_accvgpr_write_b32 a235, v11
    v_accvgpr_read_b32 v2, a18
    v_accvgpr_read_b32 v3, a19
    v_lshlrev_b32 v8, 16, v2
    v_and_b32 v9, 0xffff0000, v2
    v_lshlrev_b32 v10, 16, v3
    v_and_b32 v11, 0xffff0000, v3
    v_pk_mul_f32 v[8:9], v[8:9], v[4:5]
    v_pk_mul_f32 v[10:11], v[10:11], v[6:7]
    v_cvt_pk_bf16_f32 v12, v8, v9
    v_cvt_pk_bf16_f32 v13, v10, v11
    v_lshlrev_b32 v8, 16, v12
    v_and_b32 v9, 0xffff0000, v12
    v_lshlrev_b32 v10, 16, v13
    v_and_b32 v11, 0xffff0000, v13
    v_accvgpr_write_b32 a236, v8
    v_accvgpr_write_b32 a237, v9
    v_accvgpr_write_b32 a238, v10
    v_accvgpr_write_b32 a239, v11
    s_waitcnt lgkmcnt(0)
    s_cmp_eq_u32 s34, 0
    s_cbranch_scc1 L_wt_22
    buffer_store_dwordx4 v[176:179], v39, s[52:55], s89 offen offset:0
    buffer_store_dwordx4 v[180:183], v39, s[52:55], s89 offen offset:1024
    buffer_store_dwordx4 v[184:187], v40, s[52:55], s89 offen offset:0
    buffer_store_dwordx4 v[188:191], v41, s[52:55], s89 offen offset:0
    buffer_store_dwordx4 v[192:195], v41, s[52:55], s89 offen offset:1024
    buffer_store_dwordx4 v[196:199], v42, s[52:55], s89 offen offset:0
    buffer_store_dwordx4 v[200:203], v42, s[52:55], s89 offen offset:1024
    buffer_store_dwordx4 v[204:207], v43, s[52:55], s89 offen offset:0
    buffer_store_dwordx4 v[208:211], v44, s[52:55], s89 offen offset:0
    buffer_store_dwordx4 v[212:215], v44, s[52:55], s89 offen offset:1024
    s_branch L_j_23
L_wt_22:
    buffer_store_dwordx4 v[176:179], v39, s[52:55], s89 offen offset:0 sc1
    buffer_store_dwordx4 v[180:183], v39, s[52:55], s89 offen offset:1024 sc1
    buffer_store_dwordx4 v[184:187], v40, s[52:55], s89 offen offset:0 sc1
    buffer_store_dwordx4 v[188:191], v41, s[52:55], s89 offen offset:0 sc1
    buffer_store_dwordx4 v[192:195], v41, s[52:55], s89 offen offset:1024 sc1
    buffer_store_dwordx4 v[196:199], v42, s[52:55], s89 offen offset:0 sc1
    buffer_store_dwordx4 v[200:203], v42, s[52:55], s89 offen offset:1024 sc1
    buffer_store_dwordx4 v[204:207], v43, s[52:55], s89 offen offset:0 sc1
    buffer_store_dwordx4 v[208:211], v44, s[52:55], s89 offen offset:0 sc1
    buffer_store_dwordx4 v[212:215], v44, s[52:55], s89 offen offset:1024 sc1
L_j_23:
    v_add_u32 v96, 0, v132
    v_add_u32 v97, 0, v133
    v_add_u32 v98, 0, v134
    v_add_u32 v99, 0, v135
    v_add_u32 v100, 65536, v132
    v_add_u32 v101, 65536, v133
    v_add_u32 v102, 65536, v134
    v_add_u32 v103, 65536, v135
    v_add_u32 v104, 131072, v132
    v_add_u32 v105, 131072, v133
    v_add_u32 v106, 131072, v134
    v_add_u32 v107, 131072, v135
    v_mov_b32 v16, s79
    s_barrier
    s_and_b32 s80, s78, 3
    s_cmp_eq_u32 s80, 1
    s_cbranch_scc1 L_own1
    s_cmp_eq_u32 s80, 2
    s_cbranch_scc1 L_own2
    s_cmp_eq_u32 s80, 3
    s_cbranch_scc1 L_own3
L_own0:
    ds_read_b128 v[108:111], v100 offset:36864
    ds_read_b128 v[112:115], v100 offset:38912
    ds_read_b128 v[116:119], v100 offset:40960
    ds_read_b128 v[120:123], v100 offset:43008
    s_waitcnt vmcnt(11)
    ds_read_b128 v[124:127], v100 offset:45056
    s_waitcnt vmcnt(0)
    s_cmp_eq_u32 s34, 0
    s_cbranch_scc1 L_wt_24
    buffer_store_dword v16, v33, s[48:51], 0 offen
    s_branch L_j_25
L_wt_24:
    buffer_store_dword v16, v33, s[48:51], 0 offen sc1
L_j_25:
    s_waitcnt lgkmcnt(0)
    v_mfma_f32_16x16x32_bf16 a[200:203], v[108:111], v[176:179], a[200:203]
    ds_read_b128 v[128:131], v101 offset:36864
    v_mfma_f32_16x16x32_bf16 a[204:207], v[108:111], v[180:183], a[204:207]
    ds_read_b128 v[132:135], v101 offset:38912
    v_mfma_f32_16x16x32_bf16 a[208:211], v[112:115], v[176:179], a[208:211]
    ds_read_b128 v[136:139], v101 offset:40960
    v_mfma_f32_16x16x32_bf16 a[212:215], v[112:115], v[180:183], a[212:215]
    ds_read_b128 v[140:143], v101 offset:43008
    v_mfma_f32_16x16x32_bf16 a[216:219], v[116:119], v[176:179], a[216:219]
    ds_read_b128 v[144:147], v101 offset:45056
    v_mfma_f32_16x16x32_bf16 a[220:223], v[116:119], v[180:183], a[220:223]
    s_add_u32 m0, s98, 61440
    s_add_u32 s81, s90, 5
    s_sub_u32 s101, s81, 10
    s_cselect_b32 s81, s81, s101
    s_lshl_b32 s81, s81, 7
    buffer_load_dwordx4 v20, s[44:47], s81 offen offset:0 lds
    v_mfma_f32_16x16x32_bf16 a[224:227], v[120:123], v[176:179], a[224:227]
    v_mfma_f32_16x16x32_bf16 a[228:231], v[120:123], v[180:183], a[228:231]
    buffer_load_dwordx4 v21, s[44:47], s81 offen offset:1024 lds
    v_mfma_f32_16x16x32_bf16 a[232:235], v[124:127], v[176:179], a[232:235]
    v_mfma_f32_16x16x32_bf16 a[236:239], v[124:127], v[180:183], a[236:239]
    s_waitcnt lgkmcnt(0)
    v_mfma_f32_16x16x32_bf16 a[200:203], v[128:131], v[184:187], a[200:203]
    ds_read_b128 v[108:111], v102 offset:36864
    v_mfma_f32_16x16x32_bf16 a[204:207], v[128:131], v[188:191], a[204:207]
    ds_read_b128 v[112:115], v102 offset:38912
    v_mfma_f32_16x16x32_bf16 a[208:211], v[132:135], v[184:187], a[208:211]
    ds_read_b128 v[116:119], v102 offset:40960
    v_mfma_f32_16x16x32_bf16 a[212:215], v[132:135], v[188:191], a[212:215]
    ds_read_b128 v[120:123], v102 offset:43008
    v_mfma_f32_16x16x32_bf16 a[216:219], v[136:139], v[184:187], a[216:219]
    ds_read_b128 v[124:127], v102 offset:45056
    v_mfma_f32_16x16x32_bf16 a[220:223], v[136:139], v[188:191], a[220:223]
    buffer_load_dwordx4 v22, s[44:47], s81 offen offset:2048 lds
    v_mfma_f32_16x16x32_bf16 a[224:227], v[140:143], v[184:187], a[224:227]
    v_mfma_f32_16x16x32_bf16 a[228:231], v[140:143], v[188:191], a[228:231]
    buffer_load_dwordx4 v23, s[44:47], s81 offen offset:3072 lds
    v_mfma_f32_16x16x32_bf16 a[232:235], v[144:147], v[184:187], a[232:235]
    v_mfma_f32_16x16x32_bf16 a[236:239], v[144:147], v[188:191], a[236:239]
    s_waitcnt lgkmcnt(0)
    v_mfma_f32_16x16x32_bf16 a[200:203], v[108:111], v[192:195], a[200:203]
    ds_read_b128 v[128:131], v103 offset:36864
    v_mfma_f32_16x16x32_bf16 a[204:207], v[108:111], v[196:199], a[204:207]
    ds_read_b128 v[132:135], v103 offset:38912
    v_mfma_f32_16x16x32_bf16 a[208:211], v[112:115], v[192:195], a[208:211]
    ds_read_b128 v[136:139], v103 offset:40960
    v_mfma_f32_16x16x32_bf16 a[212:215], v[112:115], v[196:199], a[212:215]
    ds_read_b128 v[140:143], v103 offset:43008
    v_mfma_f32_16x16x32_bf16 a[216:219], v[116:119], v[192:195], a[216:219]
    ds_read_b128 v[144:147], v103 offset:45056
    v_mfma_f32_16x16x32_bf16 a[220:223], v[116:119], v[196:199], a[220:223]
    s_add_u32 m0, s98, 65536
    s_nop 0
    buffer_load_dwordx4 v24, s[44:47], s81 offen offset:0 lds
    v_mfma_f32_16x16x32_bf16 a[224:227], v[120:123], v[192:195], a[224:227]
    s_add_u32 m0, s98, 81920
    s_add_u32 s81, s90, 6
    s_sub_u32 s101, s81, 10
    s_cselect_b32 s81, s81, s101
    s_lshl_b32 s81, s81, 7
    buffer_load_dwordx4 v20, s[44:47], s81 offen offset:0 lds
    v_mfma_f32_16x16x32_bf16 a[228:231], v[120:123], v[196:199], a[228:231]
    v_mfma_f32_16x16x32_bf16 a[232:235], v[124:127], v[192:195], a[232:235]
    buffer_load_dwordx4 v21, s[44:47], s81 offen offset:1024 lds
    v_mfma_f32_16x16x32_bf16 a[236:239], v[124:127], v[196:199], a[236:239]
    s_waitcnt lgkmcnt(0)
    v_mfma_f32_16x16x32_bf16 a[200:203], v[128:131], v[200:203], a[200:203]
    ds_read_b128 v[108:111], v100 offset:57344
    v_mfma_f32_16x16x32_bf16 a[204:207], v[128:131], v[204:207], a[204:207]
    ds_read_b128 v[112:115], v100 offset:59392
    v_mfma_f32_16x16x32_bf16 a[208:211], v[132:135], v[200:203], a[208:211]
    ds_read_b128 v[116:119], v100 offset:61440
    v_mfma_f32_16x16x32_bf16 a[212:215], v[132:135], v[204:207], a[212:215]
    ds_read_b128 v[120:123], v100 offset:63488
    v_mfma_f32_16x16x32_bf16 a[216:219], v[136:139], v[200:203], a[216:219]
    ds_read_b128 v[124:127], v104 offset:0
    v_mfma_f32_16x16x32_bf16 a[220:223], v[136:139], v[204:207], a[220:223]
    buffer_load_dwordx4 v22, s[44:47], s81 offen offset:2048 lds
    v_mfma_f32_16x16x32_bf16 a[224:227], v[140:143], v[200:203], a[224:227]
    v_mfma_f32_16x16x32_bf16 a[228:231], v[140:143], v[204:207], a[228:231]
    buffer_load_dwordx4 v23, s[44:47], s81 offen offset:3072 lds
    v_mfma_f32_16x16x32_bf16 a[232:235], v[144:147], v[200:203], a[232:235]
    v_mfma_f32_16x16x32_bf16 a[236:239], v[144:147], v[204:207], a[236:239]
    s_waitcnt lgkmcnt(0)
    v_mfma_f32_16x16x32_bf16 a[200:203], v[108:111], v[208:211], a[200:203]
    ds_read_b128 v[128:131], v101 offset:57344
    v_mfma_f32_16x16x32_bf16 a[204:207], v[108:111], v[212:215], a[204:207]
    ds_read_b128 v[132:135], v101 offset:59392
    v_mfma_f32_16x16x32_bf16 a[208:211], v[112:115], v[208:211], a[208:211]
    ds_read_b128 v[136:139], v101 offset:61440
    v_mfma_f32_16x16x32_bf16 a[212:215], v[112:115], v[212:215], a[212:215]
    ds_read_b128 v[140:143], v101 offset:63488
    v_mfma_f32_16x16x32_bf16 a[216:219], v[116:119], v[208:211], a[216:219]
    ds_read_b128 v[144:147], v105 offset:0
    v_mfma_f32_16x16x32_bf16 a[220:223], v[116:119], v[212:215], a[220:223]
    s_add_u32 m0, s98, 86016
    s_nop 0
    buffer_load_dwordx4 v24, s[44:47], s81 offen offset:0 lds
    v_mfma_f32_16x16x32_bf16 a[224:227], v[120:123], v[208:211], a[224:227]
    s_add_u32 m0, s98, 143360
    s_add_u32 s81, s90, 7
    s_sub_u32 s101, s81, 10
    s_cselect_b32 s81, s81, s101
    s_lshl_b32 s81, s81, 7
    buffer_load_dwordx4 v20, s[44:47], s81 offen offset:0 lds
    v_mfma_f32_16x16x32_bf16 a[228:231], v[120:123], v[212:215], a[228:231]
    v_mfma_f32_16x16x32_bf16 a[232:235], v[124:127], v[208:211], a[232:235]
    buffer_load_dwordx4 v21, s[44:47], s81 offen offset:1024 lds
    v_mfma_f32_16x16x32_bf16 a[236:239], v[124:127], v[212:215], a[236:239]
    v_and_b32 v4, 15, v0
    v_bfe_u32 v3, v0, 4, 2
    s_mul_i32 s94, s76, 10752
    s_add_u32 s94, s94, 20480
    v_mul_u32_u24 v5, 336, v4
    v_lshl_add_u32 v5, v3, 4, v5
    v_add_u32 v48, s94, v5
    s_lshl_b32 s95, s77, 7
    s_lshl_b32 s96, s76, 5
    s_add_u32 s95, s95, s96
    s_mul_i32 s95, s95, 5120
    s_mul_i32 s96, s78, 320
    s_add_u32 s95, s95, s96
    s_add_u32 s95, s95, 2560
    v_and_b32 v3, 63, v0
    v_add_u32 v4, 0, v3
    v_mul_u32_u24 v5, 3277, v4
    v_lshrrev_b32 v5, 16, v5
    v_lshlrev_b32 v4, 4, v4
    v_lshl_add_u32 v6, v5, 4, v4
    v_add_u32 v55, s94, v6
    v_mul_u32_u24 v5, 4800, v5
    v_add3_u32 v50, v5, v4, s95
    v_add_u32 v4, 64, v3
    v_mul_u32_u24 v5, 3277, v4
    v_lshrrev_b32 v5, 16, v5
    v_lshlrev_b32 v4, 4, v4
    v_lshl_add_u32 v6, v5, 4, v4
    v_add_u32 v56, s94, v6
    v_mul_u32_u24 v5, 4800, v5
    v_add3_u32 v51, v5, v4, s95
    v_add_u32 v4, 128, v3
    v_mul_u32_u24 v5, 3277, v4
    v_lshrrev_b32 v5, 16, v5
    v_lshlrev_b32 v4, 4, v4
    v_lshl_add_u32 v6, v5, 4, v4
    v_add_u32 v57, s94, v6
    v_mul_u32_u24 v5, 4800, v5
    v_add3_u32 v52, v5, v4, s95
    v_add_u32 v4, 192, v3
    v_mul_u32_u24 v5, 3277, v4
    v_lshrrev_b32 v5, 16, v5
    v_lshlrev_b32 v4, 4, v4
    v_lshl_add_u32 v6, v5, 4, v4
    v_add_u32 v58, s94, v6
    v_mul_u32_u24 v5, 4800, v5
    v_add3_u32 v53, v5, v4, s95
    v_add_u32 v4, 256, v3
    v_mul_u32_u24 v5, 3277, v4
    v_lshrrev_b32 v5, 16, v5
    v_lshlrev_b32 v4, 4, v4
    v_lshl_add_u32 v6, v5, 4, v4
    v_add_u32 v59, s94, v6
    v_mul_u32_u24 v5, 4800, v5
    v_add3_u32 v54, v5, v4, s95
    s_mov_b32 s93, 81920
    s_mov_b32 s82, 0x40000
L_poll_26:
    buffer_load_dword v4, v34, s[48:51], 0 offen sc1
    s_waitcnt vmcnt(0)
    v_xor_b32 v4, s79, v4
    v_cmp_ne_u32 vcc, 0, v4
    s_nop 3
    s_cbranch_vccz L_pdone_27
    s_sub_u32 s82, s82, 1
    s_cbranch_scc0 L_poll_26
L_pdone_27:
    s_add_u32 s80, s78, 1
    s_and_b32 s80, s80, 7
    s_mul_i32 s80, s80, 20480
    buffer_load_dwordx4 a[40:43], v39, s[52:55], s80 offen offset:0
    buffer_load_dwordx4 a[44:47], v39, s[52:55], s80 offen offset:1024
    buffer_load_dwordx4 a[48:51], v40, s[52:55], s80 offen offset:0
    buffer_load_dwordx4 a[52:55], v41, s[52:55], s80 offen offset:0
    buffer_load_dwordx4 a[56:59], v41, s[52:55], s80 offen offset:1024
    buffer_load_dwordx4 a[60:63], v42, s[52:55], s80 offen offset:0
    buffer_load_dwordx4 a[64:67], v42, s[52:55], s80 offen offset:1024
    buffer_load_dwordx4 a[68:71], v43, s[52:55], s80 offen offset:0
    buffer_load_dwordx4 a[72:75], v44, s[52:55], s80 offen offset:0
    buffer_load_dwordx4 a[76:79], v44, s[52:55], s80 offen offset:1024
    s_add_u32 s80, s78, 2
    s_and_b32 s80, s80, 7
    s_mul_i32 s80, s80, 20480
    buffer_load_dwordx4 a[80:83], v39, s[52:55], s80 offen offset:0
    buffer_load_dwordx4 a[84:87], v39, s[52:55], s80 offen offset:1024
    s_waitcnt vmcnt(10) lgkmcnt(0)
    v_mfma_f32_16x16x32_bf16 a[200:203], v[128:131], a[40:43], a[200:203]
    ds_read_b128 v[108:111], v102 offset:57344
    v_mfma_f32_16x16x32_bf16 a[204:207], v[128:131], a[44:47], a[204:207]
    ds_read_b128 v[112:115], v102 offset:59392
    v_mfma_f32_16x16x32_bf16 a[208:211], v[132:135], a[40:43], a[208:211]
    ds_read_b128 v[116:119], v102 offset:61440
    v_mfma_f32_16x16x32_bf16 a[212:215], v[132:135], a[44:47], a[212:215]
    ds_read_b128 v[120:123], v102 offset:63488
    v_mfma_f32_16x16x32_bf16 a[216:219], v[136:139], a[40:43], a[216:219]
    ds_read_b128 v[124:127], v106 offset:0
    v_mfma_f32_16x16x32_bf16 a[220:223], v[136:139], a[44:47], a[220:223]
    buffer_load_dwordx4 a[88:91], v40, s[52:55], s80 offen offset:0
    v_mfma_f32_16x16x32_bf16 a[224:227], v[140:143], a[40:43], a[224:227]
    v_mfma_f32_16x16x32_bf16 a[228:231], v[140:143], a[44:47], a[228:231]
    buffer_load_dwordx4 a[92:95], v41, s[52:55], s80 offen offset:0
    v_mfma_f32_16x16x32_bf16 a[232:235], v[144:147], a[40:43], a[232:235]
    v_mfma_f32_16x16x32_bf16 a[236:239], v[144:147], a[44:47], a[236:239]
    s_waitcnt vmcnt(10) lgkmcnt(0)
    v_mfma_f32_16x16x32_bf16 a[200:203], v[108:111], a[48:51], a[200:203]
    ds_read_b128 v[128:131], v103 offset:57344
    v_mfma_f32_16x16x32_bf16 a[204:207], v[108:111], a[52:55], a[204:207]
    ds_read_b128 v[132:135], v103 offset:59392
    v_mfma_f32_16x16x32_bf16 a[208:211], v[112:115], a[48:51], a[208:211]
    ds_read_b128 v[136:139], v103 offset:61440
    v_mfma_f32_16x16x32_bf16 a[212:215], v[112:115], a[52:55], a[212:215]
    ds_read_b128 v[140:143], v103 offset:63488
    v_mfma_f32_16x16x32_bf16 a[216:219], v[116:119], a[48:51], a[216:219]
    ds_read_b128 v[144:147], v107 offset:0
    v_mfma_f32_16x16x32_bf16 a[220:223], v[116:119], a[52:55], a[220:223]
    buffer_load_dwordx4 a[96:99], v41, s[52:55], s80 offen offset:1024
    v_mfma_f32_16x16x32_bf16 a[224:227], v[120:123], a[48:51], a[224:227]
    buffer_load_dwordx4 a[100:103], v42, s[52:55], s80 offen offset:0
    v_mfma_f32_16x16x32_bf16 a[228:231], v[120:123], a[52:55], a[228:231]
    v_mfma_f32_16x16x32_bf16 a[232:235], v[124:127], a[48:51], a[232:235]
    buffer_load_dwordx4 v22, s[44:47], s81 offen offset:2048 lds
    v_mfma_f32_16x16x32_bf16 a[236:239], v[124:127], a[52:55], a[236:239]
    s_waitcnt vmcnt(11) lgkmcnt(0)
    v_mfma_f32_16x16x32_bf16 a[200:203], v[128:131], a[56:59], a[200:203]
    ds_read_b128 v[108:111], v96 offset:0
    v_mfma_f32_16x16x32_bf16 a[204:207], v[128:131], a[60:63], a[204:207]
    ds_read_b128 v[112:115], v96 offset:2048
    v_mfma_f32_16x16x32_bf16 a[208:211], v[132:135], a[56:59], a[208:211]
    ds_read_b128 v[116:119], v96 offset:4096
    v_mfma_f32_16x16x32_bf16 a[212:215], v[132:135], a[60:63], a[212:215]
    ds_read_b128 v[120:123], v96 offset:6144
    v_mfma_f32_16x16x32_bf16 a[216:219], v[136:139], a[56:59], a[216:219]
    ds_read_b128 v[124:127], v96 offset:8192
    v_mfma_f32_16x16x32_bf16 a[220:223], v[136:139], a[60:63], a[220:223]
    buffer_load_dwordx4 a[104:107], v42, s[52:55], s80 offen offset:1024
    v_mfma_f32_16x16x32_bf16 a[224:227], v[140:143], a[56:59], a[224:227]
    buffer_load_dwordx4 a[108:111], v43, s[52:55], s80 offen offset:0
    v_mfma_f32_16x16x32_bf16 a[228:231], v[140:143], a[60:63], a[228:231]
    v_mfma_f32_16x16x32_bf16 a[232:235], v[144:147], a[56:59], a[232:235]
    buffer_load_dwordx4 v23, s[44:47], s81 offen offset:3072 lds
    v_mfma_f32_16x16x32_bf16 a[236:239], v[144:147], a[60:63], a[236:239]
    s_waitcnt vmcnt(12) lgkmcnt(0)
    v_mfma_f32_16x16x32_bf16 a[200:203], v[108:111], a[64:67], a[200:203]
    ds_read_b128 v[128:131], v97 offset:0
    v_mfma_f32_16x16x32_bf16 a[204:207], v[108:111], a[68:71], a[204:207]
    ds_read_b128 v[132:135], v97 offset:2048
    v_mfma_f32_16x16x32_bf16 a[208:211], v[112:115], a[64:67], a[208:211]
    ds_read_b128 v[136:139], v97 offset:4096
    v_mfma_f32_16x16x32_bf16 a[212:215], v[112:115], a[68:71], a[212:215]
    ds_read_b128 v[140:143], v97 offset:6144
    v_mfma_f32_16x16x32_bf16 a[216:219], v[116:119], a[64:67], a[216:219]
    ds_read_b128 v[144:147], v97 offset:8192
    v_mfma_f32_16x16x32_bf16 a[220:223], v[116:119], a[68:71], a[220:223]
    buffer_load_dwordx4 a[112:115], v44, s[52:55], s80 offen offset:0
    v_mfma_f32_16x16x32_bf16 a[224:227], v[120:123], a[64:67], a[224:227]
    buffer_load_dwordx4 a[116:119], v44, s[52:55], s80 offen offset:1024
    v_mfma_f32_16x16x32_bf16 a[228:231], v[120:123], a[68:71], a[228:231]
    v_mfma_f32_16x16x32_bf16 a[232:235], v[124:127], a[64:67], a[232:235]
    s_add_u32 m0, s98, 147456
    s_nop 0
    buffer_load_dwordx4 v24, s[44:47], s81 offen offset:0 lds
    v_mfma_f32_16x16x32_bf16 a[236:239], v[124:127], a[68:71], a[236:239]
    s_waitcnt vmcnt(13) lgkmcnt(0)
    v_mfma_f32_16x16x32_bf16 a[200:203], v[128:131], a[72:75], a[200:203]
    ds_read_b128 v[108:111], v98 offset:0
    v_mfma_f32_16x16x32_bf16 a[204:207], v[128:131], a[76:79], a[204:207]
    ds_read_b128 v[112:115], v98 offset:2048
    v_mfma_f32_16x16x32_bf16 a[208:211], v[132:135], a[72:75], a[208:211]
    ds_read_b128 v[116:119], v98 offset:4096
    v_mfma_f32_16x16x32_bf16 a[212:215], v[132:135], a[76:79], a[212:215]
    ds_read_b128 v[120:123], v98 offset:6144
    v_mfma_f32_16x16x32_bf16 a[216:219], v[136:139], a[72:75], a[216:219]
    ds_read_b128 v[124:127], v98 offset:8192
    v_mfma_f32_16x16x32_bf16 a[220:223], v[136:139], a[76:79], a[220:223]
    s_add_u32 s80, s78, 3
    s_and_b32 s80, s80, 7
    s_mul_i32 s80, s80, 20480
    buffer_load_dwordx4 a[120:123], v39, s[52:55], s80 offen offset:0
    v_mfma_f32_16x16x32_bf16 a[224:227], v[140:143], a[72:75], a[224:227]
    v_mfma_f32_16x16x32_bf16 a[228:231], v[140:143], a[76:79], a[228:231]
    buffer_load_dwordx4 a[124:127], v39, s[52:55], s80 offen offset:1024
    v_mfma_f32_16x16x32_bf16 a[232:235], v[144:147], a[72:75], a[232:235]
    v_mfma_f32_16x16x32_bf16 a[236:239], v[144:147], a[76:79], a[236:239]
    s_waitcnt vmcnt(13) lgkmcnt(0)
    v_mfma_f32_16x16x32_bf16 a[200:203], v[108:111], a[80:83], a[200:203]
    ds_read_b128 v[128:131], v99 offset:0
    v_mfma_f32_16x16x32_bf16 a[204:207], v[108:111], a[84:87], a[204:207]
    ds_read_b128 v[132:135], v99 offset:2048
    v_mfma_f32_16x16x32_bf16 a[208:211], v[112:115], a[80:83], a[208:211]
    ds_read_b128 v[136:139], v99 offset:4096
    v_mfma_f32_16x16x32_bf16 a[212:215], v[112:115], a[84:87], a[212:215]
    ds_read_b128 v[140:143], v99 offset:6144
    v_mfma_f32_16x16x32_bf16 a[216:219], v[116:119], a[80:83], a[216:219]
    ds_read_b128 v[144:147], v99 offset:8192
    v_mfma_f32_16x16x32_bf16 a[220:223], v[116:119], a[84:87], a[220:223]
    buffer_load_dwordx4 a[128:131], v40, s[52:55], s80 offen offset:0
    v_mfma_f32_16x16x32_bf16 a[224:227], v[120:123], a[80:83], a[224:227]
    v_mfma_f32_16x16x32_bf16 a[228:231], v[120:123], a[84:87], a[228:231]
    buffer_load_dwordx4 a[132:135], v41, s[52:55], s80 offen offset:0
    v_mfma_f32_16x16x32_bf16 a[232:235], v[124:127], a[80:83], a[232:235]
    v_mfma_f32_16x16x32_bf16 a[236:239], v[124:127], a[84:87], a[236:239]
    s_waitcnt lgkmcnt(0)
    s_barrier
    s_waitcnt vmcnt(13)
    v_mfma_f32_16x16x32_bf16 a[200:203], v[128:131], a[88:91], a[200:203]
    ds_read_b128 v[108:111], v96 offset:20480
    v_mfma_f32_16x16x32_bf16 a[204:207], v[128:131], a[92:95], a[204:207]
    ds_read_b128 v[112:115], v96 offset:22528
    v_mfma_f32_16x16x32_bf16 a[208:211], v[132:135], a[88:91], a[208:211]
    ds_read_b128 v[116:119], v96 offset:24576
    v_mfma_f32_16x16x32_bf16 a[212:215], v[132:135], a[92:95], a[212:215]
    ds_read_b128 v[120:123], v96 offset:26624
    v_mfma_f32_16x16x32_bf16 a[216:219], v[136:139], a[88:91], a[216:219]
    ds_read_b128 v[124:127], v96 offset:28672
    v_mfma_f32_16x16x32_bf16 a[220:223], v[136:139], a[92:95], a[220:223]
    buffer_load_dwordx4 a[136:139], v41, s[52:55], s80 offen offset:1024
    v_mfma_f32_16x16x32_bf16 a[224:227], v[140:143], a[88:91], a[224:227]
    buffer_load_dwordx4 a[140:143], v42, s[52:55], s80 offen offset:0
    v_mfma_f32_16x16x32_bf16 a[228:231], v[140:143], a[92:95], a[228:231]
    v_mfma_f32_16x16x32_bf16 a[232:235], v[144:147], a[88:91], a[232:235]
    s_add_u32 m0, s98, 122880
    s_add_u32 s81, s90, 8
    s_sub_u32 s101, s81, 10
    s_cselect_b32 s81, s81, s101
    s_lshl_b32 s81, s81, 7
    buffer_load_dwordx4 v20, s[44:47], s81 offen offset:0 lds
    v_mfma_f32_16x16x32_bf16 a[236:239], v[144:147], a[92:95], a[236:239]
    s_waitcnt vmcnt(14) lgkmcnt(0)
    v_mfma_f32_16x16x32_bf16 a[200:203], v[108:111], a[96:99], a[200:203]
    ds_read_b128 v[128:131], v97 offset:20480
    v_mfma_f32_16x16x32_bf16 a[204:207], v[108:111], a[100:103], a[204:207]
    ds_read_b128 v[132:135], v97 offset:22528
    v_mfma_f32_16x16x32_bf16 a[208:211], v[112:115], a[96:99], a[208:211]
    ds_read_b128 v[136:139], v97 offset:24576
    v_mfma_f32_16x16x32_bf16 a[212:215], v[112:115], a[100:103], a[212:215]
    ds_read_b128 v[140:143], v97 offset:26624
    v_mfma_f32_16x16x32_bf16 a[216:219], v[116:119], a[96:99], a[216:219]
    ds_read_b128 v[144:147], v97 offset:28672
    v_mfma_f32_16x16x32_bf16 a[220:223], v[116:119], a[100:103], a[220:223]
    buffer_load_dwordx4 a[144:147], v42, s[52:55], s80 offen offset:1024
    v_mfma_f32_16x16x32_bf16 a[224:227], v[120:123], a[96:99], a[224:227]
    buffer_load_dwordx4 a[148:151], v43, s[52:55], s80 offen offset:0
    v_mfma_f32_16x16x32_bf16 a[228:231], v[120:123], a[100:103], a[228:231]
    v_mfma_f32_16x16x32_bf16 a[232:235], v[124:127], a[96:99], a[232:235]
    buffer_load_dwordx4 v21, s[44:47], s81 offen offset:1024 lds
    v_mfma_f32_16x16x32_bf16 a[236:239], v[124:127], a[100:103], a[236:239]
    s_waitcnt vmcnt(14) lgkmcnt(0)
    v_mfma_f32_16x16x32_bf16 a[200:203], v[128:131], a[104:107], a[200:203]
    ds_read_b128 v[108:111], v98 offset:20480
    v_mfma_f32_16x16x32_bf16 a[204:207], v[128:131], a[108:111], a[204:207]
    ds_read_b128 v[112:115], v98 offset:22528
    v_mfma_f32_16x16x32_bf16 a[208:211], v[132:135], a[104:107], a[208:211]
    ds_read_b128 v[116:119], v98 offset:24576
    v_mfma_f32_16x16x32_bf16 a[212:215], v[132:135], a[108:111], a[212:215]
    ds_read_b128 v[120:123], v98 offset:26624
    v_mfma_f32_16x16x32_bf16 a[216:219], v[136:139], a[104:107], a[216:219]
    ds_read_b128 v[124:127], v98 offset:28672
    v_mfma_f32_16x16x32_bf16 a[220:223], v[136:139], a[108:111], a[220:223]
    buffer_load_dwordx4 a[152:155], v44, s[52:55], s80 offen offset:0
    v_mfma_f32_16x16x32_bf16 a[224:227], v[140:143], a[104:107], a[224:227]
    v_mfma_f32_16x16x32_bf16 a[228:231], v[140:143], a[108:111], a[228:231]
    buffer_load_dwordx4 a[156:159], v44, s[52:55], s80 offen offset:1024
    v_mfma_f32_16x16x32_bf16 a[232:235], v[144:147], a[104:107], a[232:235]
    v_mfma_f32_16x16x32_bf16 a[236:239], v[144:147], a[108:111], a[236:239]
    s_waitcnt vmcnt(13) lgkmcnt(0)
    v_mfma_f32_16x16x32_bf16 a[200:203], v[108:111], a[112:115], a[200:203]
    ds_read_b128 v[128:131], v99 offset:20480
    v_mfma_f32_16x16x32_bf16 a[204:207], v[108:111], a[116:119], a[204:207]
    ds_read_b128 v[132:135], v99 offset:22528
    v_mfma_f32_16x16x32_bf16 a[208:211], v[112:115], a[112:115], a[208:211]
    ds_read_b128 v[136:139], v99 offset:24576
    v_mfma_f32_16x16x32_bf16 a[212:215], v[112:115], a[116:119], a[212:215]
    ds_read_b128 v[140:143], v99 offset:26624
    v_mfma_f32_16x16x32_bf16 a[216:219], v[116:119], a[112:115], a[216:219]
    ds_read_b128 v[144:147], v99 offset:28672
    v_mfma_f32_16x16x32_bf16 a[220:223], v[116:119], a[116:119], a[220:223]
    s_add_u32 s80, s78, 4
    s_and_b32 s80, s80, 7
    s_mul_i32 s80, s80, 20480
    buffer_load_dwordx4 a[160:163], v39, s[52:55], s80 offen offset:0
    v_mfma_f32_16x16x32_bf16 a[224:227], v[120:123], a[112:115], a[224:227]
    buffer_load_dwordx4 a[164:167], v39, s[52:55], s80 offen offset:1024
    v_mfma_f32_16x16x32_bf16 a[228:231], v[120:123], a[116:119], a[228:231]
    v_mfma_f32_16x16x32_bf16 a[232:235], v[124:127], a[112:115], a[232:235]
    buffer_load_dwordx4 v22, s[44:47], s81 offen offset:2048 lds
    v_mfma_f32_16x16x32_bf16 a[236:239], v[124:127], a[116:119], a[236:239]
    s_waitcnt vmcnt(13) lgkmcnt(0)
    v_mfma_f32_16x16x32_bf16 a[200:203], v[128:131], a[120:123], a[200:203]
    ds_read_b128 v[108:111], v96 offset:40960
    v_mfma_f32_16x16x32_bf16 a[204:207], v[128:131], a[124:127], a[204:207]
    ds_read_b128 v[112:115], v96 offset:43008
    v_mfma_f32_16x16x32_bf16 a[208:211], v[132:135], a[120:123], a[208:211]
    ds_read_b128 v[116:119], v96 offset:45056
    v_mfma_f32_16x16x32_bf16 a[212:215], v[132:135], a[124:127], a[212:215]
    ds_read_b128 v[120:123], v96 offset:47104
    v_mfma_f32_16x16x32_bf16 a[216:219], v[136:139], a[120:123], a[216:219]
    ds_read_b128 v[124:127], v96 offset:49152
    v_mfma_f32_16x16x32_bf16 a[220:223], v[136:139], a[124:127], a[220:223]
    buffer_load_dwordx4 a[168:171], v40, s[52:55], s80 offen offset:0
    v_mfma_f32_16x16x32_bf16 a[224:227], v[140:143], a[120:123], a[224:227]
    v_mfma_f32_16x16x32_bf16 a[228:231], v[140:143], a[124:127], a[228:231]
    buffer_load_dwordx4 a[172:175], v41, s[52:55], s80 offen offset:0
    v_mfma_f32_16x16x32_bf16 a[232:235], v[144:147], a[120:123], a[232:235]
    v_mfma_f32_16x16x32_bf16 a[236:239], v[144:147], a[124:127], a[236:239]
    s_waitcnt vmcnt(13) lgkmcnt(0)
    v_mfma_f32_16x16x32_bf16 a[200:203], v[108:111], a[128:131], a[200:203]
    ds_read_b128 v[128:131], v97 offset:40960
    v_mfma_f32_16x16x32_bf16 a[204:207], v[108:111], a[132:135], a[204:207]
    ds_read_b128 v[132:135], v97 offset:43008
    v_mfma_f32_16x16x32_bf16 a[208:211], v[112:115], a[128:131], a[208:211]
    ds_read_b128 v[136:139], v97 offset:45056
    v_mfma_f32_16x16x32_bf16 a[212:215], v[112:115], a[132:135], a[212:215]
    ds_read_b128 v[140:143], v97 offset:47104
    v_mfma_f32_16x16x32_bf16 a[216:219], v[116:119], a[128:131], a[216:219]
    ds_read_b128 v[144:147], v97 offset:49152
    v_mfma_f32_16x16x32_bf16 a[220:223], v[116:119], a[132:135], a[220:223]
    buffer_load_dwordx4 a[176:179], v41, s[52:55], s80 offen offset:1024
    v_mfma_f32_16x16x32_bf16 a[224:227], v[120:123], a[128:131], a[224:227]
    buffer_load_dwordx4 a[180:183], v42, s[52:55], s80 offen offset:0
    v_mfma_f32_16x16x32_bf16 a[228:231], v[120:123], a[132:135], a[228:231]
    v_mfma_f32_16x16x32_bf16 a[232:235], v[124:127], a[128:131], a[232:235]
    buffer_load_dwordx4 v23, s[44:47], s81 offen offset:3072 lds
    v_mfma_f32_16x16x32_bf16 a[236:239], v[124:127], a[132:135], a[236:239]
    s_waitcnt vmcnt(14) lgkmcnt(0)
    v_mfma_f32_16x16x32_bf16 a[200:203], v[128:131], a[136:139], a[200:203]
    ds_read_b128 v[108:111], v98 offset:40960
    v_mfma_f32_16x16x32_bf16 a[204:207], v[128:131], a[140:143], a[204:207]
    ds_read_b128 v[112:115], v98 offset:43008
    v_mfma_f32_16x16x32_bf16 a[208:211], v[132:135], a[136:139], a[208:211]
    ds_read_b128 v[116:119], v98 offset:45056
    v_mfma_f32_16x16x32_bf16 a[212:215], v[132:135], a[140:143], a[212:215]
    ds_read_b128 v[120:123], v98 offset:47104
    v_mfma_f32_16x16x32_bf16 a[216:219], v[136:139], a[136:139], a[216:219]
    ds_read_b128 v[124:127], v98 offset:49152
    v_mfma_f32_16x16x32_bf16 a[220:223], v[136:139], a[140:143], a[220:223]
    buffer_load_dwordx4 a[184:187], v42, s[52:55], s80 offen offset:1024
    v_mfma_f32_16x16x32_bf16 a[224:227], v[140:143], a[136:139], a[224:227]
    buffer_load_dwordx4 a[188:191], v43, s[52:55], s80 offen offset:0
    v_mfma_f32_16x16x32_bf16 a[228:231], v[140:143], a[140:143], a[228:231]
    v_mfma_f32_16x16x32_bf16 a[232:235], v[144:147], a[136:139], a[232:235]
    s_add_u32 m0, s98, 126976
    s_nop 0
    buffer_load_dwordx4 v24, s[44:47], s81 offen offset:0 lds
    v_mfma_f32_16x16x32_bf16 a[236:239], v[144:147], a[140:143], a[236:239]
    s_waitcnt vmcnt(14) lgkmcnt(0)
    v_mfma_f32_16x16x32_bf16 a[200:203], v[108:111], a[144:147], a[200:203]
    ds_read_b128 v[128:131], v99 offset:40960
    v_mfma_f32_16x16x32_bf16 a[204:207], v[108:111], a[148:151], a[204:207]
    ds_read_b128 v[132:135], v99 offset:43008
    v_mfma_f32_16x16x32_bf16 a[208:211], v[112:115], a[144:147], a[208:211]
    ds_read_b128 v[136:139], v99 offset:45056
    v_mfma_f32_16x16x32_bf16 a[212:215], v[112:115], a[148:151], a[212:215]
    ds_read_b128 v[140:143], v99 offset:47104
    v_mfma_f32_16x16x32_bf16 a[216:219], v[116:119], a[144:147], a[216:219]
    ds_read_b128 v[144:147], v99 offset:49152
    v_mfma_f32_16x16x32_bf16 a[220:223], v[116:119], a[148:151], a[220:223]
    buffer_load_dwordx4 a[192:195], v44, s[52:55], s80 offen offset:0
    v_mfma_f32_16x16x32_bf16 a[224:227], v[120:123], a[144:147], a[224:227]
    v_mfma_f32_16x16x32_bf16 a[228:231], v[120:123], a[148:151], a[228:231]
    buffer_load_dwordx4 a[196:199], v44, s[52:55], s80 offen offset:1024
    v_mfma_f32_16x16x32_bf16 a[232:235], v[124:127], a[144:147], a[232:235]
    v_mfma_f32_16x16x32_bf16 a[236:239], v[124:127], a[148:151], a[236:239]
    s_barrier
    s_waitcnt vmcnt(13) lgkmcnt(0)
    v_mfma_f32_16x16x32_bf16 a[200:203], v[128:131], a[152:155], a[200:203]
    ds_read_b128 v[108:111], v96 offset:61440
    v_mfma_f32_16x16x32_bf16 a[204:207], v[128:131], a[156:159], a[204:207]
    ds_read_b128 v[112:115], v96 offset:63488
    v_mfma_f32_16x16x32_bf16 a[208:211], v[132:135], a[152:155], a[208:211]
    ds_read_b128 v[116:119], v100 offset:0
    v_mfma_f32_16x16x32_bf16 a[212:215], v[132:135], a[156:159], a[212:215]
    ds_read_b128 v[120:123], v100 offset:2048
    v_mfma_f32_16x16x32_bf16 a[216:219], v[136:139], a[152:155], a[216:219]
    ds_read_b128 v[124:127], v100 offset:4096
    v_mfma_f32_16x16x32_bf16 a[220:223], v[136:139], a[156:159], a[220:223]
    s_add_u32 s80, s78, 5
    s_and_b32 s80, s80, 7
    s_mul_i32 s80, s80, 20480
    buffer_load_dwordx4 a[0:3], v39, s[52:55], s80 offen offset:0
    v_mfma_f32_16x16x32_bf16 a[224:227], v[140:143], a[152:155], a[224:227]
    buffer_load_dwordx4 a[4:7], v39, s[52:55], s80 offen offset:1024
    v_mfma_f32_16x16x32_bf16 a[228:231], v[140:143], a[156:159], a[228:231]
    v_mfma_f32_16x16x32_bf16 a[232:235], v[144:147], a[152:155], a[232:235]
    s_add_u32 m0, s98, 0
    s_add_u32 s81, s90, 9
    s_sub_u32 s101, s81, 10
    s_cselect_b32 s81, s81, s101
    s_lshl_b32 s81, s81, 7
    buffer_load_dwordx4 v20, s[44:47], s81 offen offset:0 lds
    v_mfma_f32_16x16x32_bf16 a[236:239], v[144:147], a[156:159], a[236:239]
    s_waitcnt vmcnt(14) lgkmcnt(0)
    v_mfma_f32_16x16x32_bf16 a[200:203], v[108:111], a[160:163], a[200:203]
    ds_read_b128 v[128:131], v97 offset:61440
    v_mfma_f32_16x16x32_bf16 a[204:207], v[108:111], a[164:167], a[204:207]
    ds_read_b128 v[132:135], v97 offset:63488
    v_mfma_f32_16x16x32_bf16 a[208:211], v[112:115], a[160:163], a[208:211]
    ds_read_b128 v[136:139], v101 offset:0
    v_mfma_f32_16x16x32_bf16 a[212:215], v[112:115], a[164:167], a[212:215]
    ds_read_b128 v[140:143], v101 offset:2048
    v_mfma_f32_16x16x32_bf16 a[216:219], v[116:119], a[160:163], a[216:219]
    ds_read_b128 v[144:147], v101 offset:4096
    v_mfma_f32_16x16x32_bf16 a[220:223], v[116:119], a[164:167], a[220:223]
    buffer_load_dwordx4 a[8:11], v40, s[52:55], s80 offen offset:0
    v_mfma_f32_16x16x32_bf16 a[224:227], v[120:123], a[160:163], a[224:227]
    v_mfma_f32_16x16x32_bf16 a[228:231], v[120:123], a[164:167], a[228:231]
    buffer_load_dwordx4 a[12:15], v41, s[52:55], s80 offen offset:0
    v_mfma_f32_16x16x32_bf16 a[232:235], v[124:127], a[160:163], a[232:235]
    v_mfma_f32_16x16x32_bf16 a[236:239], v[124:127], a[164:167], a[236:239]
    s_waitcnt vmcnt(13) lgkmcnt(0)
    v_mfma_f32_16x16x32_bf16 a[200:203], v[128:131], a[168:171], a[200:203]
    ds_read_b128 v[108:111], v98 offset:61440
    v_mfma_f32_16x16x32_bf16 a[204:207], v[128:131], a[172:175], a[204:207]
    ds_read_b128 v[112:115], v98 offset:63488
    v_mfma_f32_16x16x32_bf16 a[208:211], v[132:135], a[168:171], a[208:211]
    ds_read_b128 v[116:119], v102 offset:0
    v_mfma_f32_16x16x32_bf16 a[212:215], v[132:135], a[172:175], a[212:215]
    ds_read_b128 v[120:123], v102 offset:2048
    v_mfma_f32_16x16x32_bf16 a[216:219], v[136:139], a[168:171], a[216:219]
    ds_read_b128 v[124:127], v102 offset:4096
    v_mfma_f32_16x16x32_bf16 a[220:223], v[136:139], a[172:175], a[220:223]
    buffer_load_dwordx4 a[16:19], v41, s[52:55], s80 offen offset:1024
    v_mfma_f32_16x16x32_bf16 a[224:227], v[140:143], a[168:171], a[224:227]
    buffer_load_dwordx4 a[20:23], v42, s[52:55], s80 offen offset:0
    v_mfma_f32_16x16x32_bf16 a[228:231], v[140:143], a[172:175], a[228:231]
    v_mfma_f32_16x16x32_bf16 a[232:235], v[144:147], a[168:171], a[232:235]
    buffer_load_dwordx4 v21, s[44:47], s81 offen offset:1024 lds
    v_mfma_f32_16x16x32_bf16 a[236:239], v[144:147], a[172:175], a[236:239]
    s_waitcnt vmcnt(14) lgkmcnt(0)
    v_mfma_f32_16x16x32_bf16 a[200:203], v[108:111], a[176:179], a[200:203]
    ds_read_b128 v[128:131], v99 offset:61440
    v_mfma_f32_16x16x32_bf16 a[204:207], v[108:111], a[180:183], a[204:207]
    ds_read_b128 v[132:135], v99 offset:63488
    v_mfma_f32_16x16x32_bf16 a[208:211], v[112:115], a[176:179], a[208:211]
    ds_read_b128 v[136:139], v103 offset:0
    v_mfma_f32_16x16x32_bf16 a[212:215], v[112:115], a[180:183], a[212:215]
    ds_read_b128 v[140:143], v103 offset:2048
    v_mfma_f32_16x16x32_bf16 a[216:219], v[116:119], a[176:179], a[216:219]
    ds_read_b128 v[144:147], v103 offset:4096
    v_mfma_f32_16x16x32_bf16 a[220:223], v[116:119], a[180:183], a[220:223]
    buffer_load_dwordx4 a[24:27], v42, s[52:55], s80 offen offset:1024
    v_mfma_f32_16x16x32_bf16 a[224:227], v[120:123], a[176:179], a[224:227]
    buffer_load_dwordx4 a[28:31], v43, s[52:55], s80 offen offset:0
    v_mfma_f32_16x16x32_bf16 a[228:231], v[120:123], a[180:183], a[228:231]
    v_mfma_f32_16x16x32_bf16 a[232:235], v[124:127], a[176:179], a[232:235]
    buffer_load_dwordx4 v22, s[44:47], s81 offen offset:2048 lds
    v_mfma_f32_16x16x32_bf16 a[236:239], v[124:127], a[180:183], a[236:239]
    s_waitcnt vmcnt(14) lgkmcnt(0)
    v_mfma_f32_16x16x32_bf16 a[200:203], v[128:131], a[184:187], a[200:203]
    ds_read_b128 v[108:111], v100 offset:16384
    v_mfma_f32_16x16x32_bf16 a[204:207], v[128:131], a[188:191], a[204:207]
    ds_read_b128 v[112:115], v100 offset:18432
    v_mfma_f32_16x16x32_bf16 a[208:211], v[132:135], a[184:187], a[208:211]
    ds_read_b128 v[116:119], v100 offset:20480
    v_mfma_f32_16x16x32_bf16 a[212:215], v[132:135], a[188:191], a[212:215]
    ds_read_b128 v[120:123], v100 offset:22528
    v_mfma_f32_16x16x32_bf16 a[216:219], v[136:139], a[184:187], a[216:219]
    ds_read_b128 v[124:127], v100 offset:24576
    v_mfma_f32_16x16x32_bf16 a[220:223], v[136:139], a[188:191], a[220:223]
    buffer_load_dwordx4 a[32:35], v44, s[52:55], s80 offen offset:0
    v_mfma_f32_16x16x32_bf16 a[224:227], v[140:143], a[184:187], a[224:227]
    v_mfma_f32_16x16x32_bf16 a[228:231], v[140:143], a[188:191], a[228:231]
    buffer_load_dwordx4 a[36:39], v44, s[52:55], s80 offen offset:1024
    v_mfma_f32_16x16x32_bf16 a[232:235], v[144:147], a[184:187], a[232:235]
    v_mfma_f32_16x16x32_bf16 a[236:239], v[144:147], a[188:191], a[236:239]
    s_waitcnt vmcnt(13) lgkmcnt(0)
    v_mfma_f32_16x16x32_bf16 a[200:203], v[108:111], a[192:195], a[200:203]
    ds_read_b128 v[128:131], v101 offset:16384
    v_mfma_f32_16x16x32_bf16 a[204:207], v[108:111], a[196:199], a[204:207]
    ds_read_b128 v[132:135], v101 offset:18432
    v_mfma_f32_16x16x32_bf16 a[208:211], v[112:115], a[192:195], a[208:211]
    ds_read_b128 v[136:139], v101 offset:20480
    v_mfma_f32_16x16x32_bf16 a[212:215], v[112:115], a[196:199], a[212:215]
    ds_read_b128 v[140:143], v101 offset:22528
    v_mfma_f32_16x16x32_bf16 a[216:219], v[116:119], a[192:195], a[216:219]
    ds_read_b128 v[144:147], v101 offset:24576
    v_mfma_f32_16x16x32_bf16 a[220:223], v[116:119], a[196:199], a[220:223]
    s_add_u32 s80, s78, 6
    s_and_b32 s80, s80, 7
    s_mul_i32 s80, s80, 20480
    buffer_load_dwordx4 a[40:43], v39, s[52:55], s80 offen offset:0
    v_mfma_f32_16x16x32_bf16 a[224:227], v[120:123], a[192:195], a[224:227]
    buffer_load_dwordx4 a[44:47], v39, s[52:55], s80 offen offset:1024
    v_mfma_f32_16x16x32_bf16 a[228:231], v[120:123], a[196:199], a[228:231]
    v_mfma_f32_16x16x32_bf16 a[232:235], v[124:127], a[192:195], a[232:235]
    buffer_load_dwordx4 v23, s[44:47], s81 offen offset:3072 lds
    v_mfma_f32_16x16x32_bf16 a[236:239], v[124:127], a[196:199], a[236:239]
    s_waitcnt vmcnt(14) lgkmcnt(0)
    v_mfma_f32_16x16x32_bf16 a[200:203], v[128:131], a[0:3], a[200:203]
    ds_read_b128 v[108:111], v102 offset:16384
    v_mfma_f32_16x16x32_bf16 a[204:207], v[128:131], a[4:7], a[204:207]
    ds_read_b128 v[112:115], v102 offset:18432
    v_mfma_f32_16x16x32_bf16 a[208:211], v[132:135], a[0:3], a[208:211]
    ds_read_b128 v[116:119], v102 offset:20480
    v_mfma_f32_16x16x32_bf16 a[212:215], v[132:135], a[4:7], a[212:215]
    ds_read_b128 v[120:123], v102 offset:22528
    v_mfma_f32_16x16x32_bf16 a[216:219], v[136:139], a[0:3], a[216:219]
    ds_read_b128 v[124:127], v102 offset:24576
    v_mfma_f32_16x16x32_bf16 a[220:223], v[136:139], a[4:7], a[220:223]
    buffer_load_dwordx4 a[48:51], v40, s[52:55], s80 offen offset:0
    v_mfma_f32_16x16x32_bf16 a[224:227], v[140:143], a[0:3], a[224:227]
    v_mfma_f32_16x16x32_bf16 a[228:231], v[140:143], a[4:7], a[228:231]
    buffer_load_dwordx4 a[52:55], v41, s[52:55], s80 offen offset:0
    v_mfma_f32_16x16x32_bf16 a[232:235], v[144:147], a[0:3], a[232:235]
    v_mfma_f32_16x16x32_bf16 a[236:239], v[144:147], a[4:7], a[236:239]
    s_waitcnt vmcnt(13) lgkmcnt(0)
    v_mfma_f32_16x16x32_bf16 a[200:203], v[108:111], a[8:11], a[200:203]
    ds_read_b128 v[128:131], v103 offset:16384
    v_mfma_f32_16x16x32_bf16 a[204:207], v[108:111], a[12:15], a[204:207]
    ds_read_b128 v[132:135], v103 offset:18432
    v_mfma_f32_16x16x32_bf16 a[208:211], v[112:115], a[8:11], a[208:211]
    ds_read_b128 v[136:139], v103 offset:20480
    v_mfma_f32_16x16x32_bf16 a[212:215], v[112:115], a[12:15], a[212:215]
    ds_read_b128 v[140:143], v103 offset:22528
    v_mfma_f32_16x16x32_bf16 a[216:219], v[116:119], a[8:11], a[216:219]
    ds_read_b128 v[144:147], v103 offset:24576
    v_mfma_f32_16x16x32_bf16 a[220:223], v[116:119], a[12:15], a[220:223]
    buffer_load_dwordx4 a[56:59], v41, s[52:55], s80 offen offset:1024
    v_mfma_f32_16x16x32_bf16 a[224:227], v[120:123], a[8:11], a[224:227]
    buffer_load_dwordx4 a[60:63], v42, s[52:55], s80 offen offset:0
    v_mfma_f32_16x16x32_bf16 a[228:231], v[120:123], a[12:15], a[228:231]
    v_mfma_f32_16x16x32_bf16 a[232:235], v[124:127], a[8:11], a[232:235]
    s_add_u32 m0, s98, 4096
    s_nop 0
    buffer_load_dwordx4 v24, s[44:47], s81 offen offset:0 lds
    v_mfma_f32_16x16x32_bf16 a[236:239], v[124:127], a[12:15], a[236:239]
    s_waitcnt vmcnt(14) lgkmcnt(0)
    v_mfma_f32_16x16x32_bf16 a[200:203], v[128:131], a[16:19], a[200:203]
    ds_read_b128 v[108:111], v104 offset:12288
    v_mfma_f32_16x16x32_bf16 a[204:207], v[128:131], a[20:23], a[204:207]
    ds_read_b128 v[112:115], v104 offset:14336
    v_mfma_f32_16x16x32_bf16 a[208:211], v[132:135], a[16:19], a[208:211]
    ds_read_b128 v[116:119], v104 offset:16384
    v_mfma_f32_16x16x32_bf16 a[212:215], v[132:135], a[20:23], a[212:215]
    ds_read_b128 v[120:123], v104 offset:18432
    v_mfma_f32_16x16x32_bf16 a[216:219], v[136:139], a[16:19], a[216:219]
    ds_read_b128 v[124:127], v104 offset:20480
    v_mfma_f32_16x16x32_bf16 a[220:223], v[136:139], a[20:23], a[220:223]
    buffer_load_dwordx4 a[64:67], v42, s[52:55], s80 offen offset:1024
    v_mfma_f32_16x16x32_bf16 a[224:227], v[140:143], a[16:19], a[224:227]
    v_mfma_f32_16x16x32_bf16 a[228:231], v[140:143], a[20:23], a[228:231]
    buffer_load_dwordx4 a[68:71], v43, s[52:55], s80 offen offset:0
    v_mfma_f32_16x16x32_bf16 a[232:235], v[144:147], a[16:19], a[232:235]
    v_mfma_f32_16x16x32_bf16 a[236:239], v[144:147], a[20:23], a[236:239]
    s_waitcnt vmcnt(13) lgkmcnt(0)
    v_mfma_f32_16x16x32_bf16 a[200:203], v[108:111], a[24:27], a[200:203]
    ds_read_b128 v[128:131], v105 offset:12288
    v_mfma_f32_16x16x32_bf16 a[204:207], v[108:111], a[28:31], a[204:207]
    ds_read_b128 v[132:135], v105 offset:14336
    v_mfma_f32_16x16x32_bf16 a[208:211], v[112:115], a[24:27], a[208:211]
    ds_read_b128 v[136:139], v105 offset:16384
    v_mfma_f32_16x16x32_bf16 a[212:215], v[112:115], a[28:31], a[212:215]
    ds_read_b128 v[140:143], v105 offset:18432
    v_mfma_f32_16x16x32_bf16 a[216:219], v[116:119], a[24:27], a[216:219]
    ds_read_b128 v[144:147], v105 offset:20480
    v_mfma_f32_16x16x32_bf16 a[220:223], v[116:119], a[28:31], a[220:223]
    buffer_load_dwordx4 a[72:75], v44, s[52:55], s80 offen offset:0
    v_mfma_f32_16x16x32_bf16 a[224:227], v[120:123], a[24:27], a[224:227]
    v_mfma_f32_16x16x32_bf16 a[228:231], v[120:123], a[28:31], a[228:231]
    buffer_load_dwordx4 a[76:79], v44, s[52:55], s80 offen offset:1024
    v_mfma_f32_16x16x32_bf16 a[232:235], v[124:127], a[24:27], a[232:235]
    v_mfma_f32_16x16x32_bf16 a[236:239], v[124:127], a[28:31], a[236:239]
    s_waitcnt vmcnt(12) lgkmcnt(0)
    v_mfma_f32_16x16x32_bf16 a[200:203], v[128:131], a[32:35], a[200:203]
    ds_read_b128 v[108:111], v106 offset:12288
    v_mfma_f32_16x16x32_bf16 a[204:207], v[128:131], a[36:39], a[204:207]
    ds_read_b128 v[112:115], v106 offset:14336
    v_mfma_f32_16x16x32_bf16 a[208:211], v[132:135], a[32:35], a[208:211]
    ds_read_b128 v[116:119], v106 offset:16384
    v_mfma_f32_16x16x32_bf16 a[212:215], v[132:135], a[36:39], a[212:215]
    ds_read_b128 v[120:123], v106 offset:18432
    v_mfma_f32_16x16x32_bf16 a[216:219], v[136:139], a[32:35], a[216:219]
    ds_read_b128 v[124:127], v106 offset:20480
    v_mfma_f32_16x16x32_bf16 a[220:223], v[136:139], a[36:39], a[220:223]
    s_add_u32 s80, s78, 7
    s_and_b32 s80, s80, 7
    s_mul_i32 s80, s80, 20480
    buffer_load_dwordx4 a[80:83], v39, s[52:55], s80 offen offset:0
    v_mfma_f32_16x16x32_bf16 a[224:227], v[140:143], a[32:35], a[224:227]
    v_mfma_f32_16x16x32_bf16 a[228:231], v[140:143], a[36:39], a[228:231]
    buffer_load_dwordx4 a[84:87], v39, s[52:55], s80 offen offset:1024
    v_mfma_f32_16x16x32_bf16 a[232:235], v[144:147], a[32:35], a[232:235]
    v_mfma_f32_16x16x32_bf16 a[236:239], v[144:147], a[36:39], a[236:239]
    s_waitcnt vmcnt(12) lgkmcnt(0)
    v_mfma_f32_16x16x32_bf16 a[200:203], v[108:111], a[40:43], a[200:203]
    ds_read_b128 v[128:131], v107 offset:12288
    v_mfma_f32_16x16x32_bf16 a[204:207], v[108:111], a[44:47], a[204:207]
    ds_read_b128 v[132:135], v107 offset:14336
    v_mfma_f32_16x16x32_bf16 a[208:211], v[112:115], a[40:43], a[208:211]
    ds_read_b128 v[136:139], v107 offset:16384
    v_mfma_f32_16x16x32_bf16 a[212:215], v[112:115], a[44:47], a[212:215]
    ds_read_b128 v[140:143], v107 offset:18432
    v_mfma_f32_16x16x32_bf16 a[216:219], v[116:119], a[40:43], a[216:219]
    ds_read_b128 v[144:147], v107 offset:20480
    v_mfma_f32_16x16x32_bf16 a[220:223], v[116:119], a[44:47], a[220:223]
    buffer_load_dwordx4 a[88:91], v40, s[52:55], s80 offen offset:0
    v_mfma_f32_16x16x32_bf16 a[224:227], v[120:123], a[40:43], a[224:227]
    v_mfma_f32_16x16x32_bf16 a[228:231], v[120:123], a[44:47], a[228:231]
    buffer_load_dwordx4 a[92:95], v41, s[52:55], s80 offen offset:0
    v_mfma_f32_16x16x32_bf16 a[232:235], v[124:127], a[40:43], a[232:235]
    v_mfma_f32_16x16x32_bf16 a[236:239], v[124:127], a[44:47], a[236:239]
    s_waitcnt vmcnt(8)
    s_barrier
    s_waitcnt lgkmcnt(0)
    v_mfma_f32_16x16x32_bf16 a[200:203], v[128:131], a[48:51], a[200:203]
    ds_read_b128 v[108:111], v100 offset:57344
    v_mfma_f32_16x16x32_bf16 a[204:207], v[128:131], a[52:55], a[204:207]
    ds_read_b128 v[112:115], v100 offset:59392
    v_mfma_f32_16x16x32_bf16 a[208:211], v[132:135], a[48:51], a[208:211]
    ds_read_b128 v[116:119], v100 offset:61440
    v_mfma_f32_16x16x32_bf16 a[212:215], v[132:135], a[52:55], a[212:215]
    ds_read_b128 v[120:123], v100 offset:63488
    v_mfma_f32_16x16x32_bf16 a[216:219], v[136:139], a[48:51], a[216:219]
    ds_read_b128 v[124:127], v104 offset:0
    v_mfma_f32_16x16x32_bf16 a[220:223], v[136:139], a[52:55], a[220:223]
    buffer_load_dwordx4 a[96:99], v41, s[52:55], s80 offen offset:1024
    v_mfma_f32_16x16x32_bf16 a[224:227], v[140:143], a[48:51], a[224:227]
    v_mfma_f32_16x16x32_bf16 a[228:231], v[140:143], a[52:55], a[228:231]
    buffer_load_dwordx4 a[100:103], v42, s[52:55], s80 offen offset:0
    v_mfma_f32_16x16x32_bf16 a[232:235], v[144:147], a[48:51], a[232:235]
    v_mfma_f32_16x16x32_bf16 a[236:239], v[144:147], a[52:55], a[236:239]
    s_waitcnt lgkmcnt(0)
    v_mfma_f32_16x16x32_bf16 a[200:203], v[108:111], a[56:59], a[200:203]
    ds_read_b128 v[128:131], v101 offset:57344
    v_mfma_f32_16x16x32_bf16 a[204:207], v[108:111], a[60:63], a[204:207]
    ds_read_b128 v[132:135], v101 offset:59392
    v_mfma_f32_16x16x32_bf16 a[208:211], v[112:115], a[56:59], a[208:211]
    ds_read_b128 v[136:139], v101 offset:61440
    v_mfma_f32_16x16x32_bf16 a[212:215], v[112:115], a[60:63], a[212:215]
    ds_read_b128 v[140:143], v101 offset:63488
    v_mfma_f32_16x16x32_bf16 a[216:219], v[116:119], a[56:59], a[216:219]
    ds_read_b128 v[144:147], v105 offset:0
    v_mfma_f32_16x16x32_bf16 a[220:223], v[116:119], a[60:63], a[220:223]
    buffer_load_dwordx4 a[104:107], v42, s[52:55], s80 offen offset:1024
    v_mfma_f32_16x16x32_bf16 a[224:227], v[120:123], a[56:59], a[224:227]
    v_mfma_f32_16x16x32_bf16 a[228:231], v[120:123], a[60:63], a[228:231]
    buffer_load_dwordx4 a[108:111], v43, s[52:55], s80 offen offset:0
    v_mfma_f32_16x16x32_bf16 a[232:235], v[124:127], a[56:59], a[232:235]
    v_mfma_f32_16x16x32_bf16 a[236:239], v[124:127], a[60:63], a[236:239]
    s_waitcnt vmcnt(10) lgkmcnt(0)
    v_mfma_f32_16x16x32_bf16 a[200:203], v[128:131], a[64:67], a[200:203]
    ds_read_b128 v[108:111], v102 offset:57344
    v_mfma_f32_16x16x32_bf16 a[204:207], v[128:131], a[68:71], a[204:207]
    ds_read_b128 v[112:115], v102 offset:59392
    v_mfma_f32_16x16x32_bf16 a[208:211], v[132:135], a[64:67], a[208:211]
    ds_read_b128 v[116:119], v102 offset:61440
    v_mfma_f32_16x16x32_bf16 a[212:215], v[132:135], a[68:71], a[212:215]
    ds_read_b128 v[120:123], v102 offset:63488
    v_mfma_f32_16x16x32_bf16 a[216:219], v[136:139], a[64:67], a[216:219]
    ds_read_b128 v[124:127], v106 offset:0
    v_mfma_f32_16x16x32_bf16 a[220:223], v[136:139], a[68:71], a[220:223]
    buffer_load_dwordx4 a[112:115], v44, s[52:55], s80 offen offset:0
    v_mfma_f32_16x16x32_bf16 a[224:227], v[140:143], a[64:67], a[224:227]
    v_mfma_f32_16x16x32_bf16 a[228:231], v[140:143], a[68:71], a[228:231]
    buffer_load_dwordx4 a[116:119], v44, s[52:55], s80 offen offset:1024
    v_mfma_f32_16x16x32_bf16 a[232:235], v[144:147], a[64:67], a[232:235]
    v_mfma_f32_16x16x32_bf16 a[236:239], v[144:147], a[68:71], a[236:239]
    s_waitcnt vmcnt(10) lgkmcnt(0)
    v_mfma_f32_16x16x32_bf16 a[200:203], v[108:111], a[72:75], a[200:203]
    ds_read_b128 v[128:131], v103 offset:57344
    v_mfma_f32_16x16x32_bf16 a[204:207], v[108:111], a[76:79], a[204:207]
    ds_read_b128 v[132:135], v103 offset:59392
    v_mfma_f32_16x16x32_bf16 a[208:211], v[112:115], a[72:75], a[208:211]
    ds_read_b128 v[136:139], v103 offset:61440
    v_mfma_f32_16x16x32_bf16 a[212:215], v[112:115], a[76:79], a[212:215]
    ds_read_b128 v[140:143], v103 offset:63488
    v_mfma_f32_16x16x32_bf16 a[216:219], v[116:119], a[72:75], a[216:219]
    ds_read_b128 v[144:147], v107 offset:0
    v_mfma_f32_16x16x32_bf16 a[220:223], v[116:119], a[76:79], a[220:223]
    v_mfma_f32_16x16x32_bf16 a[224:227], v[120:123], a[72:75], a[224:227]
    v_mfma_f32_16x16x32_bf16 a[228:231], v[120:123], a[76:79], a[228:231]
    v_mfma_f32_16x16x32_bf16 a[232:235], v[124:127], a[72:75], a[232:235]
    v_mfma_f32_16x16x32_bf16 a[236:239], v[124:127], a[76:79], a[236:239]
    s_waitcnt vmcnt(8) lgkmcnt(0)
    v_mfma_f32_16x16x32_bf16 a[200:203], v[128:131], a[80:83], a[200:203]
    ds_read_b128 v[108:111], v96 offset:0
    v_mfma_f32_16x16x32_bf16 a[204:207], v[128:131], a[84:87], a[204:207]
    ds_read_b128 v[112:115], v96 offset:2048
    v_mfma_f32_16x16x32_bf16 a[208:211], v[132:135], a[80:83], a[208:211]
    ds_read_b128 v[116:119], v96 offset:4096
    v_mfma_f32_16x16x32_bf16 a[212:215], v[132:135], a[84:87], a[212:215]
    ds_read_b128 v[120:123], v96 offset:6144
    v_mfma_f32_16x16x32_bf16 a[216:219], v[136:139], a[80:83], a[216:219]
    ds_read_b128 v[124:127], v96 offset:8192
    v_mfma_f32_16x16x32_bf16 a[220:223], v[136:139], a[84:87], a[220:223]
    v_mfma_f32_16x16x32_bf16 a[224:227], v[140:143], a[80:83], a[224:227]
    v_mfma_f32_16x16x32_bf16 a[228:231], v[140:143], a[84:87], a[228:231]
    v_mfma_f32_16x16x32_bf16 a[232:235], v[144:147], a[80:83], a[232:235]
    v_mfma_f32_16x16x32_bf16 a[236:239], v[144:147], a[84:87], a[236:239]
    s_waitcnt vmcnt(6) lgkmcnt(0)
    v_mfma_f32_16x16x32_bf16 a[200:203], v[108:111], a[88:91], a[200:203]
    ds_read_b128 v[128:131], v97 offset:0
    v_mfma_f32_16x16x32_bf16 a[204:207], v[108:111], a[92:95], a[204:207]
    ds_read_b128 v[132:135], v97 offset:2048
    v_mfma_f32_16x16x32_bf16 a[208:211], v[112:115], a[88:91], a[208:211]
    ds_read_b128 v[136:139], v97 offset:4096
    v_mfma_f32_16x16x32_bf16 a[212:215], v[112:115], a[92:95], a[212:215]
    ds_read_b128 v[140:143], v97 offset:6144
    v_mfma_f32_16x16x32_bf16 a[216:219], v[116:119], a[88:91], a[216:219]
    ds_read_b128 v[144:147], v97 offset:8192
    v_mfma_f32_16x16x32_bf16 a[220:223], v[116:119], a[92:95], a[220:223]
    v_mfma_f32_16x16x32_bf16 a[224:227], v[120:123], a[88:91], a[224:227]
    v_mfma_f32_16x16x32_bf16 a[228:231], v[120:123], a[92:95], a[228:231]
    v_mfma_f32_16x16x32_bf16 a[232:235], v[124:127], a[88:91], a[232:235]
    v_mfma_f32_16x16x32_bf16 a[236:239], v[124:127], a[92:95], a[236:239]
    s_mov_b32 s81, 589824
    s_waitcnt vmcnt(0)
    s_cmp_eq_u32 s34, 0
    s_cbranch_scc1 L_wt_28
    buffer_store_dword v16, v33, s[48:51], s81 offen
    s_branch L_j_29
L_wt_28:
    buffer_store_dword v16, v33, s[48:51], s81 offen sc1
L_j_29:
    s_waitcnt lgkmcnt(0)
    v_mfma_f32_16x16x32_bf16 a[200:203], v[128:131], a[96:99], a[200:203]
    ds_read_b128 v[108:111], v98 offset:0
    v_mfma_f32_16x16x32_bf16 a[204:207], v[128:131], a[100:103], a[204:207]
    ds_read_b128 v[112:115], v98 offset:2048
    v_mfma_f32_16x16x32_bf16 a[208:211], v[132:135], a[96:99], a[208:211]
    ds_read_b128 v[116:119], v98 offset:4096
    v_mfma_f32_16x16x32_bf16 a[212:215], v[132:135], a[100:103], a[212:215]
    ds_read_b128 v[120:123], v98 offset:6144
    v_mfma_f32_16x16x32_bf16 a[216:219], v[136:139], a[96:99], a[216:219]
    ds_read_b128 v[124:127], v98 offset:8192
    v_mfma_f32_16x16x32_bf16 a[220:223], v[136:139], a[100:103], a[220:223]
    v_mfma_f32_16x16x32_bf16 a[224:227], v[140:143], a[96:99], a[224:227]
    v_mfma_f32_16x16x32_bf16 a[228:231], v[140:143], a[100:103], a[228:231]
    v_mfma_f32_16x16x32_bf16 a[232:235], v[144:147], a[96:99], a[232:235]
    v_mfma_f32_16x16x32_bf16 a[236:239], v[144:147], a[100:103], a[236:239]
    s_waitcnt lgkmcnt(0)
    v_mfma_f32_16x16x32_bf16 a[200:203], v[108:111], a[104:107], a[200:203]
    ds_read_b128 v[128:131], v99 offset:0
    v_mfma_f32_16x16x32_bf16 a[208:211], v[112:115], a[104:107], a[208:211]
    ds_read_b128 v[132:135], v99 offset:2048
    v_mfma_f32_16x16x32_bf16 a[216:219], v[116:119], a[104:107], a[216:219]
    ds_read_b128 v[136:139], v99 offset:4096
    v_mfma_f32_16x16x32_bf16 a[224:227], v[120:123], a[104:107], a[224:227]
    ds_read_b128 v[140:143], v99 offset:6144
    v_mfma_f32_16x16x32_bf16 a[232:235], v[124:127], a[104:107], a[232:235]
    ds_read_b128 v[144:147], v99 offset:8192
    buffer_load_dword v17, v34, s[48:51], s81 offen sc1
    s_waitcnt lgkmcnt(0)
    v_mfma_f32_16x16x32_bf16 a[200:203], v[128:131], a[112:115], a[200:203]
    v_mfma_f32_16x16x32_bf16 a[208:211], v[132:135], a[112:115], a[208:211]
    v_mfma_f32_16x16x32_bf16 a[216:219], v[136:139], a[112:115], a[216:219]
    v_mfma_f32_16x16x32_bf16 a[224:227], v[140:143], a[112:115], a[224:227]
    v_mfma_f32_16x16x32_bf16 a[232:235], v[144:147], a[112:115], a[232:235]
    v_mfma_f32_16x16x32_bf16 a[204:207], v[108:111], a[108:111], a[204:207]
    v_mfma_f32_16x16x32_bf16 a[212:215], v[112:115], a[108:111], a[212:215]
    v_mfma_f32_16x16x32_bf16 a[220:223], v[116:119], a[108:111], a[220:223]
    s_nop 0
    ds_write_b128 v48, a[200:203] offset:0
    v_mfma_f32_16x16x32_bf16 a[228:231], v[120:123], a[108:111], a[228:231]
    ds_write_b128 v48, a[208:211] offset:64
    v_mfma_f32_16x16x32_bf16 a[236:239], v[124:127], a[108:111], a[236:239]
    v_mfma_f32_16x16x32_bf16 a[204:207], v[128:131], a[116:119], a[204:207]
    ds_write_b128 v48, a[216:219] offset:128
    v_mfma_f32_16x16x32_bf16 a[212:215], v[132:135], a[116:119], a[212:215]
    ds_write_b128 v48, a[224:227] offset:192
    v_mfma_f32_16x16x32_bf16 a[220:223], v[136:139], a[116:119], a[220:223]
    v_mfma_f32_16x16x32_bf16 a[228:231], v[140:143], a[116:119], a[228:231]
    ds_write_b128 v48, a[232:235] offset:256
    v_mfma_f32_16x16x32_bf16 a[236:239], v[144:147], a[116:119], a[236:239]
    ds_read_b128 v[216:219], v55 offset:0
    ds_read_b128 v[220:223], v56 offset:0
    ds_read_b128 v[224:227], v57 offset:0
    ds_read_b128 v[228:231], v58 offset:0
    ds_read_b128 v[232:235], v59 offset:0
    ds_write_b128 v48, a[204:207] offset:5376
    ds_write_b128 v48, a[212:215] offset:5440
    ds_write_b128 v48, a[220:223] offset:5504
    ds_write_b128 v48, a[228:231] offset:5568
    ds_write_b128 v48, a[236:239] offset:5632
    ds_read_b128 v[236:239], v55 offset:5376
    ds_read_b128 v[240:243], v56 offset:5376
    ds_read_b128 v[244:247], v57 offset:5376
    ds_read_b128 v[248:251], v58 offset:5376
    ds_read_b128 v[252:255], v59 offset:5376
    s_waitcnt vmcnt(0)
    v_cmp_ne_u32 vcc, v16, v17
    s_nop 3
    s_cbranch_vccz L_rd_31
    s_mov_b32 s82, 0x40000
L_rp_30:
    buffer_load_dword v17, v34, s[48:51], s81 offen sc1
    s_waitcnt vmcnt(0)
    v_cmp_ne_u32 vcc, v16, v17
    s_nop 3
    s_cbranch_vccz L_rd_31
    s_sub_u32 s82, s82, 1
    s_cbranch_scc0 L_rp_30
L_rd_31:
    s_waitcnt lgkmcnt(14)
    buffer_store_dwordx4 v[216:219], v50, s[52:55], 0 offen nt
    s_waitcnt lgkmcnt(13)
    buffer_store_dwordx4 v[220:223], v51, s[52:55], 0 offen nt
    s_waitcnt lgkmcnt(12)
    buffer_store_dwordx4 v[224:227], v52, s[52:55], 0 offen nt
    s_waitcnt lgkmcnt(11)
    buffer_store_dwordx4 v[228:231], v53, s[52:55], 0 offen nt
    s_waitcnt lgkmcnt(10)
    buffer_store_dwordx4 v[232:235], v54, s[52:55], 0 offen nt
    s_waitcnt lgkmcnt(4)
    buffer_store_dwordx4 v[236:239], v50, s[52:55], s93 offen nt
    s_waitcnt lgkmcnt(3)
    buffer_store_dwordx4 v[240:243], v51, s[52:55], s93 offen nt
    s_waitcnt lgkmcnt(2)
    buffer_store_dwordx4 v[244:247], v52, s[52:55], s93 offen nt
    s_waitcnt lgkmcnt(1)
    buffer_store_dwordx4 v[248:251], v53, s[52:55], s93 offen nt
    s_waitcnt lgkmcnt(0)
    buffer_store_dwordx4 v[252:255], v54, s[52:55], s93 offen nt
    s_endpgm
L_own1:
    ds_read_b128 v[108:111], v101 offset:36864
    ds_read_b128 v[112:115], v101 offset:38912
    ds_read_b128 v[116:119], v101 offset:40960
    ds_read_b128 v[120:123], v101 offset:43008
    s_waitcnt vmcnt(11)
    ds_read_b128 v[124:127], v101 offset:45056
    s_waitcnt vmcnt(0)
    s_cmp_eq_u32 s34, 0
    s_cbranch_scc1 L_wt_32
    buffer_store_dword v16, v33, s[48:51], 0 offen
    s_branch L_j_33
L_wt_32:
    buffer_store_dword v16, v33, s[48:51], 0 offen sc1
L_j_33:
    s_waitcnt lgkmcnt(0)
    v_mfma_f32_16x16x32_bf16 a[200:203], v[108:111], v[176:179], a[200:203]
    ds_read_b128 v[128:131], v102 offset:36864
    v_mfma_f32_16x16x32_bf16 a[204:207], v[108:111], v[180:183], a[204:207]
    ds_read_b128 v[132:135], v102 offset:38912
    v_mfma_f32_16x16x32_bf16 a[208:211], v[112:115], v[176:179], a[208:211]
    ds_read_b128 v[136:139], v102 offset:40960
    v_mfma_f32_16x16x32_bf16 a[212:215], v[112:115], v[180:183], a[212:215]
    ds_read_b128 v[140:143], v102 offset:43008
    v_mfma_f32_16x16x32_bf16 a[216:219], v[116:119], v[176:179], a[216:219]
    ds_read_b128 v[144:147], v102 offset:45056
    v_mfma_f32_16x16x32_bf16 a[220:223], v[116:119], v[180:183], a[220:223]
    s_add_u32 m0, s98, 61440
    s_add_u32 s81, s90, 5
    s_sub_u32 s101, s81, 10
    s_cselect_b32 s81, s81, s101
    s_lshl_b32 s81, s81, 7
    buffer_load_dwordx4 v20, s[44:47], s81 offen offset:0 lds
    v_mfma_f32_16x16x32_bf16 a[224:227], v[120:123], v[176:179], a[224:227]
    v_mfma_f32_16x16x32_bf16 a[228:231], v[120:123], v[180:183], a[228:231]
    buffer_load_dwordx4 v21, s[44:47], s81 offen offset:1024 lds
    v_mfma_f32_16x16x32_bf16 a[232:235], v[124:127], v[176:179], a[232:235]
    v_mfma_f32_16x16x32_bf16 a[236:239], v[124:127], v[180:183], a[236:239]
    s_waitcnt lgkmcnt(0)
    v_mfma_f32_16x16x32_bf16 a[200:203], v[128:131], v[184:187], a[200:203]
    ds_read_b128 v[108:111], v103 offset:36864
    v_mfma_f32_16x16x32_bf16 a[204:207], v[128:131], v[188:191], a[204:207]
    ds_read_b128 v[112:115], v103 offset:38912
    v_mfma_f32_16x16x32_bf16 a[208:211], v[132:135], v[184:187], a[208:211]
    ds_read_b128 v[116:119], v103 offset:40960
    v_mfma_f32_16x16x32_bf16 a[212:215], v[132:135], v[188:191], a[212:215]
    ds_read_b128 v[120:123], v103 offset:43008
    v_mfma_f32_16x16x32_bf16 a[216:219], v[136:139], v[184:187], a[216:219]
    ds_read_b128 v[124:127], v103 offset:45056
    v_mfma_f32_16x16x32_bf16 a[220:223], v[136:139], v[188:191], a[220:223]
    buffer_load_dwordx4 v22, s[44:47], s81 offen offset:2048 lds
    v_mfma_f32_16x16x32_bf16 a[224:227], v[140:143], v[184:187], a[224:227]
    v_mfma_f32_16x16x32_bf16 a[228:231], v[140:143], v[188:191], a[228:231]
    buffer_load_dwordx4 v23, s[44:47], s81 offen offset:3072 lds
    v_mfma_f32_16x16x32_bf16 a[232:235], v[144:147], v[184:187], a[232:235]
    v_mfma_f32_16x16x32_bf16 a[236:239], v[144:147], v[188:191], a[236:239]
    s_waitcnt lgkmcnt(0)
    v_mfma_f32_16x16x32_bf16 a[200:203], v[108:111], v[192:195], a[200:203]
    ds_read_b128 v[128:131], v100 offset:57344
    v_mfma_f32_16x16x32_bf16 a[204:207], v[108:111], v[196:199], a[204:207]
    ds_read_b128 v[132:135], v100 offset:59392
    v_mfma_f32_16x16x32_bf16 a[208:211], v[112:115], v[192:195], a[208:211]
    ds_read_b128 v[136:139], v100 offset:61440
    v_mfma_f32_16x16x32_bf16 a[212:215], v[112:115], v[196:199], a[212:215]
    ds_read_b128 v[140:143], v100 offset:63488
    v_mfma_f32_16x16x32_bf16 a[216:219], v[116:119], v[192:195], a[216:219]
    ds_read_b128 v[144:147], v104 offset:0
    v_mfma_f32_16x16x32_bf16 a[220:223], v[116:119], v[196:199], a[220:223]
    s_add_u32 m0, s98, 65536
    s_nop 0
    buffer_load_dwordx4 v24, s[44:47], s81 offen offset:0 lds
    v_mfma_f32_16x16x32_bf16 a[224:227], v[120:123], v[192:195], a[224:227]
    s_add_u32 m0, s98, 81920
    s_add_u32 s81, s90, 6
    s_sub_u32 s101, s81, 10
    s_cselect_b32 s81, s81, s101
    s_lshl_b32 s81, s81, 7
    buffer_load_dwordx4 v20, s[44:47], s81 offen offset:0 lds
    v_mfma_f32_16x16x32_bf16 a[228:231], v[120:123], v[196:199], a[228:231]
    v_mfma_f32_16x16x32_bf16 a[232:235], v[124:127], v[192:195], a[232:235]
    buffer_load_dwordx4 v21, s[44:47], s81 offen offset:1024 lds
    v_mfma_f32_16x16x32_bf16 a[236:239], v[124:127], v[196:199], a[236:239]
    s_waitcnt lgkmcnt(0)
    v_mfma_f32_16x16x32_bf16 a[200:203], v[128:131], v[200:203], a[200:203]
    ds_read_b128 v[108:111], v101 offset:57344
    v_mfma_f32_16x16x32_bf16 a[204:207], v[128:131], v[204:207], a[204:207]
    ds_read_b128 v[112:115], v101 offset:59392
    v_mfma_f32_16x16x32_bf16 a[208:211], v[132:135], v[200:203], a[208:211]
    ds_read_b128 v[116:119], v101 offset:61440
    v_mfma_f32_16x16x32_bf16 a[212:215], v[132:135], v[204:207], a[212:215]
    ds_read_b128 v[120:123], v101 offset:63488
    v_mfma_f32_16x16x32_bf16 a[216:219], v[136:139], v[200:203], a[216:219]
    ds_read_b128 v[124:127], v105 offset:0
    v_mfma_f32_16x16x32_bf16 a[220:223], v[136:139], v[204:207], a[220:223]
    buffer_load_dwordx4 v22, s[44:47], s81 offen offset:2048 lds
    v_mfma_f32_16x16x32_bf16 a[224:227], v[140:143], v[200:203], a[224:227]
    v_mfma_f32_16x16x32_bf16 a[228:231], v[140:143], v[204:207], a[228:231]
    buffer_load_dwordx4 v23, s[44:47], s81 offen offset:3072 lds
    v_mfma_f32_16x16x32_bf16 a[232:235], v[144:147], v[200:203], a[232:235]
    v_mfma_f32_16x16x32_bf16 a[236:239], v[144:147], v[204:207], a[236:239]
    s_waitcnt lgkmcnt(0)
    v_mfma_f32_16x16x32_bf16 a[200:203], v[108:111], v[208:211], a[200:203]
    ds_read_b128 v[128:131], v102 offset:57344
    v_mfma_f32_16x16x32_bf16 a[204:207], v[108:111], v[212:215], a[204:207]
    ds_read_b128 v[132:135], v102 offset:59392
    v_mfma_f32_16x16x32_bf16 a[208:211], v[112:115], v[208:211], a[208:211]
    ds_read_b128 v[136:139], v102 offset:61440
    v_mfma_f32_16x16x32_bf16 a[212:215], v[112:115], v[212:215], a[212:215]
    ds_read_b128 v[140:143], v102 offset:63488
    v_mfma_f32_16x16x32_bf16 a[216:219], v[116:119], v[208:211], a[216:219]
    ds_read_b128 v[144:147], v106 offset:0
    v_mfma_f32_16x16x32_bf16 a[220:223], v[116:119], v[212:215], a[220:223]
    s_add_u32 m0, s98, 86016
    s_nop 0
    buffer_load_dwordx4 v24, s[44:47], s81 offen offset:0 lds
    v_mfma_f32_16x16x32_bf16 a[224:227], v[120:123], v[208:211], a[224:227]
    s_add_u32 m0, s98, 143360
    s_add_u32 s81, s90, 7
    s_sub_u32 s101, s81, 10
    s_cselect_b32 s81, s81, s101
    s_lshl_b32 s81, s81, 7
    buffer_load_dwordx4 v20, s[44:47], s81 offen offset:0 lds
    v_mfma_f32_16x16x32_bf16 a[228:231], v[120:123], v[212:215], a[228:231]
    v_mfma_f32_16x16x32_bf16 a[232:235], v[124:127], v[208:211], a[232:235]
    buffer_load_dwordx4 v21, s[44:47], s81 offen offset:1024 lds
    v_mfma_f32_16x16x32_bf16 a[236:239], v[124:127], v[212:215], a[236:239]
    v_and_b32 v4, 15, v0
    v_bfe_u32 v3, v0, 4, 2
    s_mul_i32 s94, s76, 10752
    s_add_u32 s94, s94, 20480
    v_mul_u32_u24 v5, 336, v4
    v_lshl_add_u32 v5, v3, 4, v5
    v_add_u32 v48, s94, v5
    s_lshl_b32 s95, s77, 7
    s_lshl_b32 s96, s76, 5
    s_add_u32 s95, s95, s96
    s_mul_i32 s95, s95, 5120
    s_mul_i32 s96, s78, 320
    s_add_u32 s95, s95, s96
    s_add_u32 s95, s95, 2560
    v_and_b32 v3, 63, v0
    v_add_u32 v4, 0, v3
    v_mul_u32_u24 v5, 3277, v4
    v_lshrrev_b32 v5, 16, v5
    v_lshlrev_b32 v4, 4, v4
    v_lshl_add_u32 v6, v5, 4, v4
    v_add_u32 v55, s94, v6
    v_mul_u32_u24 v5, 4800, v5
    v_add3_u32 v50, v5, v4, s95
    v_add_u32 v4, 64, v3
    v_mul_u32_u24 v5, 3277, v4
    v_lshrrev_b32 v5, 16, v5
    v_lshlrev_b32 v4, 4, v4
    v_lshl_add_u32 v6, v5, 4, v4
    v_add_u32 v56, s94, v6
    v_mul_u32_u24 v5, 4800, v5
    v_add3_u32 v51, v5, v4, s95
    v_add_u32 v4, 128, v3
    v_mul_u32_u24 v5, 3277, v4
    v_lshrrev_b32 v5, 16, v5
    v_lshlrev_b32 v4, 4, v4
    v_lshl_add_u32 v6, v5, 4, v4
    v_add_u32 v57, s94, v6
    v_mul_u32_u24 v5, 4800, v5
    v_add3_u32 v52, v5, v4, s95
    v_add_u32 v4, 192, v3
    v_mul_u32_u24 v5, 3277, v4
    v_lshrrev_b32 v5, 16, v5
    v_lshlrev_b32 v4, 4, v4
    v_lshl_add_u32 v6, v5, 4, v4
    v_add_u32 v58, s94, v6
    v_mul_u32_u24 v5, 4800, v5
    v_add3_u32 v53, v5, v4, s95
    v_add_u32 v4, 256, v3
    v_mul_u32_u24 v5, 3277, v4
    v_lshrrev_b32 v5, 16, v5
    v_lshlrev_b32 v4, 4, v4
    v_lshl_add_u32 v6, v5, 4, v4
    v_add_u32 v59, s94, v6
    v_mul_u32_u24 v5, 4800, v5
    v_add3_u32 v54, v5, v4, s95
    s_mov_b32 s93, 81920
    s_mov_b32 s82, 0x40000
L_poll_34:
    buffer_load_dword v4, v34, s[48:51], 0 offen sc1
    s_waitcnt vmcnt(0)
    v_xor_b32 v4, s79, v4
    v_cmp_ne_u32 vcc, 0, v4
    s_nop 3
    s_cbranch_vccz L_pdone_35
    s_sub_u32 s82, s82, 1
    s_cbranch_scc0 L_poll_34
L_pdone_35:
    s_add_u32 s80, s78, 1
    s_and_b32 s80, s80, 7
    s_mul_i32 s80, s80, 20480
    buffer_load_dwordx4 a[40:43], v39, s[52:55], s80 offen offset:0
    buffer_load_dwordx4 a[44:47], v39, s[52:55], s80 offen offset:1024
    buffer_load_dwordx4 a[48:51], v40, s[52:55], s80 offen offset:0
    buffer_load_dwordx4 a[52:55], v41, s[52:55], s80 offen offset:0
    buffer_load_dwordx4 a[56:59], v41, s[52:55], s80 offen offset:1024
    buffer_load_dwordx4 a[60:63], v42, s[52:55], s80 offen offset:0
    buffer_load_dwordx4 a[64:67], v42, s[52:55], s80 offen offset:1024
    buffer_load_dwordx4 a[68:71], v43, s[52:55], s80 offen offset:0
    buffer_load_dwordx4 a[72:75], v44, s[52:55], s80 offen offset:0
    buffer_load_dwordx4 a[76:79], v44, s[52:55], s80 offen offset:1024
    s_add_u32 s80, s78, 2
    s_and_b32 s80, s80, 7
    s_mul_i32 s80, s80, 20480
    buffer_load_dwordx4 a[80:83], v39, s[52:55], s80 offen offset:0
    buffer_load_dwordx4 a[84:87], v39, s[52:55], s80 offen offset:1024
    s_waitcnt vmcnt(10) lgkmcnt(0)
    v_mfma_f32_16x16x32_bf16 a[200:203], v[128:131], a[40:43], a[200:203]
    ds_read_b128 v[108:111], v103 offset:57344
    v_mfma_f32_16x16x32_bf16 a[204:207], v[128:131], a[44:47], a[204:207]
    ds_read_b128 v[112:115], v103 offset:59392
    v_mfma_f32_16x16x32_bf16 a[208:211], v[132:135], a[40:43], a[208:211]
    ds_read_b128 v[116:119], v103 offset:61440
    v_mfma_f32_16x16x32_bf16 a[212:215], v[132:135], a[44:47], a[212:215]
    ds_read_b128 v[120:123], v103 offset:63488
    v_mfma_f32_16x16x32_bf16 a[216:219], v[136:139], a[40:43], a[216:219]
    ds_read_b128 v[124:127], v107 offset:0
    v_mfma_f32_16x16x32_bf16 a[220:223], v[136:139], a[44:47], a[220:223]
    buffer_load_dwordx4 a[88:91], v40, s[52:55], s80 offen offset:0
    v_mfma_f32_16x16x32_bf16 a[224:227], v[140:143], a[40:43], a[224:227]
    v_mfma_f32_16x16x32_bf16 a[228:231], v[140:143], a[44:47], a[228:231]
    buffer_load_dwordx4 a[92:95], v41, s[52:55], s80 offen offset:0
    v_mfma_f32_16x16x32_bf16 a[232:235], v[144:147], a[40:43], a[232:235]
    v_mfma_f32_16x16x32_bf16 a[236:239], v[144:147], a[44:47], a[236:239]
    s_waitcnt vmcnt(10) lgkmcnt(0)
    v_mfma_f32_16x16x32_bf16 a[200:203], v[108:111], a[48:51], a[200:203]
    ds_read_b128 v[128:131], v96 offset:0
    v_mfma_f32_16x16x32_bf16 a[204:207], v[108:111], a[52:55], a[204:207]
    ds_read_b128 v[132:135], v96 offset:2048
    v_mfma_f32_16x16x32_bf16 a[208:211], v[112:115], a[48:51], a[208:211]
    ds_read_b128 v[136:139], v96 offset:4096
    v_mfma_f32_16x16x32_bf16 a[212:215], v[112:115], a[52:55], a[212:215]
    ds_read_b128 v[140:143], v96 offset:6144
    v_mfma_f32_16x16x32_bf16 a[216:219], v[116:119], a[48:51], a[216:219]
    ds_read_b128 v[144:147], v96 offset:8192
    v_mfma_f32_16x16x32_bf16 a[220:223], v[116:119], a[52:55], a[220:223]
    buffer_load_dwordx4 a[96:99], v41, s[52:55], s80 offen offset:1024
    v_mfma_f32_16x16x32_bf16 a[224:227], v[120:123], a[48:51], a[224:227]
    buffer_load_dwordx4 a[100:103], v42, s[52:55], s80 offen offset:0
    v_mfma_f32_16x16x32_bf16 a[228:231], v[120:123], a[52:55], a[228:231]
    v_mfma_f32_16x16x32_bf16 a[232:235], v[124:127], a[48:51], a[232:235]
    buffer_load_dwordx4 v22, s[44:47], s81 offen offset:2048 lds
    v_mfma_f32_16x16x32_bf16 a[236:239], v[124:127], a[52:55], a[236:239]
    s_waitcnt vmcnt(11) lgkmcnt(0)
    v_mfma_f32_16x16x32_bf16 a[200:203], v[128:131], a[56:59], a[200:203]
    ds_read_b128 v[108:111], v97 offset:0
    v_mfma_f32_16x16x32_bf16 a[204:207], v[128:131], a[60:63], a[204:207]
    ds_read_b128 v[112:115], v97 offset:2048
    v_mfma_f32_16x16x32_bf16 a[208:211], v[132:135], a[56:59], a[208:211]
    ds_read_b128 v[116:119], v97 offset:4096
    v_mfma_f32_16x16x32_bf16 a[212:215], v[132:135], a[60:63], a[212:215]
    ds_read_b128 v[120:123], v97 offset:6144
    v_mfma_f32_16x16x32_bf16 a[216:219], v[136:139], a[56:59], a[216:219]
    ds_read_b128 v[124:127], v97 offset:8192
    v_mfma_f32_16x16x32_bf16 a[220:223], v[136:139], a[60:63], a[220:223]
    buffer_load_dwordx4 a[104:107], v42, s[52:55], s80 offen offset:1024
    v_mfma_f32_16x16x32_bf16 a[224:227], v[140:143], a[56:59], a[224:227]
    buffer_load_dwordx4 a[108:111], v43, s[52:55], s80 offen offset:0
    v_mfma_f32_16x16x32_bf16 a[228:231], v[140:143], a[60:63], a[228:231]
    v_mfma_f32_16x16x32_bf16 a[232:235], v[144:147], a[56:59], a[232:235]
    buffer_load_dwordx4 v23, s[44:47], s81 offen offset:3072 lds
    v_mfma_f32_16x16x32_bf16 a[236:239], v[144:147], a[60:63], a[236:239]
    s_waitcnt vmcnt(12) lgkmcnt(0)
    v_mfma_f32_16x16x32_bf16 a[200:203], v[108:111], a[64:67], a[200:203]
    ds_read_b128 v[128:131], v98 offset:0
    v_mfma_f32_16x16x32_bf16 a[204:207], v[108:111], a[68:71], a[204:207]
    ds_read_b128 v[132:135], v98 offset:2048
    v_mfma_f32_16x16x32_bf16 a[208:211], v[112:115], a[64:67], a[208:211]
    ds_read_b128 v[136:139], v98 offset:4096
    v_mfma_f32_16x16x32_bf16 a[212:215], v[112:115], a[68:71], a[212:215]
    ds_read_b128 v[140:143], v98 offset:6144
    v_mfma_f32_16x16x32_bf16 a[216:219], v[116:119], a[64:67], a[216:219]
    ds_read_b128 v[144:147], v98 offset:8192
    v_mfma_f32_16x16x32_bf16 a[220:223], v[116:119], a[68:71], a[220:223]
    buffer_load_dwordx4 a[112:115], v44, s[52:55], s80 offen offset:0
    v_mfma_f32_16x16x32_bf16 a[224:227], v[120:123], a[64:67], a[224:227]
    buffer_load_dwordx4 a[116:119], v44, s[52:55], s80 offen offset:1024
    v_mfma_f32_16x16x32_bf16 a[228:231], v[120:123], a[68:71], a[228:231]
    v_mfma_f32_16x16x32_bf16 a[232:235], v[124:127], a[64:67], a[232:235]
    s_add_u32 m0, s98, 147456
    s_nop 0
    buffer_load_dwordx4 v24, s[44:47], s81 offen offset:0 lds
    v_mfma_f32_16x16x32_bf16 a[236:239], v[124:127], a[68:71], a[236:239]
    s_waitcnt vmcnt(13) lgkmcnt(0)
    v_mfma_f32_16x16x32_bf16 a[200:203], v[128:131], a[72:75], a[200:203]
    ds_read_b128 v[108:111], v99 offset:0
    v_mfma_f32_16x16x32_bf16 a[204:207], v[128:131], a[76:79], a[204:207]
    ds_read_b128 v[112:115], v99 offset:2048
    v_mfma_f32_16x16x32_bf16 a[208:211], v[132:135], a[72:75], a[208:211]
    ds_read_b128 v[116:119], v99 offset:4096
    v_mfma_f32_16x16x32_bf16 a[212:215], v[132:135], a[76:79], a[212:215]
    ds_read_b128 v[120:123], v99 offset:6144
    v_mfma_f32_16x16x32_bf16 a[216:219], v[136:139], a[72:75], a[216:219]
    ds_read_b128 v[124:127], v99 offset:8192
    v_mfma_f32_16x16x32_bf16 a[220:223], v[136:139], a[76:79], a[220:223]
    s_add_u32 s80, s78, 3
    s_and_b32 s80, s80, 7
    s_mul_i32 s80, s80, 20480
    buffer_load_dwordx4 a[120:123], v39, s[52:55], s80 offen offset:0
    v_mfma_f32_16x16x32_bf16 a[224:227], v[140:143], a[72:75], a[224:227]
    v_mfma_f32_16x16x32_bf16 a[228:231], v[140:143], a[76:79], a[228:231]
    buffer_load_dwordx4 a[124:127], v39, s[52:55], s80 offen offset:1024
    v_mfma_f32_16x16x32_bf16 a[232:235], v[144:147], a[72:75], a[232:235]
    v_mfma_f32_16x16x32_bf16 a[236:239], v[144:147], a[76:79], a[236:239]
    s_waitcnt lgkmcnt(0)
    s_barrier
    s_waitcnt vmcnt(13)
    v_mfma_f32_16x16x32_bf16 a[200:203], v[108:111], a[80:83], a[200:203]
    ds_read_b128 v[128:131], v96 offset:20480
    v_mfma_f32_16x16x32_bf16 a[204:207], v[108:111], a[84:87], a[204:207]
    ds_read_b128 v[132:135], v96 offset:22528
    v_mfma_f32_16x16x32_bf16 a[208:211], v[112:115], a[80:83], a[208:211]
    ds_read_b128 v[136:139], v96 offset:24576
    v_mfma_f32_16x16x32_bf16 a[212:215], v[112:115], a[84:87], a[212:215]
    ds_read_b128 v[140:143], v96 offset:26624
    v_mfma_f32_16x16x32_bf16 a[216:219], v[116:119], a[80:83], a[216:219]
    ds_read_b128 v[144:147], v96 offset:28672
    v_mfma_f32_16x16x32_bf16 a[220:223], v[116:119], a[84:87], a[220:223]
    buffer_load_dwordx4 a[128:131], v40, s[52:55], s80 offen offset:0
    v_mfma_f32_16x16x32_bf16 a[224:227], v[120:123], a[80:83], a[224:227]
    buffer_load_dwordx4 a[132:135], v41, s[52:55], s80 offen offset:0
    v_mfma_f32_16x16x32_bf16 a[228:231], v[120:123], a[84:87], a[228:231]
    v_mfma_f32_16x16x32_bf16 a[232:235], v[124:127], a[80:83], a[232:235]
    s_add_u32 m0, s98, 122880
    s_add_u32 s81, s90, 8
    s_sub_u32 s101, s81, 10
    s_cselect_b32 s81, s81, s101
    s_lshl_b32 s81, s81, 7
    buffer_load_dwordx4 v20, s[44:47], s81 offen offset:0 lds
    v_mfma_f32_16x16x32_bf16 a[236:239], v[124:127], a[84:87], a[236:239]
    s_waitcnt vmcnt(14) lgkmcnt(0)
    v_mfma_f32_16x16x32_bf16 a[200:203], v[128:131], a[88:91], a[200:203]
    ds_read_b128 v[108:111], v97 offset:20480
    v_mfma_f32_16x16x32_bf16 a[204:207], v[128:131], a[92:95], a[204:207]
    ds_read_b128 v[112:115], v97 offset:22528
    v_mfma_f32_16x16x32_bf16 a[208:211], v[132:135], a[88:91], a[208:211]
    ds_read_b128 v[116:119], v97 offset:24576
    v_mfma_f32_16x16x32_bf16 a[212:215], v[132:135], a[92:95], a[212:215]
    ds_read_b128 v[120:123], v97 offset:26624
    v_mfma_f32_16x16x32_bf16 a[216:219], v[136:139], a[88:91], a[216:219]
    ds_read_b128 v[124:127], v97 offset:28672
    v_mfma_f32_16x16x32_bf16 a[220:223], v[136:139], a[92:95], a[220:223]
    buffer_load_dwordx4 a[136:139], v41, s[52:55], s80 offen offset:1024
    v_mfma_f32_16x16x32_bf16 a[224:227], v[140:143], a[88:91], a[224:227]
    buffer_load_dwordx4 a[140:143], v42, s[52:55], s80 offen offset:0
    v_mfma_f32_16x16x32_bf16 a[228:231], v[140:143], a[92:95], a[228:231]
    v_mfma_f32_16x16x32_bf16 a[232:235], v[144:147], a[88:91], a[232:235]
    buffer_load_dwordx4 v21, s[44:47], s81 offen offset:1024 lds
    v_mfma_f32_16x16x32_bf16 a[236:239], v[144:147], a[92:95], a[236:239]
    s_waitcnt vmcnt(15) lgkmcnt(0)
    v_mfma_f32_16x16x32_bf16 a[200:203], v[108:111], a[96:99], a[200:203]
    ds_read_b128 v[128:131], v98 offset:20480
    v_mfma_f32_16x16x32_bf16 a[204:207], v[108:111], a[100:103], a[204:207]
    ds_read_b128 v[132:135], v98 offset:22528
    v_mfma_f32_16x16x32_bf16 a[208:211], v[112:115], a[96:99], a[208:211]
    ds_read_b128 v[136:139], v98 offset:24576
    v_mfma_f32_16x16x32_bf16 a[212:215], v[112:115], a[100:103], a[212:215]
    ds_read_b128 v[140:143], v98 offset:26624
    v_mfma_f32_16x16x32_bf16 a[216:219], v[116:119], a[96:99], a[216:219]
    ds_read_b128 v[144:147], v98 offset:28672
    v_mfma_f32_16x16x32_bf16 a[220:223], v[116:119], a[100:103], a[220:223]
    buffer_load_dwordx4 a[144:147], v42, s[52:55], s80 offen offset:1024
    v_mfma_f32_16x16x32_bf16 a[224:227], v[120:123], a[96:99], a[224:227]
    v_mfma_f32_16x16x32_bf16 a[228:231], v[120:123], a[100:103], a[228:231]
    buffer_load_dwordx4 a[148:151], v43, s[52:55], s80 offen offset:0
    v_mfma_f32_16x16x32_bf16 a[232:235], v[124:127], a[96:99], a[232:235]
    v_mfma_f32_16x16x32_bf16 a[236:239], v[124:127], a[100:103], a[236:239]
    s_waitcnt vmcnt(14) lgkmcnt(0)
    v_mfma_f32_16x16x32_bf16 a[200:203], v[128:131], a[104:107], a[200:203]
    ds_read_b128 v[108:111], v99 offset:20480
    v_mfma_f32_16x16x32_bf16 a[204:207], v[128:131], a[108:111], a[204:207]
    ds_read_b128 v[112:115], v99 offset:22528
    v_mfma_f32_16x16x32_bf16 a[208:211], v[132:135], a[104:107], a[208:211]
    ds_read_b128 v[116:119], v99 offset:24576
    v_mfma_f32_16x16x32_bf16 a[212:215], v[132:135], a[108:111], a[212:215]
    ds_read_b128 v[120:123], v99 offset:26624
    v_mfma_f32_16x16x32_bf16 a[216:219], v[136:139], a[104:107], a[216:219]
    ds_read_b128 v[124:127], v99 offset:28672
    v_mfma_f32_16x16x32_bf16 a[220:223], v[136:139], a[108:111], a[220:223]
    buffer_load_dwordx4 a[152:155], v44, s[52:55], s80 offen offset:0
    v_mfma_f32_16x16x32_bf16 a[224:227], v[140:143], a[104:107], a[224:227]
    buffer_load_dwordx4 a[156:159], v44, s[52:55], s80 offen offset:1024
    v_mfma_f32_16x16x32_bf16 a[228:231], v[140:143], a[108:111], a[228:231]
    v_mfma_f32_16x16x32_bf16 a[232:235], v[144:147], a[104:107], a[232:235]
    buffer_load_dwordx4 v22, s[44:47], s81 offen offset:2048 lds
    v_mfma_f32_16x16x32_bf16 a[236:239], v[144:147], a[108:111], a[236:239]
    s_waitcnt vmcnt(14) lgkmcnt(0)
    v_mfma_f32_16x16x32_bf16 a[200:203], v[108:111], a[112:115], a[200:203]
    ds_read_b128 v[128:131], v96 offset:40960
    v_mfma_f32_16x16x32_bf16 a[204:207], v[108:111], a[116:119], a[204:207]
    ds_read_b128 v[132:135], v96 offset:43008
    v_mfma_f32_16x16x32_bf16 a[208:211], v[112:115], a[112:115], a[208:211]
    ds_read_b128 v[136:139], v96 offset:45056
    v_mfma_f32_16x16x32_bf16 a[212:215], v[112:115], a[116:119], a[212:215]
    ds_read_b128 v[140:143], v96 offset:47104
    v_mfma_f32_16x16x32_bf16 a[216:219], v[116:119], a[112:115], a[216:219]
    ds_read_b128 v[144:147], v96 offset:49152
    v_mfma_f32_16x16x32_bf16 a[220:223], v[116:119], a[116:119], a[220:223]
    s_add_u32 s80, s78, 4
    s_and_b32 s80, s80, 7
    s_mul_i32 s80, s80, 20480
    buffer_load_dwordx4 a[160:163], v39, s[52:55], s80 offen offset:0
    v_mfma_f32_16x16x32_bf16 a[224:227], v[120:123], a[112:115], a[224:227]
    v_mfma_f32_16x16x32_bf16 a[228:231], v[120:123], a[116:119], a[228:231]
    buffer_load_dwordx4 a[164:167], v39, s[52:55], s80 offen offset:1024
    v_mfma_f32_16x16x32_bf16 a[232:235], v[124:127], a[112:115], a[232:235]
    v_mfma_f32_16x16x32_bf16 a[236:239], v[124:127], a[116:119], a[236:239]
    s_waitcnt vmcnt(13) lgkmcnt(0)
    v_mfma_f32_16x16x32_bf16 a[200:203], v[128:131], a[120:123], a[200:203]
    ds_read_b128 v[108:111], v97 offset:40960
    v_mfma_f32_16x16x32_bf16 a[204:207], v[128:131], a[124:127], a[204:207]
    ds_read_b128 v[112:115], v97 offset:43008
    v_mfma_f32_16x16x32_bf16 a[208:211], v[132:135], a[120:123], a[208:211]
    ds_read_b128 v[116:119], v97 offset:45056
    v_mfma_f32_16x16x32_bf16 a[212:215], v[132:135], a[124:127], a[212:215]
    ds_read_b128 v[120:123], v97 offset:47104
    v_mfma_f32_16x16x32_bf16 a[216:219], v[136:139], a[120:123], a[216:219]
    ds_read_b128 v[124:127], v97 offset:49152
    v_mfma_f32_16x16x32_bf16 a[220:223], v[136:139], a[124:127], a[220:223]
    buffer_load_dwordx4 a[168:171], v40, s[52:55], s80 offen offset:0
    v_mfma_f32_16x16x32_bf16 a[224:227], v[140:143], a[120:123], a[224:227]
    buffer_load_dwordx4 a[172:175], v41, s[52:55], s80 offen offset:0
    v_mfma_f32_16x16x32_bf16 a[228:231], v[140:143], a[124:127], a[228:231]
    v_mfma_f32_16x16x32_bf16 a[232:235], v[144:147], a[120:123], a[232:235]
    buffer_load_dwordx4 v23, s[44:47], s81 offen offset:3072 lds
    v_mfma_f32_16x16x32_bf16 a[236:239], v[144:147], a[124:127], a[236:239]
    s_waitcnt vmcnt(14) lgkmcnt(0)
    v_mfma_f32_16x16x32_bf16 a[200:203], v[108:111], a[128:131], a[200:203]
    ds_read_b128 v[128:131], v98 offset:40960
    v_mfma_f32_16x16x32_bf16 a[204:207], v[108:111], a[132:135], a[204:207]
    ds_read_b128 v[132:135], v98 offset:43008
    v_mfma_f32_16x16x32_bf16 a[208:211], v[112:115], a[128:131], a[208:211]
    ds_read_b128 v[136:139], v98 offset:45056
    v_mfma_f32_16x16x32_bf16 a[212:215], v[112:115], a[132:135], a[212:215]
    ds_read_b128 v[140:143], v98 offset:47104
    v_mfma_f32_16x16x32_bf16 a[216:219], v[116:119], a[128:131], a[216:219]
    ds_read_b128 v[144:147], v98 offset:49152
    v_mfma_f32_16x16x32_bf16 a[220:223], v[116:119], a[132:135], a[220:223]
    buffer_load_dwordx4 a[176:179], v41, s[52:55], s80 offen offset:1024
    v_mfma_f32_16x16x32_bf16 a[224:227], v[120:123], a[128:131], a[224:227]
    buffer_load_dwordx4 a[180:183], v42, s[52:55], s80 offen offset:0
    v_mfma_f32_16x16x32_bf16 a[228:231], v[120:123], a[132:135], a[228:231]
    v_mfma_f32_16x16x32_bf16 a[232:235], v[124:127], a[128:131], a[232:235]
    s_add_u32 m0, s98, 126976
    s_nop 0
    buffer_load_dwordx4 v24, s[44:47], s81 offen offset:0 lds
    v_mfma_f32_16x16x32_bf16 a[236:239], v[124:127], a[132:135], a[236:239]
    s_waitcnt vmcnt(14) lgkmcnt(0)
    v_mfma_f32_16x16x32_bf16 a[200:203], v[128:131], a[136:139], a[200:203]
    ds_read_b128 v[108:111], v99 offset:40960
    v_mfma_f32_16x16x32_bf16 a[204:207], v[128:131], a[140:143], a[204:207]
    ds_read_b128 v[112:115], v99 offset:43008
    v_mfma_f32_16x16x32_bf16 a[208:211], v[132:135], a[136:139], a[208:211]
    ds_read_b128 v[116:119], v99 offset:45056
    v_mfma_f32_16x16x32_bf16 a[212:215], v[132:135], a[140:143], a[212:215]
    ds_read_b128 v[120:123], v99 offset:47104
    v_mfma_f32_16x16x32_bf16 a[216:219], v[136:139], a[136:139], a[216:219]
    ds_read_b128 v[124:127], v99 offset:49152
    v_mfma_f32_16x16x32_bf16 a[220:223], v[136:139], a[140:143], a[220:223]
    buffer_load_dwordx4 a[184:187], v42, s[52:55], s80 offen offset:1024
    v_mfma_f32_16x16x32_bf16 a[224:227], v[140:143], a[136:139], a[224:227]
    v_mfma_f32_16x16x32_bf16 a[228:231], v[140:143], a[140:143], a[228:231]
    buffer_load_dwordx4 a[188:191], v43, s[52:55], s80 offen offset:0
    v_mfma_f32_16x16x32_bf16 a[232:235], v[144:147], a[136:139], a[232:235]
    v_mfma_f32_16x16x32_bf16 a[236:239], v[144:147], a[140:143], a[236:239]
    s_barrier
    s_waitcnt vmcnt(13) lgkmcnt(0)
    v_mfma_f32_16x16x32_bf16 a[200:203], v[108:111], a[144:147], a[200:203]
    ds_read_b128 v[128:131], v96 offset:61440
    v_mfma_f32_16x16x32_bf16 a[204:207], v[108:111], a[148:151], a[204:207]
    ds_read_b128 v[132:135], v96 offset:63488
    v_mfma_f32_16x16x32_bf16 a[208:211], v[112:115], a[144:147], a[208:211]
    ds_read_b128 v[136:139], v100 offset:0
    v_mfma_f32_16x16x32_bf16 a[212:215], v[112:115], a[148:151], a[212:215]
    ds_read_b128 v[140:143], v100 offset:2048
    v_mfma_f32_16x16x32_bf16 a[216:219], v[116:119], a[144:147], a[216:219]
    ds_read_b128 v[144:147], v100 offset:4096
    v_mfma_f32_16x16x32_bf16 a[220:223], v[116:119], a[148:151], a[220:223]
    buffer_load_dwordx4 a[192:195], v44, s[52:55], s80 offen offset:0
    v_mfma_f32_16x16x32_bf16 a[224:227], v[120:123], a[144:147], a[224:227]
    buffer_load_dwordx4 a[196:199], v44, s[52:55], s80 offen offset:1024
    v_mfma_f32_16x16x32_bf16 a[228:231], v[120:123], a[148:151], a[228:231]
    v_mfma_f32_16x16x32_bf16 a[232:235], v[124:127], a[144:147], a[232:235]
    s_add_u32 m0, s98, 0
    s_add_u32 s81, s90, 9
    s_sub_u32 s101, s81, 10
    s_cselect_b32 s81, s81, s101
    s_lshl_b32 s81, s81, 7
    buffer_load_dwordx4 v20, s[44:47], s81 offen offset:0 lds
    v_mfma_f32_16x16x32_bf16 a[236:239], v[124:127], a[148:151], a[236:239]
    s_waitcnt vmcnt(14) lgkmcnt(0)
    v_mfma_f32_16x16x32_bf16 a[200:203], v[128:131], a[152:155], a[200:203]
    ds_read_b128 v[108:111], v97 offset:61440
    v_mfma_f32_16x16x32_bf16 a[204:207], v[128:131], a[156:159], a[204:207]
    ds_read_b128 v[112:115], v97 offset:63488
    v_mfma_f32_16x16x32_bf16 a[208:211], v[132:135], a[152:155], a[208:211]
    ds_read_b128 v[116:119], v101 offset:0
    v_mfma_f32_16x16x32_bf16 a[212:215], v[132:135], a[156:159], a[212:215]
    ds_read_b128 v[120:123], v101 offset:2048
    v_mfma_f32_16x16x32_bf16 a[216:219], v[136:139], a[152:155], a[216:219]
    ds_read_b128 v[124:127], v101 offset:4096
    v_mfma_f32_16x16x32_bf16 a[220:223], v[136:139], a[156:159], a[220:223]
    s_add_u32 s80, s78, 5
    s_and_b32 s80, s80, 7
    s_mul_i32 s80, s80, 20480
    buffer_load_dwordx4 a[0:3], v39, s[52:55], s80 offen offset:0
    v_mfma_f32_16x16x32_bf16 a[224:227], v[140:143], a[152:155], a[224:227]
    v_mfma_f32_16x16x32_bf16 a[228:231], v[140:143], a[156:159], a[228:231]
    buffer_load_dwordx4 a[4:7], v39, s[52:55], s80 offen offset:1024
    v_mfma_f32_16x16x32_bf16 a[232:235], v[144:147], a[152:155], a[232:235]
    v_mfma_f32_16x16x32_bf16 a[236:239], v[144:147], a[156:159], a[236:239]
    s_waitcnt vmcnt(13) lgkmcnt(0)
    v_mfma_f32_16x16x32_bf16 a[200:203], v[108:111], a[160:163], a[200:203]
    ds_read_b128 v[128:131], v98 offset:61440
    v_mfma_f32_16x16x32_bf16 a[204:207], v[108:111], a[164:167], a[204:207]
    ds_read_b128 v[132:135], v98 offset:63488
    v_mfma_f32_16x16x32_bf16 a[208:211], v[112:115], a[160:163], a[208:211]
    ds_read_b128 v[136:139], v102 offset:0
    v_mfma_f32_16x16x32_bf16 a[212:215], v[112:115], a[164:167], a[212:215]
    ds_read_b128 v[140:143], v102 offset:2048
    v_mfma_f32_16x16x32_bf16 a[216:219], v[116:119], a[160:163], a[216:219]
    ds_read_b128 v[144:147], v102 offset:4096
    v_mfma_f32_16x16x32_bf16 a[220:223], v[116:119], a[164:167], a[220:223]
    buffer_load_dwordx4 a[8:11], v40, s[52:55], s80 offen offset:0
    v_mfma_f32_16x16x32_bf16 a[224:227], v[120:123], a[160:163], a[224:227]
    buffer_load_dwordx4 a[12:15], v41, s[52:55], s80 offen offset:0
    v_mfma_f32_16x16x32_bf16 a[228:231], v[120:123], a[164:167], a[228:231]
    v_mfma_f32_16x16x32_bf16 a[232:235], v[124:127], a[160:163], a[232:235]
    buffer_load_dwordx4 v21, s[44:47], s81 offen offset:1024 lds
    v_mfma_f32_16x16x32_bf16 a[236:239], v[124:127], a[164:167], a[236:239]
    s_waitcnt vmcnt(14) lgkmcnt(0)
    v_mfma_f32_16x16x32_bf16 a[200:203], v[128:131], a[168:171], a[200:203]
    ds_read_b128 v[108:111], v99 offset:61440
    v_mfma_f32_16x16x32_bf16 a[204:207], v[128:131], a[172:175], a[204:207]
    ds_read_b128 v[112:115], v99 offset:63488
    v_mfma_f32_16x16x32_bf16 a[208:211], v[132:135], a[168:171], a[208:211]
    ds_read_b128 v[116:119], v103 offset:0
    v_mfma_f32_16x16x32_bf16 a[212:215], v[132:135], a[172:175], a[212:215]
    ds_read_b128 v[120:123], v103 offset:2048
    v_mfma_f32_16x16x32_bf16 a[216:219], v[136:139], a[168:171], a[216:219]
    ds_read_b128 v[124:127], v103 offset:4096
    v_mfma_f32_16x16x32_bf16 a[220:223], v[136:139], a[172:175], a[220:223]
    buffer_load_dwordx4 a[16:19], v41, s[52:55], s80 offen offset:1024
    v_mfma_f32_16x16x32_bf16 a[224:227], v[140:143], a[168:171], a[224:227]
    buffer_load_dwordx4 a[20:23], v42, s[52:55], s80 offen offset:0
    v_mfma_f32_16x16x32_bf16 a[228:231], v[140:143], a[172:175], a[228:231]
    v_mfma_f32_16x16x32_bf16 a[232:235], v[144:147], a[168:171], a[232:235]
    buffer_load_dwordx4 v22, s[44:47], s81 offen offset:2048 lds
    v_mfma_f32_16x16x32_bf16 a[236:239], v[144:147], a[172:175], a[236:239]
    s_waitcnt vmcnt(14) lgkmcnt(0)
    v_mfma_f32_16x16x32_bf16 a[200:203], v[108:111], a[176:179], a[200:203]
    ds_read_b128 v[128:131], v100 offset:16384
    v_mfma_f32_16x16x32_bf16 a[204:207], v[108:111], a[180:183], a[204:207]
    ds_read_b128 v[132:135], v100 offset:18432
    v_mfma_f32_16x16x32_bf16 a[208:211], v[112:115], a[176:179], a[208:211]
    ds_read_b128 v[136:139], v100 offset:20480
    v_mfma_f32_16x16x32_bf16 a[212:215], v[112:115], a[180:183], a[212:215]
    ds_read_b128 v[140:143], v100 offset:22528
    v_mfma_f32_16x16x32_bf16 a[216:219], v[116:119], a[176:179], a[216:219]
    ds_read_b128 v[144:147], v100 offset:24576
    v_mfma_f32_16x16x32_bf16 a[220:223], v[116:119], a[180:183], a[220:223]
    buffer_load_dwordx4 a[24:27], v42, s[52:55], s80 offen offset:1024
    v_mfma_f32_16x16x32_bf16 a[224:227], v[120:123], a[176:179], a[224:227]
    v_mfma_f32_16x16x32_bf16 a[228:231], v[120:123], a[180:183], a[228:231]
    buffer_load_dwordx4 a[28:31], v43, s[52:55], s80 offen offset:0
    v_mfma_f32_16x16x32_bf16 a[232:235], v[124:127], a[176:179], a[232:235]
    v_mfma_f32_16x16x32_bf16 a[236:239], v[124:127], a[180:183], a[236:239]
    s_waitcnt vmcnt(13) lgkmcnt(0)
    v_mfma_f32_16x16x32_bf16 a[200:203], v[128:131], a[184:187], a[200:203]
    ds_read_b128 v[108:111], v101 offset:16384
    v_mfma_f32_16x16x32_bf16 a[204:207], v[128:131], a[188:191], a[204:207]
    ds_read_b128 v[112:115], v101 offset:18432
    v_mfma_f32_16x16x32_bf16 a[208:211], v[132:135], a[184:187], a[208:211]
    ds_read_b128 v[116:119], v101 offset:20480
    v_mfma_f32_16x16x32_bf16 a[212:215], v[132:135], a[188:191], a[212:215]
    ds_read_b128 v[120:123], v101 offset:22528
    v_mfma_f32_16x16x32_bf16 a[216:219], v[136:139], a[184:187], a[216:219]
    ds_read_b128 v[124:127], v101 offset:24576
    v_mfma_f32_16x16x32_bf16 a[220:223], v[136:139], a[188:191], a[220:223]
    buffer_load_dwordx4 a[32:35], v44, s[52:55], s80 offen offset:0
    v_mfma_f32_16x16x32_bf16 a[224:227], v[140:143], a[184:187], a[224:227]
    buffer_load_dwordx4 a[36:39], v44, s[52:55], s80 offen offset:1024
    v_mfma_f32_16x16x32_bf16 a[228:231], v[140:143], a[188:191], a[228:231]
    v_mfma_f32_16x16x32_bf16 a[232:235], v[144:147], a[184:187], a[232:235]
    buffer_load_dwordx4 v23, s[44:47], s81 offen offset:3072 lds
    v_mfma_f32_16x16x32_bf16 a[236:239], v[144:147], a[188:191], a[236:239]
    s_waitcnt vmcnt(14) lgkmcnt(0)
    v_mfma_f32_16x16x32_bf16 a[200:203], v[108:111], a[192:195], a[200:203]
    ds_read_b128 v[128:131], v102 offset:16384
    v_mfma_f32_16x16x32_bf16 a[204:207], v[108:111], a[196:199], a[204:207]
    ds_read_b128 v[132:135], v102 offset:18432
    v_mfma_f32_16x16x32_bf16 a[208:211], v[112:115], a[192:195], a[208:211]
    ds_read_b128 v[136:139], v102 offset:20480
    v_mfma_f32_16x16x32_bf16 a[212:215], v[112:115], a[196:199], a[212:215]
    ds_read_b128 v[140:143], v102 offset:22528
    v_mfma_f32_16x16x32_bf16 a[216:219], v[116:119], a[192:195], a[216:219]
    ds_read_b128 v[144:147], v102 offset:24576
    v_mfma_f32_16x16x32_bf16 a[220:223], v[116:119], a[196:199], a[220:223]
    s_add_u32 s80, s78, 6
    s_and_b32 s80, s80, 7
    s_mul_i32 s80, s80, 20480
    buffer_load_dwordx4 a[40:43], v39, s[52:55], s80 offen offset:0
    v_mfma_f32_16x16x32_bf16 a[224:227], v[120:123], a[192:195], a[224:227]
    v_mfma_f32_16x16x32_bf16 a[228:231], v[120:123], a[196:199], a[228:231]
    buffer_load_dwordx4 a[44:47], v39, s[52:55], s80 offen offset:1024
    v_mfma_f32_16x16x32_bf16 a[232:235], v[124:127], a[192:195], a[232:235]
    v_mfma_f32_16x16x32_bf16 a[236:239], v[124:127], a[196:199], a[236:239]
    s_waitcnt vmcnt(13) lgkmcnt(0)
    v_mfma_f32_16x16x32_bf16 a[200:203], v[128:131], a[0:3], a[200:203]
    ds_read_b128 v[108:111], v103 offset:16384
    v_mfma_f32_16x16x32_bf16 a[204:207], v[128:131], a[4:7], a[204:207]
    ds_read_b128 v[112:115], v103 offset:18432
    v_mfma_f32_16x16x32_bf16 a[208:211], v[132:135], a[0:3], a[208:211]
    ds_read_b128 v[116:119], v103 offset:20480
    v_mfma_f32_16x16x32_bf16 a[212:215], v[132:135], a[4:7], a[212:215]
    ds_read_b128 v[120:123], v103 offset:22528
    v_mfma_f32_16x16x32_bf16 a[216:219], v[136:139], a[0:3], a[216:219]
    ds_read_b128 v[124:127], v103 offset:24576
    v_mfma_f32_16x16x32_bf16 a[220:223], v[136:139], a[4:7], a[220:223]
    buffer_load_dwordx4 a[48:51], v40, s[52:55], s80 offen offset:0
    v_mfma_f32_16x16x32_bf16 a[224:227], v[140:143], a[0:3], a[224:227]
    buffer_load_dwordx4 a[52:55], v41, s[52:55], s80 offen offset:0
    v_mfma_f32_16x16x32_bf16 a[228:231], v[140:143], a[4:7], a[228:231]
    v_mfma_f32_16x16x32_bf16 a[232:235], v[144:147], a[0:3], a[232:235]
    s_add_u32 m0, s98, 4096
    s_nop 0
    buffer_load_dwordx4 v24, s[44:47], s81 offen offset:0 lds
    v_mfma_f32_16x16x32_bf16 a[236:239], v[144:147], a[4:7], a[236:239]
    s_waitcnt vmcnt(14) lgkmcnt(0)
    v_mfma_f32_16x16x32_bf16 a[200:203], v[108:111], a[8:11], a[200:203]
    ds_read_b128 v[128:131], v104 offset:12288
    v_mfma_f32_16x16x32_bf16 a[204:207], v[108:111], a[12:15], a[204:207]
    ds_read_b128 v[132:135], v104 offset:14336
    v_mfma_f32_16x16x32_bf16 a[208:211], v[112:115], a[8:11], a[208:211]
    ds_read_b128 v[136:139], v104 offset:16384
    v_mfma_f32_16x16x32_bf16 a[212:215], v[112:115], a[12:15], a[212:215]
    ds_read_b128 v[140:143], v104 offset:18432
    v_mfma_f32_16x16x32_bf16 a[216:219], v[116:119], a[8:11], a[216:219]
    ds_read_b128 v[144:147], v104 offset:20480
    v_mfma_f32_16x16x32_bf16 a[220:223], v[116:119], a[12:15], a[220:223]
    buffer_load_dwordx4 a[56:59], v41, s[52:55], s80 offen offset:1024
    v_mfma_f32_16x16x32_bf16 a[224:227], v[120:123], a[8:11], a[224:227]
    v_mfma_f32_16x16x32_bf16 a[228:231], v[120:123], a[12:15], a[228:231]
    buffer_load_dwordx4 a[60:63], v42, s[52:55], s80 offen offset:0
    v_mfma_f32_16x16x32_bf16 a[232:235], v[124:127], a[8:11], a[232:235]
    v_mfma_f32_16x16x32_bf16 a[236:239], v[124:127], a[12:15], a[236:239]
    s_waitcnt vmcnt(13) lgkmcnt(0)
    v_mfma_f32_16x16x32_bf16 a[200:203], v[128:131], a[16:19], a[200:203]
    ds_read_b128 v[108:111], v105 offset:12288
    v_mfma_f32_16x16x32_bf16 a[204:207], v[128:131], a[20:23], a[204:207]
    ds_read_b128 v[112:115], v105 offset:14336
    v_mfma_f32_16x16x32_bf16 a[208:211], v[132:135], a[16:19], a[208:211]
    ds_read_b128 v[116:119], v105 offset:16384
    v_mfma_f32_16x16x32_bf16 a[212:215], v[132:135], a[20:23], a[212:215]
    ds_read_b128 v[120:123], v105 offset:18432
    v_mfma_f32_16x16x32_bf16 a[216:219], v[136:139], a[16:19], a[216:219]
    ds_read_b128 v[124:127], v105 offset:20480
    v_mfma_f32_16x16x32_bf16 a[220:223], v[136:139], a[20:23], a[220:223]
    buffer_load_dwordx4 a[64:67], v42, s[52:55], s80 offen offset:1024
    v_mfma_f32_16x16x32_bf16 a[224:227], v[140:143], a[16:19], a[224:227]
    v_mfma_f32_16x16x32_bf16 a[228:231], v[140:143], a[20:23], a[228:231]
    buffer_load_dwordx4 a[68:71], v43, s[52:55], s80 offen offset:0
    v_mfma_f32_16x16x32_bf16 a[232:235], v[144:147], a[16:19], a[232:235]
    v_mfma_f32_16x16x32_bf16 a[236:239], v[144:147], a[20:23], a[236:239]
    s_waitcnt vmcnt(12) lgkmcnt(0)
    v_mfma_f32_16x16x32_bf16 a[200:203], v[108:111], a[24:27], a[200:203]
    ds_read_b128 v[128:131], v106 offset:12288
    v_mfma_f32_16x16x32_bf16 a[204:207], v[108:111], a[28:31], a[204:207]
    ds_read_b128 v[132:135], v106 offset:14336
    v_mfma_f32_16x16x32_bf16 a[208:211], v[112:115], a[24:27], a[208:211]
    ds_read_b128 v[136:139], v106 offset:16384
    v_mfma_f32_16x16x32_bf16 a[212:215], v[112:115], a[28:31], a[212:215]
    ds_read_b128 v[140:143], v106 offset:18432
    v_mfma_f32_16x16x32_bf16 a[216:219], v[116:119], a[24:27], a[216:219]
    ds_read_b128 v[144:147], v106 offset:20480
    v_mfma_f32_16x16x32_bf16 a[220:223], v[116:119], a[28:31], a[220:223]
    buffer_load_dwordx4 a[72:75], v44, s[52:55], s80 offen offset:0
    v_mfma_f32_16x16x32_bf16 a[224:227], v[120:123], a[24:27], a[224:227]
    v_mfma_f32_16x16x32_bf16 a[228:231], v[120:123], a[28:31], a[228:231]
    buffer_load_dwordx4 a[76:79], v44, s[52:55], s80 offen offset:1024
    v_mfma_f32_16x16x32_bf16 a[232:235], v[124:127], a[24:27], a[232:235]
    v_mfma_f32_16x16x32_bf16 a[236:239], v[124:127], a[28:31], a[236:239]
    s_waitcnt vmcnt(12) lgkmcnt(0)
    v_mfma_f32_16x16x32_bf16 a[200:203], v[128:131], a[32:35], a[200:203]
    ds_read_b128 v[108:111], v107 offset:12288
    v_mfma_f32_16x16x32_bf16 a[204:207], v[128:131], a[36:39], a[204:207]
    ds_read_b128 v[112:115], v107 offset:14336
    v_mfma_f32_16x16x32_bf16 a[208:211], v[132:135], a[32:35], a[208:211]
    ds_read_b128 v[116:119], v107 offset:16384
    v_mfma_f32_16x16x32_bf16 a[212:215], v[132:135], a[36:39], a[212:215]
    ds_read_b128 v[120:123], v107 offset:18432
    v_mfma_f32_16x16x32_bf16 a[216:219], v[136:139], a[32:35], a[216:219]
    ds_read_b128 v[124:127], v107 offset:20480
    v_mfma_f32_16x16x32_bf16 a[220:223], v[136:139], a[36:39], a[220:223]
    s_add_u32 s80, s78, 7
    s_and_b32 s80, s80, 7
    s_mul_i32 s80, s80, 20480
    buffer_load_dwordx4 a[80:83], v39, s[52:55], s80 offen offset:0
    v_mfma_f32_16x16x32_bf16 a[224:227], v[140:143], a[32:35], a[224:227]
    v_mfma_f32_16x16x32_bf16 a[228:231], v[140:143], a[36:39], a[228:231]
    buffer_load_dwordx4 a[84:87], v39, s[52:55], s80 offen offset:1024
    v_mfma_f32_16x16x32_bf16 a[232:235], v[144:147], a[32:35], a[232:235]
    v_mfma_f32_16x16x32_bf16 a[236:239], v[144:147], a[36:39], a[236:239]
    s_waitcnt vmcnt(8)
    s_barrier
    s_waitcnt lgkmcnt(0)
    v_mfma_f32_16x16x32_bf16 a[200:203], v[108:111], a[40:43], a[200:203]
    ds_read_b128 v[128:131], v100 offset:57344
    v_mfma_f32_16x16x32_bf16 a[204:207], v[108:111], a[44:47], a[204:207]
    ds_read_b128 v[132:135], v100 offset:59392
    v_mfma_f32_16x16x32_bf16 a[208:211], v[112:115], a[40:43], a[208:211]
    ds_read_b128 v[136:139], v100 offset:61440
    v_mfma_f32_16x16x32_bf16 a[212:215], v[112:115], a[44:47], a[212:215]
    ds_read_b128 v[140:143], v100 offset:63488
    v_mfma_f32_16x16x32_bf16 a[216:219], v[116:119], a[40:43], a[216:219]
    ds_read_b128 v[144:147], v104 offset:0
    v_mfma_f32_16x16x32_bf16 a[220:223], v[116:119], a[44:47], a[220:223]
    buffer_load_dwordx4 a[88:91], v40, s[52:55], s80 offen offset:0
    v_mfma_f32_16x16x32_bf16 a[224:227], v[120:123], a[40:43], a[224:227]
    v_mfma_f32_16x16x32_bf16 a[228:231], v[120:123], a[44:47], a[228:231]
    buffer_load_dwordx4 a[92:95], v41, s[52:55], s80 offen offset:0
    v_mfma_f32_16x16x32_bf16 a[232:235], v[124:127], a[40:43], a[232:235]
    v_mfma_f32_16x16x32_bf16 a[236:239], v[124:127], a[44:47], a[236:239]
    s_waitcnt lgkmcnt(0)
    v_mfma_f32_16x16x32_bf16 a[200:203], v[128:131], a[48:51], a[200:203]
    ds_read_b128 v[108:111], v101 offset:57344
    v_mfma_f32_16x16x32_bf16 a[204:207], v[128:131], a[52:55], a[204:207]
    ds_read_b128 v[112:115], v101 offset:59392
    v_mfma_f32_16x16x32_bf16 a[208:211], v[132:135], a[48:51], a[208:211]
    ds_read_b128 v[116:119], v101 offset:61440
    v_mfma_f32_16x16x32_bf16 a[212:215], v[132:135], a[52:55], a[212:215]
    ds_read_b128 v[120:123], v101 offset:63488
    v_mfma_f32_16x16x32_bf16 a[216:219], v[136:139], a[48:51], a[216:219]
    ds_read_b128 v[124:127], v105 offset:0
    v_mfma_f32_16x16x32_bf16 a[220:223], v[136:139], a[52:55], a[220:223]
    buffer_load_dwordx4 a[96:99], v41, s[52:55], s80 offen offset:1024
    v_mfma_f32_16x16x32_bf16 a[224:227], v[140:143], a[48:51], a[224:227]
    v_mfma_f32_16x16x32_bf16 a[228:231], v[140:143], a[52:55], a[228:231]
    buffer_load_dwordx4 a[100:103], v42, s[52:55], s80 offen offset:0
    v_mfma_f32_16x16x32_bf16 a[232:235], v[144:147], a[48:51], a[232:235]
    v_mfma_f32_16x16x32_bf16 a[236:239], v[144:147], a[52:55], a[236:239]
    s_waitcnt vmcnt(10) lgkmcnt(0)
    v_mfma_f32_16x16x32_bf16 a[200:203], v[108:111], a[56:59], a[200:203]
    ds_read_b128 v[128:131], v102 offset:57344
    v_mfma_f32_16x16x32_bf16 a[204:207], v[108:111], a[60:63], a[204:207]
    ds_read_b128 v[132:135], v102 offset:59392
    v_mfma_f32_16x16x32_bf16 a[208:211], v[112:115], a[56:59], a[208:211]
    ds_read_b128 v[136:139], v102 offset:61440
    v_mfma_f32_16x16x32_bf16 a[212:215], v[112:115], a[60:63], a[212:215]
    ds_read_b128 v[140:143], v102 offset:63488
    v_mfma_f32_16x16x32_bf16 a[216:219], v[116:119], a[56:59], a[216:219]
    ds_read_b128 v[144:147], v106 offset:0
    v_mfma_f32_16x16x32_bf16 a[220:223], v[116:119], a[60:63], a[220:223]
    buffer_load_dwordx4 a[104:107], v42, s[52:55], s80 offen offset:1024
    v_mfma_f32_16x16x32_bf16 a[224:227], v[120:123], a[56:59], a[224:227]
    v_mfma_f32_16x16x32_bf16 a[228:231], v[120:123], a[60:63], a[228:231]
    buffer_load_dwordx4 a[108:111], v43, s[52:55], s80 offen offset:0
    v_mfma_f32_16x16x32_bf16 a[232:235], v[124:127], a[56:59], a[232:235]
    v_mfma_f32_16x16x32_bf16 a[236:239], v[124:127], a[60:63], a[236:239]
    s_waitcnt vmcnt(10) lgkmcnt(0)
    v_mfma_f32_16x16x32_bf16 a[200:203], v[128:131], a[64:67], a[200:203]
    ds_read_b128 v[108:111], v103 offset:57344
    v_mfma_f32_16x16x32_bf16 a[204:207], v[128:131], a[68:71], a[204:207]
    ds_read_b128 v[112:115], v103 offset:59392
    v_mfma_f32_16x16x32_bf16 a[208:211], v[132:135], a[64:67], a[208:211]
    ds_read_b128 v[116:119], v103 offset:61440
    v_mfma_f32_16x16x32_bf16 a[212:215], v[132:135], a[68:71], a[212:215]
    ds_read_b128 v[120:123], v103 offset:63488
    v_mfma_f32_16x16x32_bf16 a[216:219], v[136:139], a[64:67], a[216:219]
    ds_read_b128 v[124:127], v107 offset:0
    v_mfma_f32_16x16x32_bf16 a[220:223], v[136:139], a[68:71], a[220:223]
    buffer_load_dwordx4 a[112:115], v44, s[52:55], s80 offen offset:0
    v_mfma_f32_16x16x32_bf16 a[224:227], v[140:143], a[64:67], a[224:227]
    v_mfma_f32_16x16x32_bf16 a[228:231], v[140:143], a[68:71], a[228:231]
    buffer_load_dwordx4 a[116:119], v44, s[52:55], s80 offen offset:1024
    v_mfma_f32_16x16x32_bf16 a[232:235], v[144:147], a[64:67], a[232:235]
    v_mfma_f32_16x16x32_bf16 a[236:239], v[144:147], a[68:71], a[236:239]
    s_waitcnt vmcnt(10) lgkmcnt(0)
    v_mfma_f32_16x16x32_bf16 a[200:203], v[108:111], a[72:75], a[200:203]
    ds_read_b128 v[128:131], v96 offset:0
    v_mfma_f32_16x16x32_bf16 a[204:207], v[108:111], a[76:79], a[204:207]
    ds_read_b128 v[132:135], v96 offset:2048
    v_mfma_f32_16x16x32_bf16 a[208:211], v[112:115], a[72:75], a[208:211]
    ds_read_b128 v[136:139], v96 offset:4096
    v_mfma_f32_16x16x32_bf16 a[212:215], v[112:115], a[76:79], a[212:215]
    ds_read_b128 v[140:143], v96 offset:6144
    v_mfma_f32_16x16x32_bf16 a[216:219], v[116:119], a[72:75], a[216:219]
    ds_read_b128 v[144:147], v96 offset:8192
    v_mfma_f32_16x16x32_bf16 a[220:223], v[116:119], a[76:79], a[220:223]
    v_mfma_f32_16x16x32_bf16 a[224:227], v[120:123], a[72:75], a[224:227]
    v_mfma_f32_16x16x32_bf16 a[228:231], v[120:123], a[76:79], a[228:231]
    v_mfma_f32_16x16x32_bf16 a[232:235], v[124:127], a[72:75], a[232:235]
    v_mfma_f32_16x16x32_bf16 a[236:239], v[124:127], a[76:79], a[236:239]
    s_waitcnt vmcnt(8) lgkmcnt(0)
    v_mfma_f32_16x16x32_bf16 a[200:203], v[128:131], a[80:83], a[200:203]
    ds_read_b128 v[108:111], v97 offset:0
    v_mfma_f32_16x16x32_bf16 a[204:207], v[128:131], a[84:87], a[204:207]
    ds_read_b128 v[112:115], v97 offset:2048
    v_mfma_f32_16x16x32_bf16 a[208:211], v[132:135], a[80:83], a[208:211]
    ds_read_b128 v[116:119], v97 offset:4096
    v_mfma_f32_16x16x32_bf16 a[212:215], v[132:135], a[84:87], a[212:215]
    ds_read_b128 v[120:123], v97 offset:6144
    v_mfma_f32_16x16x32_bf16 a[216:219], v[136:139], a[80:83], a[216:219]
    ds_read_b128 v[124:127], v97 offset:8192
    v_mfma_f32_16x16x32_bf16 a[220:223], v[136:139], a[84:87], a[220:223]
    v_mfma_f32_16x16x32_bf16 a[224:227], v[140:143], a[80:83], a[224:227]
    v_mfma_f32_16x16x32_bf16 a[228:231], v[140:143], a[84:87], a[228:231]
    v_mfma_f32_16x16x32_bf16 a[232:235], v[144:147], a[80:83], a[232:235]
    v_mfma_f32_16x16x32_bf16 a[236:239], v[144:147], a[84:87], a[236:239]
    s_waitcnt vmcnt(6) lgkmcnt(0)
    v_mfma_f32_16x16x32_bf16 a[200:203], v[108:111], a[88:91], a[200:203]
    ds_read_b128 v[128:131], v98 offset:0
    v_mfma_f32_16x16x32_bf16 a[204:207], v[108:111], a[92:95], a[204:207]
    ds_read_b128 v[132:135], v98 offset:2048
    v_mfma_f32_16x16x32_bf16 a[208:211], v[112:115], a[88:91], a[208:211]
    ds_read_b128 v[136:139], v98 offset:4096
    v_mfma_f32_16x16x32_bf16 a[212:215], v[112:115], a[92:95], a[212:215]
    ds_read_b128 v[140:143], v98 offset:6144
    v_mfma_f32_16x16x32_bf16 a[216:219], v[116:119], a[88:91], a[216:219]
    ds_read_b128 v[144:147], v98 offset:8192
    v_mfma_f32_16x16x32_bf16 a[220:223], v[116:119], a[92:95], a[220:223]
    v_mfma_f32_16x16x32_bf16 a[224:227], v[120:123], a[88:91], a[224:227]
    v_mfma_f32_16x16x32_bf16 a[228:231], v[120:123], a[92:95], a[228:231]
    v_mfma_f32_16x16x32_bf16 a[232:235], v[124:127], a[88:91], a[232:235]
    v_mfma_f32_16x16x32_bf16 a[236:239], v[124:127], a[92:95], a[236:239]
    s_mov_b32 s81, 589824
    s_waitcnt vmcnt(0)
    s_cmp_eq_u32 s34, 0
    s_cbranch_scc1 L_wt_36
    buffer_store_dword v16, v33, s[48:51], s81 offen
    s_branch L_j_37
L_wt_36:
    buffer_store_dword v16, v33, s[48:51], s81 offen sc1
L_j_37:
    s_waitcnt lgkmcnt(0)
    v_mfma_f32_16x16x32_bf16 a[200:203], v[128:131], a[96:99], a[200:203]
    ds_read_b128 v[108:111], v99 offset:0
    v_mfma_f32_16x16x32_bf16 a[204:207], v[128:131], a[100:103], a[204:207]
    ds_read_b128 v[112:115], v99 offset:2048
    v_mfma_f32_16x16x32_bf16 a[208:211], v[132:135], a[96:99], a[208:211]
    ds_read_b128 v[116:119], v99 offset:4096
    v_mfma_f32_16x16x32_bf16 a[212:215], v[132:135], a[100:103], a[212:215]
    ds_read_b128 v[120:123], v99 offset:6144
    v_mfma_f32_16x16x32_bf16 a[216:219], v[136:139], a[96:99], a[216:219]
    ds_read_b128 v[124:127], v99 offset:8192
    v_mfma_f32_16x16x32_bf16 a[220:223], v[136:139], a[100:103], a[220:223]
    v_mfma_f32_16x16x32_bf16 a[224:227], v[140:143], a[96:99], a[224:227]
    v_mfma_f32_16x16x32_bf16 a[228:231], v[140:143], a[100:103], a[228:231]
    v_mfma_f32_16x16x32_bf16 a[232:235], v[144:147], a[96:99], a[232:235]
    v_mfma_f32_16x16x32_bf16 a[236:239], v[144:147], a[100:103], a[236:239]
    s_waitcnt lgkmcnt(0)
    v_mfma_f32_16x16x32_bf16 a[200:203], v[108:111], a[104:107], a[200:203]
    ds_read_b128 v[128:131], v100 offset:36864
    v_mfma_f32_16x16x32_bf16 a[208:211], v[112:115], a[104:107], a[208:211]
    ds_read_b128 v[132:135], v100 offset:38912
    v_mfma_f32_16x16x32_bf16 a[216:219], v[116:119], a[104:107], a[216:219]
    ds_read_b128 v[136:139], v100 offset:40960
    v_mfma_f32_16x16x32_bf16 a[224:227], v[120:123], a[104:107], a[224:227]
    ds_read_b128 v[140:143], v100 offset:43008
    v_mfma_f32_16x16x32_bf16 a[232:235], v[124:127], a[104:107], a[232:235]
    ds_read_b128 v[144:147], v100 offset:45056
    buffer_load_dword v17, v34, s[48:51], s81 offen sc1
    s_waitcnt lgkmcnt(0)
    v_mfma_f32_16x16x32_bf16 a[200:203], v[128:131], a[112:115], a[200:203]
    v_mfma_f32_16x16x32_bf16 a[208:211], v[132:135], a[112:115], a[208:211]
    v_mfma_f32_16x16x32_bf16 a[216:219], v[136:139], a[112:115], a[216:219]
    v_mfma_f32_16x16x32_bf16 a[224:227], v[140:143], a[112:115], a[224:227]
    v_mfma_f32_16x16x32_bf16 a[232:235], v[144:147], a[112:115], a[232:235]
    v_mfma_f32_16x16x32_bf16 a[204:207], v[108:111], a[108:111], a[204:207]
    v_mfma_f32_16x16x32_bf16 a[212:215], v[112:115], a[108:111], a[212:215]
    v_mfma_f32_16x16x32_bf16 a[220:223], v[116:119], a[108:111], a[220:223]
    s_nop 0
    ds_write_b128 v48, a[200:203] offset:0
    v_mfma_f32_16x16x32_bf16 a[228:231], v[120:123], a[108:111], a[228:231]
    ds_write_b128 v48, a[208:211] offset:64
    v_mfma_f32_16x16x32_bf16 a[236:239], v[124:127], a[108:111], a[236:239]
    v_mfma_f32_16x16x32_bf16 a[204:207], v[128:131], a[116:119], a[204:207]
    ds_write_b128 v48, a[216:219] offset:128
    v_mfma_f32_16x16x32_bf16 a[212:215], v[132:135], a[116:119], a[212:215]
    ds_write_b128 v48, a[224:227] offset:192
    v_mfma_f32_16x16x32_bf16 a[220:223], v[136:139], a[116:119], a[220:223]
    v_mfma_f32_16x16x32_bf16 a[228:231], v[140:143], a[116:119], a[228:231]
    ds_write_b128 v48, a[232:235] offset:256
    v_mfma_f32_16x16x32_bf16 a[236:239], v[144:147], a[116:119], a[236:239]
    ds_read_b128 v[216:219], v55 offset:0
    ds_read_b128 v[220:223], v56 offset:0
    ds_read_b128 v[224:227], v57 offset:0
    ds_read_b128 v[228:231], v58 offset:0
    ds_read_b128 v[232:235], v59 offset:0
    ds_write_b128 v48, a[204:207] offset:5376
    ds_write_b128 v48, a[212:215] offset:5440
    ds_write_b128 v48, a[220:223] offset:5504
    ds_write_b128 v48, a[228:231] offset:5568
    ds_write_b128 v48, a[236:239] offset:5632
    ds_read_b128 v[236:239], v55 offset:5376
    ds_read_b128 v[240:243], v56 offset:5376
    ds_read_b128 v[244:247], v57 offset:5376
    ds_read_b128 v[248:251], v58 offset:5376
    ds_read_b128 v[252:255], v59 offset:5376
    s_waitcnt vmcnt(0)
    v_cmp_ne_u32 vcc, v16, v17
    s_nop 3
    s_cbranch_vccz L_rd_39
    s_mov_b32 s82, 0x40000
L_rp_38:
    buffer_load_dword v17, v34, s[48:51], s81 offen sc1
    s_waitcnt vmcnt(0)
    v_cmp_ne_u32 vcc, v16, v17
    s_nop 3
    s_cbranch_vccz L_rd_39
    s_sub_u32 s82, s82, 1
    s_cbranch_scc0 L_rp_38
L_rd_39:
    s_waitcnt lgkmcnt(14)
    buffer_store_dwordx4 v[216:219], v50, s[52:55], 0 offen nt
    s_waitcnt lgkmcnt(13)
    buffer_store_dwordx4 v[220:223], v51, s[52:55], 0 offen nt
    s_waitcnt lgkmcnt(12)
    buffer_store_dwordx4 v[224:227], v52, s[52:55], 0 offen nt
    s_waitcnt lgkmcnt(11)
    buffer_store_dwordx4 v[228:231], v53, s[52:55], 0 offen nt
    s_waitcnt lgkmcnt(10)
    buffer_store_dwordx4 v[232:235], v54, s[52:55], 0 offen nt
    s_waitcnt lgkmcnt(4)
    buffer_store_dwordx4 v[236:239], v50, s[52:55], s93 offen nt
    s_waitcnt lgkmcnt(3)
    buffer_store_dwordx4 v[240:243], v51, s[52:55], s93 offen nt
    s_waitcnt lgkmcnt(2)
    buffer_store_dwordx4 v[244:247], v52, s[52:55], s93 offen nt
    s_waitcnt lgkmcnt(1)
    buffer_store_dwordx4 v[248:251], v53, s[52:55], s93 offen nt
    s_waitcnt lgkmcnt(0)
    buffer_store_dwordx4 v[252:255], v54, s[52:55], s93 offen nt
    s_endpgm
L_own2:
    ds_read_b128 v[108:111], v102 offset:36864
    ds_read_b128 v[112:115], v102 offset:38912
    ds_read_b128 v[116:119], v102 offset:40960
    ds_read_b128 v[120:123], v102 offset:43008
    s_waitcnt vmcnt(11)
    ds_read_b128 v[124:127], v102 offset:45056
    s_waitcnt vmcnt(0)
    s_cmp_eq_u32 s34, 0
    s_cbranch_scc1 L_wt_40
    buffer_store_dword v16, v33, s[48:51], 0 offen
    s_branch L_j_41
L_wt_40:
    buffer_store_dword v16, v33, s[48:51], 0 offen sc1
L_j_41:
    s_waitcnt lgkmcnt(0)
    v_mfma_f32_16x16x32_bf16 a[200:203], v[108:111], v[176:179], a[200:203]
    ds_read_b128 v[128:131], v103 offset:36864
    v_mfma_f32_16x16x32_bf16 a[204:207], v[108:111], v[180:183], a[204:207]
    ds_read_b128 v[132:135], v103 offset:38912
    v_mfma_f32_16x16x32_bf16 a[208:211], v[112:115], v[176:179], a[208:211]
    ds_read_b128 v[136:139], v103 offset:40960
    v_mfma_f32_16x16x32_bf16 a[212:215], v[112:115], v[180:183], a[212:215]
    ds_read_b128 v[140:143], v103 offset:43008
    v_mfma_f32_16x16x32_bf16 a[216:219], v[116:119], v[176:179], a[216:219]
    ds_read_b128 v[144:147], v103 offset:45056
    v_mfma_f32_16x16x32_bf16 a[220:223], v[116:119], v[180:183], a[220:223]
    s_add_u32 m0, s98, 61440
    s_add_u32 s81, s90, 5
    s_sub_u32 s101, s81, 10
    s_cselect_b32 s81, s81, s101
    s_lshl_b32 s81, s81, 7
    buffer_load_dwordx4 v20, s[44:47], s81 offen offset:0 lds
    v_mfma_f32_16x16x32_bf16 a[224:227], v[120:123], v[176:179], a[224:227]
    v_mfma_f32_16x16x32_bf16 a[228:231], v[120:123], v[180:183], a[228:231]
    buffer_load_dwordx4 v21, s[44:47], s81 offen offset:1024 lds
    v_mfma_f32_16x16x32_bf16 a[232:235], v[124:127], v[176:179], a[232:235]
    v_mfma_f32_16x16x32_bf16 a[236:239], v[124:127], v[180:183], a[236:239]
    s_waitcnt lgkmcnt(0)
    v_mfma_f32_16x16x32_bf16 a[200:203], v[128:131], v[184:187], a[200:203]
    ds_read_b128 v[108:111], v100 offset:57344
    v_mfma_f32_16x16x32_bf16 a[204:207], v[128:131], v[188:191], a[204:207]
    ds_read_b128 v[112:115], v100 offset:59392
    v_mfma_f32_16x16x32_bf16 a[208:211], v[132:135], v[184:187], a[208:211]
    ds_read_b128 v[116:119], v100 offset:61440
    v_mfma_f32_16x16x32_bf16 a[212:215], v[132:135], v[188:191], a[212:215]
    ds_read_b128 v[120:123], v100 offset:63488
    v_mfma_f32_16x16x32_bf16 a[216:219], v[136:139], v[184:187], a[216:219]
    ds_read_b128 v[124:127], v104 offset:0
    v_mfma_f32_16x16x32_bf16 a[220:223], v[136:139], v[188:191], a[220:223]
    buffer_load_dwordx4 v22, s[44:47], s81 offen offset:2048 lds
    v_mfma_f32_16x16x32_bf16 a[224:227], v[140:143], v[184:187], a[224:227]
    v_mfma_f32_16x16x32_bf16 a[228:231], v[140:143], v[188:191], a[228:231]
    buffer_load_dwordx4 v23, s[44:47], s81 offen offset:3072 lds
    v_mfma_f32_16x16x32_bf16 a[232:235], v[144:147], v[184:187], a[232:235]
    v_mfma_f32_16x16x32_bf16 a[236:239], v[144:147], v[188:191], a[236:239]
    s_waitcnt lgkmcnt(0)
    v_mfma_f32_16x16x32_bf16 a[200:203], v[108:111], v[192:195], a[200:203]
    ds_read_b128 v[128:131], v101 offset:57344
    v_mfma_f32_16x16x32_bf16 a[204:207], v[108:111], v[196:199], a[204:207]
    ds_read_b128 v[132:135], v101 offset:59392
    v_mfma_f32_16x16x32_bf16 a[208:211], v[112:115], v[192:195], a[208:211]
    ds_read_b128 v[136:139], v101 offset:61440
    v_mfma_f32_16x16x32_bf16 a[212:215], v[112:115], v[196:199], a[212:215]
    ds_read_b128 v[140:143], v101 offset:63488
    v_mfma_f32_16x16x32_bf16 a[216:219], v[116:119], v[192:195], a[216:219]
    ds_read_b128 v[144:147], v105 offset:0
    v_mfma_f32_16x16x32_bf16 a[220:223], v[116:119], v[196:199], a[220:223]
    s_add_u32 m0, s98, 65536
    s_nop 0
    buffer_load_dwordx4 v24, s[44:47], s81 offen offset:0 lds
    v_mfma_f32_16x16x32_bf16 a[224:227], v[120:123], v[192:195], a[224:227]
    s_add_u32 m0, s98, 81920
    s_add_u32 s81, s90, 6
    s_sub_u32 s101, s81, 10
    s_cselect_b32 s81, s81, s101
    s_lshl_b32 s81, s81, 7
    buffer_load_dwordx4 v20, s[44:47], s81 offen offset:0 lds
    v_mfma_f32_16x16x32_bf16 a[228:231], v[120:123], v[196:199], a[228:231]
    v_mfma_f32_16x16x32_bf16 a[232:235], v[124:127], v[192:195], a[232:235]
    buffer_load_dwordx4 v21, s[44:47], s81 offen offset:1024 lds
    v_mfma_f32_16x16x32_bf16 a[236:239], v[124:127], v[196:199], a[236:239]
    s_waitcnt lgkmcnt(0)
    v_mfma_f32_16x16x32_bf16 a[200:203], v[128:131], v[200:203], a[200:203]
    ds_read_b128 v[108:111], v102 offset:57344
    v_mfma_f32_16x16x32_bf16 a[204:207], v[128:131], v[204:207], a[204:207]
    ds_read_b128 v[112:115], v102 offset:59392
    v_mfma_f32_16x16x32_bf16 a[208:211], v[132:135], v[200:203], a[208:211]
    ds_read_b128 v[116:119], v102 offset:61440
    v_mfma_f32_16x16x32_bf16 a[212:215], v[132:135], v[204:207], a[212:215]
    ds_read_b128 v[120:123], v102 offset:63488
    v_mfma_f32_16x16x32_bf16 a[216:219], v[136:139], v[200:203], a[216:219]
    ds_read_b128 v[124:127], v106 offset:0
    v_mfma_f32_16x16x32_bf16 a[220:223], v[136:139], v[204:207], a[220:223]
    buffer_load_dwordx4 v22, s[44:47], s81 offen offset:2048 lds
    v_mfma_f32_16x16x32_bf16 a[224:227], v[140:143], v[200:203], a[224:227]
    v_mfma_f32_16x16x32_bf16 a[228:231], v[140:143], v[204:207], a[228:231]
    buffer_load_dwordx4 v23, s[44:47], s81 offen offset:3072 lds
    v_mfma_f32_16x16x32_bf16 a[232:235], v[144:147], v[200:203], a[232:235]
    v_mfma_f32_16x16x32_bf16 a[236:239], v[144:147], v[204:207], a[236:239]
    s_waitcnt lgkmcnt(0)
    v_mfma_f32_16x16x32_bf16 a[200:203], v[108:111], v[208:211], a[200:203]
    ds_read_b128 v[128:131], v103 offset:57344
    v_mfma_f32_16x16x32_bf16 a[204:207], v[108:111], v[212:215], a[204:207]
    ds_read_b128 v[132:135], v103 offset:59392
    v_mfma_f32_16x16x32_bf16 a[208:211], v[112:115], v[208:211], a[208:211]
    ds_read_b128 v[136:139], v103 offset:61440
    v_mfma_f32_16x16x32_bf16 a[212:215], v[112:115], v[212:215], a[212:215]
    ds_read_b128 v[140:143], v103 offset:63488
    v_mfma_f32_16x16x32_bf16 a[216:219], v[116:119], v[208:211], a[216:219]
    ds_read_b128 v[144:147], v107 offset:0
    v_mfma_f32_16x16x32_bf16 a[220:223], v[116:119], v[212:215], a[220:223]
    s_add_u32 m0, s98, 86016
    s_nop 0
    buffer_load_dwordx4 v24, s[44:47], s81 offen offset:0 lds
    v_mfma_f32_16x16x32_bf16 a[224:227], v[120:123], v[208:211], a[224:227]
    s_add_u32 m0, s98, 143360
    s_add_u32 s81, s90, 7
    s_sub_u32 s101, s81, 10
    s_cselect_b32 s81, s81, s101
    s_lshl_b32 s81, s81, 7
    buffer_load_dwordx4 v20, s[44:47], s81 offen offset:0 lds
    v_mfma_f32_16x16x32_bf16 a[228:231], v[120:123], v[212:215], a[228:231]
    v_mfma_f32_16x16x32_bf16 a[232:235], v[124:127], v[208:211], a[232:235]
    buffer_load_dwordx4 v21, s[44:47], s81 offen offset:1024 lds
    v_mfma_f32_16x16x32_bf16 a[236:239], v[124:127], v[212:215], a[236:239]
    v_and_b32 v4, 15, v0
    v_bfe_u32 v3, v0, 4, 2
    s_mul_i32 s94, s76, 10752
    s_add_u32 s94, s94, 20480
    v_mul_u32_u24 v5, 336, v4
    v_lshl_add_u32 v5, v3, 4, v5
    v_add_u32 v48, s94, v5
    s_lshl_b32 s95, s77, 7
    s_lshl_b32 s96, s76, 5
    s_add_u32 s95, s95, s96
    s_mul_i32 s95, s95, 5120
    s_mul_i32 s96, s78, 320
    s_add_u32 s95, s95, s96
    s_add_u32 s95, s95, 2560
    v_and_b32 v3, 63, v0
    v_add_u32 v4, 0, v3
    v_mul_u32_u24 v5, 3277, v4
    v_lshrrev_b32 v5, 16, v5
    v_lshlrev_b32 v4, 4, v4
    v_lshl_add_u32 v6, v5, 4, v4
    v_add_u32 v55, s94, v6
    v_mul_u32_u24 v5, 4800, v5
    v_add3_u32 v50, v5, v4, s95
    v_add_u32 v4, 64, v3
    v_mul_u32_u24 v5, 3277, v4
    v_lshrrev_b32 v5, 16, v5
    v_lshlrev_b32 v4, 4, v4
    v_lshl_add_u32 v6, v5, 4, v4
    v_add_u32 v56, s94, v6
    v_mul_u32_u24 v5, 4800, v5
    v_add3_u32 v51, v5, v4, s95
    v_add_u32 v4, 128, v3
    v_mul_u32_u24 v5, 3277, v4
    v_lshrrev_b32 v5, 16, v5
    v_lshlrev_b32 v4, 4, v4
    v_lshl_add_u32 v6, v5, 4, v4
    v_add_u32 v57, s94, v6
    v_mul_u32_u24 v5, 4800, v5
    v_add3_u32 v52, v5, v4, s95
    v_add_u32 v4, 192, v3
    v_mul_u32_u24 v5, 3277, v4
    v_lshrrev_b32 v5, 16, v5
    v_lshlrev_b32 v4, 4, v4
    v_lshl_add_u32 v6, v5, 4, v4
    v_add_u32 v58, s94, v6
    v_mul_u32_u24 v5, 4800, v5
    v_add3_u32 v53, v5, v4, s95
    v_add_u32 v4, 256, v3
    v_mul_u32_u24 v5, 3277, v4
    v_lshrrev_b32 v5, 16, v5
    v_lshlrev_b32 v4, 4, v4
    v_lshl_add_u32 v6, v5, 4, v4
    v_add_u32 v59, s94, v6
    v_mul_u32_u24 v5, 4800, v5
    v_add3_u32 v54, v5, v4, s95
    s_mov_b32 s93, 81920
    s_mov_b32 s82, 0x40000
L_poll_42:
    buffer_load_dword v4, v34, s[48:51], 0 offen sc1
    s_waitcnt vmcnt(0)
    v_xor_b32 v4, s79, v4
    v_cmp_ne_u32 vcc, 0, v4
    s_nop 3
    s_cbranch_vccz L_pdone_43
    s_sub_u32 s82, s82, 1
    s_cbranch_scc0 L_poll_42
L_pdone_43:
    s_add_u32 s80, s78, 1
    s_and_b32 s80, s80, 7
    s_mul_i32 s80, s80, 20480
    buffer_load_dwordx4 a[40:43], v39, s[52:55], s80 offen offset:0
    buffer_load_dwordx4 a[44:47], v39, s[52:55], s80 offen offset:1024
    buffer_load_dwordx4 a[48:51], v40, s[52:55], s80 offen offset:0
    buffer_load_dwordx4 a[52:55], v41, s[52:55], s80 offen offset:0
    buffer_load_dwordx4 a[56:59], v41, s[52:55], s80 offen offset:1024
    buffer_load_dwordx4 a[60:63], v42, s[52:55], s80 offen offset:0
    buffer_load_dwordx4 a[64:67], v42, s[52:55], s80 offen offset:1024
    buffer_load_dwordx4 a[68:71], v43, s[52:55], s80 offen offset:0
    buffer_load_dwordx4 a[72:75], v44, s[52:55], s80 offen offset:0
    buffer_load_dwordx4 a[76:79], v44, s[52:55], s80 offen offset:1024
    s_add_u32 s80, s78, 2
    s_and_b32 s80, s80, 7
    s_mul_i32 s80, s80, 20480
    buffer_load_dwordx4 a[80:83], v39, s[52:55], s80 offen offset:0
    buffer_load_dwordx4 a[84:87], v39, s[52:55], s80 offen offset:1024
    s_waitcnt vmcnt(10) lgkmcnt(0)
    v_mfma_f32_16x16x32_bf16 a[200:203], v[128:131], a[40:43], a[200:203]
    ds_read_b128 v[108:111], v96 offset:0
    v_mfma_f32_16x16x32_bf16 a[204:207], v[128:131], a[44:47], a[204:207]
    ds_read_b128 v[112:115], v96 offset:2048
    v_mfma_f32_16x16x32_bf16 a[208:211], v[132:135], a[40:43], a[208:211]
    ds_read_b128 v[116:119], v96 offset:4096
    v_mfma_f32_16x16x32_bf16 a[212:215], v[132:135], a[44:47], a[212:215]
    ds_read_b128 v[120:123], v96 offset:6144
    v_mfma_f32_16x16x32_bf16 a[216:219], v[136:139], a[40:43], a[216:219]
    ds_read_b128 v[124:127], v96 offset:8192
    v_mfma_f32_16x16x32_bf16 a[220:223], v[136:139], a[44:47], a[220:223]
    buffer_load_dwordx4 a[88:91], v40, s[52:55], s80 offen offset:0
    v_mfma_f32_16x16x32_bf16 a[224:227], v[140:143], a[40:43], a[224:227]
    v_mfma_f32_16x16x32_bf16 a[228:231], v[140:143], a[44:47], a[228:231]
    buffer_load_dwordx4 a[92:95], v41, s[52:55], s80 offen offset:0
    v_mfma_f32_16x16x32_bf16 a[232:235], v[144:147], a[40:43], a[232:235]
    v_mfma_f32_16x16x32_bf16 a[236:239], v[144:147], a[44:47], a[236:239]
    s_waitcnt vmcnt(10) lgkmcnt(0)
    v_mfma_f32_16x16x32_bf16 a[200:203], v[108:111], a[48:51], a[200:203]
    ds_read_b128 v[128:131], v97 offset:0
    v_mfma_f32_16x16x32_bf16 a[204:207], v[108:111], a[52:55], a[204:207]
    ds_read_b128 v[132:135], v97 offset:2048
    v_mfma_f32_16x16x32_bf16 a[208:211], v[112:115], a[48:51], a[208:211]
    ds_read_b128 v[136:139], v97 offset:4096
    v_mfma_f32_16x16x32_bf16 a[212:215], v[112:115], a[52:55], a[212:215]
    ds_read_b128 v[140:143], v97 offset:6144
    v_mfma_f32_16x16x32_bf16 a[216:219], v[116:119], a[48:51], a[216:219]
    ds_read_b128 v[144:147], v97 offset:8192
    v_mfma_f32_16x16x32_bf16 a[220:223], v[116:119], a[52:55], a[220:223]
    buffer_load_dwordx4 a[96:99], v41, s[52:55], s80 offen offset:1024
    v_mfma_f32_16x16x32_bf16 a[224:227], v[120:123], a[48:51], a[224:227]
    buffer_load_dwordx4 a[100:103], v42, s[52:55], s80 offen offset:0
    v_mfma_f32_16x16x32_bf16 a[228:231], v[120:123], a[52:55], a[228:231]
    v_mfma_f32_16x16x32_bf16 a[232:235], v[124:127], a[48:51], a[232:235]
    buffer_load_dwordx4 v22, s[44:47], s81 offen offset:2048 lds
    v_mfma_f32_16x16x32_bf16 a[236:239], v[124:127], a[52:55], a[236:239]
    s_waitcnt vmcnt(11) lgkmcnt(0)
    v_mfma_f32_16x16x32_bf16 a[200:203], v[128:131], a[56:59], a[200:203]
    ds_read_b128 v[108:111], v98 offset:0
    v_mfma_f32_16x16x32_bf16 a[204:207], v[128:131], a[60:63], a[204:207]
    ds_read_b128 v[112:115], v98 offset:2048
    v_mfma_f32_16x16x32_bf16 a[208:211], v[132:135], a[56:59], a[208:211]
    ds_read_b128 v[116:119], v98 offset:4096
    v_mfma_f32_16x16x32_bf16 a[212:215], v[132:135], a[60:63], a[212:215]
    ds_read_b128 v[120:123], v98 offset:6144
    v_mfma_f32_16x16x32_bf16 a[216:219], v[136:139], a[56:59], a[216:219]
    ds_read_b128 v[124:127], v98 offset:8192
    v_mfma_f32_16x16x32_bf16 a[220:223], v[136:139], a[60:63], a[220:223]
    buffer_load_dwordx4 a[104:107], v42, s[52:55], s80 offen offset:1024
    v_mfma_f32_16x16x32_bf16 a[224:227], v[140:143], a[56:59], a[224:227]
    buffer_load_dwordx4 a[108:111], v43, s[52:55], s80 offen offset:0
    v_mfma_f32_16x16x32_bf16 a[228:231], v[140:143], a[60:63], a[228:231]
    v_mfma_f32_16x16x32_bf16 a[232:235], v[144:147], a[56:59], a[232:235]
    buffer_load_dwordx4 v23, s[44:47], s81 offen offset:3072 lds
    v_mfma_f32_16x16x32_bf16 a[236:239], v[144:147], a[60:63], a[236:239]
    s_waitcnt vmcnt(12) lgkmcnt(0)
    v_mfma_f32_16x16x32_bf16 a[200:203], v[108:111], a[64:67], a[200:203]
    ds_read_b128 v[128:131], v99 offset:0
    v_mfma_f32_16x16x32_bf16 a[204:207], v[108:111], a[68:71], a[204:207]
    ds_read_b128 v[132:135], v99 offset:2048
    v_mfma_f32_16x16x32_bf16 a[208:211], v[112:115], a[64:67], a[208:211]
    ds_read_b128 v[136:139], v99 offset:4096
    v_mfma_f32_16x16x32_bf16 a[212:215], v[112:115], a[68:71], a[212:215]
    ds_read_b128 v[140:143], v99 offset:6144
    v_mfma_f32_16x16x32_bf16 a[216:219], v[116:119], a[64:67], a[216:219]
    ds_read_b128 v[144:147], v99 offset:8192
    v_mfma_f32_16x16x32_bf16 a[220:223], v[116:119], a[68:71], a[220:223]
    buffer_load_dwordx4 a[112:115], v44, s[52:55], s80 offen offset:0
    v_mfma_f32_16x16x32_bf16 a[224:227], v[120:123], a[64:67], a[224:227]
    buffer_load_dwordx4 a[116:119], v44, s[52:55], s80 offen offset:1024
    v_mfma_f32_16x16x32_bf16 a[228:231], v[120:123], a[68:71], a[228:231]
    v_mfma_f32_16x16x32_bf16 a[232:235], v[124:127], a[64:67], a[232:235]
    s_add_u32 m0, s98, 147456
    s_nop 0
    buffer_load_dwordx4 v24, s[44:47], s81 offen offset:0 lds
    v_mfma_f32_16x16x32_bf16 a[236:239], v[124:127], a[68:71], a[236:239]
    s_waitcnt lgkmcnt(0)
    s_barrier
    s_waitcnt vmcnt(13)
    v_mfma_f32_16x16x32_bf16 a[200:203], v[128:131], a[72:75], a[200:203]
    ds_read_b128 v[108:111], v96 offset:20480
    v_mfma_f32_16x16x32_bf16 a[204:207], v[128:131], a[76:79], a[204:207]
    ds_read_b128 v[112:115], v96 offset:22528
    v_mfma_f32_16x16x32_bf16 a[208:211], v[132:135], a[72:75], a[208:211]
    ds_read_b128 v[116:119], v96 offset:24576
    v_mfma_f32_16x16x32_bf16 a[212:215], v[132:135], a[76:79], a[212:215]
    ds_read_b128 v[120:123], v96 offset:26624
    v_mfma_f32_16x16x32_bf16 a[216:219], v[136:139], a[72:75], a[216:219]
    ds_read_b128 v[124:127], v96 offset:28672
    v_mfma_f32_16x16x32_bf16 a[220:223], v[136:139], a[76:79], a[220:223]
    s_add_u32 s80, s78, 3
    s_and_b32 s80, s80, 7
    s_mul_i32 s80, s80, 20480
    buffer_load_dwordx4 a[120:123], v39, s[52:55], s80 offen offset:0
    v_mfma_f32_16x16x32_bf16 a[224:227], v[140:143], a[72:75], a[224:227]
    buffer_load_dwordx4 a[124:127], v39, s[52:55], s80 offen offset:1024
    v_mfma_f32_16x16x32_bf16 a[228:231], v[140:143], a[76:79], a[228:231]
    v_mfma_f32_16x16x32_bf16 a[232:235], v[144:147], a[72:75], a[232:235]
    s_add_u32 m0, s98, 122880
    s_add_u32 s81, s90, 8
    s_sub_u32 s101, s81, 10
    s_cselect_b32 s81, s81, s101
    s_lshl_b32 s81, s81, 7
    buffer_load_dwordx4 v20, s[44:47], s81 offen offset:0 lds
    v_mfma_f32_16x16x32_bf16 a[236:239], v[144:147], a[76:79], a[236:239]
    s_waitcnt vmcnt(14) lgkmcnt(0)
    v_mfma_f32_16x16x32_bf16 a[200:203], v[108:111], a[80:83], a[200:203]
    ds_read_b128 v[128:131], v97 offset:20480
    v_mfma_f32_16x16x32_bf16 a[204:207], v[108:111], a[84:87], a[204:207]
    ds_read_b128 v[132:135], v97 offset:22528
    v_mfma_f32_16x16x32_bf16 a[208:211], v[112:115], a[80:83], a[208:211]
    ds_read_b128 v[136:139], v97 offset:24576
    v_mfma_f32_16x16x32_bf16 a[212:215], v[112:115], a[84:87], a[212:215]
    ds_read_b128 v[140:143], v97 offset:26624
    v_mfma_f32_16x16x32_bf16 a[216:219], v[116:119], a[80:83], a[216:219]
    ds_read_b128 v[144:147], v97 offset:28672
    v_mfma_f32_16x16x32_bf16 a[220:223], v[116:119], a[84:87], a[220:223]
    buffer_load_dwordx4 a[128:131], v40, s[52:55], s80 offen offset:0
    v_mfma_f32_16x16x32_bf16 a[224:227], v[120:123], a[80:83], a[224:227]
    buffer_load_dwordx4 a[132:135], v41, s[52:55], s80 offen offset:0
    v_mfma_f32_16x16x32_bf16 a[228:231], v[120:123], a[84:87], a[228:231]
    v_mfma_f32_16x16x32_bf16 a[232:235], v[124:127], a[80:83], a[232:235]
    buffer_load_dwordx4 v21, s[44:47], s81 offen offset:1024 lds
    v_mfma_f32_16x16x32_bf16 a[236:239], v[124:127], a[84:87], a[236:239]
    s_waitcnt vmcnt(15) lgkmcnt(0)
    v_mfma_f32_16x16x32_bf16 a[200:203], v[128:131], a[88:91], a[200:203]
    ds_read_b128 v[108:111], v98 offset:20480
    v_mfma_f32_16x16x32_bf16 a[204:207], v[128:131], a[92:95], a[204:207]
    ds_read_b128 v[112:115], v98 offset:22528
    v_mfma_f32_16x16x32_bf16 a[208:211], v[132:135], a[88:91], a[208:211]
    ds_read_b128 v[116:119], v98 offset:24576
    v_mfma_f32_16x16x32_bf16 a[212:215], v[132:135], a[92:95], a[212:215]
    ds_read_b128 v[120:123], v98 offset:26624
    v_mfma_f32_16x16x32_bf16 a[216:219], v[136:139], a[88:91], a[216:219]
    ds_read_b128 v[124:127], v98 offset:28672
    v_mfma_f32_16x16x32_bf16 a[220:223], v[136:139], a[92:95], a[220:223]
    buffer_load_dwordx4 a[136:139], v41, s[52:55], s80 offen offset:1024
    v_mfma_f32_16x16x32_bf16 a[224:227], v[140:143], a[88:91], a[224:227]
    v_mfma_f32_16x16x32_bf16 a[228:231], v[140:143], a[92:95], a[228:231]
    buffer_load_dwordx4 a[140:143], v42, s[52:55], s80 offen offset:0
    v_mfma_f32_16x16x32_bf16 a[232:235], v[144:147], a[88:91], a[232:235]
    v_mfma_f32_16x16x32_bf16 a[236:239], v[144:147], a[92:95], a[236:239]
    s_waitcnt vmcnt(15) lgkmcnt(0)
    v_mfma_f32_16x16x32_bf16 a[200:203], v[108:111], a[96:99], a[200:203]
    ds_read_b128 v[128:131], v99 offset:20480
    v_mfma_f32_16x16x32_bf16 a[204:207], v[108:111], a[100:103], a[204:207]
    ds_read_b128 v[132:135], v99 offset:22528
    v_mfma_f32_16x16x32_bf16 a[208:211], v[112:115], a[96:99], a[208:211]
    ds_read_b128 v[136:139], v99 offset:24576
    v_mfma_f32_16x16x32_bf16 a[212:215], v[112:115], a[100:103], a[212:215]
    ds_read_b128 v[140:143], v99 offset:26624
    v_mfma_f32_16x16x32_bf16 a[216:219], v[116:119], a[96:99], a[216:219]
    ds_read_b128 v[144:147], v99 offset:28672
    v_mfma_f32_16x16x32_bf16 a[220:223], v[116:119], a[100:103], a[220:223]
    buffer_load_dwordx4 a[144:147], v42, s[52:55], s80 offen offset:1024
    v_mfma_f32_16x16x32_bf16 a[224:227], v[120:123], a[96:99], a[224:227]
    buffer_load_dwordx4 a[148:151], v43, s[52:55], s80 offen offset:0
    v_mfma_f32_16x16x32_bf16 a[228:231], v[120:123], a[100:103], a[228:231]
    v_mfma_f32_16x16x32_bf16 a[232:235], v[124:127], a[96:99], a[232:235]
    buffer_load_dwordx4 v22, s[44:47], s81 offen offset:2048 lds
    v_mfma_f32_16x16x32_bf16 a[236:239], v[124:127], a[100:103], a[236:239]
    s_waitcnt vmcnt(15) lgkmcnt(0)
    v_mfma_f32_16x16x32_bf16 a[200:203], v[128:131], a[104:107], a[200:203]
    ds_read_b128 v[108:111], v96 offset:40960
    v_mfma_f32_16x16x32_bf16 a[204:207], v[128:131], a[108:111], a[204:207]
    ds_read_b128 v[112:115], v96 offset:43008
    v_mfma_f32_16x16x32_bf16 a[208:211], v[132:135], a[104:107], a[208:211]
    ds_read_b128 v[116:119], v96 offset:45056
    v_mfma_f32_16x16x32_bf16 a[212:215], v[132:135], a[108:111], a[212:215]
    ds_read_b128 v[120:123], v96 offset:47104
    v_mfma_f32_16x16x32_bf16 a[216:219], v[136:139], a[104:107], a[216:219]
    ds_read_b128 v[124:127], v96 offset:49152
    v_mfma_f32_16x16x32_bf16 a[220:223], v[136:139], a[108:111], a[220:223]
    buffer_load_dwordx4 a[152:155], v44, s[52:55], s80 offen offset:0
    v_mfma_f32_16x16x32_bf16 a[224:227], v[140:143], a[104:107], a[224:227]
    v_mfma_f32_16x16x32_bf16 a[228:231], v[140:143], a[108:111], a[228:231]
    buffer_load_dwordx4 a[156:159], v44, s[52:55], s80 offen offset:1024
    v_mfma_f32_16x16x32_bf16 a[232:235], v[144:147], a[104:107], a[232:235]
    v_mfma_f32_16x16x32_bf16 a[236:239], v[144:147], a[108:111], a[236:239]
    s_waitcnt vmcnt(14) lgkmcnt(0)
    v_mfma_f32_16x16x32_bf16 a[200:203], v[108:111], a[112:115], a[200:203]
    ds_read_b128 v[128:131], v97 offset:40960
    v_mfma_f32_16x16x32_bf16 a[204:207], v[108:111], a[116:119], a[204:207]
    ds_read_b128 v[132:135], v97 offset:43008
    v_mfma_f32_16x16x32_bf16 a[208:211], v[112:115], a[112:115], a[208:211]
    ds_read_b128 v[136:139], v97 offset:45056
    v_mfma_f32_16x16x32_bf16 a[212:215], v[112:115], a[116:119], a[212:215]
    ds_read_b128 v[140:143], v97 offset:47104
    v_mfma_f32_16x16x32_bf16 a[216:219], v[116:119], a[112:115], a[216:219]
    ds_read_b128 v[144:147], v97 offset:49152
    v_mfma_f32_16x16x32_bf16 a[220:223], v[116:119], a[116:119], a[220:223]
    s_add_u32 s80, s78, 4
    s_and_b32 s80, s80, 7
    s_mul_i32 s80, s80, 20480
    buffer_load_dwordx4 a[160:163], v39, s[52:55], s80 offen offset:0
    v_mfma_f32_16x16x32_bf16 a[224:227], v[120:123], a[112:115], a[224:227]
    buffer_load_dwordx4 a[164:167], v39, s[52:55], s80 offen offset:1024
    v_mfma_f32_16x16x32_bf16 a[228:231], v[120:123], a[116:119], a[228:231]
    v_mfma_f32_16x16x32_bf16 a[232:235], v[124:127], a[112:115], a[232:235]
    buffer_load_dwordx4 v23, s[44:47], s81 offen offset:3072 lds
    v_mfma_f32_16x16x32_bf16 a[236:239], v[124:127], a[116:119], a[236:239]
    s_waitcnt vmcnt(14) lgkmcnt(0)
    v_mfma_f32_16x16x32_bf16 a[200:203], v[128:131], a[120:123], a[200:203]
    ds_read_b128 v[108:111], v98 offset:40960
    v_mfma_f32_16x16x32_bf16 a[204:207], v[128:131], a[124:127], a[204:207]
    ds_read_b128 v[112:115], v98 offset:43008
    v_mfma_f32_16x16x32_bf16 a[208:211], v[132:135], a[120:123], a[208:211]
    ds_read_b128 v[116:119], v98 offset:45056
    v_mfma_f32_16x16x32_bf16 a[212:215], v[132:135], a[124:127], a[212:215]
    ds_read_b128 v[120:123], v98 offset:47104
    v_mfma_f32_16x16x32_bf16 a[216:219], v[136:139], a[120:123], a[216:219]
    ds_read_b128 v[124:127], v98 offset:49152
    v_mfma_f32_16x16x32_bf16 a[220:223], v[136:139], a[124:127], a[220:223]
    buffer_load_dwordx4 a[168:171], v40, s[52:55], s80 offen offset:0
    v_mfma_f32_16x16x32_bf16 a[224:227], v[140:143], a[120:123], a[224:227]
    buffer_load_dwordx4 a[172:175], v41, s[52:55], s80 offen offset:0
    v_mfma_f32_16x16x32_bf16 a[228:231], v[140:143], a[124:127], a[228:231]
    v_mfma_f32_16x16x32_bf16 a[232:235], v[144:147], a[120:123], a[232:235]
    s_add_u32 m0, s98, 126976
    s_nop 0
    buffer_load_dwordx4 v24, s[44:47], s81 offen offset:0 lds
    v_mfma_f32_16x16x32_bf16 a[236:239], v[144:147], a[124:127], a[236:239]
    s_waitcnt vmcnt(14) lgkmcnt(0)
    v_mfma_f32_16x16x32_bf16 a[200:203], v[108:111], a[128:131], a[200:203]
    ds_read_b128 v[128:131], v99 offset:40960
    v_mfma_f32_16x16x32_bf16 a[204:207], v[108:111], a[132:135], a[204:207]
    ds_read_b128 v[132:135], v99 offset:43008
    v_mfma_f32_16x16x32_bf16 a[208:211], v[112:115], a[128:131], a[208:211]
    ds_read_b128 v[136:139], v99 offset:45056
    v_mfma_f32_16x16x32_bf16 a[212:215], v[112:115], a[132:135], a[212:215]
    ds_read_b128 v[140:143], v99 offset:47104
    v_mfma_f32_16x16x32_bf16 a[216:219], v[116:119], a[128:131], a[216:219]
    ds_read_b128 v[144:147], v99 offset:49152
    v_mfma_f32_16x16x32_bf16 a[220:223], v[116:119], a[132:135], a[220:223]
    buffer_load_dwordx4 a[176:179], v41, s[52:55], s80 offen offset:1024
    v_mfma_f32_16x16x32_bf16 a[224:227], v[120:123], a[128:131], a[224:227]
    v_mfma_f32_16x16x32_bf16 a[228:231], v[120:123], a[132:135], a[228:231]
    buffer_load_dwordx4 a[180:183], v42, s[52:55], s80 offen offset:0
    v_mfma_f32_16x16x32_bf16 a[232:235], v[124:127], a[128:131], a[232:235]
    v_mfma_f32_16x16x32_bf16 a[236:239], v[124:127], a[132:135], a[236:239]
    s_barrier
    s_waitcnt vmcnt(13) lgkmcnt(0)
    v_mfma_f32_16x16x32_bf16 a[200:203], v[128:131], a[136:139], a[200:203]
    ds_read_b128 v[108:111], v96 offset:61440
    v_mfma_f32_16x16x32_bf16 a[204:207], v[128:131], a[140:143], a[204:207]
    ds_read_b128 v[112:115], v96 offset:63488
    v_mfma_f32_16x16x32_bf16 a[208:211], v[132:135], a[136:139], a[208:211]
    ds_read_b128 v[116:119], v100 offset:0
    v_mfma_f32_16x16x32_bf16 a[212:215], v[132:135], a[140:143], a[212:215]
    ds_read_b128 v[120:123], v100 offset:2048
    v_mfma_f32_16x16x32_bf16 a[216:219], v[136:139], a[136:139], a[216:219]
    ds_read_b128 v[124:127], v100 offset:4096
    v_mfma_f32_16x16x32_bf16 a[220:223], v[136:139], a[140:143], a[220:223]
    buffer_load_dwordx4 a[184:187], v42, s[52:55], s80 offen offset:1024
    v_mfma_f32_16x16x32_bf16 a[224:227], v[140:143], a[136:139], a[224:227]
    buffer_load_dwordx4 a[188:191], v43, s[52:55], s80 offen offset:0
    v_mfma_f32_16x16x32_bf16 a[228:231], v[140:143], a[140:143], a[228:231]
    v_mfma_f32_16x16x32_bf16 a[232:235], v[144:147], a[136:139], a[232:235]
    s_add_u32 m0, s98, 0
    s_add_u32 s81, s90, 9
    s_sub_u32 s101, s81, 10
    s_cselect_b32 s81, s81, s101
    s_lshl_b32 s81, s81, 7
    buffer_load_dwordx4 v20, s[44:47], s81 offen offset:0 lds
    v_mfma_f32_16x16x32_bf16 a[236:239], v[144:147], a[140:143], a[236:239]
    s_waitcnt vmcnt(14) lgkmcnt(0)
    v_mfma_f32_16x16x32_bf16 a[200:203], v[108:111], a[144:147], a[200:203]
    ds_read_b128 v[128:131], v97 offset:61440
    v_mfma_f32_16x16x32_bf16 a[204:207], v[108:111], a[148:151], a[204:207]
    ds_read_b128 v[132:135], v97 offset:63488
    v_mfma_f32_16x16x32_bf16 a[208:211], v[112:115], a[144:147], a[208:211]
    ds_read_b128 v[136:139], v101 offset:0
    v_mfma_f32_16x16x32_bf16 a[212:215], v[112:115], a[148:151], a[212:215]
    ds_read_b128 v[140:143], v101 offset:2048
    v_mfma_f32_16x16x32_bf16 a[216:219], v[116:119], a[144:147], a[216:219]
    ds_read_b128 v[144:147], v101 offset:4096
    v_mfma_f32_16x16x32_bf16 a[220:223], v[116:119], a[148:151], a[220:223]
    buffer_load_dwordx4 a[192:195], v44, s[52:55], s80 offen offset:0
    v_mfma_f32_16x16x32_bf16 a[224:227], v[120:123], a[144:147], a[224:227]
    v_mfma_f32_16x16x32_bf16 a[228:231], v[120:123], a[148:151], a[228:231]
    buffer_load_dwordx4 a[196:199], v44, s[52:55], s80 offen offset:1024
    v_mfma_f32_16x16x32_bf16 a[232:235], v[124:127], a[144:147], a[232:235]
    v_mfma_f32_16x16x32_bf16 a[236:239], v[124:127], a[148:151], a[236:239]
    s_waitcnt vmcnt(13) lgkmcnt(0)
    v_mfma_f32_16x16x32_bf16 a[200:203], v[128:131], a[152:155], a[200:203]
    ds_read_b128 v[108:111], v98 offset:61440
    v_mfma_f32_16x16x32_bf16 a[204:207], v[128:131], a[156:159], a[204:207]
    ds_read_b128 v[112:115], v98 offset:63488
    v_mfma_f32_16x16x32_bf16 a[208:211], v[132:135], a[152:155], a[208:211]
    ds_read_b128 v[116:119], v102 offset:0
    v_mfma_f32_16x16x32_bf16 a[212:215], v[132:135], a[156:159], a[212:215]
    ds_read_b128 v[120:123], v102 offset:2048
    v_mfma_f32_16x16x32_bf16 a[216:219], v[136:139], a[152:155], a[216:219]
    ds_read_b128 v[124:127], v102 offset:4096
    v_mfma_f32_16x16x32_bf16 a[220:223], v[136:139], a[156:159], a[220:223]
    s_add_u32 s80, s78, 5
    s_and_b32 s80, s80, 7
    s_mul_i32 s80, s80, 20480
    buffer_load_dwordx4 a[0:3], v39, s[52:55], s80 offen offset:0
    v_mfma_f32_16x16x32_bf16 a[224:227], v[140:143], a[152:155], a[224:227]
    buffer_load_dwordx4 a[4:7], v39, s[52:55], s80 offen offset:1024
    v_mfma_f32_16x16x32_bf16 a[228:231], v[140:143], a[156:159], a[228:231]
    v_mfma_f32_16x16x32_bf16 a[232:235], v[144:147], a[152:155], a[232:235]
    buffer_load_dwordx4 v21, s[44:47], s81 offen offset:1024 lds
    v_mfma_f32_16x16x32_bf16 a[236:239], v[144:147], a[156:159], a[236:239]
    s_waitcnt vmcnt(14) lgkmcnt(0)
    v_mfma_f32_16x16x32_bf16 a[200:203], v[108:111], a[160:163], a[200:203]
    ds_read_b128 v[128:131], v99 offset:61440
    v_mfma_f32_16x16x32_bf16 a[204:207], v[108:111], a[164:167], a[204:207]
    ds_read_b128 v[132:135], v99 offset:63488
    v_mfma_f32_16x16x32_bf16 a[208:211], v[112:115], a[160:163], a[208:211]
    ds_read_b128 v[136:139], v103 offset:0
    v_mfma_f32_16x16x32_bf16 a[212:215], v[112:115], a[164:167], a[212:215]
    ds_read_b128 v[140:143], v103 offset:2048
    v_mfma_f32_16x16x32_bf16 a[216:219], v[116:119], a[160:163], a[216:219]
    ds_read_b128 v[144:147], v103 offset:4096
    v_mfma_f32_16x16x32_bf16 a[220:223], v[116:119], a[164:167], a[220:223]
    buffer_load_dwordx4 a[8:11], v40, s[52:55], s80 offen offset:0
    v_mfma_f32_16x16x32_bf16 a[224:227], v[120:123], a[160:163], a[224:227]
    buffer_load_dwordx4 a[12:15], v41, s[52:55], s80 offen offset:0
    v_mfma_f32_16x16x32_bf16 a[228:231], v[120:123], a[164:167], a[228:231]
    v_mfma_f32_16x16x32_bf16 a[232:235], v[124:127], a[160:163], a[232:235]
    buffer_load_dwordx4 v22, s[44:47], s81 offen offset:2048 lds
    v_mfma_f32_16x16x32_bf16 a[236:239], v[124:127], a[164:167], a[236:239]
    s_waitcnt vmcnt(14) lgkmcnt(0)
    v_mfma_f32_16x16x32_bf16 a[200:203], v[128:131], a[168:171], a[200:203]
    ds_read_b128 v[108:111], v100 offset:16384
    v_mfma_f32_16x16x32_bf16 a[204:207], v[128:131], a[172:175], a[204:207]
    ds_read_b128 v[112:115], v100 offset:18432
    v_mfma_f32_16x16x32_bf16 a[208:211], v[132:135], a[168:171], a[208:211]
    ds_read_b128 v[116:119], v100 offset:20480
    v_mfma_f32_16x16x32_bf16 a[212:215], v[132:135], a[172:175], a[212:215]
    ds_read_b128 v[120:123], v100 offset:22528
    v_mfma_f32_16x16x32_bf16 a[216:219], v[136:139], a[168:171], a[216:219]
    ds_read_b128 v[124:127], v100 offset:24576
    v_mfma_f32_16x16x32_bf16 a[220:223], v[136:139], a[172:175], a[220:223]
    buffer_load_dwordx4 a[16:19], v41, s[52:55], s80 offen offset:1024
    v_mfma_f32_16x16x32_bf16 a[224:227], v[140:143], a[168:171], a[224:227]
    v_mfma_f32_16x16x32_bf16 a[228:231], v[140:143], a[172:175], a[228:231]
    buffer_load_dwordx4 a[20:23], v42, s[52:55], s80 offen offset:0
    v_mfma_f32_16x16x32_bf16 a[232:235], v[144:147], a[168:171], a[232:235]
    v_mfma_f32_16x16x32_bf16 a[236:239], v[144:147], a[172:175], a[236:239]
    s_waitcnt vmcnt(13) lgkmcnt(0)
    v_mfma_f32_16x16x32_bf16 a[200:203], v[108:111], a[176:179], a[200:203]
    ds_read_b128 v[128:131], v101 offset:16384
    v_mfma_f32_16x16x32_bf16 a[204:207], v[108:111], a[180:183], a[204:207]
    ds_read_b128 v[132:135], v101 offset:18432
    v_mfma_f32_16x16x32_bf16 a[208:211], v[112:115], a[176:179], a[208:211]
    ds_read_b128 v[136:139], v101 offset:20480
    v_mfma_f32_16x16x32_bf16 a[212:215], v[112:115], a[180:183], a[212:215]
    ds_read_b128 v[140:143], v101 offset:22528
    v_mfma_f32_16x16x32_bf16 a[216:219], v[116:119], a[176:179], a[216:219]
    ds_read_b128 v[144:147], v101 offset:24576
    v_mfma_f32_16x16x32_bf16 a[220:223], v[116:119], a[180:183], a[220:223]
    buffer_load_dwordx4 a[24:27], v42, s[52:55], s80 offen offset:1024
    v_mfma_f32_16x16x32_bf16 a[224:227], v[120:123], a[176:179], a[224:227]
    buffer_load_dwordx4 a[28:31], v43, s[52:55], s80 offen offset:0
    v_mfma_f32_16x16x32_bf16 a[228:231], v[120:123], a[180:183], a[228:231]
    v_mfma_f32_16x16x32_bf16 a[232:235], v[124:127], a[176:179], a[232:235]
    buffer_load_dwordx4 v23, s[44:47], s81 offen offset:3072 lds
    v_mfma_f32_16x16x32_bf16 a[236:239], v[124:127], a[180:183], a[236:239]
    s_waitcnt vmcnt(14) lgkmcnt(0)
    v_mfma_f32_16x16x32_bf16 a[200:203], v[128:131], a[184:187], a[200:203]
    ds_read_b128 v[108:111], v102 offset:16384
    v_mfma_f32_16x16x32_bf16 a[204:207], v[128:131], a[188:191], a[204:207]
    ds_read_b128 v[112:115], v102 offset:18432
    v_mfma_f32_16x16x32_bf16 a[208:211], v[132:135], a[184:187], a[208:211]
    ds_read_b128 v[116:119], v102 offset:20480
    v_mfma_f32_16x16x32_bf16 a[212:215], v[132:135], a[188:191], a[212:215]
    ds_read_b128 v[120:123], v102 offset:22528
    v_mfma_f32_16x16x32_bf16 a[216:219], v[136:139], a[184:187], a[216:219]
    ds_read_b128 v[124:127], v102 offset:24576
    v_mfma_f32_16x16x32_bf16 a[220:223], v[136:139], a[188:191], a[220:223]
    buffer_load_dwordx4 a[32:35], v44, s[52:55], s80 offen offset:0
    v_mfma_f32_16x16x32_bf16 a[224:227], v[140:143], a[184:187], a[224:227]
    v_mfma_f32_16x16x32_bf16 a[228:231], v[140:143], a[188:191], a[228:231]
    buffer_load_dwordx4 a[36:39], v44, s[52:55], s80 offen offset:1024
    v_mfma_f32_16x16x32_bf16 a[232:235], v[144:147], a[184:187], a[232:235]
    v_mfma_f32_16x16x32_bf16 a[236:239], v[144:147], a[188:191], a[236:239]
    s_waitcnt vmcnt(13) lgkmcnt(0)
    v_mfma_f32_16x16x32_bf16 a[200:203], v[108:111], a[192:195], a[200:203]
    ds_read_b128 v[128:131], v103 offset:16384
    v_mfma_f32_16x16x32_bf16 a[204:207], v[108:111], a[196:199], a[204:207]
    ds_read_b128 v[132:135], v103 offset:18432
    v_mfma_f32_16x16x32_bf16 a[208:211], v[112:115], a[192:195], a[208:211]
    ds_read_b128 v[136:139], v103 offset:20480
    v_mfma_f32_16x16x32_bf16 a[212:215], v[112:115], a[196:199], a[212:215]
    ds_read_b128 v[140:143], v103 offset:22528
    v_mfma_f32_16x16x32_bf16 a[216:219], v[116:119], a[192:195], a[216:219]
    ds_read_b128 v[144:147], v103 offset:24576
    v_mfma_f32_16x16x32_bf16 a[220:223], v[116:119], a[196:199], a[220:223]
    s_add_u32 s80, s78, 6
    s_and_b32 s80, s80, 7
    s_mul_i32 s80, s80, 20480
    buffer_load_dwordx4 a[40:43], v39, s[52:55], s80 offen offset:0
    v_mfma_f32_16x16x32_bf16 a[224:227], v[120:123], a[192:195], a[224:227]
    buffer_load_dwordx4 a[44:47], v39, s[52:55], s80 offen offset:1024
    v_mfma_f32_16x16x32_bf16 a[228:231], v[120:123], a[196:199], a[228:231]
    v_mfma_f32_16x16x32_bf16 a[232:235], v[124:127], a[192:195], a[232:235]
    s_add_u32 m0, s98, 4096
    s_nop 0
    buffer_load_dwordx4 v24, s[44:47], s81 offen offset:0 lds
    v_mfma_f32_16x16x32_bf16 a[236:239], v[124:127], a[196:199], a[236:239]
    s_waitcnt vmcnt(14) lgkmcnt(0)
    v_mfma_f32_16x16x32_bf16 a[200:203], v[128:131], a[0:3], a[200:203]
    ds_read_b128 v[108:111], v104 offset:12288
    v_mfma_f32_16x16x32_bf16 a[204:207], v[128:131], a[4:7], a[204:207]
    ds_read_b128 v[112:115], v104 offset:14336
    v_mfma_f32_16x16x32_bf16 a[208:211], v[132:135], a[0:3], a[208:211]
    ds_read_b128 v[116:119], v104 offset:16384
    v_mfma_f32_16x16x32_bf16 a[212:215], v[132:135], a[4:7], a[212:215]
    ds_read_b128 v[120:123], v104 offset:18432
    v_mfma_f32_16x16x32_bf16 a[216:219], v[136:139], a[0:3], a[216:219]
    ds_read_b128 v[124:127], v104 offset:20480
    v_mfma_f32_16x16x32_bf16 a[220:223], v[136:139], a[4:7], a[220:223]
    buffer_load_dwordx4 a[48:51], v40, s[52:55], s80 offen offset:0
    v_mfma_f32_16x16x32_bf16 a[224:227], v[140:143], a[0:3], a[224:227]
    v_mfma_f32_16x16x32_bf16 a[228:231], v[140:143], a[4:7], a[228:231]
    buffer_load_dwordx4 a[52:55], v41, s[52:55], s80 offen offset:0
    v_mfma_f32_16x16x32_bf16 a[232:235], v[144:147], a[0:3], a[232:235]
    v_mfma_f32_16x16x32_bf16 a[236:239], v[144:147], a[4:7], a[236:239]
    s_waitcnt vmcnt(13) lgkmcnt(0)
    v_mfma_f32_16x16x32_bf16 a[200:203], v[108:111], a[8:11], a[200:203]
    ds_read_b128 v[128:131], v105 offset:12288
    v_mfma_f32_16x16x32_bf16 a[204:207], v[108:111], a[12:15], a[204:207]
    ds_read_b128 v[132:135], v105 offset:14336
    v_mfma_f32_16x16x32_bf16 a[208:211], v[112:115], a[8:11], a[208:211]
    ds_read_b128 v[136:139], v105 offset:16384
    v_mfma_f32_16x16x32_bf16 a[212:215], v[112:115], a[12:15], a[212:215]
    ds_read_b128 v[140:143], v105 offset:18432
    v_mfma_f32_16x16x32_bf16 a[216:219], v[116:119], a[8:11], a[216:219]
    ds_read_b128 v[144:147], v105 offset:20480
    v_mfma_f32_16x16x32_bf16 a[220:223], v[116:119], a[12:15], a[220:223]
    buffer_load_dwordx4 a[56:59], v41, s[52:55], s80 offen offset:1024
    v_mfma_f32_16x16x32_bf16 a[224:227], v[120:123], a[8:11], a[224:227]
    v_mfma_f32_16x16x32_bf16 a[228:231], v[120:123], a[12:15], a[228:231]
    buffer_load_dwordx4 a[60:63], v42, s[52:55], s80 offen offset:0
    v_mfma_f32_16x16x32_bf16 a[232:235], v[124:127], a[8:11], a[232:235]
    v_mfma_f32_16x16x32_bf16 a[236:239], v[124:127], a[12:15], a[236:239]
    s_waitcnt vmcnt(12) lgkmcnt(0)
    v_mfma_f32_16x16x32_bf16 a[200:203], v[128:131], a[16:19], a[200:203]
    ds_read_b128 v[108:111], v106 offset:12288
    v_mfma_f32_16x16x32_bf16 a[204:207], v[128:131], a[20:23], a[204:207]
    ds_read_b128 v[112:115], v106 offset:14336
    v_mfma_f32_16x16x32_bf16 a[208:211], v[132:135], a[16:19], a[208:211]
    ds_read_b128 v[116:119], v106 offset:16384
    v_mfma_f32_16x16x32_bf16 a[212:215], v[132:135], a[20:23], a[212:215]
    ds_read_b128 v[120:123], v106 offset:18432
    v_mfma_f32_16x16x32_bf16 a[216:219], v[136:139], a[16:19], a[216:219]
    ds_read_b128 v[124:127], v106 offset:20480
    v_mfma_f32_16x16x32_bf16 a[220:223], v[136:139], a[20:23], a[220:223]
    buffer_load_dwordx4 a[64:67], v42, s[52:55], s80 offen offset:1024
    v_mfma_f32_16x16x32_bf16 a[224:227], v[140:143], a[16:19], a[224:227]
    v_mfma_f32_16x16x32_bf16 a[228:231], v[140:143], a[20:23], a[228:231]
    buffer_load_dwordx4 a[68:71], v43, s[52:55], s80 offen offset:0
    v_mfma_f32_16x16x32_bf16 a[232:235], v[144:147], a[16:19], a[232:235]
    v_mfma_f32_16x16x32_bf16 a[236:239], v[144:147], a[20:23], a[236:239]
    s_waitcnt vmcnt(12) lgkmcnt(0)
    v_mfma_f32_16x16x32_bf16 a[200:203], v[108:111], a[24:27], a[200:203]
    ds_read_b128 v[128:131], v107 offset:12288
    v_mfma_f32_16x16x32_bf16 a[204:207], v[108:111], a[28:31], a[204:207]
    ds_read_b128 v[132:135], v107 offset:14336
    v_mfma_f32_16x16x32_bf16 a[208:211], v[112:115], a[24:27], a[208:211]
    ds_read_b128 v[136:139], v107 offset:16384
    v_mfma_f32_16x16x32_bf16 a[212:215], v[112:115], a[28:31], a[212:215]
    ds_read_b128 v[140:143], v107 offset:18432
    v_mfma_f32_16x16x32_bf16 a[216:219], v[116:119], a[24:27], a[216:219]
    ds_read_b128 v[144:147], v107 offset:20480
    v_mfma_f32_16x16x32_bf16 a[220:223], v[116:119], a[28:31], a[220:223]
    buffer_load_dwordx4 a[72:75], v44, s[52:55], s80 offen offset:0
    v_mfma_f32_16x16x32_bf16 a[224:227], v[120:123], a[24:27], a[224:227]
    v_mfma_f32_16x16x32_bf16 a[228:231], v[120:123], a[28:31], a[228:231]
    buffer_load_dwordx4 a[76:79], v44, s[52:55], s80 offen offset:1024
    v_mfma_f32_16x16x32_bf16 a[232:235], v[124:127], a[24:27], a[232:235]
    v_mfma_f32_16x16x32_bf16 a[236:239], v[124:127], a[28:31], a[236:239]
    s_waitcnt vmcnt(8)
    s_barrier
    s_waitcnt lgkmcnt(0)
    v_mfma_f32_16x16x32_bf16 a[200:203], v[128:131], a[32:35], a[200:203]
    ds_read_b128 v[108:111], v100 offset:57344
    v_mfma_f32_16x16x32_bf16 a[204:207], v[128:131], a[36:39], a[204:207]
    ds_read_b128 v[112:115], v100 offset:59392
    v_mfma_f32_16x16x32_bf16 a[208:211], v[132:135], a[32:35], a[208:211]
    ds_read_b128 v[116:119], v100 offset:61440
    v_mfma_f32_16x16x32_bf16 a[212:215], v[132:135], a[36:39], a[212:215]
    ds_read_b128 v[120:123], v100 offset:63488
    v_mfma_f32_16x16x32_bf16 a[216:219], v[136:139], a[32:35], a[216:219]
    ds_read_b128 v[124:127], v104 offset:0
    v_mfma_f32_16x16x32_bf16 a[220:223], v[136:139], a[36:39], a[220:223]
    s_add_u32 s80, s78, 7
    s_and_b32 s80, s80, 7
    s_mul_i32 s80, s80, 20480
    buffer_load_dwordx4 a[80:83], v39, s[52:55], s80 offen offset:0
    v_mfma_f32_16x16x32_bf16 a[224:227], v[140:143], a[32:35], a[224:227]
    v_mfma_f32_16x16x32_bf16 a[228:231], v[140:143], a[36:39], a[228:231]
    buffer_load_dwordx4 a[84:87], v39, s[52:55], s80 offen offset:1024
    v_mfma_f32_16x16x32_bf16 a[232:235], v[144:147], a[32:35], a[232:235]
    v_mfma_f32_16x16x32_bf16 a[236:239], v[144:147], a[36:39], a[236:239]
    s_waitcnt lgkmcnt(0)
    v_mfma_f32_16x16x32_bf16 a[200:203], v[108:111], a[40:43], a[200:203]
    ds_read_b128 v[128:131], v101 offset:57344
    v_mfma_f32_16x16x32_bf16 a[204:207], v[108:111], a[44:47], a[204:207]
    ds_read_b128 v[132:135], v101 offset:59392
    v_mfma_f32_16x16x32_bf16 a[208:211], v[112:115], a[40:43], a[208:211]
    ds_read_b128 v[136:139], v101 offset:61440
    v_mfma_f32_16x16x32_bf16 a[212:215], v[112:115], a[44:47], a[212:215]
    ds_read_b128 v[140:143], v101 offset:63488
    v_mfma_f32_16x16x32_bf16 a[216:219], v[116:119], a[40:43], a[216:219]
    ds_read_b128 v[144:147], v105 offset:0
    v_mfma_f32_16x16x32_bf16 a[220:223], v[116:119], a[44:47], a[220:223]
    buffer_load_dwordx4 a[88:91], v40, s[52:55], s80 offen offset:0
    v_mfma_f32_16x16x32_bf16 a[224:227], v[120:123], a[40:43], a[224:227]
    v_mfma_f32_16x16x32_bf16 a[228:231], v[120:123], a[44:47], a[228:231]
    buffer_load_dwordx4 a[92:95], v41, s[52:55], s80 offen offset:0
    v_mfma_f32_16x16x32_bf16 a[232:235], v[124:127], a[40:43], a[232:235]
    v_mfma_f32_16x16x32_bf16 a[236:239], v[124:127], a[44:47], a[236:239]
    s_waitcnt vmcnt(10) lgkmcnt(0)
    v_mfma_f32_16x16x32_bf16 a[200:203], v[128:131], a[48:51], a[200:203]
    ds_read_b128 v[108:111], v102 offset:57344
    v_mfma_f32_16x16x32_bf16 a[204:207], v[128:131], a[52:55], a[204:207]
    ds_read_b128 v[112:115], v102 offset:59392
    v_mfma_f32_16x16x32_bf16 a[208:211], v[132:135], a[48:51], a[208:211]
    ds_read_b128 v[116:119], v102 offset:61440
    v_mfma_f32_16x16x32_bf16 a[212:215], v[132:135], a[52:55], a[212:215]
    ds_read_b128 v[120:123], v102 offset:63488
    v_mfma_f32_16x16x32_bf16 a[216:219], v[136:139], a[48:51], a[216:219]
    ds_read_b128 v[124:127], v106 offset:0
    v_mfma_f32_16x16x32_bf16 a[220:223], v[136:139], a[52:55], a[220:223]
    buffer_load_dwordx4 a[96:99], v41, s[52:55], s80 offen offset:1024
    v_mfma_f32_16x16x32_bf16 a[224:227], v[140:143], a[48:51], a[224:227]
    v_mfma_f32_16x16x32_bf16 a[228:231], v[140:143], a[52:55], a[228:231]
    buffer_load_dwordx4 a[100:103], v42, s[52:55], s80 offen offset:0
    v_mfma_f32_16x16x32_bf16 a[232:235], v[144:147], a[48:51], a[232:235]
    v_mfma_f32_16x16x32_bf16 a[236:239], v[144:147], a[52:55], a[236:239]
    s_waitcnt vmcnt(10) lgkmcnt(0)
    v_mfma_f32_16x16x32_bf16 a[200:203], v[108:111], a[56:59], a[200:203]
    ds_read_b128 v[128:131], v103 offset:57344
    v_mfma_f32_16x16x32_bf16 a[204:207], v[108:111], a[60:63], a[204:207]
    ds_read_b128 v[132:135], v103 offset:59392
    v_mfma_f32_16x16x32_bf16 a[208:211], v[112:115], a[56:59], a[208:211]
    ds_read_b128 v[136:139], v103 offset:61440
    v_mfma_f32_16x16x32_bf16 a[212:215], v[112:115], a[60:63], a[212:215]
    ds_read_b128 v[140:143], v103 offset:63488
    v_mfma_f32_16x16x32_bf16 a[216:219], v[116:119], a[56:59], a[216:219]
    ds_read_b128 v[144:147], v107 offset:0
    v_mfma_f32_16x16x32_bf16 a[220:223], v[116:119], a[60:63], a[220:223]
    buffer_load_dwordx4 a[104:107], v42, s[52:55], s80 offen offset:1024
    v_mfma_f32_16x16x32_bf16 a[224:227], v[120:123], a[56:59], a[224:227]
    v_mfma_f32_16x16x32_bf16 a[228:231], v[120:123], a[60:63], a[228:231]
    buffer_load_dwordx4 a[108:111], v43, s[52:55], s80 offen offset:0
    v_mfma_f32_16x16x32_bf16 a[232:235], v[124:127], a[56:59], a[232:235]
    v_mfma_f32_16x16x32_bf16 a[236:239], v[124:127], a[60:63], a[236:239]
    s_waitcnt vmcnt(10) lgkmcnt(0)
    v_mfma_f32_16x16x32_bf16 a[200:203], v[128:131], a[64:67], a[200:203]
    ds_read_b128 v[108:111], v96 offset:0
    v_mfma_f32_16x16x32_bf16 a[204:207], v[128:131], a[68:71], a[204:207]
    ds_read_b128 v[112:115], v96 offset:2048
    v_mfma_f32_16x16x32_bf16 a[208:211], v[132:135], a[64:67], a[208:211]
    ds_read_b128 v[116:119], v96 offset:4096
    v_mfma_f32_16x16x32_bf16 a[212:215], v[132:135], a[68:71], a[212:215]
    ds_read_b128 v[120:123], v96 offset:6144
    v_mfma_f32_16x16x32_bf16 a[216:219], v[136:139], a[64:67], a[216:219]
    ds_read_b128 v[124:127], v96 offset:8192
    v_mfma_f32_16x16x32_bf16 a[220:223], v[136:139], a[68:71], a[220:223]
    buffer_load_dwordx4 a[112:115], v44, s[52:55], s80 offen offset:0
    v_mfma_f32_16x16x32_bf16 a[224:227], v[140:143], a[64:67], a[224:227]
    v_mfma_f32_16x16x32_bf16 a[228:231], v[140:143], a[68:71], a[228:231]
    buffer_load_dwordx4 a[116:119], v44, s[52:55], s80 offen offset:1024
    v_mfma_f32_16x16x32_bf16 a[232:235], v[144:147], a[64:67], a[232:235]
    v_mfma_f32_16x16x32_bf16 a[236:239], v[144:147], a[68:71], a[236:239]
    s_waitcnt vmcnt(10) lgkmcnt(0)
    v_mfma_f32_16x16x32_bf16 a[200:203], v[108:111], a[72:75], a[200:203]
    ds_read_b128 v[128:131], v97 offset:0
    v_mfma_f32_16x16x32_bf16 a[204:207], v[108:111], a[76:79], a[204:207]
    ds_read_b128 v[132:135], v97 offset:2048
    v_mfma_f32_16x16x32_bf16 a[208:211], v[112:115], a[72:75], a[208:211]
    ds_read_b128 v[136:139], v97 offset:4096
    v_mfma_f32_16x16x32_bf16 a[212:215], v[112:115], a[76:79], a[212:215]
    ds_read_b128 v[140:143], v97 offset:6144
    v_mfma_f32_16x16x32_bf16 a[216:219], v[116:119], a[72:75], a[216:219]
    ds_read_b128 v[144:147], v97 offset:8192
    v_mfma_f32_16x16x32_bf16 a[220:223], v[116:119], a[76:79], a[220:223]
    v_mfma_f32_16x16x32_bf16 a[224:227], v[120:123], a[72:75], a[224:227]
    v_mfma_f32_16x16x32_bf16 a[228:231], v[120:123], a[76:79], a[228:231]
    v_mfma_f32_16x16x32_bf16 a[232:235], v[124:127], a[72:75], a[232:235]
    v_mfma_f32_16x16x32_bf16 a[236:239], v[124:127], a[76:79], a[236:239]
    s_waitcnt vmcnt(8) lgkmcnt(0)
    v_mfma_f32_16x16x32_bf16 a[200:203], v[128:131], a[80:83], a[200:203]
    ds_read_b128 v[108:111], v98 offset:0
    v_mfma_f32_16x16x32_bf16 a[204:207], v[128:131], a[84:87], a[204:207]
    ds_read_b128 v[112:115], v98 offset:2048
    v_mfma_f32_16x16x32_bf16 a[208:211], v[132:135], a[80:83], a[208:211]
    ds_read_b128 v[116:119], v98 offset:4096
    v_mfma_f32_16x16x32_bf16 a[212:215], v[132:135], a[84:87], a[212:215]
    ds_read_b128 v[120:123], v98 offset:6144
    v_mfma_f32_16x16x32_bf16 a[216:219], v[136:139], a[80:83], a[216:219]
    ds_read_b128 v[124:127], v98 offset:8192
    v_mfma_f32_16x16x32_bf16 a[220:223], v[136:139], a[84:87], a[220:223]
    v_mfma_f32_16x16x32_bf16 a[224:227], v[140:143], a[80:83], a[224:227]
    v_mfma_f32_16x16x32_bf16 a[228:231], v[140:143], a[84:87], a[228:231]
    v_mfma_f32_16x16x32_bf16 a[232:235], v[144:147], a[80:83], a[232:235]
    v_mfma_f32_16x16x32_bf16 a[236:239], v[144:147], a[84:87], a[236:239]
    s_waitcnt vmcnt(6) lgkmcnt(0)
    v_mfma_f32_16x16x32_bf16 a[200:203], v[108:111], a[88:91], a[200:203]
    ds_read_b128 v[128:131], v99 offset:0
    v_mfma_f32_16x16x32_bf16 a[204:207], v[108:111], a[92:95], a[204:207]
    ds_read_b128 v[132:135], v99 offset:2048
    v_mfma_f32_16x16x32_bf16 a[208:211], v[112:115], a[88:91], a[208:211]
    ds_read_b128 v[136:139], v99 offset:4096
    v_mfma_f32_16x16x32_bf16 a[212:215], v[112:115], a[92:95], a[212:215]
    ds_read_b128 v[140:143], v99 offset:6144
    v_mfma_f32_16x16x32_bf16 a[216:219], v[116:119], a[88:91], a[216:219]
    ds_read_b128 v[144:147], v99 offset:8192
    v_mfma_f32_16x16x32_bf16 a[220:223], v[116:119], a[92:95], a[220:223]
    v_mfma_f32_16x16x32_bf16 a[224:227], v[120:123], a[88:91], a[224:227]
    v_mfma_f32_16x16x32_bf16 a[228:231], v[120:123], a[92:95], a[228:231]
    v_mfma_f32_16x16x32_bf16 a[232:235], v[124:127], a[88:91], a[232:235]
    v_mfma_f32_16x16x32_bf16 a[236:239], v[124:127], a[92:95], a[236:239]
    s_mov_b32 s81, 589824
    s_waitcnt vmcnt(0)
    s_cmp_eq_u32 s34, 0
    s_cbranch_scc1 L_wt_44
    buffer_store_dword v16, v33, s[48:51], s81 offen
    s_branch L_j_45
L_wt_44:
    buffer_store_dword v16, v33, s[48:51], s81 offen sc1
L_j_45:
    s_waitcnt lgkmcnt(0)
    v_mfma_f32_16x16x32_bf16 a[200:203], v[128:131], a[96:99], a[200:203]
    ds_read_b128 v[108:111], v100 offset:36864
    v_mfma_f32_16x16x32_bf16 a[204:207], v[128:131], a[100:103], a[204:207]
    ds_read_b128 v[112:115], v100 offset:38912
    v_mfma_f32_16x16x32_bf16 a[208:211], v[132:135], a[96:99], a[208:211]
    ds_read_b128 v[116:119], v100 offset:40960
    v_mfma_f32_16x16x32_bf16 a[212:215], v[132:135], a[100:103], a[212:215]
    ds_read_b128 v[120:123], v100 offset:43008
    v_mfma_f32_16x16x32_bf16 a[216:219], v[136:139], a[96:99], a[216:219]
    ds_read_b128 v[124:127], v100 offset:45056
    v_mfma_f32_16x16x32_bf16 a[220:223], v[136:139], a[100:103], a[220:223]
    v_mfma_f32_16x16x32_bf16 a[224:227], v[140:143], a[96:99], a[224:227]
    v_mfma_f32_16x16x32_bf16 a[228:231], v[140:143], a[100:103], a[228:231]
    v_mfma_f32_16x16x32_bf16 a[232:235], v[144:147], a[96:99], a[232:235]
    v_mfma_f32_16x16x32_bf16 a[236:239], v[144:147], a[100:103], a[236:239]
    s_waitcnt lgkmcnt(0)
    v_mfma_f32_16x16x32_bf16 a[200:203], v[108:111], a[104:107], a[200:203]
    ds_read_b128 v[128:131], v101 offset:36864
    v_mfma_f32_16x16x32_bf16 a[208:211], v[112:115], a[104:107], a[208:211]
    ds_read_b128 v[132:135], v101 offset:38912
    v_mfma_f32_16x16x32_bf16 a[216:219], v[116:119], a[104:107], a[216:219]
    ds_read_b128 v[136:139], v101 offset:40960
    v_mfma_f32_16x16x32_bf16 a[224:227], v[120:123], a[104:107], a[224:227]
    ds_read_b128 v[140:143], v101 offset:43008
    v_mfma_f32_16x16x32_bf16 a[232:235], v[124:127], a[104:107], a[232:235]
    ds_read_b128 v[144:147], v101 offset:45056
    buffer_load_dword v17, v34, s[48:51], s81 offen sc1
    s_waitcnt lgkmcnt(0)
    v_mfma_f32_16x16x32_bf16 a[200:203], v[128:131], a[112:115], a[200:203]
    v_mfma_f32_16x16x32_bf16 a[208:211], v[132:135], a[112:115], a[208:211]
    v_mfma_f32_16x16x32_bf16 a[216:219], v[136:139], a[112:115], a[216:219]
    v_mfma_f32_16x16x32_bf16 a[224:227], v[140:143], a[112:115], a[224:227]
    v_mfma_f32_16x16x32_bf16 a[232:235], v[144:147], a[112:115], a[232:235]
    v_mfma_f32_16x16x32_bf16 a[204:207], v[108:111], a[108:111], a[204:207]
    v_mfma_f32_16x16x32_bf16 a[212:215], v[112:115], a[108:111], a[212:215]
    v_mfma_f32_16x16x32_bf16 a[220:223], v[116:119], a[108:111], a[220:223]
    s_nop 0
    ds_write_b128 v48, a[200:203] offset:0
    v_mfma_f32_16x16x32_bf16 a[228:231], v[120:123], a[108:111], a[228:231]
    ds_write_b128 v48, a[208:211] offset:64
    v_mfma_f32_16x16x32_bf16 a[236:239], v[124:127], a[108:111], a[236:239]
    v_mfma_f32_16x16x32_bf16 a[204:207], v[128:131], a[116:119], a[204:207]
    ds_write_b128 v48, a[216:219] offset:128
    v_mfma_f32_16x16x32_bf16 a[212:215], v[132:135], a[116:119], a[212:215]
    ds_write_b128 v48, a[224:227] offset:192
    v_mfma_f32_16x16x32_bf16 a[220:223], v[136:139], a[116:119], a[220:223]
    v_mfma_f32_16x16x32_bf16 a[228:231], v[140:143], a[116:119], a[228:231]
    ds_write_b128 v48, a[232:235] offset:256
    v_mfma_f32_16x16x32_bf16 a[236:239], v[144:147], a[116:119], a[236:239]
    ds_read_b128 v[216:219], v55 offset:0
    ds_read_b128 v[220:223], v56 offset:0
    ds_read_b128 v[224:227], v57 offset:0
    ds_read_b128 v[228:231], v58 offset:0
    ds_read_b128 v[232:235], v59 offset:0
    ds_write_b128 v48, a[204:207] offset:5376
    ds_write_b128 v48, a[212:215] offset:5440
    ds_write_b128 v48, a[220:223] offset:5504
    ds_write_b128 v48, a[228:231] offset:5568
    ds_write_b128 v48, a[236:239] offset:5632
    ds_read_b128 v[236:239], v55 offset:5376
    ds_read_b128 v[240:243], v56 offset:5376
    ds_read_b128 v[244:247], v57 offset:5376
    ds_read_b128 v[248:251], v58 offset:5376
    ds_read_b128 v[252:255], v59 offset:5376
    s_waitcnt vmcnt(0)
    v_cmp_ne_u32 vcc, v16, v17
    s_nop 3
    s_cbranch_vccz L_rd_47
    s_mov_b32 s82, 0x40000
L_rp_46:
    buffer_load_dword v17, v34, s[48:51], s81 offen sc1
    s_waitcnt vmcnt(0)
    v_cmp_ne_u32 vcc, v16, v17
    s_nop 3
    s_cbranch_vccz L_rd_47
    s_sub_u32 s82, s82, 1
    s_cbranch_scc0 L_rp_46
L_rd_47:
    s_waitcnt lgkmcnt(14)
    buffer_store_dwordx4 v[216:219], v50, s[52:55], 0 offen nt
    s_waitcnt lgkmcnt(13)
    buffer_store_dwordx4 v[220:223], v51, s[52:55], 0 offen nt
    s_waitcnt lgkmcnt(12)
    buffer_store_dwordx4 v[224:227], v52, s[52:55], 0 offen nt
    s_waitcnt lgkmcnt(11)
    buffer_store_dwordx4 v[228:231], v53, s[52:55], 0 offen nt
    s_waitcnt lgkmcnt(10)
    buffer_store_dwordx4 v[232:235], v54, s[52:55], 0 offen nt
    s_waitcnt lgkmcnt(4)
    buffer_store_dwordx4 v[236:239], v50, s[52:55], s93 offen nt
    s_waitcnt lgkmcnt(3)
    buffer_store_dwordx4 v[240:243], v51, s[52:55], s93 offen nt
    s_waitcnt lgkmcnt(2)
    buffer_store_dwordx4 v[244:247], v52, s[52:55], s93 offen nt
    s_waitcnt lgkmcnt(1)
    buffer_store_dwordx4 v[248:251], v53, s[52:55], s93 offen nt
    s_waitcnt lgkmcnt(0)
    buffer_store_dwordx4 v[252:255], v54, s[52:55], s93 offen nt
    s_endpgm
L_own3:
    ds_read_b128 v[108:111], v103 offset:36864
    ds_read_b128 v[112:115], v103 offset:38912
    ds_read_b128 v[116:119], v103 offset:40960
    ds_read_b128 v[120:123], v103 offset:43008
    s_waitcnt vmcnt(11)
    ds_read_b128 v[124:127], v103 offset:45056
    s_waitcnt vmcnt(0)
    s_cmp_eq_u32 s34, 0
    s_cbranch_scc1 L_wt_48
    buffer_store_dword v16, v33, s[48:51], 0 offen
    s_branch L_j_49
L_wt_48:
    buffer_store_dword v16, v33, s[48:51], 0 offen sc1
L_j_49:
    s_waitcnt lgkmcnt(0)
    v_mfma_f32_16x16x32_bf16 a[200:203], v[108:111], v[176:179], a[200:203]
    ds_read_b128 v[128:131], v100 offset:57344
    v_mfma_f32_16x16x32_bf16 a[204:207], v[108:111], v[180:183], a[204:207]
    ds_read_b128 v[132:135], v100 offset:59392
    v_mfma_f32_16x16x32_bf16 a[208:211], v[112:115], v[176:179], a[208:211]
    ds_read_b128 v[136:139], v100 offset:61440
    v_mfma_f32_16x16x32_bf16 a[212:215], v[112:115], v[180:183], a[212:215]
    ds_read_b128 v[140:143], v100 offset:63488
    v_mfma_f32_16x16x32_bf16 a[216:219], v[116:119], v[176:179], a[216:219]
    ds_read_b128 v[144:147], v104 offset:0
    v_mfma_f32_16x16x32_bf16 a[220:223], v[116:119], v[180:183], a[220:223]
    s_add_u32 m0, s98, 61440
    s_add_u32 s81, s90, 5
    s_sub_u32 s101, s81, 10
    s_cselect_b32 s81, s81, s101
    s_lshl_b32 s81, s81, 7
    buffer_load_dwordx4 v20, s[44:47], s81 offen offset:0 lds
    v_mfma_f32_16x16x32_bf16 a[224:227], v[120:123], v[176:179], a[224:227]
    v_mfma_f32_16x16x32_bf16 a[228:231], v[120:123], v[180:183], a[228:231]
    buffer_load_dwordx4 v21, s[44:47], s81 offen offset:1024 lds
    v_mfma_f32_16x16x32_bf16 a[232:235], v[124:127], v[176:179], a[232:235]
    v_mfma_f32_16x16x32_bf16 a[236:239], v[124:127], v[180:183], a[236:239]
    s_waitcnt lgkmcnt(0)
    v_mfma_f32_16x16x32_bf16 a[200:203], v[128:131], v[184:187], a[200:203]
    ds_read_b128 v[108:111], v101 offset:57344
    v_mfma_f32_16x16x32_bf16 a[204:207], v[128:131], v[188:191], a[204:207]
    ds_read_b128 v[112:115], v101 offset:59392
    v_mfma_f32_16x16x32_bf16 a[208:211], v[132:135], v[184:187], a[208:211]
    ds_read_b128 v[116:119], v101 offset:61440
    v_mfma_f32_16x16x32_bf16 a[212:215], v[132:135], v[188:191], a[212:215]
    ds_read_b128 v[120:123], v101 offset:63488
    v_mfma_f32_16x16x32_bf16 a[216:219], v[136:139], v[184:187], a[216:219]
    ds_read_b128 v[124:127], v105 offset:0
    v_mfma_f32_16x16x32_bf16 a[220:223], v[136:139], v[188:191], a[220:223]
    buffer_load_dwordx4 v22, s[44:47], s81 offen offset:2048 lds
    v_mfma_f32_16x16x32_bf16 a[224:227], v[140:143], v[184:187], a[224:227]
    v_mfma_f32_16x16x32_bf16 a[228:231], v[140:143], v[188:191], a[228:231]
    buffer_load_dwordx4 v23, s[44:47], s81 offen offset:3072 lds
    v_mfma_f32_16x16x32_bf16 a[232:235], v[144:147], v[184:187], a[232:235]
    v_mfma_f32_16x16x32_bf16 a[236:239], v[144:147], v[188:191], a[236:239]
    s_waitcnt lgkmcnt(0)
    v_mfma_f32_16x16x32_bf16 a[200:203], v[108:111], v[192:195], a[200:203]
    ds_read_b128 v[128:131], v102 offset:57344
    v_mfma_f32_16x16x32_bf16 a[204:207], v[108:111], v[196:199], a[204:207]
    ds_read_b128 v[132:135], v102 offset:59392
    v_mfma_f32_16x16x32_bf16 a[208:211], v[112:115], v[192:195], a[208:211]
    ds_read_b128 v[136:139], v102 offset:61440
    v_mfma_f32_16x16x32_bf16 a[212:215], v[112:115], v[196:199], a[212:215]
    ds_read_b128 v[140:143], v102 offset:63488
    v_mfma_f32_16x16x32_bf16 a[216:219], v[116:119], v[192:195], a[216:219]
    ds_read_b128 v[144:147], v106 offset:0
    v_mfma_f32_16x16x32_bf16 a[220:223], v[116:119], v[196:199], a[220:223]
    s_add_u32 m0, s98, 65536
    s_nop 0
    buffer_load_dwordx4 v24, s[44:47], s81 offen offset:0 lds
    v_mfma_f32_16x16x32_bf16 a[224:227], v[120:123], v[192:195], a[224:227]
    s_add_u32 m0, s98, 81920
    s_add_u32 s81, s90, 6
    s_sub_u32 s101, s81, 10
    s_cselect_b32 s81, s81, s101
    s_lshl_b32 s81, s81, 7
    buffer_load_dwordx4 v20, s[44:47], s81 offen offset:0 lds
    v_mfma_f32_16x16x32_bf16 a[228:231], v[120:123], v[196:199], a[228:231]
    v_mfma_f32_16x16x32_bf16 a[232:235], v[124:127], v[192:195], a[232:235]
    buffer_load_dwordx4 v21, s[44:47], s81 offen offset:1024 lds
    v_mfma_f32_16x16x32_bf16 a[236:239], v[124:127], v[196:199], a[236:239]
    s_waitcnt lgkmcnt(0)
    v_mfma_f32_16x16x32_bf16 a[200:203], v[128:131], v[200:203], a[200:203]
    ds_read_b128 v[108:111], v103 offset:57344
    v_mfma_f32_16x16x32_bf16 a[204:207], v[128:131], v[204:207], a[204:207]
    ds_read_b128 v[112:115], v103 offset:59392
    v_mfma_f32_16x16x32_bf16 a[208:211], v[132:135], v[200:203], a[208:211]
    ds_read_b128 v[116:119], v103 offset:61440
    v_mfma_f32_16x16x32_bf16 a[212:215], v[132:135], v[204:207], a[212:215]
    ds_read_b128 v[120:123], v103 offset:63488
    v_mfma_f32_16x16x32_bf16 a[216:219], v[136:139], v[200:203], a[216:219]
    ds_read_b128 v[124:127], v107 offset:0
    v_mfma_f32_16x16x32_bf16 a[220:223], v[136:139], v[204:207], a[220:223]
    buffer_load_dwordx4 v22, s[44:47], s81 offen offset:2048 lds
    v_mfma_f32_16x16x32_bf16 a[224:227], v[140:143], v[200:203], a[224:227]
    v_mfma_f32_16x16x32_bf16 a[228:231], v[140:143], v[204:207], a[228:231]
    buffer_load_dwordx4 v23, s[44:47], s81 offen offset:3072 lds
    v_mfma_f32_16x16x32_bf16 a[232:235], v[144:147], v[200:203], a[232:235]
    v_mfma_f32_16x16x32_bf16 a[236:239], v[144:147], v[204:207], a[236:239]
    s_waitcnt lgkmcnt(0)
    v_mfma_f32_16x16x32_bf16 a[200:203], v[108:111], v[208:211], a[200:203]
    ds_read_b128 v[128:131], v96 offset:0
    v_mfma_f32_16x16x32_bf16 a[204:207], v[108:111], v[212:215], a[204:207]
    ds_read_b128 v[132:135], v96 offset:2048
    v_mfma_f32_16x16x32_bf16 a[208:211], v[112:115], v[208:211], a[208:211]
    ds_read_b128 v[136:139], v96 offset:4096
    v_mfma_f32_16x16x32_bf16 a[212:215], v[112:115], v[212:215], a[212:215]
    ds_read_b128 v[140:143], v96 offset:6144
    v_mfma_f32_16x16x32_bf16 a[216:219], v[116:119], v[208:211], a[216:219]
    ds_read_b128 v[144:147], v96 offset:8192
    v_mfma_f32_16x16x32_bf16 a[220:223], v[116:119], v[212:215], a[220:223]
    s_add_u32 m0, s98, 86016
    s_nop 0
    buffer_load_dwordx4 v24, s[44:47], s81 offen offset:0 lds
    v_mfma_f32_16x16x32_bf16 a[224:227], v[120:123], v[208:211], a[224:227]
    s_add_u32 m0, s98, 143360
    s_add_u32 s81, s90, 7
    s_sub_u32 s101, s81, 10
    s_cselect_b32 s81, s81, s101
    s_lshl_b32 s81, s81, 7
    buffer_load_dwordx4 v20, s[44:47], s81 offen offset:0 lds
    v_mfma_f32_16x16x32_bf16 a[228:231], v[120:123], v[212:215], a[228:231]
    v_mfma_f32_16x16x32_bf16 a[232:235], v[124:127], v[208:211], a[232:235]
    buffer_load_dwordx4 v21, s[44:47], s81 offen offset:1024 lds
    v_mfma_f32_16x16x32_bf16 a[236:239], v[124:127], v[212:215], a[236:239]
    v_and_b32 v4, 15, v0
    v_bfe_u32 v3, v0, 4, 2
    s_mul_i32 s94, s76, 10752
    s_add_u32 s94, s94, 20480
    v_mul_u32_u24 v5, 336, v4
    v_lshl_add_u32 v5, v3, 4, v5
    v_add_u32 v48, s94, v5
    s_lshl_b32 s95, s77, 7
    s_lshl_b32 s96, s76, 5
    s_add_u32 s95, s95, s96
    s_mul_i32 s95, s95, 5120
    s_mul_i32 s96, s78, 320
    s_add_u32 s95, s95, s96
    s_add_u32 s95, s95, 2560
    v_and_b32 v3, 63, v0
    v_add_u32 v4, 0, v3
    v_mul_u32_u24 v5, 3277, v4
    v_lshrrev_b32 v5, 16, v5
    v_lshlrev_b32 v4, 4, v4
    v_lshl_add_u32 v6, v5, 4, v4
    v_add_u32 v55, s94, v6
    v_mul_u32_u24 v5, 4800, v5
    v_add3_u32 v50, v5, v4, s95
    v_add_u32 v4, 64, v3
    v_mul_u32_u24 v5, 3277, v4
    v_lshrrev_b32 v5, 16, v5
    v_lshlrev_b32 v4, 4, v4
    v_lshl_add_u32 v6, v5, 4, v4
    v_add_u32 v56, s94, v6
    v_mul_u32_u24 v5, 4800, v5
    v_add3_u32 v51, v5, v4, s95
    v_add_u32 v4, 128, v3
    v_mul_u32_u24 v5, 3277, v4
    v_lshrrev_b32 v5, 16, v5
    v_lshlrev_b32 v4, 4, v4
    v_lshl_add_u32 v6, v5, 4, v4
    v_add_u32 v57, s94, v6
    v_mul_u32_u24 v5, 4800, v5
    v_add3_u32 v52, v5, v4, s95
    v_add_u32 v4, 192, v3
    v_mul_u32_u24 v5, 3277, v4
    v_lshrrev_b32 v5, 16, v5
    v_lshlrev_b32 v4, 4, v4
    v_lshl_add_u32 v6, v5, 4, v4
    v_add_u32 v58, s94, v6
    v_mul_u32_u24 v5, 4800, v5
    v_add3_u32 v53, v5, v4, s95
    v_add_u32 v4, 256, v3
    v_mul_u32_u24 v5, 3277, v4
    v_lshrrev_b32 v5, 16, v5
    v_lshlrev_b32 v4, 4, v4
    v_lshl_add_u32 v6, v5, 4, v4
    v_add_u32 v59, s94, v6
    v_mul_u32_u24 v5, 4800, v5
    v_add3_u32 v54, v5, v4, s95
    s_mov_b32 s93, 81920
    s_mov_b32 s82, 0x40000
L_poll_50:
    buffer_load_dword v4, v34, s[48:51], 0 offen sc1
    s_waitcnt vmcnt(0)
    v_xor_b32 v4, s79, v4
    v_cmp_ne_u32 vcc, 0, v4
    s_nop 3
    s_cbranch_vccz L_pdone_51
    s_sub_u32 s82, s82, 1
    s_cbranch_scc0 L_poll_50
L_pdone_51:
    s_add_u32 s80, s78, 1
    s_and_b32 s80, s80, 7
    s_mul_i32 s80, s80, 20480
    buffer_load_dwordx4 a[40:43], v39, s[52:55], s80 offen offset:0
    buffer_load_dwordx4 a[44:47], v39, s[52:55], s80 offen offset:1024
    buffer_load_dwordx4 a[48:51], v40, s[52:55], s80 offen offset:0
    buffer_load_dwordx4 a[52:55], v41, s[52:55], s80 offen offset:0
    buffer_load_dwordx4 a[56:59], v41, s[52:55], s80 offen offset:1024
    buffer_load_dwordx4 a[60:63], v42, s[52:55], s80 offen offset:0
    buffer_load_dwordx4 a[64:67], v42, s[52:55], s80 offen offset:1024
    buffer_load_dwordx4 a[68:71], v43, s[52:55], s80 offen offset:0
    buffer_load_dwordx4 a[72:75], v44, s[52:55], s80 offen offset:0
    buffer_load_dwordx4 a[76:79], v44, s[52:55], s80 offen offset:1024
    s_add_u32 s80, s78, 2
    s_and_b32 s80, s80, 7
    s_mul_i32 s80, s80, 20480
    buffer_load_dwordx4 a[80:83], v39, s[52:55], s80 offen offset:0
    buffer_load_dwordx4 a[84:87], v39, s[52:55], s80 offen offset:1024
    s_waitcnt vmcnt(10) lgkmcnt(0)
    v_mfma_f32_16x16x32_bf16 a[200:203], v[128:131], a[40:43], a[200:203]
    ds_read_b128 v[108:111], v97 offset:0
    v_mfma_f32_16x16x32_bf16 a[204:207], v[128:131], a[44:47], a[204:207]
    ds_read_b128 v[112:115], v97 offset:2048
    v_mfma_f32_16x16x32_bf16 a[208:211], v[132:135], a[40:43], a[208:211]
    ds_read_b128 v[116:119], v97 offset:4096
    v_mfma_f32_16x16x32_bf16 a[212:215], v[132:135], a[44:47], a[212:215]
    ds_read_b128 v[120:123], v97 offset:6144
    v_mfma_f32_16x16x32_bf16 a[216:219], v[136:139], a[40:43], a[216:219]
    ds_read_b128 v[124:127], v97 offset:8192
    v_mfma_f32_16x16x32_bf16 a[220:223], v[136:139], a[44:47], a[220:223]
    buffer_load_dwordx4 a[88:91], v40, s[52:55], s80 offen offset:0
    v_mfma_f32_16x16x32_bf16 a[224:227], v[140:143], a[40:43], a[224:227]
    v_mfma_f32_16x16x32_bf16 a[228:231], v[140:143], a[44:47], a[228:231]
    buffer_load_dwordx4 a[92:95], v41, s[52:55], s80 offen offset:0
    v_mfma_f32_16x16x32_bf16 a[232:235], v[144:147], a[40:43], a[232:235]
    v_mfma_f32_16x16x32_bf16 a[236:239], v[144:147], a[44:47], a[236:239]
    s_waitcnt vmcnt(10) lgkmcnt(0)
    v_mfma_f32_16x16x32_bf16 a[200:203], v[108:111], a[48:51], a[200:203]
    ds_read_b128 v[128:131], v98 offset:0
    v_mfma_f32_16x16x32_bf16 a[204:207], v[108:111], a[52:55], a[204:207]
    ds_read_b128 v[132:135], v98 offset:2048
    v_mfma_f32_16x16x32_bf16 a[208:211], v[112:115], a[48:51], a[208:211]
    ds_read_b128 v[136:139], v98 offset:4096
    v_mfma_f32_16x16x32_bf16 a[212:215], v[112:115], a[52:55], a[212:215]
    ds_read_b128 v[140:143], v98 offset:6144
    v_mfma_f32_16x16x32_bf16 a[216:219], v[116:119], a[48:51], a[216:219]
    ds_read_b128 v[144:147], v98 offset:8192
    v_mfma_f32_16x16x32_bf16 a[220:223], v[116:119], a[52:55], a[220:223]
    buffer_load_dwordx4 a[96:99], v41, s[52:55], s80 offen offset:1024
    v_mfma_f32_16x16x32_bf16 a[224:227], v[120:123], a[48:51], a[224:227]
    buffer_load_dwordx4 a[100:103], v42, s[52:55], s80 offen offset:0
    v_mfma_f32_16x16x32_bf16 a[228:231], v[120:123], a[52:55], a[228:231]
    v_mfma_f32_16x16x32_bf16 a[232:235], v[124:127], a[48:51], a[232:235]
    buffer_load_dwordx4 v22, s[44:47], s81 offen offset:2048 lds
    v_mfma_f32_16x16x32_bf16 a[236:239], v[124:127], a[52:55], a[236:239]
    s_waitcnt vmcnt(11) lgkmcnt(0)
    v_mfma_f32_16x16x32_bf16 a[200:203], v[128:131], a[56:59], a[200:203]
    ds_read_b128 v[108:111], v99 offset:0
    v_mfma_f32_16x16x32_bf16 a[204:207], v[128:131], a[60:63], a[204:207]
    ds_read_b128 v[112:115], v99 offset:2048
    v_mfma_f32_16x16x32_bf16 a[208:211], v[132:135], a[56:59], a[208:211]
    ds_read_b128 v[116:119], v99 offset:4096
    v_mfma_f32_16x16x32_bf16 a[212:215], v[132:135], a[60:63], a[212:215]
    ds_read_b128 v[120:123], v99 offset:6144
    v_mfma_f32_16x16x32_bf16 a[216:219], v[136:139], a[56:59], a[216:219]
    ds_read_b128 v[124:127], v99 offset:8192
    v_mfma_f32_16x16x32_bf16 a[220:223], v[136:139], a[60:63], a[220:223]
    buffer_load_dwordx4 a[104:107], v42, s[52:55], s80 offen offset:1024
    v_mfma_f32_16x16x32_bf16 a[224:227], v[140:143], a[56:59], a[224:227]
    buffer_load_dwordx4 a[108:111], v43, s[52:55], s80 offen offset:0
    v_mfma_f32_16x16x32_bf16 a[228:231], v[140:143], a[60:63], a[228:231]
    v_mfma_f32_16x16x32_bf16 a[232:235], v[144:147], a[56:59], a[232:235]
    buffer_load_dwordx4 v23, s[44:47], s81 offen offset:3072 lds
    v_mfma_f32_16x16x32_bf16 a[236:239], v[144:147], a[60:63], a[236:239]
    s_waitcnt lgkmcnt(0)
    s_barrier
    s_waitcnt vmcnt(12)
    v_mfma_f32_16x16x32_bf16 a[200:203], v[108:111], a[64:67], a[200:203]
    ds_read_b128 v[128:131], v96 offset:20480
    v_mfma_f32_16x16x32_bf16 a[204:207], v[108:111], a[68:71], a[204:207]
    ds_read_b128 v[132:135], v96 offset:22528
    v_mfma_f32_16x16x32_bf16 a[208:211], v[112:115], a[64:67], a[208:211]
    ds_read_b128 v[136:139], v96 offset:24576
    v_mfma_f32_16x16x32_bf16 a[212:215], v[112:115], a[68:71], a[212:215]
    ds_read_b128 v[140:143], v96 offset:26624
    v_mfma_f32_16x16x32_bf16 a[216:219], v[116:119], a[64:67], a[216:219]
    ds_read_b128 v[144:147], v96 offset:28672
    v_mfma_f32_16x16x32_bf16 a[220:223], v[116:119], a[68:71], a[220:223]
    buffer_load_dwordx4 a[112:115], v44, s[52:55], s80 offen offset:0
    v_mfma_f32_16x16x32_bf16 a[224:227], v[120:123], a[64:67], a[224:227]
    buffer_load_dwordx4 a[116:119], v44, s[52:55], s80 offen offset:1024
    v_mfma_f32_16x16x32_bf16 a[228:231], v[120:123], a[68:71], a[228:231]
    v_mfma_f32_16x16x32_bf16 a[232:235], v[124:127], a[64:67], a[232:235]
    s_add_u32 m0, s98, 147456
    s_nop 0
    buffer_load_dwordx4 v24, s[44:47], s81 offen offset:0 lds
    v_mfma_f32_16x16x32_bf16 a[236:239], v[124:127], a[68:71], a[236:239]
    s_waitcnt vmcnt(13) lgkmcnt(0)
    v_mfma_f32_16x16x32_bf16 a[200:203], v[128:131], a[72:75], a[200:203]
    ds_read_b128 v[108:111], v97 offset:20480
    v_mfma_f32_16x16x32_bf16 a[204:207], v[128:131], a[76:79], a[204:207]
    ds_read_b128 v[112:115], v97 offset:22528
    v_mfma_f32_16x16x32_bf16 a[208:211], v[132:135], a[72:75], a[208:211]
    ds_read_b128 v[116:119], v97 offset:24576
    v_mfma_f32_16x16x32_bf16 a[212:215], v[132:135], a[76:79], a[212:215]
    ds_read_b128 v[120:123], v97 offset:26624
    v_mfma_f32_16x16x32_bf16 a[216:219], v[136:139], a[72:75], a[216:219]
    ds_read_b128 v[124:127], v97 offset:28672
    v_mfma_f32_16x16x32_bf16 a[220:223], v[136:139], a[76:79], a[220:223]
    s_add_u32 s80, s78, 3
    s_and_b32 s80, s80, 7
    s_mul_i32 s80, s80, 20480
    buffer_load_dwordx4 a[120:123], v39, s[52:55], s80 offen offset:0
    v_mfma_f32_16x16x32_bf16 a[224:227], v[140:143], a[72:75], a[224:227]
    buffer_load_dwordx4 a[124:127], v39, s[52:55], s80 offen offset:1024
    v_mfma_f32_16x16x32_bf16 a[228:231], v[140:143], a[76:79], a[228:231]
    v_mfma_f32_16x16x32_bf16 a[232:235], v[144:147], a[72:75], a[232:235]
    s_add_u32 m0, s98, 122880
    s_add_u32 s81, s90, 8
    s_sub_u32 s101, s81, 10
    s_cselect_b32 s81, s81, s101
    s_lshl_b32 s81, s81, 7
    buffer_load_dwordx4 v20, s[44:47], s81 offen offset:0 lds
    v_mfma_f32_16x16x32_bf16 a[236:239], v[144:147], a[76:79], a[236:239]
    s_waitcnt vmcnt(14) lgkmcnt(0)
    v_mfma_f32_16x16x32_bf16 a[200:203], v[108:111], a[80:83], a[200:203]
    ds_read_b128 v[128:131], v98 offset:20480
    v_mfma_f32_16x16x32_bf16 a[204:207], v[108:111], a[84:87], a[204:207]
    ds_read_b128 v[132:135], v98 offset:22528
    v_mfma_f32_16x16x32_bf16 a[208:211], v[112:115], a[80:83], a[208:211]
    ds_read_b128 v[136:139], v98 offset:24576
    v_mfma_f32_16x16x32_bf16 a[212:215], v[112:115], a[84:87], a[212:215]
    ds_read_b128 v[140:143], v98 offset:26624
    v_mfma_f32_16x16x32_bf16 a[216:219], v[116:119], a[80:83], a[216:219]
    ds_read_b128 v[144:147], v98 offset:28672
    v_mfma_f32_16x16x32_bf16 a[220:223], v[116:119], a[84:87], a[220:223]
    buffer_load_dwordx4 a[128:131], v40, s[52:55], s80 offen offset:0
    v_mfma_f32_16x16x32_bf16 a[224:227], v[120:123], a[80:83], a[224:227]
    buffer_load_dwordx4 a[132:135], v41, s[52:55], s80 offen offset:0
    v_mfma_f32_16x16x32_bf16 a[228:231], v[120:123], a[84:87], a[228:231]
    v_mfma_f32_16x16x32_bf16 a[232:235], v[124:127], a[80:83], a[232:235]
    buffer_load_dwordx4 v21, s[44:47], s81 offen offset:1024 lds
    v_mfma_f32_16x16x32_bf16 a[236:239], v[124:127], a[84:87], a[236:239]
    s_waitcnt vmcnt(15) lgkmcnt(0)
    v_mfma_f32_16x16x32_bf16 a[200:203], v[128:131], a[88:91], a[200:203]
    ds_read_b128 v[108:111], v99 offset:20480
    v_mfma_f32_16x16x32_bf16 a[204:207], v[128:131], a[92:95], a[204:207]
    ds_read_b128 v[112:115], v99 offset:22528
    v_mfma_f32_16x16x32_bf16 a[208:211], v[132:135], a[88:91], a[208:211]
    ds_read_b128 v[116:119], v99 offset:24576
    v_mfma_f32_16x16x32_bf16 a[212:215], v[132:135], a[92:95], a[212:215]
    ds_read_b128 v[120:123], v99 offset:26624
    v_mfma_f32_16x16x32_bf16 a[216:219], v[136:139], a[88:91], a[216:219]
    ds_read_b128 v[124:127], v99 offset:28672
    v_mfma_f32_16x16x32_bf16 a[220:223], v[136:139], a[92:95], a[220:223]
    buffer_load_dwordx4 a[136:139], v41, s[52:55], s80 offen offset:1024
    v_mfma_f32_16x16x32_bf16 a[224:227], v[140:143], a[88:91], a[224:227]
    v_mfma_f32_16x16x32_bf16 a[228:231], v[140:143], a[92:95], a[228:231]
    buffer_load_dwordx4 a[140:143], v42, s[52:55], s80 offen offset:0
    v_mfma_f32_16x16x32_bf16 a[232:235], v[144:147], a[88:91], a[232:235]
    v_mfma_f32_16x16x32_bf16 a[236:239], v[144:147], a[92:95], a[236:239]
    s_waitcnt vmcnt(15) lgkmcnt(0)
    v_mfma_f32_16x16x32_bf16 a[200:203], v[108:111], a[96:99], a[200:203]
    ds_read_b128 v[128:131], v96 offset:40960
    v_mfma_f32_16x16x32_bf16 a[204:207], v[108:111], a[100:103], a[204:207]
    ds_read_b128 v[132:135], v96 offset:43008
    v_mfma_f32_16x16x32_bf16 a[208:211], v[112:115], a[96:99], a[208:211]
    ds_read_b128 v[136:139], v96 offset:45056
    v_mfma_f32_16x16x32_bf16 a[212:215], v[112:115], a[100:103], a[212:215]
    ds_read_b128 v[140:143], v96 offset:47104
    v_mfma_f32_16x16x32_bf16 a[216:219], v[116:119], a[96:99], a[216:219]
    ds_read_b128 v[144:147], v96 offset:49152
    v_mfma_f32_16x16x32_bf16 a[220:223], v[116:119], a[100:103], a[220:223]
    buffer_load_dwordx4 a[144:147], v42, s[52:55], s80 offen offset:1024
    v_mfma_f32_16x16x32_bf16 a[224:227], v[120:123], a[96:99], a[224:227]
    buffer_load_dwordx4 a[148:151], v43, s[52:55], s80 offen offset:0
    v_mfma_f32_16x16x32_bf16 a[228:231], v[120:123], a[100:103], a[228:231]
    v_mfma_f32_16x16x32_bf16 a[232:235], v[124:127], a[96:99], a[232:235]
    buffer_load_dwordx4 v22, s[44:47], s81 offen offset:2048 lds
    v_mfma_f32_16x16x32_bf16 a[236:239], v[124:127], a[100:103], a[236:239]
    s_waitcnt vmcnt(15) lgkmcnt(0)
    v_mfma_f32_16x16x32_bf16 a[200:203], v[128:131], a[104:107], a[200:203]
    ds_read_b128 v[108:111], v97 offset:40960
    v_mfma_f32_16x16x32_bf16 a[204:207], v[128:131], a[108:111], a[204:207]
    ds_read_b128 v[112:115], v97 offset:43008
    v_mfma_f32_16x16x32_bf16 a[208:211], v[132:135], a[104:107], a[208:211]
    ds_read_b128 v[116:119], v97 offset:45056
    v_mfma_f32_16x16x32_bf16 a[212:215], v[132:135], a[108:111], a[212:215]
    ds_read_b128 v[120:123], v97 offset:47104
    v_mfma_f32_16x16x32_bf16 a[216:219], v[136:139], a[104:107], a[216:219]
    ds_read_b128 v[124:127], v97 offset:49152
    v_mfma_f32_16x16x32_bf16 a[220:223], v[136:139], a[108:111], a[220:223]
    buffer_load_dwordx4 a[152:155], v44, s[52:55], s80 offen offset:0
    v_mfma_f32_16x16x32_bf16 a[224:227], v[140:143], a[104:107], a[224:227]
    buffer_load_dwordx4 a[156:159], v44, s[52:55], s80 offen offset:1024
    v_mfma_f32_16x16x32_bf16 a[228:231], v[140:143], a[108:111], a[228:231]
    v_mfma_f32_16x16x32_bf16 a[232:235], v[144:147], a[104:107], a[232:235]
    buffer_load_dwordx4 v23, s[44:47], s81 offen offset:3072 lds
    v_mfma_f32_16x16x32_bf16 a[236:239], v[144:147], a[108:111], a[236:239]
    s_waitcnt vmcnt(15) lgkmcnt(0)
    v_mfma_f32_16x16x32_bf16 a[200:203], v[108:111], a[112:115], a[200:203]
    ds_read_b128 v[128:131], v98 offset:40960
    v_mfma_f32_16x16x32_bf16 a[204:207], v[108:111], a[116:119], a[204:207]
    ds_read_b128 v[132:135], v98 offset:43008
    v_mfma_f32_16x16x32_bf16 a[208:211], v[112:115], a[112:115], a[208:211]
    ds_read_b128 v[136:139], v98 offset:45056
    v_mfma_f32_16x16x32_bf16 a[212:215], v[112:115], a[116:119], a[212:215]
    ds_read_b128 v[140:143], v98 offset:47104
    v_mfma_f32_16x16x32_bf16 a[216:219], v[116:119], a[112:115], a[216:219]
    ds_read_b128 v[144:147], v98 offset:49152
    v_mfma_f32_16x16x32_bf16 a[220:223], v[116:119], a[116:119], a[220:223]
    s_add_u32 s80, s78, 4
    s_and_b32 s80, s80, 7
    s_mul_i32 s80, s80, 20480
    buffer_load_dwordx4 a[160:163], v39, s[52:55], s80 offen offset:0
    v_mfma_f32_16x16x32_bf16 a[224:227], v[120:123], a[112:115], a[224:227]
    v_mfma_f32_16x16x32_bf16 a[228:231], v[120:123], a[116:119], a[228:231]
    buffer_load_dwordx4 a[164:167], v39, s[52:55], s80 offen offset:1024
    v_mfma_f32_16x16x32_bf16 a[232:235], v[124:127], a[112:115], a[232:235]
    v_mfma_f32_16x16x32_bf16 a[236:239], v[124:127], a[116:119], a[236:239]
    s_waitcnt vmcnt(14) lgkmcnt(0)
    v_mfma_f32_16x16x32_bf16 a[200:203], v[128:131], a[120:123], a[200:203]
    ds_read_b128 v[108:111], v99 offset:40960
    v_mfma_f32_16x16x32_bf16 a[204:207], v[128:131], a[124:127], a[204:207]
    ds_read_b128 v[112:115], v99 offset:43008
    v_mfma_f32_16x16x32_bf16 a[208:211], v[132:135], a[120:123], a[208:211]
    ds_read_b128 v[116:119], v99 offset:45056
    v_mfma_f32_16x16x32_bf16 a[212:215], v[132:135], a[124:127], a[212:215]
    ds_read_b128 v[120:123], v99 offset:47104
    v_mfma_f32_16x16x32_bf16 a[216:219], v[136:139], a[120:123], a[216:219]
    ds_read_b128 v[124:127], v99 offset:49152
    v_mfma_f32_16x16x32_bf16 a[220:223], v[136:139], a[124:127], a[220:223]
    buffer_load_dwordx4 a[168:171], v40, s[52:55], s80 offen offset:0
    v_mfma_f32_16x16x32_bf16 a[224:227], v[140:143], a[120:123], a[224:227]
    buffer_load_dwordx4 a[172:175], v41, s[52:55], s80 offen offset:0
    v_mfma_f32_16x16x32_bf16 a[228:231], v[140:143], a[124:127], a[228:231]
    v_mfma_f32_16x16x32_bf16 a[232:235], v[144:147], a[120:123], a[232:235]
    s_add_u32 m0, s98, 126976
    s_nop 0
    buffer_load_dwordx4 v24, s[44:47], s81 offen offset:0 lds
    v_mfma_f32_16x16x32_bf16 a[236:239], v[144:147], a[124:127], a[236:239]
    s_barrier
    s_waitcnt vmcnt(14) lgkmcnt(0)
    v_mfma_f32_16x16x32_bf16 a[200:203], v[108:111], a[128:131], a[200:203]
    ds_read_b128 v[128:131], v96 offset:61440
    v_mfma_f32_16x16x32_bf16 a[204:207], v[108:111], a[132:135], a[204:207]
    ds_read_b128 v[132:135], v96 offset:63488
    v_mfma_f32_16x16x32_bf16 a[208:211], v[112:115], a[128:131], a[208:211]
    ds_read_b128 v[136:139], v100 offset:0
    v_mfma_f32_16x16x32_bf16 a[212:215], v[112:115], a[132:135], a[212:215]
    ds_read_b128 v[140:143], v100 offset:2048
    v_mfma_f32_16x16x32_bf16 a[216:219], v[116:119], a[128:131], a[216:219]
    ds_read_b128 v[144:147], v100 offset:4096
    v_mfma_f32_16x16x32_bf16 a[220:223], v[116:119], a[132:135], a[220:223]
    buffer_load_dwordx4 a[176:179], v41, s[52:55], s80 offen offset:1024
    v_mfma_f32_16x16x32_bf16 a[224:227], v[120:123], a[128:131], a[224:227]
    v_mfma_f32_16x16x32_bf16 a[228:231], v[120:123], a[132:135], a[228:231]
    buffer_load_dwordx4 a[180:183], v42, s[52:55], s80 offen offset:0
    v_mfma_f32_16x16x32_bf16 a[232:235], v[124:127], a[128:131], a[232:235]
    v_mfma_f32_16x16x32_bf16 a[236:239], v[124:127], a[132:135], a[236:239]
    s_waitcnt vmcnt(13) lgkmcnt(0)
    v_mfma_f32_16x16x32_bf16 a[200:203], v[128:131], a[136:139], a[200:203]
    ds_read_b128 v[108:111], v97 offset:61440
    v_mfma_f32_16x16x32_bf16 a[204:207], v[128:131], a[140:143], a[204:207]
    ds_read_b128 v[112:115], v97 offset:63488
    v_mfma_f32_16x16x32_bf16 a[208:211], v[132:135], a[136:139], a[208:211]
    ds_read_b128 v[116:119], v101 offset:0
    v_mfma_f32_16x16x32_bf16 a[212:215], v[132:135], a[140:143], a[212:215]
    ds_read_b128 v[120:123], v101 offset:2048
    v_mfma_f32_16x16x32_bf16 a[216:219], v[136:139], a[136:139], a[216:219]
    ds_read_b128 v[124:127], v101 offset:4096
    v_mfma_f32_16x16x32_bf16 a[220:223], v[136:139], a[140:143], a[220:223]
    buffer_load_dwordx4 a[184:187], v42, s[52:55], s80 offen offset:1024
    v_mfma_f32_16x16x32_bf16 a[224:227], v[140:143], a[136:139], a[224:227]
    buffer_load_dwordx4 a[188:191], v43, s[52:55], s80 offen offset:0
    v_mfma_f32_16x16x32_bf16 a[228:231], v[140:143], a[140:143], a[228:231]
    v_mfma_f32_16x16x32_bf16 a[232:235], v[144:147], a[136:139], a[232:235]
    s_add_u32 m0, s98, 0
    s_add_u32 s81, s90, 9
    s_sub_u32 s101, s81, 10
    s_cselect_b32 s81, s81, s101
    s_lshl_b32 s81, s81, 7
    buffer_load_dwordx4 v20, s[44:47], s81 offen offset:0 lds
    v_mfma_f32_16x16x32_bf16 a[236:239], v[144:147], a[140:143], a[236:239]
    s_waitcnt vmcnt(14) lgkmcnt(0)
    v_mfma_f32_16x16x32_bf16 a[200:203], v[108:111], a[144:147], a[200:203]
    ds_read_b128 v[128:131], v98 offset:61440
    v_mfma_f32_16x16x32_bf16 a[204:207], v[108:111], a[148:151], a[204:207]
    ds_read_b128 v[132:135], v98 offset:63488
    v_mfma_f32_16x16x32_bf16 a[208:211], v[112:115], a[144:147], a[208:211]
    ds_read_b128 v[136:139], v102 offset:0
    v_mfma_f32_16x16x32_bf16 a[212:215], v[112:115], a[148:151], a[212:215]
    ds_read_b128 v[140:143], v102 offset:2048
    v_mfma_f32_16x16x32_bf16 a[216:219], v[116:119], a[144:147], a[216:219]
    ds_read_b128 v[144:147], v102 offset:4096
    v_mfma_f32_16x16x32_bf16 a[220:223], v[116:119], a[148:151], a[220:223]
    buffer_load_dwordx4 a[192:195], v44, s[52:55], s80 offen offset:0
    v_mfma_f32_16x16x32_bf16 a[224:227], v[120:123], a[144:147], a[224:227]
    buffer_load_dwordx4 a[196:199], v44, s[52:55], s80 offen offset:1024
    v_mfma_f32_16x16x32_bf16 a[228:231], v[120:123], a[148:151], a[228:231]
    v_mfma_f32_16x16x32_bf16 a[232:235], v[124:127], a[144:147], a[232:235]
    buffer_load_dwordx4 v21, s[44:47], s81 offen offset:1024 lds
    v_mfma_f32_16x16x32_bf16 a[236:239], v[124:127], a[148:151], a[236:239]
    s_waitcnt vmcnt(14) lgkmcnt(0)
    v_mfma_f32_16x16x32_bf16 a[200:203], v[128:131], a[152:155], a[200:203]
    ds_read_b128 v[108:111], v99 offset:61440
    v_mfma_f32_16x16x32_bf16 a[204:207], v[128:131], a[156:159], a[204:207]
    ds_read_b128 v[112:115], v99 offset:63488
    v_mfma_f32_16x16x32_bf16 a[208:211], v[132:135], a[152:155], a[208:211]
    ds_read_b128 v[116:119], v103 offset:0
    v_mfma_f32_16x16x32_bf16 a[212:215], v[132:135], a[156:159], a[212:215]
    ds_read_b128 v[120:123], v103 offset:2048
    v_mfma_f32_16x16x32_bf16 a[216:219], v[136:139], a[152:155], a[216:219]
    ds_read_b128 v[124:127], v103 offset:4096
    v_mfma_f32_16x16x32_bf16 a[220:223], v[136:139], a[156:159], a[220:223]
    s_add_u32 s80, s78, 5
    s_and_b32 s80, s80, 7
    s_mul_i32 s80, s80, 20480
    buffer_load_dwordx4 a[0:3], v39, s[52:55], s80 offen offset:0
    v_mfma_f32_16x16x32_bf16 a[224:227], v[140:143], a[152:155], a[224:227]
    v_mfma_f32_16x16x32_bf16 a[228:231], v[140:143], a[156:159], a[228:231]
    buffer_load_dwordx4 a[4:7], v39, s[52:55], s80 offen offset:1024
    v_mfma_f32_16x16x32_bf16 a[232:235], v[144:147], a[152:155], a[232:235]
    v_mfma_f32_16x16x32_bf16 a[236:239], v[144:147], a[156:159], a[236:239]
    s_waitcnt vmcnt(13) lgkmcnt(0)
    v_mfma_f32_16x16x32_bf16 a[200:203], v[108:111], a[160:163], a[200:203]
    ds_read_b128 v[128:131], v100 offset:16384
    v_mfma_f32_16x16x32_bf16 a[204:207], v[108:111], a[164:167], a[204:207]
    ds_read_b128 v[132:135], v100 offset:18432
    v_mfma_f32_16x16x32_bf16 a[208:211], v[112:115], a[160:163], a[208:211]
    ds_read_b128 v[136:139], v100 offset:20480
    v_mfma_f32_16x16x32_bf16 a[212:215], v[112:115], a[164:167], a[212:215]
    ds_read_b128 v[140:143], v100 offset:22528
    v_mfma_f32_16x16x32_bf16 a[216:219], v[116:119], a[160:163], a[216:219]
    ds_read_b128 v[144:147], v100 offset:24576
    v_mfma_f32_16x16x32_bf16 a[220:223], v[116:119], a[164:167], a[220:223]
    buffer_load_dwordx4 a[8:11], v40, s[52:55], s80 offen offset:0
    v_mfma_f32_16x16x32_bf16 a[224:227], v[120:123], a[160:163], a[224:227]
    buffer_load_dwordx4 a[12:15], v41, s[52:55], s80 offen offset:0
    v_mfma_f32_16x16x32_bf16 a[228:231], v[120:123], a[164:167], a[228:231]
    v_mfma_f32_16x16x32_bf16 a[232:235], v[124:127], a[160:163], a[232:235]
    buffer_load_dwordx4 v22, s[44:47], s81 offen offset:2048 lds
    v_mfma_f32_16x16x32_bf16 a[236:239], v[124:127], a[164:167], a[236:239]
    s_waitcnt vmcnt(14) lgkmcnt(0)
    v_mfma_f32_16x16x32_bf16 a[200:203], v[128:131], a[168:171], a[200:203]
    ds_read_b128 v[108:111], v101 offset:16384
    v_mfma_f32_16x16x32_bf16 a[204:207], v[128:131], a[172:175], a[204:207]
    ds_read_b128 v[112:115], v101 offset:18432
    v_mfma_f32_16x16x32_bf16 a[208:211], v[132:135], a[168:171], a[208:211]
    ds_read_b128 v[116:119], v101 offset:20480
    v_mfma_f32_16x16x32_bf16 a[212:215], v[132:135], a[172:175], a[212:215]
    ds_read_b128 v[120:123], v101 offset:22528
    v_mfma_f32_16x16x32_bf16 a[216:219], v[136:139], a[168:171], a[216:219]
    ds_read_b128 v[124:127], v101 offset:24576
    v_mfma_f32_16x16x32_bf16 a[220:223], v[136:139], a[172:175], a[220:223]
    buffer_load_dwordx4 a[16:19], v41, s[52:55], s80 offen offset:1024
    v_mfma_f32_16x16x32_bf16 a[224:227], v[140:143], a[168:171], a[224:227]
    buffer_load_dwordx4 a[20:23], v42, s[52:55], s80 offen offset:0
    v_mfma_f32_16x16x32_bf16 a[228:231], v[140:143], a[172:175], a[228:231]
    v_mfma_f32_16x16x32_bf16 a[232:235], v[144:147], a[168:171], a[232:235]
    buffer_load_dwordx4 v23, s[44:47], s81 offen offset:3072 lds
    v_mfma_f32_16x16x32_bf16 a[236:239], v[144:147], a[172:175], a[236:239]
    s_waitcnt vmcnt(14) lgkmcnt(0)
    v_mfma_f32_16x16x32_bf16 a[200:203], v[108:111], a[176:179], a[200:203]
    ds_read_b128 v[128:131], v102 offset:16384
    v_mfma_f32_16x16x32_bf16 a[204:207], v[108:111], a[180:183], a[204:207]
    ds_read_b128 v[132:135], v102 offset:18432
    v_mfma_f32_16x16x32_bf16 a[208:211], v[112:115], a[176:179], a[208:211]
    ds_read_b128 v[136:139], v102 offset:20480
    v_mfma_f32_16x16x32_bf16 a[212:215], v[112:115], a[180:183], a[212:215]
    ds_read_b128 v[140:143], v102 offset:22528
    v_mfma_f32_16x16x32_bf16 a[216:219], v[116:119], a[176:179], a[216:219]
    ds_read_b128 v[144:147], v102 offset:24576
    v_mfma_f32_16x16x32_bf16 a[220:223], v[116:119], a[180:183], a[220:223]
    buffer_load_dwordx4 a[24:27], v42, s[52:55], s80 offen offset:1024
    v_mfma_f32_16x16x32_bf16 a[224:227], v[120:123], a[176:179], a[224:227]
    v_mfma_f32_16x16x32_bf16 a[228:231], v[120:123], a[180:183], a[228:231]
    buffer_load_dwordx4 a[28:31], v43, s[52:55], s80 offen offset:0
    v_mfma_f32_16x16x32_bf16 a[232:235], v[124:127], a[176:179], a[232:235]
    v_mfma_f32_16x16x32_bf16 a[236:239], v[124:127], a[180:183], a[236:239]
    s_waitcnt vmcnt(14) lgkmcnt(0)
    v_mfma_f32_16x16x32_bf16 a[200:203], v[128:131], a[184:187], a[200:203]
    ds_read_b128 v[108:111], v103 offset:16384
    v_mfma_f32_16x16x32_bf16 a[204:207], v[128:131], a[188:191], a[204:207]
    ds_read_b128 v[112:115], v103 offset:18432
    v_mfma_f32_16x16x32_bf16 a[208:211], v[132:135], a[184:187], a[208:211]
    ds_read_b128 v[116:119], v103 offset:20480
    v_mfma_f32_16x16x32_bf16 a[212:215], v[132:135], a[188:191], a[212:215]
    ds_read_b128 v[120:123], v103 offset:22528
    v_mfma_f32_16x16x32_bf16 a[216:219], v[136:139], a[184:187], a[216:219]
    ds_read_b128 v[124:127], v103 offset:24576
    v_mfma_f32_16x16x32_bf16 a[220:223], v[136:139], a[188:191], a[220:223]
    buffer_load_dwordx4 a[32:35], v44, s[52:55], s80 offen offset:0
    v_mfma_f32_16x16x32_bf16 a[224:227], v[140:143], a[184:187], a[224:227]
    buffer_load_dwordx4 a[36:39], v44, s[52:55], s80 offen offset:1024
    v_mfma_f32_16x16x32_bf16 a[228:231], v[140:143], a[188:191], a[228:231]
    v_mfma_f32_16x16x32_bf16 a[232:235], v[144:147], a[184:187], a[232:235]
    s_add_u32 m0, s98, 4096
    s_nop 0
    buffer_load_dwordx4 v24, s[44:47], s81 offen offset:0 lds
    v_mfma_f32_16x16x32_bf16 a[236:239], v[144:147], a[188:191], a[236:239]
    s_waitcnt vmcnt(14) lgkmcnt(0)
    v_mfma_f32_16x16x32_bf16 a[200:203], v[108:111], a[192:195], a[200:203]
    ds_read_b128 v[128:131], v104 offset:12288
    v_mfma_f32_16x16x32_bf16 a[204:207], v[108:111], a[196:199], a[204:207]
    ds_read_b128 v[132:135], v104 offset:14336
    v_mfma_f32_16x16x32_bf16 a[208:211], v[112:115], a[192:195], a[208:211]
    ds_read_b128 v[136:139], v104 offset:16384
    v_mfma_f32_16x16x32_bf16 a[212:215], v[112:115], a[196:199], a[212:215]
    ds_read_b128 v[140:143], v104 offset:18432
    v_mfma_f32_16x16x32_bf16 a[216:219], v[116:119], a[192:195], a[216:219]
    ds_read_b128 v[144:147], v104 offset:20480
    v_mfma_f32_16x16x32_bf16 a[220:223], v[116:119], a[196:199], a[220:223]
    s_add_u32 s80, s78, 6
    s_and_b32 s80, s80, 7
    s_mul_i32 s80, s80, 20480
    buffer_load_dwordx4 a[40:43], v39, s[52:55], s80 offen offset:0
    v_mfma_f32_16x16x32_bf16 a[224:227], v[120:123], a[192:195], a[224:227]
    v_mfma_f32_16x16x32_bf16 a[228:231], v[120:123], a[196:199], a[228:231]
    buffer_load_dwordx4 a[44:47], v39, s[52:55], s80 offen offset:1024
    v_mfma_f32_16x16x32_bf16 a[232:235], v[124:127], a[192:195], a[232:235]
    v_mfma_f32_16x16x32_bf16 a[236:239], v[124:127], a[196:199], a[236:239]
    s_waitcnt vmcnt(13) lgkmcnt(0)
    v_mfma_f32_16x16x32_bf16 a[200:203], v[128:131], a[0:3], a[200:203]
    ds_read_b128 v[108:111], v105 offset:12288
    v_mfma_f32_16x16x32_bf16 a[204:207], v[128:131], a[4:7], a[204:207]
    ds_read_b128 v[112:115], v105 offset:14336
    v_mfma_f32_16x16x32_bf16 a[208:211], v[132:135], a[0:3], a[208:211]
    ds_read_b128 v[116:119], v105 offset:16384
    v_mfma_f32_16x16x32_bf16 a[212:215], v[132:135], a[4:7], a[212:215]
    ds_read_b128 v[120:123], v105 offset:18432
    v_mfma_f32_16x16x32_bf16 a[216:219], v[136:139], a[0:3], a[216:219]
    ds_read_b128 v[124:127], v105 offset:20480
    v_mfma_f32_16x16x32_bf16 a[220:223], v[136:139], a[4:7], a[220:223]
    buffer_load_dwordx4 a[48:51], v40, s[52:55], s80 offen offset:0
    v_mfma_f32_16x16x32_bf16 a[224:227], v[140:143], a[0:3], a[224:227]
    v_mfma_f32_16x16x32_bf16 a[228:231], v[140:143], a[4:7], a[228:231]
    buffer_load_dwordx4 a[52:55], v41, s[52:55], s80 offen offset:0
    v_mfma_f32_16x16x32_bf16 a[232:235], v[144:147], a[0:3], a[232:235]
    v_mfma_f32_16x16x32_bf16 a[236:239], v[144:147], a[4:7], a[236:239]
    s_waitcnt vmcnt(13) lgkmcnt(0)
    v_mfma_f32_16x16x32_bf16 a[200:203], v[108:111], a[8:11], a[200:203]
    ds_read_b128 v[128:131], v106 offset:12288
    v_mfma_f32_16x16x32_bf16 a[204:207], v[108:111], a[12:15], a[204:207]
    ds_read_b128 v[132:135], v106 offset:14336
    v_mfma_f32_16x16x32_bf16 a[208:211], v[112:115], a[8:11], a[208:211]
    ds_read_b128 v[136:139], v106 offset:16384
    v_mfma_f32_16x16x32_bf16 a[212:215], v[112:115], a[12:15], a[212:215]
    ds_read_b128 v[140:143], v106 offset:18432
    v_mfma_f32_16x16x32_bf16 a[216:219], v[116:119], a[8:11], a[216:219]
    ds_read_b128 v[144:147], v106 offset:20480
    v_mfma_f32_16x16x32_bf16 a[220:223], v[116:119], a[12:15], a[220:223]
    buffer_load_dwordx4 a[56:59], v41, s[52:55], s80 offen offset:1024
    v_mfma_f32_16x16x32_bf16 a[224:227], v[120:123], a[8:11], a[224:227]
    v_mfma_f32_16x16x32_bf16 a[228:231], v[120:123], a[12:15], a[228:231]
    buffer_load_dwordx4 a[60:63], v42, s[52:55], s80 offen offset:0
    v_mfma_f32_16x16x32_bf16 a[232:235], v[124:127], a[8:11], a[232:235]
    v_mfma_f32_16x16x32_bf16 a[236:239], v[124:127], a[12:15], a[236:239]
    s_waitcnt vmcnt(12) lgkmcnt(0)
    v_mfma_f32_16x16x32_bf16 a[200:203], v[128:131], a[16:19], a[200:203]
    ds_read_b128 v[108:111], v107 offset:12288
    v_mfma_f32_16x16x32_bf16 a[204:207], v[128:131], a[20:23], a[204:207]
    ds_read_b128 v[112:115], v107 offset:14336
    v_mfma_f32_16x16x32_bf16 a[208:211], v[132:135], a[16:19], a[208:211]
    ds_read_b128 v[116:119], v107 offset:16384
    v_mfma_f32_16x16x32_bf16 a[212:215], v[132:135], a[20:23], a[212:215]
    ds_read_b128 v[120:123], v107 offset:18432
    v_mfma_f32_16x16x32_bf16 a[216:219], v[136:139], a[16:19], a[216:219]
    ds_read_b128 v[124:127], v107 offset:20480
    v_mfma_f32_16x16x32_bf16 a[220:223], v[136:139], a[20:23], a[220:223]
    buffer_load_dwordx4 a[64:67], v42, s[52:55], s80 offen offset:1024
    v_mfma_f32_16x16x32_bf16 a[224:227], v[140:143], a[16:19], a[224:227]
    v_mfma_f32_16x16x32_bf16 a[228:231], v[140:143], a[20:23], a[228:231]
    buffer_load_dwordx4 a[68:71], v43, s[52:55], s80 offen offset:0
    v_mfma_f32_16x16x32_bf16 a[232:235], v[144:147], a[16:19], a[232:235]
    v_mfma_f32_16x16x32_bf16 a[236:239], v[144:147], a[20:23], a[236:239]
    s_waitcnt vmcnt(8)
    s_barrier
    s_waitcnt lgkmcnt(0)
    v_mfma_f32_16x16x32_bf16 a[200:203], v[108:111], a[24:27], a[200:203]
    ds_read_b128 v[128:131], v100 offset:57344
    v_mfma_f32_16x16x32_bf16 a[204:207], v[108:111], a[28:31], a[204:207]
    ds_read_b128 v[132:135], v100 offset:59392
    v_mfma_f32_16x16x32_bf16 a[208:211], v[112:115], a[24:27], a[208:211]
    ds_read_b128 v[136:139], v100 offset:61440
    v_mfma_f32_16x16x32_bf16 a[212:215], v[112:115], a[28:31], a[212:215]
    ds_read_b128 v[140:143], v100 offset:63488
    v_mfma_f32_16x16x32_bf16 a[216:219], v[116:119], a[24:27], a[216:219]
    ds_read_b128 v[144:147], v104 offset:0
    v_mfma_f32_16x16x32_bf16 a[220:223], v[116:119], a[28:31], a[220:223]
    buffer_load_dwordx4 a[72:75], v44, s[52:55], s80 offen offset:0
    v_mfma_f32_16x16x32_bf16 a[224:227], v[120:123], a[24:27], a[224:227]
    v_mfma_f32_16x16x32_bf16 a[228:231], v[120:123], a[28:31], a[228:231]
    buffer_load_dwordx4 a[76:79], v44, s[52:55], s80 offen offset:1024
    v_mfma_f32_16x16x32_bf16 a[232:235], v[124:127], a[24:27], a[232:235]
    v_mfma_f32_16x16x32_bf16 a[236:239], v[124:127], a[28:31], a[236:239]
    s_waitcnt lgkmcnt(0)
    v_mfma_f32_16x16x32_bf16 a[200:203], v[128:131], a[32:35], a[200:203]
    ds_read_b128 v[108:111], v101 offset:57344
    v_mfma_f32_16x16x32_bf16 a[204:207], v[128:131], a[36:39], a[204:207]
    ds_read_b128 v[112:115], v101 offset:59392
    v_mfma_f32_16x16x32_bf16 a[208:211], v[132:135], a[32:35], a[208:211]
    ds_read_b128 v[116:119], v101 offset:61440
    v_mfma_f32_16x16x32_bf16 a[212:215], v[132:135], a[36:39], a[212:215]
    ds_read_b128 v[120:123], v101 offset:63488
    v_mfma_f32_16x16x32_bf16 a[216:219], v[136:139], a[32:35], a[216:219]
    ds_read_b128 v[124:127], v105 offset:0
    v_mfma_f32_16x16x32_bf16 a[220:223], v[136:139], a[36:39], a[220:223]
    s_add_u32 s80, s78, 7
    s_and_b32 s80, s80, 7
    s_mul_i32 s80, s80, 20480
    buffer_load_dwordx4 a[80:83], v39, s[52:55], s80 offen offset:0
    v_mfma_f32_16x16x32_bf16 a[224:227], v[140:143], a[32:35], a[224:227]
    v_mfma_f32_16x16x32_bf16 a[228:231], v[140:143], a[36:39], a[228:231]
    buffer_load_dwordx4 a[84:87], v39, s[52:55], s80 offen offset:1024
    v_mfma_f32_16x16x32_bf16 a[232:235], v[144:147], a[32:35], a[232:235]
    v_mfma_f32_16x16x32_bf16 a[236:239], v[144:147], a[36:39], a[236:239]
    s_waitcnt vmcnt(10) lgkmcnt(0)
    v_mfma_f32_16x16x32_bf16 a[200:203], v[108:111], a[40:43], a[200:203]
    ds_read_b128 v[128:131], v102 offset:57344
    v_mfma_f32_16x16x32_bf16 a[204:207], v[108:111], a[44:47], a[204:207]
    ds_read_b128 v[132:135], v102 offset:59392
    v_mfma_f32_16x16x32_bf16 a[208:211], v[112:115], a[40:43], a[208:211]
    ds_read_b128 v[136:139], v102 offset:61440
    v_mfma_f32_16x16x32_bf16 a[212:215], v[112:115], a[44:47], a[212:215]
    ds_read_b128 v[140:143], v102 offset:63488
    v_mfma_f32_16x16x32_bf16 a[216:219], v[116:119], a[40:43], a[216:219]
    ds_read_b128 v[144:147], v106 offset:0
    v_mfma_f32_16x16x32_bf16 a[220:223], v[116:119], a[44:47], a[220:223]
    buffer_load_dwordx4 a[88:91], v40, s[52:55], s80 offen offset:0
    v_mfma_f32_16x16x32_bf16 a[224:227], v[120:123], a[40:43], a[224:227]
    v_mfma_f32_16x16x32_bf16 a[228:231], v[120:123], a[44:47], a[228:231]
    buffer_load_dwordx4 a[92:95], v41, s[52:55], s80 offen offset:0
    v_mfma_f32_16x16x32_bf16 a[232:235], v[124:127], a[40:43], a[232:235]
    v_mfma_f32_16x16x32_bf16 a[236:239], v[124:127], a[44:47], a[236:239]
    s_waitcnt vmcnt(10) lgkmcnt(0)
    v_mfma_f32_16x16x32_bf16 a[200:203], v[128:131], a[48:51], a[200:203]
    ds_read_b128 v[108:111], v103 offset:57344
    v_mfma_f32_16x16x32_bf16 a[204:207], v[128:131], a[52:55], a[204:207]
    ds_read_b128 v[112:115], v103 offset:59392
    v_mfma_f32_16x16x32_bf16 a[208:211], v[132:135], a[48:51], a[208:211]
    ds_read_b128 v[116:119], v103 offset:61440
    v_mfma_f32_16x16x32_bf16 a[212:215], v[132:135], a[52:55], a[212:215]
    ds_read_b128 v[120:123], v103 offset:63488
    v_mfma_f32_16x16x32_bf16 a[216:219], v[136:139], a[48:51], a[216:219]
    ds_read_b128 v[124:127], v107 offset:0
    v_mfma_f32_16x16x32_bf16 a[220:223], v[136:139], a[52:55], a[220:223]
    buffer_load_dwordx4 a[96:99], v41, s[52:55], s80 offen offset:1024
    v_mfma_f32_16x16x32_bf16 a[224:227], v[140:143], a[48:51], a[224:227]
    v_mfma_f32_16x16x32_bf16 a[228:231], v[140:143], a[52:55], a[228:231]
    buffer_load_dwordx4 a[100:103], v42, s[52:55], s80 offen offset:0
    v_mfma_f32_16x16x32_bf16 a[232:235], v[144:147], a[48:51], a[232:235]
    v_mfma_f32_16x16x32_bf16 a[236:239], v[144:147], a[52:55], a[236:239]
    s_waitcnt vmcnt(10) lgkmcnt(0)
    v_mfma_f32_16x16x32_bf16 a[200:203], v[108:111], a[56:59], a[200:203]
    ds_read_b128 v[128:131], v96 offset:0
    v_mfma_f32_16x16x32_bf16 a[204:207], v[108:111], a[60:63], a[204:207]
    ds_read_b128 v[132:135], v96 offset:2048
    v_mfma_f32_16x16x32_bf16 a[208:211], v[112:115], a[56:59], a[208:211]
    ds_read_b128 v[136:139], v96 offset:4096
    v_mfma_f32_16x16x32_bf16 a[212:215], v[112:115], a[60:63], a[212:215]
    ds_read_b128 v[140:143], v96 offset:6144
    v_mfma_f32_16x16x32_bf16 a[216:219], v[116:119], a[56:59], a[216:219]
    ds_read_b128 v[144:147], v96 offset:8192
    v_mfma_f32_16x16x32_bf16 a[220:223], v[116:119], a[60:63], a[220:223]
    buffer_load_dwordx4 a[104:107], v42, s[52:55], s80 offen offset:1024
    v_mfma_f32_16x16x32_bf16 a[224:227], v[120:123], a[56:59], a[224:227]
    v_mfma_f32_16x16x32_bf16 a[228:231], v[120:123], a[60:63], a[228:231]
    buffer_load_dwordx4 a[108:111], v43, s[52:55], s80 offen offset:0
    v_mfma_f32_16x16x32_bf16 a[232:235], v[124:127], a[56:59], a[232:235]
    v_mfma_f32_16x16x32_bf16 a[236:239], v[124:127], a[60:63], a[236:239]
    s_waitcnt vmcnt(10) lgkmcnt(0)
    v_mfma_f32_16x16x32_bf16 a[200:203], v[128:131], a[64:67], a[200:203]
    ds_read_b128 v[108:111], v97 offset:0
    v_mfma_f32_16x16x32_bf16 a[204:207], v[128:131], a[68:71], a[204:207]
    ds_read_b128 v[112:115], v97 offset:2048
    v_mfma_f32_16x16x32_bf16 a[208:211], v[132:135], a[64:67], a[208:211]
    ds_read_b128 v[116:119], v97 offset:4096
    v_mfma_f32_16x16x32_bf16 a[212:215], v[132:135], a[68:71], a[212:215]
    ds_read_b128 v[120:123], v97 offset:6144
    v_mfma_f32_16x16x32_bf16 a[216:219], v[136:139], a[64:67], a[216:219]
    ds_read_b128 v[124:127], v97 offset:8192
    v_mfma_f32_16x16x32_bf16 a[220:223], v[136:139], a[68:71], a[220:223]
    buffer_load_dwordx4 a[112:115], v44, s[52:55], s80 offen offset:0
    v_mfma_f32_16x16x32_bf16 a[224:227], v[140:143], a[64:67], a[224:227]
    v_mfma_f32_16x16x32_bf16 a[228:231], v[140:143], a[68:71], a[228:231]
    buffer_load_dwordx4 a[116:119], v44, s[52:55], s80 offen offset:1024
    v_mfma_f32_16x16x32_bf16 a[232:235], v[144:147], a[64:67], a[232:235]
    v_mfma_f32_16x16x32_bf16 a[236:239], v[144:147], a[68:71], a[236:239]
    s_waitcnt vmcnt(10) lgkmcnt(0)
    v_mfma_f32_16x16x32_bf16 a[200:203], v[108:111], a[72:75], a[200:203]
    ds_read_b128 v[128:131], v98 offset:0
    v_mfma_f32_16x16x32_bf16 a[204:207], v[108:111], a[76:79], a[204:207]
    ds_read_b128 v[132:135], v98 offset:2048
    v_mfma_f32_16x16x32_bf16 a[208:211], v[112:115], a[72:75], a[208:211]
    ds_read_b128 v[136:139], v98 offset:4096
    v_mfma_f32_16x16x32_bf16 a[212:215], v[112:115], a[76:79], a[212:215]
    ds_read_b128 v[140:143], v98 offset:6144
    v_mfma_f32_16x16x32_bf16 a[216:219], v[116:119], a[72:75], a[216:219]
    ds_read_b128 v[144:147], v98 offset:8192
    v_mfma_f32_16x16x32_bf16 a[220:223], v[116:119], a[76:79], a[220:223]
    v_mfma_f32_16x16x32_bf16 a[224:227], v[120:123], a[72:75], a[224:227]
    v_mfma_f32_16x16x32_bf16 a[228:231], v[120:123], a[76:79], a[228:231]
    v_mfma_f32_16x16x32_bf16 a[232:235], v[124:127], a[72:75], a[232:235]
    v_mfma_f32_16x16x32_bf16 a[236:239], v[124:127], a[76:79], a[236:239]
    s_waitcnt vmcnt(8) lgkmcnt(0)
    v_mfma_f32_16x16x32_bf16 a[200:203], v[128:131], a[80:83], a[200:203]
    ds_read_b128 v[108:111], v99 offset:0
    v_mfma_f32_16x16x32_bf16 a[204:207], v[128:131], a[84:87], a[204:207]
    ds_read_b128 v[112:115], v99 offset:2048
    v_mfma_f32_16x16x32_bf16 a[208:211], v[132:135], a[80:83], a[208:211]
    ds_read_b128 v[116:119], v99 offset:4096
    v_mfma_f32_16x16x32_bf16 a[212:215], v[132:135], a[84:87], a[212:215]
    ds_read_b128 v[120:123], v99 offset:6144
    v_mfma_f32_16x16x32_bf16 a[216:219], v[136:139], a[80:83], a[216:219]
    ds_read_b128 v[124:127], v99 offset:8192
    v_mfma_f32_16x16x32_bf16 a[220:223], v[136:139], a[84:87], a[220:223]
    v_mfma_f32_16x16x32_bf16 a[224:227], v[140:143], a[80:83], a[224:227]
    v_mfma_f32_16x16x32_bf16 a[228:231], v[140:143], a[84:87], a[228:231]
    v_mfma_f32_16x16x32_bf16 a[232:235], v[144:147], a[80:83], a[232:235]
    v_mfma_f32_16x16x32_bf16 a[236:239], v[144:147], a[84:87], a[236:239]
    s_waitcnt vmcnt(6) lgkmcnt(0)
    v_mfma_f32_16x16x32_bf16 a[200:203], v[108:111], a[88:91], a[200:203]
    ds_read_b128 v[128:131], v100 offset:36864
    v_mfma_f32_16x16x32_bf16 a[204:207], v[108:111], a[92:95], a[204:207]
    ds_read_b128 v[132:135], v100 offset:38912
    v_mfma_f32_16x16x32_bf16 a[208:211], v[112:115], a[88:91], a[208:211]
    ds_read_b128 v[136:139], v100 offset:40960
    v_mfma_f32_16x16x32_bf16 a[212:215], v[112:115], a[92:95], a[212:215]
    ds_read_b128 v[140:143], v100 offset:43008
    v_mfma_f32_16x16x32_bf16 a[216:219], v[116:119], a[88:91], a[216:219]
    ds_read_b128 v[144:147], v100 offset:45056
    v_mfma_f32_16x16x32_bf16 a[220:223], v[116:119], a[92:95], a[220:223]
    v_mfma_f32_16x16x32_bf16 a[224:227], v[120:123], a[88:91], a[224:227]
    v_mfma_f32_16x16x32_bf16 a[228:231], v[120:123], a[92:95], a[228:231]
    v_mfma_f32_16x16x32_bf16 a[232:235], v[124:127], a[88:91], a[232:235]
    v_mfma_f32_16x16x32_bf16 a[236:239], v[124:127], a[92:95], a[236:239]
    s_mov_b32 s81, 589824
    s_waitcnt vmcnt(0)
    s_cmp_eq_u32 s34, 0
    s_cbranch_scc1 L_wt_52
    buffer_store_dword v16, v33, s[48:51], s81 offen
    s_branch L_j_53
L_wt_52:
    buffer_store_dword v16, v33, s[48:51], s81 offen sc1
L_j_53:
    s_waitcnt lgkmcnt(0)
    v_mfma_f32_16x16x32_bf16 a[200:203], v[128:131], a[96:99], a[200:203]
    ds_read_b128 v[108:111], v101 offset:36864
    v_mfma_f32_16x16x32_bf16 a[204:207], v[128:131], a[100:103], a[204:207]
    ds_read_b128 v[112:115], v101 offset:38912
    v_mfma_f32_16x16x32_bf16 a[208:211], v[132:135], a[96:99], a[208:211]
    ds_read_b128 v[116:119], v101 offset:40960
    v_mfma_f32_16x16x32_bf16 a[212:215], v[132:135], a[100:103], a[212:215]
    ds_read_b128 v[120:123], v101 offset:43008
    v_mfma_f32_16x16x32_bf16 a[216:219], v[136:139], a[96:99], a[216:219]
    ds_read_b128 v[124:127], v101 offset:45056
    v_mfma_f32_16x16x32_bf16 a[220:223], v[136:139], a[100:103], a[220:223]
    v_mfma_f32_16x16x32_bf16 a[224:227], v[140:143], a[96:99], a[224:227]
    v_mfma_f32_16x16x32_bf16 a[228:231], v[140:143], a[100:103], a[228:231]
    v_mfma_f32_16x16x32_bf16 a[232:235], v[144:147], a[96:99], a[232:235]
    v_mfma_f32_16x16x32_bf16 a[236:239], v[144:147], a[100:103], a[236:239]
    s_waitcnt lgkmcnt(0)
    v_mfma_f32_16x16x32_bf16 a[200:203], v[108:111], a[104:107], a[200:203]
    ds_read_b128 v[128:131], v102 offset:36864
    v_mfma_f32_16x16x32_bf16 a[208:211], v[112:115], a[104:107], a[208:211]
    ds_read_b128 v[132:135], v102 offset:38912
    v_mfma_f32_16x16x32_bf16 a[216:219], v[116:119], a[104:107], a[216:219]
    ds_read_b128 v[136:139], v102 offset:40960
    v_mfma_f32_16x16x32_bf16 a[224:227], v[120:123], a[104:107], a[224:227]
    ds_read_b128 v[140:143], v102 offset:43008
    v_mfma_f32_16x16x32_bf16 a[232:235], v[124:127], a[104:107], a[232:235]
    ds_read_b128 v[144:147], v102 offset:45056
    buffer_load_dword v17, v34, s[48:51], s81 offen sc1
    s_waitcnt lgkmcnt(0)
    v_mfma_f32_16x16x32_bf16 a[200:203], v[128:131], a[112:115], a[200:203]
    v_mfma_f32_16x16x32_bf16 a[208:211], v[132:135], a[112:115], a[208:211]
    v_mfma_f32_16x16x32_bf16 a[216:219], v[136:139], a[112:115], a[216:219]
    v_mfma_f32_16x16x32_bf16 a[224:227], v[140:143], a[112:115], a[224:227]
    v_mfma_f32_16x16x32_bf16 a[232:235], v[144:147], a[112:115], a[232:235]
    v_mfma_f32_16x16x32_bf16 a[204:207], v[108:111], a[108:111], a[204:207]
    v_mfma_f32_16x16x32_bf16 a[212:215], v[112:115], a[108:111], a[212:215]
    v_mfma_f32_16x16x32_bf16 a[220:223], v[116:119], a[108:111], a[220:223]
    s_nop 0
    ds_write_b128 v48, a[200:203] offset:0
    v_mfma_f32_16x16x32_bf16 a[228:231], v[120:123], a[108:111], a[228:231]
    ds_write_b128 v48, a[208:211] offset:64
    v_mfma_f32_16x16x32_bf16 a[236:239], v[124:127], a[108:111], a[236:239]
    v_mfma_f32_16x16x32_bf16 a[204:207], v[128:131], a[116:119], a[204:207]
    ds_write_b128 v48, a[216:219] offset:128
    v_mfma_f32_16x16x32_bf16 a[212:215], v[132:135], a[116:119], a[212:215]
    ds_write_b128 v48, a[224:227] offset:192
    v_mfma_f32_16x16x32_bf16 a[220:223], v[136:139], a[116:119], a[220:223]
    v_mfma_f32_16x16x32_bf16 a[228:231], v[140:143], a[116:119], a[228:231]
    ds_write_b128 v48, a[232:235] offset:256
    v_mfma_f32_16x16x32_bf16 a[236:239], v[144:147], a[116:119], a[236:239]
    ds_read_b128 v[216:219], v55 offset:0
    ds_read_b128 v[220:223], v56 offset:0
    ds_read_b128 v[224:227], v57 offset:0
    ds_read_b128 v[228:231], v58 offset:0
    ds_read_b128 v[232:235], v59 offset:0
    ds_write_b128 v48, a[204:207] offset:5376
    ds_write_b128 v48, a[212:215] offset:5440
    ds_write_b128 v48, a[220:223] offset:5504
    ds_write_b128 v48, a[228:231] offset:5568
    ds_write_b128 v48, a[236:239] offset:5632
    ds_read_b128 v[236:239], v55 offset:5376
    ds_read_b128 v[240:243], v56 offset:5376
    ds_read_b128 v[244:247], v57 offset:5376
    ds_read_b128 v[248:251], v58 offset:5376
    ds_read_b128 v[252:255], v59 offset:5376
    s_waitcnt vmcnt(0)
    v_cmp_ne_u32 vcc, v16, v17
    s_nop 3
    s_cbranch_vccz L_rd_55
    s_mov_b32 s82, 0x40000
L_rp_54:
    buffer_load_dword v17, v34, s[48:51], s81 offen sc1
    s_waitcnt vmcnt(0)
    v_cmp_ne_u32 vcc, v16, v17
    s_nop 3
    s_cbranch_vccz L_rd_55
    s_sub_u32 s82, s82, 1
    s_cbranch_scc0 L_rp_54
L_rd_55:
    s_waitcnt lgkmcnt(14)
    buffer_store_dwordx4 v[216:219], v50, s[52:55], 0 offen nt
    s_waitcnt lgkmcnt(13)
    buffer_store_dwordx4 v[220:223], v51, s[52:55], 0 offen nt
    s_waitcnt lgkmcnt(12)
    buffer_store_dwordx4 v[224:227], v52, s[52:55], 0 offen nt
    s_waitcnt lgkmcnt(11)
    buffer_store_dwordx4 v[228:231], v53, s[52:55], 0 offen nt
    s_waitcnt lgkmcnt(10)
    buffer_store_dwordx4 v[232:235], v54, s[52:55], 0 offen nt
    s_waitcnt lgkmcnt(4)
    buffer_store_dwordx4 v[236:239], v50, s[52:55], s93 offen nt
    s_waitcnt lgkmcnt(3)
    buffer_store_dwordx4 v[240:243], v51, s[52:55], s93 offen nt
    s_waitcnt lgkmcnt(2)
    buffer_store_dwordx4 v[244:247], v52, s[52:55], s93 offen nt
    s_waitcnt lgkmcnt(1)
    buffer_store_dwordx4 v[248:251], v53, s[52:55], s93 offen nt
    s_waitcnt lgkmcnt(0)
    buffer_store_dwordx4 v[252:255], v54, s[52:55], s93 offen nt
    s_endpgm
L_end:
    s_endpgm
.section .rodata,"a"
.p2align 6
.amdhsa_kernel concat_heads__linear_attn_block__ssm_conv_s5__prompt_kernel
  .amdhsa_next_free_vgpr 512
  .amdhsa_next_free_sgpr 102
  .amdhsa_accum_offset 256
  .amdhsa_group_segment_fixed_size 0
  .amdhsa_kernarg_size 120
  .amdhsa_user_sgpr_count 2
  .amdhsa_user_sgpr_kernarg_segment_ptr 1
  .amdhsa_system_sgpr_workgroup_id_x 1
.end_amdhsa_kernel
```
